```python
import torch

def _softmax(x, axis=-1):
    return torch.softmax(x, dim=axis)
def _gelu(x):
    return torch.nn.functional.gelu(x, approximate="tanh")
def _silu(x):
    return torch.nn.functional.silu(x)
def _sigmoid(x):
    return torch.sigmoid(x)
def _layernorm(x, axis=-1, eps=1e-5):
    m = x.mean(dim=axis, keepdim=True)
    v = x.var(dim=axis, keepdim=True, unbiased=False)
    return (x - m) / torch.sqrt(v + eps)
def _scatter_add(tgt, idx, src, axis=0):
    return tgt.clone().index_add_(axis, idx, src)
def _segment_sum(src, seg, n):
    out = torch.zeros((n,) + src.shape[1:], dtype=src.dtype)
    return out.index_add_(0, seg, src)
def _pad(x, pw):
    flat = tuple(v for pair in reversed(pw) for v in pair)
    return torch.nn.functional.pad(x, flat)

kernel_name = 'gated_mix__ssm_conv_s5__dense_activation_squared_relu__prompt'

def setup_inputs():

    _w = (lambda a: (lambda t: t.to(torch.bfloat16) if t.is_floating_point() else t)(torch.as_tensor(a)))
    def _A_setup():
        B, S, D = 1, 2048, 1024
        P = D
        Lambda_re = -0.5 * (lambda _x: torch.exp(torch.as_tensor(_x)))((lambda *s: torch.randn(*s, dtype=torch.bfloat16) * 0.4)(P))
        Lambda_im = (lambda *s: torch.randn(*s, dtype=torch.bfloat16) * 0.8)(P) * 1.0
        B_re = (lambda *s: torch.randn(*s, dtype=torch.bfloat16) * 0.8)(P, D) * (D ** -0.5)
        B_im = (lambda *s: torch.randn(*s, dtype=torch.bfloat16) * 0.8)(P, D) * (D ** -0.5)
        C_re = (lambda *s: torch.randn(*s, dtype=torch.bfloat16) * 0.8)(D, P) * (P ** -0.5)
        C_im = (lambda *s: torch.randn(*s, dtype=torch.bfloat16) * 0.8)(D, P) * (P ** -0.5)
        log_dt = (lambda *s: torch.randn(*s, dtype=torch.bfloat16) * 0.4)(P) * 0.3 - 2.0
        Dskip = (lambda *s: torch.randn(*s, dtype=torch.bfloat16) * 0.1)(D)
        return {
            "x": _w((lambda *s: torch.randn(*s, dtype=torch.bfloat16) * 0.05)(B, S, D)),
            "Lambda_re": _w(Lambda_re),
            "Lambda_im": _w(Lambda_im),
            "B_re": _w(B_re),
            "B_im": _w(B_im),
            "C_re": _w(C_re),
            "C_im": _w(C_im),
            "log_dt": _w(log_dt),
            "Dskip": _w(Dskip),
        }
    _A_in = _A_setup()

    def _B_setup():
        B, S, D, F = 1, 2048, 1024, 3584
        return {
            "x": _w((lambda *s: torch.randn(*s, dtype=torch.bfloat16) * 0.05)(B, S, D)),
            "w1": _w((lambda *s: torch.randn(*s, dtype=torch.bfloat16) * 0.05)(D, F)),
            "b1": _w((lambda *s: torch.randn(*s, dtype=torch.bfloat16) * 0.05)(F)),
            "w2": _w((lambda *s: torch.randn(*s, dtype=torch.bfloat16) * 0.05)(F, D)),
            "b2": _w((lambda *s: torch.randn(*s, dtype=torch.bfloat16) * 0.05)(D)),
        }
    _B_in = _B_setup()

    return {
        "A_x": _A_in["x"],
        "A_Lambda_re": _A_in["Lambda_re"],
        "A_Lambda_im": _A_in["Lambda_im"],
        "A_B_re": _A_in["B_re"],
        "A_B_im": _A_in["B_im"],
        "A_C_re": _A_in["C_re"],
        "A_C_im": _A_in["C_im"],
        "A_log_dt": _A_in["log_dt"],
        "A_Dskip": _A_in["Dskip"],
        "B_x": _B_in["x"],
        "B_w1": _B_in["w1"],
        "B_b1": _B_in["b1"],
        "B_w2": _B_in["w2"],
        "B_b2": _B_in["b2"],
        "gate_w": _w((lambda *s: torch.randn(*s, dtype=torch.bfloat16) * 0.05)(1024) * 16.0),
    }

def reference(A_x, A_Lambda_re, A_Lambda_im, A_B_re, A_B_im, A_C_re, A_C_im, A_log_dt, A_Dskip, B_x, B_w1, B_b1, B_w2, B_b2, gate_w):
    def _A_ref(x, Lambda_re, Lambda_im, B_re, B_im, C_re, C_im, log_dt, Dskip):
        Bsz, L, H = x.shape
        Lam = Lambda_re + 1j * Lambda_im
        Bmat = B_re + 1j * B_im
        Cmat = C_re + 1j * C_im
        dt = torch.exp(log_dt)
        Lam_bar = torch.exp(dt * Lam)
        B_bar = ((Lam_bar - 1.0) / Lam)[:, None] * Bmat
        Bu = torch.einsum("bld,pd->blp", x + 0j, B_bar)
        h = torch.zeros_like(Bu[:, 0, :])
        hs = []
        for t in range(L):
            h = Lam_bar[None, :] * h + Bu[:, t, :]
            hs.append(h)
        hseq = torch.stack(hs, 1)
        y = 2.0 * torch.einsum("blp,dp->bld", hseq, Cmat).real + x * Dskip[None, None, :]
        return y

    def _B_ref(x, w1, b1, w2, b2):
        h = torch.einsum("bsd,df->bsf", x, w1) + b1
        zero = torch.zeros_like(h)
        r = torch.where(h > zero, h, zero)
        h = r * r
        out = torch.einsum("bsf,fd->bsd", h, w2) + b2
        return out

    x = A_x
    g = _sigmoid((x * gate_w).sum(-1, keepdims=True))
    a = _A_ref(x, A_Lambda_re, A_Lambda_im, A_B_re, A_B_im, A_C_re, A_C_im, A_log_dt, A_Dskip)
    b = _B_ref(x, B_w1, B_b1, B_w2, B_b2)
    return g * a + (1 - g) * b
```

```asm
; @launch grid=(256,1,1) block=(512,1,1) lds=163840
.amdgcn_target "amdgcn-amd-amdhsa--gfx950"
.text
.globl gated_mix__ssm_conv_s5__dense_activation_squared_relu__prompt_kernel
.p2align 8
.type gated_mix__ssm_conv_s5__dense_activation_squared_relu__prompt_kernel,@function
gated_mix__ssm_conv_s5__dense_activation_squared_relu__prompt_kernel:
    s_cmp_ge_u32 s2, 256
    s_cbranch_scc1 L_gated_mix__ssm_conv_s5__dense_activation_squared_relu__prompt_kernel_end
    s_load_dwordx8 s[40:47], s[0:1], 0
    s_load_dwordx16 s[64:79], s[0:1], 80
    s_load_dwordx8 s[48:55], s[0:1], 32
    s_load_dwordx2 s[56:57], s[0:1], 64
    v_lshrrev_b32 v1, 6, v0
    v_and_b32 v0, 63, v0
    s_and_b32 s85, s2, 7
    s_lshr_b32 s86, s2, 3
    v_readfirstlane_b32 s83, v1
    s_getpc_b64 s[6:7]
L_gated_mix__ssm_conv_s5__dense_activation_squared_relu__prompt_kernel_pc0:
    s_sub_u32 s6, s6, L_gated_mix__ssm_conv_s5__dense_activation_squared_relu__prompt_kernel_pc0-gated_mix__ssm_conv_s5__dense_activation_squared_relu__prompt_kernel
    s_subb_u32 s7, s7, 0
    s_lshl_b32 s8, s86, 3
    v_add_u32 v2, s8, v1
    v_mul_u32_u24 v2, 3, v2
    v_add_u32 v2, v2, v0
    v_lshlrev_b32 v2, 7, v2
    s_mov_b32 s8, L_gated_mix__ssm_conv_s5__dense_activation_squared_relu__prompt_kernel_end-gated_mix__ssm_conv_s5__dense_activation_squared_relu__prompt_kernel
    v_cmp_gt_u32 vcc, 3, v0
    v_cmp_gt_u32 s[10:11], s8, v2
    v_mov_b32 v3, s7
    s_nop 0
    s_and_b64 s[10:11], s[10:11], vcc
    v_add_co_u32 v2, vcc, s6, v2
    s_nop 1
    v_addc_co_u32 v3, vcc, 0, v3, vcc
    s_and_saveexec_b64 s[12:13], s[10:11]
    s_cbranch_execz L_gated_mix__ssm_conv_s5__dense_activation_squared_relu__prompt_kernel_ecpd
    global_load_dword v1, v[2:3], off
L_gated_mix__ssm_conv_s5__dense_activation_squared_relu__prompt_kernel_ecpd:
    s_mov_b64 exec, s[12:13]
    s_and_b32 s82, s85, 1
    s_lshr_b32 s85, s85, 1
    s_lshl_b32 s85, s85, 2
    s_lshr_b32 s80, s86, 3
    s_add_u32 s80, s80, s85
    s_and_b32 s81, s86, 7
    s_lshl_b32 s84, s82, 3
    s_add_u32 s84, s84, s81
    s_cmp_lt_u32 s83, 4
    s_cbranch_scc1 L_gated_mix__ssm_conv_s5__dense_activation_squared_relu__prompt_kernel_cons
L_gated_mix__ssm_conv_s5__dense_activation_squared_relu__prompt_kernel_prod:
    s_sub_u32 s83, s83, 4
    v_lshrrev_b32 v20, 4, v0
    v_lshrrev_b32 v21, 3, v0
    v_and_b32 v22, 7, v0
    v_add_u32 v23, 0, v20
    v_and_b32 v23, 7, v23
    v_xor_b32 v23, v23, v22
    v_lshlrev_b32 v23, 4, v23
    v_lshlrev_b32 v30, 11, v21
    v_add_u32 v30, v30, v23
    v_add_u32 v2, 0, v30
    v_add_u32 v23, 4, v20
    v_and_b32 v23, 7, v23
    v_xor_b32 v23, v23, v22
    v_lshlrev_b32 v23, 4, v23
    v_lshlrev_b32 v30, 11, v21
    v_add_u32 v30, v30, v23
    v_add_u32 v3, 15360, v30
    v_add_u32 v23, 0, v20
    v_and_b32 v23, 7, v23
    v_xor_b32 v23, v23, v22
    v_lshlrev_b32 v23, 4, v23
    v_lshlrev_b32 v30, 11, v21
    v_add_u32 v30, v30, v23
    v_add_u32 v4, 30720, v30
    v_add_u32 v23, 4, v20
    v_and_b32 v23, 7, v23
    v_xor_b32 v23, v23, v22
    v_lshlrev_b32 v23, 4, v23
    v_lshlrev_b32 v30, 11, v21
    v_add_u32 v30, v30, v23
    v_add_u32 v5, 46080, v30
    s_mul_i32 s85, s83, 448
    s_mov_b32 s86, 2341
    v_add_u32 v20, s85, v0
    v_add_u32 v20, 0, v20
    v_mul_lo_u32 v21, v20, s86
    v_lshrrev_b32 v21, 16, v21
    v_mul_u32_u24 v22, 28, v21
    v_sub_u32 v22, v20, v22
    v_lshrrev_b32 v23, 3, v21
    v_and_b32 v23, 1, v23
    v_lshlrev_b32 v23, 1, v23
    v_xor_b32 v22, v22, v23
    v_lshlrev_b32 v22, 4, v22
    v_mul_u32_u24 v21, 7168, v21
    v_add_u32 v21, v21, v22
    v_subrev_u32 v10, 0, v21
    v_add_u32 v20, s85, v0
    v_add_u32 v20, 64, v20
    v_mul_lo_u32 v21, v20, s86
    v_lshrrev_b32 v21, 16, v21
    v_mul_u32_u24 v22, 28, v21
    v_sub_u32 v22, v20, v22
    v_lshrrev_b32 v23, 3, v21
    v_and_b32 v23, 1, v23
    v_lshlrev_b32 v23, 1, v23
    v_xor_b32 v22, v22, v23
    v_lshlrev_b32 v22, 4, v22
    v_mul_u32_u24 v21, 7168, v21
    v_add_u32 v21, v21, v22
    v_subrev_u32 v11, 1024, v21
    v_add_u32 v20, s85, v0
    v_add_u32 v20, 128, v20
    v_mul_lo_u32 v21, v20, s86
    v_lshrrev_b32 v21, 16, v21
    v_mul_u32_u24 v22, 28, v21
    v_sub_u32 v22, v20, v22
    v_lshrrev_b32 v23, 3, v21
    v_and_b32 v23, 1, v23
    v_lshlrev_b32 v23, 1, v23
    v_xor_b32 v22, v22, v23
    v_lshlrev_b32 v22, 4, v22
    v_mul_u32_u24 v21, 7168, v21
    v_add_u32 v21, v21, v22
    v_subrev_u32 v12, 2048, v21
    v_add_u32 v20, s85, v0
    v_add_u32 v20, 192, v20
    v_mul_lo_u32 v21, v20, s86
    v_lshrrev_b32 v21, 16, v21
    v_mul_u32_u24 v22, 28, v21
    v_sub_u32 v22, v20, v22
    v_lshrrev_b32 v23, 3, v21
    v_and_b32 v23, 1, v23
    v_lshlrev_b32 v23, 1, v23
    v_xor_b32 v22, v22, v23
    v_lshlrev_b32 v22, 4, v22
    v_mul_u32_u24 v21, 7168, v21
    v_add_u32 v21, v21, v22
    v_subrev_u32 v13, 3072, v21
    v_add_u32 v20, s85, v0
    v_add_u32 v20, 256, v20
    v_mul_lo_u32 v21, v20, s86
    v_lshrrev_b32 v21, 16, v21
    v_mul_u32_u24 v22, 28, v21
    v_sub_u32 v22, v20, v22
    v_lshrrev_b32 v23, 3, v21
    v_and_b32 v23, 1, v23
    v_lshlrev_b32 v23, 1, v23
    v_xor_b32 v22, v22, v23
    v_lshlrev_b32 v22, 4, v22
    v_mul_u32_u24 v21, 7168, v21
    v_add_u32 v21, v21, v22
    v_subrev_u32 v14, 0, v21
    v_add_u32 v20, s85, v0
    v_add_u32 v20, 320, v20
    v_mul_lo_u32 v21, v20, s86
    v_lshrrev_b32 v21, 16, v21
    v_mul_u32_u24 v22, 28, v21
    v_sub_u32 v22, v20, v22
    v_lshrrev_b32 v23, 3, v21
    v_and_b32 v23, 1, v23
    v_lshlrev_b32 v23, 1, v23
    v_xor_b32 v22, v22, v23
    v_lshlrev_b32 v22, 4, v22
    v_mul_u32_u24 v21, 7168, v21
    v_add_u32 v21, v21, v22
    v_subrev_u32 v15, 1024, v21
    v_add_u32 v20, s85, v0
    v_add_u32 v20, 384, v20
    v_mul_lo_u32 v21, v20, s86
    v_lshrrev_b32 v21, 16, v21
    v_mul_u32_u24 v22, 28, v21
    v_sub_u32 v22, v20, v22
    v_lshrrev_b32 v23, 3, v21
    v_and_b32 v23, 1, v23
    v_lshlrev_b32 v23, 1, v23
    v_xor_b32 v22, v22, v23
    v_lshlrev_b32 v22, 4, v22
    v_mul_u32_u24 v21, 7168, v21
    v_add_u32 v21, v21, v22
    v_subrev_u32 v16, 2048, v21
    s_lshl_b32 s89, s80, 7
    s_lshl_b32 s85, s83, 5
    s_add_u32 s89, s89, s85
    s_lshl_b32 s89, s89, 11
    s_mul_i32 s90, s84, 448
    s_lshl_b32 s97, s83, 12
    s_mul_i32 s98, s83, 7168
    s_lshr_b32 s58, s2, 3
    s_lshl_b32 s58, s58, 2
    s_add_u32 s58, s58, s83
    s_lshr_b32 s59, s2, 1
    s_and_b32 s59, s59, 3
    v_mov_b32 v95, 0x7ff00000
    s_mov_b32 s27, 0x20000
    s_mov_b32 s26, 0
    s_mov_b32 s24, 0
    s_cmp_ge_u32 s58, 108
    s_cbranch_scc1 L_gated_mix__ssm_conv_s5__dense_activation_squared_relu__prompt_kernel_efd
    s_mul_i32 s85, s58, 1821
    s_lshr_b32 s85, s85, 16
    s_mul_i32 s86, s85, 36
    s_sub_u32 s86, s58, s86
    s_cmp_ge_u32 s86, 28
    s_cbranch_scc1 L_gated_mix__ssm_conv_s5__dense_activation_squared_relu__prompt_kernel_efx
    s_lshl_b32 s86, s86, 6
    v_add_u32 v20, s86, v0
    s_mov_b32 s86, 2341
    v_mul_lo_u32 v21, v20, s86
    v_lshrrev_b32 v21, 16, v21
    v_mul_u32_u24 v22, 28, v21
    v_sub_u32 v22, v20, v22
    v_lshlrev_b32 v22, 7, v22
    v_mul_u32_u24 v21, 7168, v21
    v_add_u32 v21, v21, v22
    s_mul_i32 s85, s85, 458752
    s_mul_i32 s86, s82, 3584
    s_add_u32 s85, s85, s86
    v_add_u32 v95, s85, v21
    s_mov_b32 s26, 7340032
    s_branch L_gated_mix__ssm_conv_s5__dense_activation_squared_relu__prompt_kernel_efd
L_gated_mix__ssm_conv_s5__dense_activation_squared_relu__prompt_kernel_efx:
    s_sub_u32 s86, s86, 28
    s_lshl_b32 s86, s86, 6
    s_lshl_b32 s87, s59, 9
    s_add_u32 s86, s86, s87
    s_lshl_b32 s86, s86, 11
    s_lshl_b32 s85, s85, 7
    s_add_u32 s85, s85, s86
    v_lshlrev_b32 v21, 11, v0
    v_add_u32 v95, s85, v21
    s_mov_b32 s24, 1
    s_mov_b32 s26, 4194304
L_gated_mix__ssm_conv_s5__dense_activation_squared_relu__prompt_kernel_efd:
    s_add_u32 s88, s58, 0
    v_mov_b32 v28, 0x7ff00000
    s_mov_b32 s31, 0x20000
    s_mov_b32 s30, 0
    s_mov_b32 s28, 0
    s_cmp_ge_u32 s88, 21
    s_cbranch_scc1 L_gated_mix__ssm_conv_s5__dense_activation_squared_relu__prompt_kernel_e0x
    s_mul_i32 s85, s88, 9363
    s_lshr_b32 s85, s85, 16
    s_mul_i32 s86, s85, 7
    s_sub_u32 s86, s88, s86
    s_lshl_b32 s86, s86, 6
    v_add_u32 v20, s86, v0
    s_mov_b32 s86, 2341
    v_mul_lo_u32 v21, v20, s86
    v_lshrrev_b32 v21, 16, v21
    v_mul_u32_u24 v22, 28, v21
    v_sub_u32 v22, v20, v22
    v_lshlrev_b32 v22, 7, v22
    v_mul_u32_u24 v21, 7168, v21
    v_add_u32 v21, v21, v22
    s_add_u32 s85, s85, 3
    s_lshl_b32 s85, s85, 6
    s_lshl_b32 s86, s59, 4
    s_add_u32 s85, s85, s86
    s_mul_i32 s85, s85, 7168
    s_mul_i32 s86, s82, 3584
    s_add_u32 s85, s85, s86
    v_add_u32 v28, s85, v21
    s_mov_b32 s30, 7340032
    s_branch L_gated_mix__ssm_conv_s5__dense_activation_squared_relu__prompt_kernel_e0d
L_gated_mix__ssm_conv_s5__dense_activation_squared_relu__prompt_kernel_e0x:
    s_cmp_ge_u32 s88, 33
    s_cbranch_scc1 L_gated_mix__ssm_conv_s5__dense_activation_squared_relu__prompt_kernel_e0c
    s_sub_u32 s85, s88, 21
    s_and_b32 s86, s85, 3
    s_lshr_b32 s85, s85, 2
    s_add_u32 s85, s85, 3
    s_lshl_b32 s85, s85, 7
    s_lshl_b32 s86, s86, 6
    s_lshl_b32 s87, s59, 9
    s_add_u32 s86, s86, s87
    s_lshl_b32 s87, s82, 8
    s_add_u32 s86, s86, s87
    s_lshl_b32 s86, s86, 11
    s_add_u32 s85, s85, s86
    v_lshlrev_b32 v21, 11, v0
    v_add_u32 v28, s85, v21
    s_mov_b32 s28, 1
    s_mov_b32 s30, 4194304
    s_branch L_gated_mix__ssm_conv_s5__dense_activation_squared_relu__prompt_kernel_e0d
L_gated_mix__ssm_conv_s5__dense_activation_squared_relu__prompt_kernel_e0c:
    s_sub_u32 s85, s88, 33
    s_cmp_ge_u32 s85, 12
    s_cbranch_scc1 L_gated_mix__ssm_conv_s5__dense_activation_squared_relu__prompt_kernel_e0d
    v_lshlrev_b32 v21, 7, v0
    s_cmp_lt_u32 s85, 10
    s_cbranch_scc0 L_gated_mix__ssm_conv_s5__dense_activation_squared_relu__prompt_kernel_e0s
    s_branch L_gated_mix__ssm_conv_s5__dense_activation_squared_relu__prompt_kernel_e0d
L_gated_mix__ssm_conv_s5__dense_activation_squared_relu__prompt_kernel_e0s:
    s_sub_u32 s28, s85, 7
    v_mov_b32 v28, v21
    s_mov_b32 s30, 2048
L_gated_mix__ssm_conv_s5__dense_activation_squared_relu__prompt_kernel_e0d:
    s_waitcnt lgkmcnt(0)
    s_mov_b32 s12, s40
    s_and_b32 s13, s41, 0xffff
    s_mov_b32 s14, 4194304
    s_mov_b32 s15, 0x20000
    s_mov_b32 s16, s64
    s_and_b32 s17, s65, 0xffff
    s_mov_b32 s18, 7340032
    s_mov_b32 s19, 0x20000
    s_mov_b32 s88, s24
    s_cmp_eq_u32 s88, 1
    s_cselect_b32 s24, s40, s64
    s_cselect_b32 s25, s41, s65
    s_cmp_eq_u32 s88, 3
    s_cselect_b32 s24, s56, s24
    s_cselect_b32 s25, s57, s25
    s_cmp_eq_u32 s88, 4
    s_cselect_b32 s24, s70, s24
    s_cselect_b32 s25, s71, s25
    s_and_b32 s25, s25, 0xffff
    buffer_load_dword v90, v95, s[24:27], 0 offen
    s_add_u32 m0, s97, 0
    s_nop 0
    buffer_load_dwordx4 v2, s[12:15], s89 offen offset:0  lds
    buffer_load_dwordx4 v3, s[12:15], s89 offen offset:1024  lds
    buffer_load_dwordx4 v4, s[12:15], s89 offen offset:2048  lds
    buffer_load_dwordx4 v5, s[12:15], s89 offen offset:3072  lds
    s_add_u32 m0, s98, 16384
    s_add_u32 s89, s89, 128
    buffer_load_dwordx4 v10, s[16:19], s90 offen offset:0  lds
    buffer_load_dwordx4 v11, s[16:19], s90 offen offset:1024  lds
    buffer_load_dwordx4 v12, s[16:19], s90 offen offset:2048  lds
    buffer_load_dwordx4 v13, s[16:19], s90 offen offset:3072  lds
    s_add_u32 m0, s98, 20480
    s_nop 0
    buffer_load_dwordx4 v14, s[16:19], s90 offen offset:0  lds
    buffer_load_dwordx4 v15, s[16:19], s90 offen offset:1024  lds
    buffer_load_dwordx4 v16, s[16:19], s90 offen offset:2048  lds
    s_add_u32 s90, s90, 458752
    s_mov_b32 s88, s28
    s_cmp_eq_u32 s88, 1
    s_cselect_b32 s28, s40, s64
    s_cselect_b32 s29, s41, s65
    s_cmp_eq_u32 s88, 3
    s_cselect_b32 s28, s56, s28
    s_cselect_b32 s29, s57, s29
    s_cmp_eq_u32 s88, 4
    s_cselect_b32 s28, s70, s28
    s_cselect_b32 s29, s71, s29
    s_and_b32 s29, s29, 0xffff
    buffer_load_dword v90, v28, s[28:31], 0 offen
    s_mov_b32 s62, s72
    s_mov_b32 s63, s73
    s_mov_b32 s8, s78
    s_and_b32 s9, s79, 0xffff
    s_mov_b32 s10, 37748736
    s_mov_b32 s11, 0x20000
    v_lshrrev_b32 v20, 4, v0
    v_lshrrev_b32 v21, 3, v0
    v_and_b32 v22, 7, v0
    v_add_u32 v23, 0, v20
    v_and_b32 v23, 7, v23
    v_xor_b32 v23, v23, v22
    v_lshlrev_b32 v23, 4, v23
    v_lshrrev_b32 v30, 2, v21
    v_lshlrev_b32 v30, 4, v30
    v_and_b32 v31, 1, v21
    v_lshlrev_b32 v31, 3, v31
    v_add_u32 v30, v30, v31
    v_lshrrev_b32 v31, 1, v21
    v_and_b32 v31, 1, v31
    v_add_u32 v30, v30, v31
    v_lshlrev_b32 v30, 11, v30
    v_add_u32 v30, v30, v23
    v_add_u32 v6, 0, v30
    v_add_u32 v23, 4, v20
    v_and_b32 v23, 7, v23
    v_xor_b32 v23, v23, v22
    v_lshlrev_b32 v23, 4, v23
    v_lshrrev_b32 v30, 2, v21
    v_lshlrev_b32 v30, 4, v30
    v_and_b32 v31, 1, v21
    v_lshlrev_b32 v31, 3, v31
    v_add_u32 v30, v30, v31
    v_lshrrev_b32 v31, 1, v21
    v_and_b32 v31, 1, v31
    v_add_u32 v30, v30, v31
    v_lshlrev_b32 v30, 11, v30
    v_add_u32 v30, v30, v23
    v_add_u32 v7, 64512, v30
    v_add_u32 v23, 0, v20
    v_and_b32 v23, 7, v23
    v_xor_b32 v23, v23, v22
    v_lshlrev_b32 v23, 4, v23
    v_lshrrev_b32 v30, 2, v21
    v_lshlrev_b32 v30, 4, v30
    v_and_b32 v31, 1, v21
    v_lshlrev_b32 v31, 3, v31
    v_add_u32 v30, v30, v31
    v_lshrrev_b32 v31, 1, v21
    v_and_b32 v31, 1, v31
    v_add_u32 v30, v30, v31
    v_lshlrev_b32 v30, 11, v30
    v_add_u32 v30, v30, v23
    v_add_u32 v8, 2048, v30
    v_add_u32 v23, 4, v20
    v_and_b32 v23, 7, v23
    v_xor_b32 v23, v23, v22
    v_lshlrev_b32 v23, 4, v23
    v_lshrrev_b32 v30, 2, v21
    v_lshlrev_b32 v30, 4, v30
    v_and_b32 v31, 1, v21
    v_lshlrev_b32 v31, 3, v31
    v_add_u32 v30, v30, v31
    v_lshrrev_b32 v31, 1, v21
    v_and_b32 v31, 1, v31
    v_add_u32 v30, v30, v31
    v_lshlrev_b32 v30, 11, v30
    v_add_u32 v30, v30, v23
    v_add_u32 v9, 66560, v30
    v_lshlrev_b32 v17, 4, v0
    v_and_b32 v21, 15, v0
    v_lshrrev_b32 v22, 1, v21
    v_and_b32 v23, 1, v21
    v_lshlrev_b32 v23, 4, v23
    v_add_u32 v30, 0, v20
    v_xor_b32 v30, v30, v22
    v_lshlrev_b32 v30, 5, v30
    v_add_u32 v30, v30, v23
    v_lshlrev_b32 v31, 11, v20
    v_add_u32 v30, v30, v31
    v_add_u32 v18, 0, v30
    v_add_u32 v30, 4, v20
    v_xor_b32 v30, v30, v22
    v_lshlrev_b32 v30, 5, v30
    v_add_u32 v30, v30, v23
    v_lshlrev_b32 v31, 11, v20
    v_add_u32 v30, v30, v31
    v_add_u32 v19, 7168, v30
    v_add_u32 v30, 0, v20
    v_xor_b32 v30, v30, v22
    v_lshlrev_b32 v30, 5, v30
    v_add_u32 v30, v30, v23
    v_lshlrev_b32 v31, 11, v20
    v_add_u32 v30, v30, v31
    v_add_u32 v24, 14336, v30
    v_add_u32 v30, 4, v20
    v_xor_b32 v30, v30, v22
    v_lshlrev_b32 v30, 5, v30
    v_add_u32 v30, v30, v23
    v_lshlrev_b32 v31, 11, v20
    v_add_u32 v30, v30, v31
    v_add_u32 v25, 21504, v30
    s_lshl_b32 s91, s80, 7
    s_lshr_b32 s85, s83, 1
    s_lshl_b32 s85, s85, 6
    s_add_u32 s91, s91, s85
    s_and_b32 s85, s83, 1
    s_lshl_b32 s85, s85, 2
    s_add_u32 s91, s91, s85
    s_lshl_b32 s91, s91, 11
    s_lshl_b32 s92, s84, 6
    s_and_b32 s85, s83, 1
    s_lshl_b32 s85, s85, 5
    s_add_u32 s92, s92, s85
    s_lshl_b32 s92, s92, 11
    s_cmp_ge_u32 s83, 2
    s_cselect_b32 s20, s48, s46
    s_cselect_b32 s21, s49, s47
    s_and_b32 s21, s21, 0xffff
    s_mov_b32 s22, 2097152
    s_mov_b32 s23, 0x20000
    s_mov_b32 s24, s68
    s_and_b32 s25, s69, 0xffff
    s_mov_b32 s26, 7340032
    s_mov_b32 s27, 0x20000
    s_mov_b32 s28, s50
    s_and_b32 s29, s51, 0xffff
    s_mov_b32 s30, 2097152
    s_mov_b32 s31, 0x20000
    s_mov_b32 s32, s52
    s_and_b32 s33, s53, 0xffff
    s_mov_b32 s34, 2097152
    s_mov_b32 s35, 0x20000
    s_mul_i32 s93, s80, 56
    s_mul_i32 s85, s82, 28
    s_add_u32 s93, s93, s85
    s_lshl_b32 s93, s93, 14
    s_lshl_b32 s85, s83, 12
    s_add_u32 s93, s93, s85
    s_mul_i32 s94, s82, 1792
    s_lshl_b32 s85, s83, 4
    s_add_u32 s94, s94, s85
    s_lshl_b32 s94, s94, 11
    s_lshl_b32 s85, s81, 8
    s_add_u32 s94, s94, s85
    s_lshl_b32 s95, s80, 4
    s_lshl_b32 s85, s82, 3
    s_add_u32 s95, s95, s85
    s_lshl_b32 s95, s95, 15
    s_lshl_b32 s85, s83, 12
    s_add_u32 s95, s95, s85
    s_add_u32 s95, s95, 16777216
    s_lshl_b32 s96, s81, 7
    s_lshl_b32 s85, s83, 5
    s_add_u32 s96, s96, s85
    s_lshl_b32 s96, s96, 11
    s_lshl_b32 s85, s82, 10
    s_add_u32 s96, s96, s85
    s_lshr_b32 s3, s2, 3
    s_mul_i32 s85, s3, 43
    s_lshr_b32 s74, s85, 7
    s_mul_i32 s85, s74, 3
    s_sub_u32 s85, s3, s85
    s_lshl_b32 s85, s85, 2
    s_add_u32 s85, s85, s83
    s_cmp_ge_u32 s85, 11
    s_cselect_b32 s74, 99, s74
    s_cmp_ge_u32 s85, 7
    s_cbranch_scc1 L_gated_mix__ssm_conv_s5__dense_activation_squared_relu__prompt_kernel_rpx
    s_lshl_b32 s86, s85, 6
    v_add_u32 v20, s86, v0
    s_mov_b32 s86, 2341
    v_mul_lo_u32 v21, v20, s86
    v_lshrrev_b32 v21, 16, v21
    v_mul_u32_u24 v22, 28, v21
    v_sub_u32 v22, v20, v22
    v_lshlrev_b32 v22, 7, v22
    v_mul_u32_u24 v21, 7168, v21
    v_add_u32 v27, v21, v22
    s_mul_i32 s72, s59, 114688
    s_mul_i32 s86, s82, 3584
    s_add_u32 s72, s72, s86
    s_mov_b32 s73, 458752
    s_mov_b32 s64, s16
    s_mov_b32 s65, s17
    s_mov_b32 s66, s18
    s_mov_b32 s67, 0x20000
    s_branch L_gated_mix__ssm_conv_s5__dense_activation_squared_relu__prompt_kernel_rpd
L_gated_mix__ssm_conv_s5__dense_activation_squared_relu__prompt_kernel_rpx:
    s_sub_u32 s85, s85, 7
    s_lshl_b32 s85, s85, 6
    s_lshl_b32 s86, s59, 9
    s_add_u32 s85, s85, s86
    s_lshl_b32 s86, s82, 8
    s_add_u32 s85, s85, s86
    s_lshl_b32 s72, s85, 11
    v_lshlrev_b32 v27, 11, v0
    s_mov_b32 s73, 128
    s_mov_b32 s64, s12
    s_mov_b32 s65, s13
    s_mov_b32 s66, s14
    s_mov_b32 s67, 0x20000
L_gated_mix__ssm_conv_s5__dense_activation_squared_relu__prompt_kernel_rpd:
    v_lshlrev_b32 v92, 11, v0
    v_lshlrev_b32 v26, 7, v0
    s_lshl_b32 s75, s82, 9
    s_lshl_b32 s86, s59, 7
    s_add_u32 s75, s75, s86
    s_and_b32 s86, s83, 1
    s_lshl_b32 s86, s86, 6
    s_add_u32 s75, s75, s86
    s_lshl_b32 s75, s75, 11
    s_mul_i32 s100, s82, 1792
    s_lshl_b32 s86, s59, 4
    s_add_u32 s100, s100, s86
    s_lshl_b32 s86, s83, 2
    s_add_u32 s100, s100, s86
    s_lshl_b32 s100, s100, 11
    s_lshl_b32 s101, s59, 8
    s_lshl_b32 s86, s83, 6
    s_add_u32 s101, s101, s86
    s_lshl_b32 s101, s101, 11
    s_lshl_b32 s86, s82, 10
    s_add_u32 s101, s101, s86
    s_add_u32 m0, s97, 45056
    s_nop 0
    buffer_load_dwordx4 v2, s[12:15], s89 offen offset:0  lds
    buffer_load_dwordx4 v3, s[12:15], s89 offen offset:1024  lds
    buffer_load_dwordx4 v4, s[12:15], s89 offen offset:2048  lds
    buffer_load_dwordx4 v5, s[12:15], s89 offen offset:3072  lds
    s_add_u32 m0, s98, 61440
    s_add_u32 s89, s89, 128
    buffer_load_dwordx4 v10, s[16:19], s90 offen offset:0  lds
    buffer_load_dwordx4 v11, s[16:19], s90 offen offset:1024  lds
    buffer_load_dwordx4 v12, s[16:19], s90 offen offset:2048  lds
    buffer_load_dwordx4 v13, s[16:19], s90 offen offset:3072  lds
    s_add_u32 m0, s98, 65536
    s_nop 0
    buffer_load_dwordx4 v14, s[16:19], s90 offen offset:0  lds
    buffer_load_dwordx4 v15, s[16:19], s90 offen offset:1024  lds
    buffer_load_dwordx4 v16, s[16:19], s90 offen offset:2048  lds
    s_add_u32 s90, s90, 458752
    s_waitcnt vmcnt(12)
    s_barrier
    s_add_u32 m0, s97, 90112
    s_nop 0
    buffer_load_dwordx4 v2, s[12:15], s89 offen offset:0  lds
    buffer_load_dwordx4 v3, s[12:15], s89 offen offset:1024  lds
    buffer_load_dwordx4 v4, s[12:15], s89 offen offset:2048  lds
    buffer_load_dwordx4 v5, s[12:15], s89 offen offset:3072  lds
    s_add_u32 m0, s98, 106496
    s_add_u32 s89, s89, 128
    buffer_load_dwordx4 v10, s[16:19], s90 offen offset:0  lds
    buffer_load_dwordx4 v11, s[16:19], s90 offen offset:1024  lds
    buffer_load_dwordx4 v12, s[16:19], s90 offen offset:2048  lds
    buffer_load_dwordx4 v13, s[16:19], s90 offen offset:3072  lds
    s_add_u32 m0, s98, 110592
    s_nop 0
    buffer_load_dwordx4 v14, s[16:19], s90 offen offset:0  lds
    buffer_load_dwordx4 v15, s[16:19], s90 offen offset:1024  lds
    buffer_load_dwordx4 v16, s[16:19], s90 offen offset:2048  lds
    s_add_u32 s90, s90, 458752
    v_lshlrev_b32 v30, 5, v0
    s_lshl_b32 s85, s84, 3
    s_lshl_b32 s86, s83, 1
    s_add_u32 s85, s85, s86
    s_lshl_b32 s86, s80, 7
    s_add_u32 s60, s85, s86
    s_lshl_b32 s85, s60, 11
    buffer_load_dwordx4 v[32:35], v30, s[12:15], s85 offen offset:0
    buffer_load_dwordx4 v[36:39], v30, s[12:15], s85 offen offset:16
    buffer_load_dwordx4 v[40:43], v30, s[12:15], s85 offen offset:2048
    buffer_load_dwordx4 v[44:47], v30, s[12:15], s85 offen offset:2064
    s_mov_b32 s36, s62
    s_and_b32 s37, s63, 0xffff
    s_mov_b32 s38, 2048
    s_mov_b32 s39, 0x20000
    buffer_load_dwordx4 v[48:51], v30, s[36:39], 0 offen offset:0
    buffer_load_dwordx4 v[52:55], v30, s[36:39], 0 offen offset:16
    s_lshl_b32 s85, s84, 7
    v_lshlrev_b32 v31, 1, v0
    v_add_u32 v31, s85, v31
    s_mov_b32 s36, s42
    s_and_b32 s37, s43, 0xffff
    buffer_load_ushort v56, v31, s[36:39], 0 offen
    s_mov_b32 s36, s44
    s_and_b32 s37, s45, 0xffff
    buffer_load_ushort v57, v31, s[36:39], 0 offen
    s_mov_b32 s36, s54
    s_and_b32 s37, s55, 0xffff
    buffer_load_ushort v58, v31, s[36:39], 0 offen
    s_waitcnt vmcnt(20)
    s_barrier
    s_mov_b32 s36, s76
    s_and_b32 s37, s77, 0xffff
    s_mov_b32 s38, 256
    v_mov_b32 v86, 0
    buffer_load_dword v87, v86, s[36:39], 0 offen sc1
    s_add_u32 m0, s97, 0
    s_nop 0
    buffer_load_dwordx4 v2, s[12:15], s89 offen offset:0  lds
    buffer_load_dwordx4 v3, s[12:15], s89 offen offset:1024  lds
    buffer_load_dwordx4 v4, s[12:15], s89 offen offset:2048  lds
    buffer_load_dwordx4 v5, s[12:15], s89 offen offset:3072  lds
    s_add_u32 m0, s98, 16384
    s_add_u32 s89, s89, 128
    buffer_load_dwordx4 v10, s[16:19], s90 offen offset:0  lds
    buffer_load_dwordx4 v11, s[16:19], s90 offen offset:1024  lds
    buffer_load_dwordx4 v12, s[16:19], s90 offen offset:2048  lds
    buffer_load_dwordx4 v13, s[16:19], s90 offen offset:3072  lds
    s_add_u32 m0, s98, 20480
    s_nop 0
    buffer_load_dwordx4 v14, s[16:19], s90 offen offset:0  lds
    buffer_load_dwordx4 v15, s[16:19], s90 offen offset:1024  lds
    buffer_load_dwordx4 v16, s[16:19], s90 offen offset:2048  lds
    s_add_u32 s90, s90, 458752
    s_mul_i32 s85, s73, 6
    s_add_u32 s85, s85, s72
    s_cmp_eq_u32 s74, 6
    s_cselect_b32 s85, s85, 0x7ff00000
    buffer_load_dword v90, v27, s[64:67], s85 offen
    s_waitcnt vmcnt(22)
    s_barrier
    s_add_u32 m0, s97, 45056
    s_nop 0
    buffer_load_dwordx4 v2, s[12:15], s89 offen offset:0  lds
    buffer_load_dwordx4 v3, s[12:15], s89 offen offset:1024  lds
    buffer_load_dwordx4 v4, s[12:15], s89 offen offset:2048  lds
    buffer_load_dwordx4 v5, s[12:15], s89 offen offset:3072  lds
    s_add_u32 m0, s98, 61440
    s_add_u32 s89, s89, 128
    buffer_load_dwordx4 v10, s[16:19], s90 offen offset:0  lds
    buffer_load_dwordx4 v11, s[16:19], s90 offen offset:1024  lds
    buffer_load_dwordx4 v12, s[16:19], s90 offen offset:2048  lds
    buffer_load_dwordx4 v13, s[16:19], s90 offen offset:3072  lds
    s_add_u32 m0, s98, 65536
    s_nop 0
    buffer_load_dwordx4 v14, s[16:19], s90 offen offset:0  lds
    buffer_load_dwordx4 v15, s[16:19], s90 offen offset:1024  lds
    buffer_load_dwordx4 v16, s[16:19], s90 offen offset:2048  lds
    s_add_u32 s90, s90, 458752
    s_and_b32 s85, s58, 63
    s_lshl_b32 s85, s85, 1
    s_lshl_b32 s86, s82, 9
    s_add_u32 s85, s85, s86
    s_lshl_b32 s86, s59, 7
    s_add_u32 s85, s85, s86
    s_lshl_b32 s85, s85, 11
    s_cmp_ge_u32 s58, 64
    s_cselect_b32 s40, s48, s46
    s_cselect_b32 s41, s49, s47
    s_add_u32 s40, s40, s85
    s_addc_u32 s41, s41, 0
    s_mul_i32 s85, s82, 1792
    s_lshl_b32 s86, s59, 4
    s_add_u32 s85, s85, s86
    s_lshr_b32 s86, s58, 3
    s_add_u32 s85, s85, s86
    s_lshl_b32 s85, s85, 11
    s_and_b32 s86, s58, 7
    s_lshl_b32 s86, s86, 8
    s_add_u32 s85, s85, s86
    s_add_u32 s42, s68, s85
    s_addc_u32 s43, s69, 0
    s_lshl_b32 s85, s59, 8
    s_lshl_b32 s86, s58, 1
    s_add_u32 s85, s85, s86
    s_lshl_b32 s85, s85, 11
    s_lshl_b32 s86, s82, 10
    s_add_u32 s85, s85, s86
    s_add_u32 s44, s50, s85
    s_addc_u32 s45, s51, 0
    s_add_u32 s68, s52, s85
    s_addc_u32 s69, s53, 0
    s_mul_i32 s85, s73, 7
    s_add_u32 s85, s85, s72
    s_cmp_eq_u32 s74, 7
    s_cselect_b32 s85, s85, 0x7ff00000
    buffer_load_dword v90, v27, s[64:67], s85 offen
    s_waitcnt vmcnt(24)
    v_readfirstlane_b32 s99, v87
    s_mov_b32 s6, 262144
L_gated_mix__ssm_conv_s5__dense_activation_squared_relu__prompt_kernel_pn:
    s_cmp_lg_u32 s99, 0
    s_cbranch_scc1 L_gated_mix__ssm_conv_s5__dense_activation_squared_relu__prompt_kernel_pn_ok
    s_sub_u32 s6, s6, 1
    s_cbranch_scc1 L_gated_mix__ssm_conv_s5__dense_activation_squared_relu__prompt_kernel_pn_ok
    s_sleep 2
    s_mov_b32 s36, s76
    s_and_b32 s37, s77, 0xffff
    s_mov_b32 s38, 256
    buffer_load_dword v87, v86, s[36:39], 0 offen sc1
    s_waitcnt vmcnt(0)
    v_readfirstlane_b32 s99, v87
    s_branch L_gated_mix__ssm_conv_s5__dense_activation_squared_relu__prompt_kernel_pn
L_gated_mix__ssm_conv_s5__dense_activation_squared_relu__prompt_kernel_pn_ok:
    s_mul_i32 s85, s58, 7168
    v_lshlrev_b32 v20, 7, v0
    v_add_u32 v20, s85, v20
    v_cmp_gt_u32 vcc, 56, v0
    v_mov_b32 v21, 0x7ff00000
    s_nop 0
    v_cndmask_b32 v93, v21, v20, vcc
    s_mul_i32 s50, s82, 1792
    s_mul_i32 s85, s59, 448
    s_add_u32 s50, s50, s85
    s_lshl_b32 s50, s50, 11
    s_and_b32 s85, s58, 63
    s_lshl_b32 s85, s85, 5
    v_add_u32 v20, s85, v0
    v_lshrrev_b32 v22, 3, v20
    v_lshlrev_b32 v22, 11, v22
    v_and_b32 v20, 7, v20
    v_lshlrev_b32 v20, 7, v20
    v_add_u32 v20, v20, v22
    v_cmp_gt_u32 vcc, 32, v0
    s_nop 1
    v_cndmask_b32 v94, v21, v20, vcc
    s_lshl_b32 s51, s59, 19
    s_lshl_b32 s85, s82, 10
    s_add_u32 s51, s51, s85
    s_cmp_ge_u32 s58, 64
    s_cselect_b32 s76, s32, s28
    s_cselect_b32 s77, s33, s29
    s_mov_b32 s78, 2097152
    s_mov_b32 s79, 0x20000
    s_lshr_b32 s85, s2, 3
    s_mul_i32 s86, s85, 13108
    s_lshr_b32 s86, s86, 16
    s_mul_i32 s86, s86, 5
    s_sub_u32 s52, s85, s86
    s_waitcnt vmcnt(13)
    s_barrier
    s_add_u32 m0, s97, 90112
    s_nop 0
    buffer_load_dwordx4 v2, s[12:15], s89 offen offset:0  lds
    buffer_load_dwordx4 v3, s[12:15], s89 offen offset:1024  lds
    buffer_load_dwordx4 v4, s[12:15], s89 offen offset:2048  lds
    buffer_load_dwordx4 v5, s[12:15], s89 offen offset:3072  lds
    s_add_u32 m0, s98, 106496
    s_add_u32 s89, s89, 128
    buffer_load_dwordx4 v10, s[16:19], s90 offen offset:0  lds
    buffer_load_dwordx4 v11, s[16:19], s90 offen offset:1024  lds
    buffer_load_dwordx4 v12, s[16:19], s90 offen offset:2048  lds
    buffer_load_dwordx4 v13, s[16:19], s90 offen offset:3072  lds
    s_add_u32 m0, s98, 110592
    s_nop 0
    buffer_load_dwordx4 v14, s[16:19], s90 offen offset:0  lds
    buffer_load_dwordx4 v15, s[16:19], s90 offen offset:1024  lds
    buffer_load_dwordx4 v16, s[16:19], s90 offen offset:2048  lds
    s_add_u32 s90, s90, 458752
    s_mul_i32 s85, s73, 8
    s_add_u32 s85, s85, s72
    s_cmp_eq_u32 s74, 8
    s_cselect_b32 s85, s85, 0x7ff00000
    buffer_load_dword v90, v27, s[64:67], s85 offen
    s_load_dword s5, s[40:41], 0
    s_load_dword s5, s[40:41], 64
    s_load_dword s5, s[40:41], 2048
    s_load_dword s5, s[40:41], 2112
    s_load_dword s5, s[40:41], 128
    s_waitcnt vmcnt(13)
    s_barrier
    s_add_u32 m0, s97, 0
    s_nop 0
    buffer_load_dwordx4 v2, s[12:15], s89 offen offset:0  lds
    buffer_load_dwordx4 v3, s[12:15], s89 offen offset:1024  lds
    buffer_load_dwordx4 v4, s[12:15], s89 offen offset:2048  lds
    buffer_load_dwordx4 v5, s[12:15], s89 offen offset:3072  lds
    s_add_u32 m0, s98, 16384
    s_add_u32 s89, s89, 128
    buffer_load_dwordx4 v10, s[16:19], s90 offen offset:0  lds
    buffer_load_dwordx4 v11, s[16:19], s90 offen offset:1024  lds
    buffer_load_dwordx4 v12, s[16:19], s90 offen offset:2048  lds
    buffer_load_dwordx4 v13, s[16:19], s90 offen offset:3072  lds
    s_add_u32 m0, s98, 20480
    s_nop 0
    buffer_load_dwordx4 v14, s[16:19], s90 offen offset:0  lds
    buffer_load_dwordx4 v15, s[16:19], s90 offen offset:1024  lds
    buffer_load_dwordx4 v16, s[16:19], s90 offen offset:2048  lds
    s_add_u32 s90, s90, 458752
    s_mul_i32 s85, s73, 9
    s_add_u32 s85, s85, s72
    s_cmp_eq_u32 s74, 9
    s_cselect_b32 s85, s85, 0x7ff00000
    buffer_load_dword v90, v27, s[64:67], s85 offen
    s_load_dword s5, s[40:41], 192
    s_load_dword s5, s[40:41], 2176
    s_load_dword s5, s[40:41], 2240
    s_load_dword s5, s[40:41], 256
    s_load_dword s5, s[40:41], 320
    s_waitcnt vmcnt(13)
    s_barrier
    s_add_u32 m0, s97, 45056
    s_nop 0
    buffer_load_dwordx4 v2, s[12:15], s89 offen offset:0  lds
    buffer_load_dwordx4 v3, s[12:15], s89 offen offset:1024  lds
    buffer_load_dwordx4 v4, s[12:15], s89 offen offset:2048  lds
    buffer_load_dwordx4 v5, s[12:15], s89 offen offset:3072  lds
    s_add_u32 m0, s98, 61440
    s_add_u32 s89, s89, 128
    buffer_load_dwordx4 v10, s[16:19], s90 offen offset:0  lds
    buffer_load_dwordx4 v11, s[16:19], s90 offen offset:1024  lds
    buffer_load_dwordx4 v12, s[16:19], s90 offen offset:2048  lds
    buffer_load_dwordx4 v13, s[16:19], s90 offen offset:3072  lds
    s_add_u32 m0, s98, 65536
    s_nop 0
    buffer_load_dwordx4 v14, s[16:19], s90 offen offset:0  lds
    buffer_load_dwordx4 v15, s[16:19], s90 offen offset:1024  lds
    buffer_load_dwordx4 v16, s[16:19], s90 offen offset:2048  lds
    s_add_u32 s90, s90, 458752
    s_mul_i32 s85, s73, 10
    s_add_u32 s85, s85, s72
    s_cmp_eq_u32 s74, 0
    s_cselect_b32 s85, s85, 0x7ff00000
    buffer_load_dword v90, v27, s[64:67], s85 offen
    s_cmp_eq_u32 s52, 0
    s_cselect_b32 s85, s50, 0x7ff00000
    buffer_load_dword v90, v93, s[24:27], s85 offen
    s_load_dword s5, s[40:41], 2304
    s_load_dword s5, s[40:41], 2368
    s_load_dword s5, s[40:41], 384
    s_load_dword s5, s[40:41], 448
    s_load_dword s5, s[40:41], 2432
    v_mov_b32 v60, 0
    v_mov_b32 v61, 0
    s_waitcnt vmcnt(14)
    s_barrier
    s_add_u32 m0, s97, 90112
    s_nop 0
    buffer_load_dwordx4 v2, s[12:15], s89 offen offset:0  lds
    buffer_load_dwordx4 v3, s[12:15], s89 offen offset:1024  lds
    buffer_load_dwordx4 v4, s[12:15], s89 offen offset:2048  lds
    buffer_load_dwordx4 v5, s[12:15], s89 offen offset:3072  lds
    s_add_u32 m0, s98, 106496
    s_add_u32 s89, s89, 128
    buffer_load_dwordx4 v10, s[16:19], s90 offen offset:0  lds
    buffer_load_dwordx4 v11, s[16:19], s90 offen offset:1024  lds
    buffer_load_dwordx4 v12, s[16:19], s90 offen offset:2048  lds
    buffer_load_dwordx4 v13, s[16:19], s90 offen offset:3072  lds
    s_add_u32 m0, s98, 110592
    s_nop 0
    buffer_load_dwordx4 v14, s[16:19], s90 offen offset:0  lds
    buffer_load_dwordx4 v15, s[16:19], s90 offen offset:1024  lds
    buffer_load_dwordx4 v16, s[16:19], s90 offen offset:2048  lds
    s_add_u32 s90, s90, 458752
    s_mul_i32 s85, s73, 11
    s_add_u32 s85, s85, s72
    s_cmp_eq_u32 s74, 1
    s_cselect_b32 s85, s85, 0x7ff00000
    buffer_load_dword v90, v27, s[64:67], s85 offen
    s_cmp_eq_u32 s52, 1
    s_cselect_b32 s85, s50, 0x7ff00000
    buffer_load_dword v90, v93, s[24:27], s85 offen
    s_load_dword s5, s[40:41], 2496
    s_load_dword s5, s[40:41], 512
    s_load_dword s5, s[40:41], 576
    s_load_dword s5, s[40:41], 2560
    s_load_dword s5, s[40:41], 2624
    v_lshlrev_b32 v62, 16, v48
    v_and_b32 v63, 0xffff0000, v48
    v_lshlrev_b32 v64, 16, v32
    v_and_b32 v65, 0xffff0000, v32
    v_mul_f32 v64, v64, v62
    v_mul_f32 v65, v65, v63
    v_cvt_pk_bf16_f32 v64, v64, v65
    v_lshlrev_b32 v65, 16, v64
    v_and_b32 v64, 0xffff0000, v64
    v_add_f32 v60, v60, v65
    v_add_f32 v60, v60, v64
    v_lshlrev_b32 v64, 16, v40
    v_and_b32 v65, 0xffff0000, v40
    v_mul_f32 v64, v64, v62
    v_mul_f32 v65, v65, v63
    v_cvt_pk_bf16_f32 v64, v64, v65
    v_lshlrev_b32 v65, 16, v64
    v_and_b32 v64, 0xffff0000, v64
    v_add_f32 v61, v61, v65
    v_add_f32 v61, v61, v64
    s_waitcnt vmcnt(15)
    s_barrier
    s_add_u32 m0, s97, 0
    s_nop 0
    buffer_load_dwordx4 v2, s[12:15], s89 offen offset:0  lds
    buffer_load_dwordx4 v3, s[12:15], s89 offen offset:1024  lds
    buffer_load_dwordx4 v4, s[12:15], s89 offen offset:2048  lds
    buffer_load_dwordx4 v5, s[12:15], s89 offen offset:3072  lds
    s_add_u32 m0, s98, 16384
    s_add_u32 s89, s89, 128
    buffer_load_dwordx4 v10, s[16:19], s90 offen offset:0  lds
    buffer_load_dwordx4 v11, s[16:19], s90 offen offset:1024  lds
    buffer_load_dwordx4 v12, s[16:19], s90 offen offset:2048  lds
    buffer_load_dwordx4 v13, s[16:19], s90 offen offset:3072  lds
    s_add_u32 m0, s98, 20480
    s_nop 0
    buffer_load_dwordx4 v14, s[16:19], s90 offen offset:0  lds
    buffer_load_dwordx4 v15, s[16:19], s90 offen offset:1024  lds
    buffer_load_dwordx4 v16, s[16:19], s90 offen offset:2048  lds
    s_add_u32 s90, s90, 458752
    s_mul_i32 s85, s73, 12
    s_add_u32 s85, s85, s72
    s_cmp_eq_u32 s74, 2
    s_cselect_b32 s85, s85, 0x7ff00000
    buffer_load_dword v90, v27, s[64:67], s85 offen
    s_cmp_eq_u32 s52, 2
    s_cselect_b32 s85, s50, 0x7ff00000
    buffer_load_dword v90, v93, s[24:27], s85 offen
    s_load_dword s5, s[40:41], 640
    s_load_dword s5, s[40:41], 704
    s_load_dword s5, s[40:41], 2688
    s_load_dword s5, s[40:41], 2752
    s_load_dword s5, s[40:41], 768
    v_lshlrev_b32 v62, 16, v49
    v_and_b32 v63, 0xffff0000, v49
    v_lshlrev_b32 v64, 16, v33
    v_and_b32 v65, 0xffff0000, v33
    v_mul_f32 v64, v64, v62
    v_mul_f32 v65, v65, v63
    v_cvt_pk_bf16_f32 v64, v64, v65
    v_lshlrev_b32 v65, 16, v64
    v_and_b32 v64, 0xffff0000, v64
    v_add_f32 v60, v60, v65
    v_add_f32 v60, v60, v64
    v_lshlrev_b32 v64, 16, v41
    v_and_b32 v65, 0xffff0000, v41
    v_mul_f32 v64, v64, v62
    v_mul_f32 v65, v65, v63
    v_cvt_pk_bf16_f32 v64, v64, v65
    v_lshlrev_b32 v65, 16, v64
    v_and_b32 v64, 0xffff0000, v64
    v_add_f32 v61, v61, v65
    v_add_f32 v61, v61, v64
    s_waitcnt vmcnt(15)
    s_barrier
    s_add_u32 m0, s97, 45056
    s_nop 0
    buffer_load_dwordx4 v2, s[12:15], s89 offen offset:0  lds
    buffer_load_dwordx4 v3, s[12:15], s89 offen offset:1024  lds
    buffer_load_dwordx4 v4, s[12:15], s89 offen offset:2048  lds
    buffer_load_dwordx4 v5, s[12:15], s89 offen offset:3072  lds
    s_add_u32 m0, s98, 61440
    s_add_u32 s89, s89, 128
    buffer_load_dwordx4 v10, s[16:19], s90 offen offset:0  lds
    buffer_load_dwordx4 v11, s[16:19], s90 offen offset:1024  lds
    buffer_load_dwordx4 v12, s[16:19], s90 offen offset:2048  lds
    buffer_load_dwordx4 v13, s[16:19], s90 offen offset:3072  lds
    s_add_u32 m0, s98, 65536
    s_nop 0
    buffer_load_dwordx4 v14, s[16:19], s90 offen offset:0  lds
    buffer_load_dwordx4 v15, s[16:19], s90 offen offset:1024  lds
    buffer_load_dwordx4 v16, s[16:19], s90 offen offset:2048  lds
    s_add_u32 s90, s90, 458752
    s_mul_i32 s85, s73, 13
    s_add_u32 s85, s85, s72
    s_cmp_eq_u32 s74, 3
    s_cselect_b32 s85, s85, 0x7ff00000
    buffer_load_dword v90, v27, s[64:67], s85 offen
    s_cmp_eq_u32 s52, 3
    s_cselect_b32 s85, s50, 0x7ff00000
    buffer_load_dword v90, v93, s[24:27], s85 offen
    s_load_dword s5, s[40:41], 832
    s_load_dword s5, s[40:41], 2816
    s_load_dword s5, s[40:41], 2880
    s_load_dword s5, s[40:41], 896
    s_load_dword s5, s[40:41], 960
    v_lshlrev_b32 v62, 16, v50
    v_and_b32 v63, 0xffff0000, v50
    v_lshlrev_b32 v64, 16, v34
    v_and_b32 v65, 0xffff0000, v34
    v_mul_f32 v64, v64, v62
    v_mul_f32 v65, v65, v63
    v_cvt_pk_bf16_f32 v64, v64, v65
    v_lshlrev_b32 v65, 16, v64
    v_and_b32 v64, 0xffff0000, v64
    v_add_f32 v60, v60, v65
    v_add_f32 v60, v60, v64
    v_lshlrev_b32 v64, 16, v42
    v_and_b32 v65, 0xffff0000, v42
    v_mul_f32 v64, v64, v62
    v_mul_f32 v65, v65, v63
    v_cvt_pk_bf16_f32 v64, v64, v65
    v_lshlrev_b32 v65, 16, v64
    v_and_b32 v64, 0xffff0000, v64
    v_add_f32 v61, v61, v65
    v_add_f32 v61, v61, v64
    s_waitcnt vmcnt(15)
    s_barrier
    s_add_u32 m0, s97, 90112
    s_nop 0
    buffer_load_dwordx4 v2, s[12:15], s89 offen offset:0  lds
    buffer_load_dwordx4 v3, s[12:15], s89 offen offset:1024  lds
    buffer_load_dwordx4 v4, s[12:15], s89 offen offset:2048  lds
    buffer_load_dwordx4 v5, s[12:15], s89 offen offset:3072  lds
    s_add_u32 m0, s98, 106496
    s_add_u32 s89, s89, 128
    buffer_load_dwordx4 v10, s[16:19], s90 offen offset:0  lds
    buffer_load_dwordx4 v11, s[16:19], s90 offen offset:1024  lds
    buffer_load_dwordx4 v12, s[16:19], s90 offen offset:2048  lds
    buffer_load_dwordx4 v13, s[16:19], s90 offen offset:3072  lds
    s_add_u32 m0, s98, 110592
    s_nop 0
    buffer_load_dwordx4 v14, s[16:19], s90 offen offset:0  lds
    buffer_load_dwordx4 v15, s[16:19], s90 offen offset:1024  lds
    buffer_load_dwordx4 v16, s[16:19], s90 offen offset:2048  lds
    s_add_u32 s90, s90, 458752
    s_mul_i32 s85, s73, 14
    s_add_u32 s85, s85, s72
    s_cmp_eq_u32 s74, 4
    s_cselect_b32 s85, s85, 0x7ff00000
    buffer_load_dword v90, v27, s[64:67], s85 offen
    s_cmp_eq_u32 s52, 4
    s_cselect_b32 s85, s50, 0x7ff00000
    buffer_load_dword v90, v93, s[24:27], s85 offen
    s_load_dword s5, s[40:41], 2944
    s_load_dword s5, s[40:41], 3008
    s_load_dword s5, s[40:41], 1024
    s_load_dword s5, s[40:41], 1088
    s_load_dword s5, s[40:41], 3072
    v_lshlrev_b32 v62, 16, v51
    v_and_b32 v63, 0xffff0000, v51
    v_lshlrev_b32 v64, 16, v35
    v_and_b32 v65, 0xffff0000, v35
    v_mul_f32 v64, v64, v62
    v_mul_f32 v65, v65, v63
    v_cvt_pk_bf16_f32 v64, v64, v65
    v_lshlrev_b32 v65, 16, v64
    v_and_b32 v64, 0xffff0000, v64
    v_add_f32 v60, v60, v65
    v_add_f32 v60, v60, v64
    v_lshlrev_b32 v64, 16, v43
    v_and_b32 v65, 0xffff0000, v43
    v_mul_f32 v64, v64, v62
    v_mul_f32 v65, v65, v63
    v_cvt_pk_bf16_f32 v64, v64, v65
    v_lshlrev_b32 v65, 16, v64
    v_and_b32 v64, 0xffff0000, v64
    v_add_f32 v61, v61, v65
    v_add_f32 v61, v61, v64
    s_waitcnt vmcnt(15)
    s_barrier
    s_add_u32 m0, s97, 0
    s_nop 0
    buffer_load_dwordx4 v2, s[12:15], s89 offen offset:0  lds
    buffer_load_dwordx4 v3, s[12:15], s89 offen offset:1024  lds
    buffer_load_dwordx4 v4, s[12:15], s89 offen offset:2048  lds
    buffer_load_dwordx4 v5, s[12:15], s89 offen offset:3072  lds
    s_add_u32 m0, s98, 16384
    s_add_u32 s89, s89, 128
    buffer_load_dwordx4 v10, s[16:19], s90 offen offset:0  lds
    buffer_load_dwordx4 v11, s[16:19], s90 offen offset:1024  lds
    buffer_load_dwordx4 v12, s[16:19], s90 offen offset:2048  lds
    buffer_load_dwordx4 v13, s[16:19], s90 offen offset:3072  lds
    s_add_u32 m0, s98, 20480
    s_nop 0
    buffer_load_dwordx4 v14, s[16:19], s90 offen offset:0  lds
    buffer_load_dwordx4 v15, s[16:19], s90 offen offset:1024  lds
    buffer_load_dwordx4 v16, s[16:19], s90 offen offset:2048  lds
    s_add_u32 s90, s90, 458752
    s_mul_i32 s85, s73, 15
    s_add_u32 s85, s85, s72
    s_cmp_eq_u32 s74, 5
    s_cselect_b32 s85, s85, 0x7ff00000
    buffer_load_dword v90, v27, s[64:67], s85 offen
    s_cmp_eq_u32 s52, 0
    s_cselect_b32 s85, s51, 0x7ff00000
    buffer_load_dword v90, v94, s[76:79], s85 offen
    s_load_dword s5, s[40:41], 3136
    s_load_dword s5, s[40:41], 1152
    s_load_dword s5, s[40:41], 1216
    s_load_dword s5, s[40:41], 3200
    s_load_dword s5, s[40:41], 3264
    v_lshlrev_b32 v62, 16, v52
    v_and_b32 v63, 0xffff0000, v52
    v_lshlrev_b32 v64, 16, v36
    v_and_b32 v65, 0xffff0000, v36
    v_mul_f32 v64, v64, v62
    v_mul_f32 v65, v65, v63
    v_cvt_pk_bf16_f32 v64, v64, v65
    v_lshlrev_b32 v65, 16, v64
    v_and_b32 v64, 0xffff0000, v64
    v_add_f32 v60, v60, v65
    v_add_f32 v60, v60, v64
    v_lshlrev_b32 v64, 16, v44
    v_and_b32 v65, 0xffff0000, v44
    v_mul_f32 v64, v64, v62
    v_mul_f32 v65, v65, v63
    v_cvt_pk_bf16_f32 v64, v64, v65
    v_lshlrev_b32 v65, 16, v64
    v_and_b32 v64, 0xffff0000, v64
    v_add_f32 v61, v61, v65
    v_add_f32 v61, v61, v64
    s_waitcnt vmcnt(15)
    s_barrier
    s_add_u32 m0, s97, 45056
    s_nop 0
    buffer_load_dwordx4 v2, s[12:15], s89 offen offset:0  lds
    buffer_load_dwordx4 v3, s[12:15], s89 offen offset:1024  lds
    buffer_load_dwordx4 v4, s[12:15], s89 offen offset:2048  lds
    buffer_load_dwordx4 v5, s[12:15], s89 offen offset:3072  lds
    s_add_u32 m0, s98, 61440
    s_add_u32 s89, s89, 128
    buffer_load_dwordx4 v10, s[16:19], s90 offen offset:0  lds
    buffer_load_dwordx4 v11, s[16:19], s90 offen offset:1024  lds
    buffer_load_dwordx4 v12, s[16:19], s90 offen offset:2048  lds
    buffer_load_dwordx4 v13, s[16:19], s90 offen offset:3072  lds
    s_add_u32 m0, s98, 65536
    s_nop 0
    buffer_load_dwordx4 v14, s[16:19], s90 offen offset:0  lds
    buffer_load_dwordx4 v15, s[16:19], s90 offen offset:1024  lds
    buffer_load_dwordx4 v16, s[16:19], s90 offen offset:2048  lds
    s_add_u32 s90, s90, 458752
    s_cmp_eq_u32 s52, 1
    s_cselect_b32 s85, s51, 0x7ff00000
    buffer_load_dword v90, v94, s[76:79], s85 offen
    s_load_dword s5, s[40:41], 1280
    s_load_dword s5, s[40:41], 1344
    s_load_dword s5, s[40:41], 3328
    s_load_dword s5, s[40:41], 3392
    s_load_dword s5, s[40:41], 1408
    v_lshlrev_b32 v62, 16, v53
    v_and_b32 v63, 0xffff0000, v53
    v_lshlrev_b32 v64, 16, v37
    v_and_b32 v65, 0xffff0000, v37
    v_mul_f32 v64, v64, v62
    v_mul_f32 v65, v65, v63
    v_cvt_pk_bf16_f32 v64, v64, v65
    v_lshlrev_b32 v65, 16, v64
    v_and_b32 v64, 0xffff0000, v64
    v_add_f32 v60, v60, v65
    v_add_f32 v60, v60, v64
    v_lshlrev_b32 v64, 16, v45
    v_and_b32 v65, 0xffff0000, v45
    v_mul_f32 v64, v64, v62
    v_mul_f32 v65, v65, v63
    v_cvt_pk_bf16_f32 v64, v64, v65
    v_lshlrev_b32 v65, 16, v64
    v_and_b32 v64, 0xffff0000, v64
    v_add_f32 v61, v61, v65
    v_add_f32 v61, v61, v64
    s_waitcnt vmcnt(14)
    s_barrier
    s_add_u32 m0, s97, 90112
    s_nop 0
    buffer_load_dwordx4 v2, s[12:15], s89 offen offset:0  lds
    buffer_load_dwordx4 v3, s[12:15], s89 offen offset:1024  lds
    buffer_load_dwordx4 v4, s[12:15], s89 offen offset:2048  lds
    buffer_load_dwordx4 v5, s[12:15], s89 offen offset:3072  lds
    s_add_u32 m0, s98, 106496
    s_add_u32 s89, s89, 128
    buffer_load_dwordx4 v10, s[16:19], s90 offen offset:0  lds
    buffer_load_dwordx4 v11, s[16:19], s90 offen offset:1024  lds
    buffer_load_dwordx4 v12, s[16:19], s90 offen offset:2048  lds
    buffer_load_dwordx4 v13, s[16:19], s90 offen offset:3072  lds
    s_add_u32 m0, s98, 110592
    s_nop 0
    buffer_load_dwordx4 v14, s[16:19], s90 offen offset:0  lds
    buffer_load_dwordx4 v15, s[16:19], s90 offen offset:1024  lds
    buffer_load_dwordx4 v16, s[16:19], s90 offen offset:2048  lds
    s_add_u32 s90, s90, 458752
    s_cmp_eq_u32 s52, 2
    s_cselect_b32 s85, s51, 0x7ff00000
    buffer_load_dword v90, v94, s[76:79], s85 offen
    s_load_dword s5, s[40:41], 1472
    s_load_dword s5, s[40:41], 3456
    s_load_dword s5, s[40:41], 3520
    s_load_dword s5, s[40:41], 1536
    s_load_dword s5, s[40:41], 1600
    v_lshlrev_b32 v62, 16, v54
    v_and_b32 v63, 0xffff0000, v54
    v_lshlrev_b32 v64, 16, v38
    v_and_b32 v65, 0xffff0000, v38
    v_mul_f32 v64, v64, v62
    v_mul_f32 v65, v65, v63
    v_cvt_pk_bf16_f32 v64, v64, v65
    v_lshlrev_b32 v65, 16, v64
    v_and_b32 v64, 0xffff0000, v64
    v_add_f32 v60, v60, v65
    v_add_f32 v60, v60, v64
    v_lshlrev_b32 v64, 16, v46
    v_and_b32 v65, 0xffff0000, v46
    v_mul_f32 v64, v64, v62
    v_mul_f32 v65, v65, v63
    v_cvt_pk_bf16_f32 v64, v64, v65
    v_lshlrev_b32 v65, 16, v64
    v_and_b32 v64, 0xffff0000, v64
    v_add_f32 v61, v61, v65
    v_add_f32 v61, v61, v64
    s_waitcnt vmcnt(13)
    s_barrier
    s_add_u32 m0, s97, 0
    s_nop 0
    buffer_load_dwordx4 v2, s[12:15], s89 offen offset:0  lds
    buffer_load_dwordx4 v3, s[12:15], s89 offen offset:1024  lds
    buffer_load_dwordx4 v4, s[12:15], s89 offen offset:2048  lds
    buffer_load_dwordx4 v5, s[12:15], s89 offen offset:3072  lds
    s_add_u32 m0, s98, 16384
    s_add_u32 s89, s89, 128
    buffer_load_dwordx4 v10, s[16:19], s90 offen offset:0  lds
    buffer_load_dwordx4 v11, s[16:19], s90 offen offset:1024  lds
    buffer_load_dwordx4 v12, s[16:19], s90 offen offset:2048  lds
    buffer_load_dwordx4 v13, s[16:19], s90 offen offset:3072  lds
    s_add_u32 m0, s98, 20480
    s_nop 0
    buffer_load_dwordx4 v14, s[16:19], s90 offen offset:0  lds
    buffer_load_dwordx4 v15, s[16:19], s90 offen offset:1024  lds
    buffer_load_dwordx4 v16, s[16:19], s90 offen offset:2048  lds
    s_add_u32 s90, s90, 458752
    s_cmp_eq_u32 s52, 3
    s_cselect_b32 s85, s51, 0x7ff00000
    buffer_load_dword v90, v94, s[76:79], s85 offen
    s_load_dword s5, s[40:41], 3584
    s_load_dword s5, s[40:41], 3648
    s_load_dword s5, s[40:41], 1664
    s_load_dword s5, s[40:41], 1728
    s_load_dword s5, s[40:41], 3712
    v_lshlrev_b32 v62, 16, v55
    v_and_b32 v63, 0xffff0000, v55
    v_lshlrev_b32 v64, 16, v39
    v_and_b32 v65, 0xffff0000, v39
    v_mul_f32 v64, v64, v62
    v_mul_f32 v65, v65, v63
    v_cvt_pk_bf16_f32 v64, v64, v65
    v_lshlrev_b32 v65, 16, v64
    v_and_b32 v64, 0xffff0000, v64
    v_add_f32 v60, v60, v65
    v_add_f32 v60, v60, v64
    v_lshlrev_b32 v64, 16, v47
    v_and_b32 v65, 0xffff0000, v47
    v_mul_f32 v64, v64, v62
    v_mul_f32 v65, v65, v63
    v_cvt_pk_bf16_f32 v64, v64, v65
    v_lshlrev_b32 v65, 16, v64
    v_and_b32 v64, 0xffff0000, v64
    v_add_f32 v61, v61, v65
    v_add_f32 v61, v61, v64
    s_waitcnt vmcnt(13)
    s_barrier
    s_add_u32 m0, s97, 45056
    s_nop 0
    buffer_load_dwordx4 v6, s[12:15], s91 offen offset:0  lds
    buffer_load_dwordx4 v7, s[12:15], s91 offen offset:1024  lds
    buffer_load_dwordx4 v8, s[12:15], s91 offen offset:2048  lds
    buffer_load_dwordx4 v9, s[12:15], s91 offen offset:3072  lds
    s_add_u32 m0, s97, 61440
    s_add_u32 s91, s91, 128
    buffer_load_dwordx4 v2, s[20:23], s92 offen offset:0  lds
    buffer_load_dwordx4 v3, s[20:23], s92 offen offset:1024  lds
    buffer_load_dwordx4 v4, s[20:23], s92 offen offset:2048  lds
    buffer_load_dwordx4 v5, s[20:23], s92 offen offset:3072  lds
    s_add_u32 s92, s92, 128
    s_cmp_eq_u32 s52, 4
    s_cselect_b32 s85, s51, 0x7ff00000
    buffer_load_dword v90, v94, s[76:79], s85 offen
    s_load_dword s5, s[40:41], 3776
    s_load_dword s5, s[40:41], 1792
    s_load_dword s5, s[40:41], 1856
    s_load_dword s5, s[40:41], 3840
    s_load_dword s5, s[40:41], 3904
    s_nop 1
    v_mov_b32_dpp v66, v60 row_shr:1 row_mask:0xf bank_mask:0xf bound_ctrl:0
    v_add_f32 v60, v60, v66
    s_nop 1
    v_mov_b32_dpp v66, v60 row_shr:2 row_mask:0xf bank_mask:0xf bound_ctrl:0
    v_add_f32 v60, v60, v66
    s_nop 1
    v_mov_b32_dpp v66, v60 row_shr:4 row_mask:0xf bank_mask:0xf bound_ctrl:0
    v_add_f32 v60, v60, v66
    s_nop 1
    v_mov_b32_dpp v66, v60 row_shr:8 row_mask:0xf bank_mask:0xf bound_ctrl:0
    v_add_f32 v60, v60, v66
    s_nop 0
    v_readlane_b32 s61, v60, 15
    v_readlane_b32 s62, v60, 31
    v_readlane_b32 s63, v60, 47
    v_readlane_b32 s7, v60, 63
    s_nop 1
    v_mov_b32 v66, s61
    v_add_f32 v66, s62, v66
    v_add_f32 v66, s63, v66
    v_add_f32 v60, s7, v66
    s_waitcnt vmcnt(10)
    s_barrier
    s_add_u32 m0, s97, 90112
    s_nop 0
    buffer_load_dwordx4 v6, s[12:15], s91 offen offset:0  lds
    buffer_load_dwordx4 v7, s[12:15], s91 offen offset:1024  lds
    buffer_load_dwordx4 v8, s[12:15], s91 offen offset:2048  lds
    buffer_load_dwordx4 v9, s[12:15], s91 offen offset:3072  lds
    s_add_u32 m0, s97, 106496
    s_add_u32 s91, s91, 128
    buffer_load_dwordx4 v2, s[20:23], s92 offen offset:0  lds
    buffer_load_dwordx4 v3, s[20:23], s92 offen offset:1024  lds
    buffer_load_dwordx4 v4, s[20:23], s92 offen offset:2048  lds
    buffer_load_dwordx4 v5, s[20:23], s92 offen offset:3072  lds
    s_add_u32 s92, s92, 128
    s_add_u32 m0, s97, 122880
    s_nop 0
    buffer_load_dwordx4 v6, s[12:15], s91 offen offset:0  lds
    buffer_load_dwordx4 v7, s[12:15], s91 offen offset:1024  lds
    buffer_load_dwordx4 v8, s[12:15], s91 offen offset:2048  lds
    buffer_load_dwordx4 v9, s[12:15], s91 offen offset:3072  lds
    s_add_u32 m0, s97, 139264
    s_add_u32 s91, s91, 128
    buffer_load_dwordx4 v2, s[20:23], s92 offen offset:0  lds
    buffer_load_dwordx4 v3, s[20:23], s92 offen offset:1024  lds
    buffer_load_dwordx4 v4, s[20:23], s92 offen offset:2048  lds
    buffer_load_dwordx4 v5, s[20:23], s92 offen offset:3072  lds
    s_add_u32 s92, s92, 128
    s_load_dword s5, s[40:41], 1920
    s_load_dword s5, s[40:41], 1984
    s_load_dword s5, s[40:41], 3968
    s_load_dword s5, s[40:41], 4032
    s_add_u32 s42, s42, 917504
    s_addc_u32 s43, s43, 0
    s_add_u32 s42, s42, 917504
    s_addc_u32 s43, s43, 0
    s_add_u32 s42, s42, 917504
    s_addc_u32 s43, s43, 0
    s_nop 1
    v_mov_b32_dpp v66, v61 row_shr:1 row_mask:0xf bank_mask:0xf bound_ctrl:0
    v_add_f32 v61, v61, v66
    s_nop 1
    v_mov_b32_dpp v66, v61 row_shr:2 row_mask:0xf bank_mask:0xf bound_ctrl:0
    v_add_f32 v61, v61, v66
    s_nop 1
    v_mov_b32_dpp v66, v61 row_shr:4 row_mask:0xf bank_mask:0xf bound_ctrl:0
    v_add_f32 v61, v61, v66
    s_nop 1
    v_mov_b32_dpp v66, v61 row_shr:8 row_mask:0xf bank_mask:0xf bound_ctrl:0
    v_add_f32 v61, v61, v66
    s_nop 0
    v_readlane_b32 s61, v61, 15
    v_readlane_b32 s62, v61, 31
    v_readlane_b32 s63, v61, 47
    v_readlane_b32 s7, v61, 63
    s_nop 1
    v_mov_b32 v66, s61
    v_add_f32 v66, s62, v66
    v_add_f32 v66, s63, v66
    v_add_f32 v61, s7, v66
    s_waitcnt vmcnt(17)
    s_barrier
    s_add_u32 m0, s97, 0
    s_nop 0
    buffer_load_dwordx4 v6, s[12:15], s91 offen offset:0  lds
    buffer_load_dwordx4 v7, s[12:15], s91 offen offset:1024  lds
    buffer_load_dwordx4 v8, s[12:15], s91 offen offset:2048  lds
    buffer_load_dwordx4 v9, s[12:15], s91 offen offset:3072  lds
    s_add_u32 m0, s97, 16384
    s_add_u32 s91, s91, 128
    buffer_load_dwordx4 v2, s[20:23], s92 offen offset:0  lds
    buffer_load_dwordx4 v3, s[20:23], s92 offen offset:1024  lds
    buffer_load_dwordx4 v4, s[20:23], s92 offen offset:2048  lds
    buffer_load_dwordx4 v5, s[20:23], s92 offen offset:3072  lds
    s_add_u32 s92, s92, 128
    v_cmp_eq_u32 vcc, 1, v0
    s_nop 1
    v_cndmask_b32 v60, v60, v61, vcc
    v_cvt_pk_bf16_f32 v60, v60, v60
    v_lshlrev_b32 v60, 16, v60
    v_mul_f32 v61, 3216550459, v60
    v_exp_f32 v61, v61
    s_nop 0
    v_add_f32 v61, 1.0, v61
    v_rcp_f32 v61, v61
    s_nop 0
    v_cvt_pk_bf16_f32 v61, v61, v61
    v_lshlrev_b32 v62, 16, v61
    v_sub_f32 v63, 1.0, v62
    v_cvt_pk_bf16_f32 v63, v63, v63
    v_lshlrev_b32 v63, 16, v63
    v_mov_b32 v64, s99
    v_mov_b32 v65, s99
    v_add_u32 v66, s60, v0
    v_lshlrev_b32 v66, 4, v66
    v_add_u32 v66, 25165824, v66
    s_mov_b64 exec, 3
    buffer_store_dwordx4 v[62:65], v66, s[8:11], 0 offen sc1
    s_mov_b64 exec, -1
    s_waitcnt vmcnt(17)
    s_barrier
    s_add_u32 m0, s97, 45056
    s_nop 0
    buffer_load_dwordx4 v6, s[12:15], s91 offen offset:0  lds
    buffer_load_dwordx4 v7, s[12:15], s91 offen offset:1024  lds
    buffer_load_dwordx4 v8, s[12:15], s91 offen offset:2048  lds
    buffer_load_dwordx4 v9, s[12:15], s91 offen offset:3072  lds
    s_add_u32 m0, s97, 61440
    s_add_u32 s91, s91, 128
    buffer_load_dwordx4 v2, s[20:23], s92 offen offset:0  lds
    buffer_load_dwordx4 v3, s[20:23], s92 offen offset:1024  lds
    buffer_load_dwordx4 v4, s[20:23], s92 offen offset:2048  lds
    buffer_load_dwordx4 v5, s[20:23], s92 offen offset:3072  lds
    s_add_u32 s92, s92, 128
    s_waitcnt vmcnt(9)
    s_barrier
    s_add_u32 m0, s97, 90112
    s_nop 0
    buffer_load_dwordx4 v6, s[12:15], s91 offen offset:0  lds
    buffer_load_dwordx4 v7, s[12:15], s91 offen offset:1024  lds
    buffer_load_dwordx4 v8, s[12:15], s91 offen offset:2048  lds
    buffer_load_dwordx4 v9, s[12:15], s91 offen offset:3072  lds
    s_add_u32 m0, s97, 106496
    s_add_u32 s91, s91, 128
    buffer_load_dwordx4 v2, s[20:23], s92 offen offset:0  lds
    buffer_load_dwordx4 v3, s[20:23], s92 offen offset:1024  lds
    buffer_load_dwordx4 v4, s[20:23], s92 offen offset:2048  lds
    buffer_load_dwordx4 v5, s[20:23], s92 offen offset:3072  lds
    s_add_u32 s92, s92, 128
    s_waitcnt vmcnt(25)
    s_barrier
    s_add_u32 m0, s97, 0
    s_nop 0
    buffer_load_dwordx4 v6, s[12:15], s91 offen offset:0  lds
    buffer_load_dwordx4 v7, s[12:15], s91 offen offset:1024  lds
    buffer_load_dwordx4 v8, s[12:15], s91 offen offset:2048  lds
    buffer_load_dwordx4 v9, s[12:15], s91 offen offset:3072  lds
    s_add_u32 m0, s97, 16384
    s_add_u32 s91, s91, 128
    buffer_load_dwordx4 v2, s[20:23], s92 offen offset:0  lds
    buffer_load_dwordx4 v3, s[20:23], s92 offen offset:1024  lds
    buffer_load_dwordx4 v4, s[20:23], s92 offen offset:2048  lds
    buffer_load_dwordx4 v5, s[20:23], s92 offen offset:3072  lds
    s_add_u32 s92, s92, 128
    s_waitcnt vmcnt(16)
    s_barrier
    s_add_u32 m0, s97, 122880
    s_nop 0
    buffer_load_dwordx4 v6, s[12:15], s91 offen offset:0  lds
    buffer_load_dwordx4 v7, s[12:15], s91 offen offset:1024  lds
    buffer_load_dwordx4 v8, s[12:15], s91 offen offset:2048  lds
    buffer_load_dwordx4 v9, s[12:15], s91 offen offset:3072  lds
    s_add_u32 m0, s97, 139264
    s_add_u32 s91, s91, 128
    buffer_load_dwordx4 v2, s[20:23], s92 offen offset:0  lds
    buffer_load_dwordx4 v3, s[20:23], s92 offen offset:1024  lds
    buffer_load_dwordx4 v4, s[20:23], s92 offen offset:2048  lds
    buffer_load_dwordx4 v5, s[20:23], s92 offen offset:3072  lds
    s_add_u32 s92, s92, 128
    s_waitcnt vmcnt(16)
    s_barrier
    s_add_u32 m0, s97, 45056
    s_nop 0
    buffer_load_dwordx4 v6, s[12:15], s91 offen offset:0  lds
    buffer_load_dwordx4 v7, s[12:15], s91 offen offset:1024  lds
    buffer_load_dwordx4 v8, s[12:15], s91 offen offset:2048  lds
    buffer_load_dwordx4 v9, s[12:15], s91 offen offset:3072  lds
    s_add_u32 m0, s97, 61440
    s_add_u32 s91, s91, 128
    buffer_load_dwordx4 v2, s[20:23], s92 offen offset:0  lds
    buffer_load_dwordx4 v3, s[20:23], s92 offen offset:1024  lds
    buffer_load_dwordx4 v4, s[20:23], s92 offen offset:2048  lds
    buffer_load_dwordx4 v5, s[20:23], s92 offen offset:3072  lds
    s_add_u32 s92, s92, 128
    v_lshlrev_b32 v56, 16, v56
    v_lshlrev_b32 v57, 16, v57
    v_lshlrev_b32 v58, 16, v58
    v_mul_f32 v58, 1069066811, v58
    v_exp_f32 v58, v58
    s_nop 0
    v_cvt_pk_bf16_f32 v58, v58, v58
    v_lshlrev_b32 v58, 16, v58
    v_mul_f32 v59, v58, v56
    v_mul_f32 v67, v58, v57
    v_mul_f32 v68, 1069066811, v59
    v_mul_f32 v69, 1042479491, v67
    v_lshlrev_b32 v70, 3, v0
    v_add_u32 v70, 155648, v70
    s_waitcnt vmcnt(16)
    s_barrier
    s_add_u32 m0, s97, 90112
    s_nop 0
    buffer_load_dwordx4 v6, s[12:15], s91 offen offset:0  lds
    buffer_load_dwordx4 v7, s[12:15], s91 offen offset:1024  lds
    buffer_load_dwordx4 v8, s[12:15], s91 offen offset:2048  lds
    buffer_load_dwordx4 v9, s[12:15], s91 offen offset:3072  lds
    s_add_u32 m0, s97, 106496
    s_add_u32 s91, s91, 128
    buffer_load_dwordx4 v2, s[20:23], s92 offen offset:0  lds
    buffer_load_dwordx4 v3, s[20:23], s92 offen offset:1024  lds
    buffer_load_dwordx4 v4, s[20:23], s92 offen offset:2048  lds
    buffer_load_dwordx4 v5, s[20:23], s92 offen offset:3072  lds
    s_add_u32 s92, s92, 128
    s_cmp_lg_u32 s83, 0
    s_cbranch_scc1 L_gated_mix__ssm_conv_s5__dense_activation_squared_relu__prompt_kernel_c0_0
    v_mul_f32 v71, 0x3f800000, v68
    v_mul_f32 v72, 0x3f800000, v69
    v_exp_f32 v71, v71
    v_fract_f32 v72, v72
    s_nop 0
    v_cos_f32 v74, v72
    v_sin_f32 v75, v72
    s_nop 0
    v_mul_f32 v74, v74, v71
    v_mul_f32 v75, v75, v71
    ds_write_b64 v70, v[74:75] offset:0
    v_mov_b32 v82, v74
    v_mov_b32 v83, v75
L_gated_mix__ssm_conv_s5__dense_activation_squared_relu__prompt_kernel_c0_0:
    s_cmp_lg_u32 s83, 1
    s_cbranch_scc1 L_gated_mix__ssm_conv_s5__dense_activation_squared_relu__prompt_kernel_c0_1
    v_mul_f32 v71, 0x41000000, v68
    v_mul_f32 v72, 0x41000000, v69
    v_exp_f32 v71, v71
    v_fract_f32 v72, v72
    s_nop 0
    v_cos_f32 v74, v72
    v_sin_f32 v75, v72
    s_nop 0
    v_mul_f32 v74, v74, v71
    v_mul_f32 v75, v75, v71
    ds_write_b64 v70, v[74:75] offset:512
L_gated_mix__ssm_conv_s5__dense_activation_squared_relu__prompt_kernel_c0_1:
    s_cmp_lg_u32 s83, 2
    s_cbranch_scc1 L_gated_mix__ssm_conv_s5__dense_activation_squared_relu__prompt_kernel_c0_2
    v_mul_f32 v71, 0x41800000, v68
    v_mul_f32 v72, 0x41800000, v69
    v_exp_f32 v71, v71
    v_fract_f32 v72, v72
    s_nop 0
    v_cos_f32 v74, v72
    v_sin_f32 v75, v72
    s_nop 0
    v_mul_f32 v74, v74, v71
    v_mul_f32 v75, v75, v71
    ds_write_b64 v70, v[74:75] offset:1024
L_gated_mix__ssm_conv_s5__dense_activation_squared_relu__prompt_kernel_c0_2:
    s_cmp_lg_u32 s83, 3
    s_cbranch_scc1 L_gated_mix__ssm_conv_s5__dense_activation_squared_relu__prompt_kernel_c0_3
    v_mul_f32 v71, 0x43000000, v68
    v_mul_f32 v72, 0x43000000, v69
    v_exp_f32 v71, v71
    v_fract_f32 v72, v72
    s_nop 0
    v_cos_f32 v74, v72
    v_sin_f32 v75, v72
    s_nop 0
    v_mul_f32 v74, v74, v71
    v_mul_f32 v75, v75, v71
    ds_write_b64 v70, v[74:75] offset:1536
L_gated_mix__ssm_conv_s5__dense_activation_squared_relu__prompt_kernel_c0_3:
    s_waitcnt vmcnt(16)
    s_barrier
    s_add_u32 m0, s97, 0
    s_nop 0
    buffer_load_dwordx4 v6, s[12:15], s91 offen offset:0  lds
    buffer_load_dwordx4 v7, s[12:15], s91 offen offset:1024  lds
    buffer_load_dwordx4 v8, s[12:15], s91 offen offset:2048  lds
    buffer_load_dwordx4 v9, s[12:15], s91 offen offset:3072  lds
    s_add_u32 m0, s97, 16384
    s_add_u32 s91, s91, 128
    buffer_load_dwordx4 v2, s[20:23], s92 offen offset:0  lds
    buffer_load_dwordx4 v3, s[20:23], s92 offen offset:1024  lds
    buffer_load_dwordx4 v4, s[20:23], s92 offen offset:2048  lds
    buffer_load_dwordx4 v5, s[20:23], s92 offen offset:3072  lds
    s_add_u32 s92, s92, 128
    s_cmp_lg_u32 s83, 0
    s_cbranch_scc1 L_gated_mix__ssm_conv_s5__dense_activation_squared_relu__prompt_kernel_c1_0
    v_mul_f32 v71, 0x0, v68
    v_mul_f32 v72, 0x0, v69
    v_exp_f32 v71, v71
    v_fract_f32 v72, v72
    s_nop 0
    v_cos_f32 v74, v72
    v_sin_f32 v75, v72
    s_nop 0
    v_mul_f32 v74, v74, v71
    v_mul_f32 v75, v75, v71
    ds_write_b64 v70, v[74:75] offset:2560
L_gated_mix__ssm_conv_s5__dense_activation_squared_relu__prompt_kernel_c1_0:
    s_cmp_lg_u32 s83, 1
    s_cbranch_scc1 L_gated_mix__ssm_conv_s5__dense_activation_squared_relu__prompt_kernel_c1_1
    v_mul_f32 v71, 0x42000000, v68
    v_mul_f32 v72, 0x42000000, v69
    v_exp_f32 v71, v71
    v_fract_f32 v72, v72
    s_nop 0
    v_cos_f32 v74, v72
    v_sin_f32 v75, v72
    s_nop 0
    v_mul_f32 v74, v74, v71
    v_mul_f32 v75, v75, v71
    ds_write_b64 v70, v[74:75] offset:3584
L_gated_mix__ssm_conv_s5__dense_activation_squared_relu__prompt_kernel_c1_1:
    s_cmp_lg_u32 s83, 2
    s_cbranch_scc1 L_gated_mix__ssm_conv_s5__dense_activation_squared_relu__prompt_kernel_c1_2
    v_mul_f32 v71, 0x42800000, v68
    v_mul_f32 v72, 0x42800000, v69
    v_exp_f32 v71, v71
    v_fract_f32 v72, v72
    s_nop 0
    v_cos_f32 v74, v72
    v_sin_f32 v75, v72
    s_nop 0
    v_mul_f32 v74, v74, v71
    v_mul_f32 v75, v75, v71
    ds_write_b64 v70, v[74:75] offset:4608
L_gated_mix__ssm_conv_s5__dense_activation_squared_relu__prompt_kernel_c1_2:
    s_cmp_lg_u32 s83, 3
    s_cbranch_scc1 L_gated_mix__ssm_conv_s5__dense_activation_squared_relu__prompt_kernel_c1_3
    v_mul_f32 v71, 0x42c00000, v68
    v_mul_f32 v72, 0x42c00000, v69
    v_exp_f32 v71, v71
    v_fract_f32 v72, v72
    s_nop 0
    v_cos_f32 v74, v72
    v_sin_f32 v75, v72
    s_nop 0
    v_mul_f32 v74, v74, v71
    v_mul_f32 v75, v75, v71
    ds_write_b64 v70, v[74:75] offset:5632
L_gated_mix__ssm_conv_s5__dense_activation_squared_relu__prompt_kernel_c1_3:
    s_waitcnt vmcnt(16)
    s_barrier
    s_add_u32 m0, s97, 122880
    s_nop 0
    buffer_load_dwordx4 v6, s[12:15], s91 offen offset:0  lds
    buffer_load_dwordx4 v7, s[12:15], s91 offen offset:1024  lds
    buffer_load_dwordx4 v8, s[12:15], s91 offen offset:2048  lds
    buffer_load_dwordx4 v9, s[12:15], s91 offen offset:3072  lds
    s_add_u32 m0, s97, 139264
    s_add_u32 s91, s91, 128
    buffer_load_dwordx4 v2, s[20:23], s92 offen offset:0  lds
    buffer_load_dwordx4 v3, s[20:23], s92 offen offset:1024  lds
    buffer_load_dwordx4 v4, s[20:23], s92 offen offset:2048  lds
    buffer_load_dwordx4 v5, s[20:23], s92 offen offset:3072  lds
    s_add_u32 s92, s92, 128
    s_cmp_lg_u32 s83, 0
    s_cbranch_scc1 L_gated_mix__ssm_conv_s5__dense_activation_squared_relu__prompt_kernel_c2_0
    v_mul_f32 v71, 0x41800000, v68
    v_mul_f32 v72, 0x41800000, v69
    v_exp_f32 v71, v71
    v_fract_f32 v72, v72
    s_nop 0
    v_cos_f32 v74, v72
    v_sin_f32 v75, v72
    s_nop 0
    v_mul_f32 v74, v74, v71
    v_mul_f32 v75, v75, v71
    ds_write_b64 v70, v[74:75] offset:3072
L_gated_mix__ssm_conv_s5__dense_activation_squared_relu__prompt_kernel_c2_0:
    s_cmp_lg_u32 s83, 1
    s_cbranch_scc1 L_gated_mix__ssm_conv_s5__dense_activation_squared_relu__prompt_kernel_c2_1
    v_mul_f32 v71, 0x42400000, v68
    v_mul_f32 v72, 0x42400000, v69
    v_exp_f32 v71, v71
    v_fract_f32 v72, v72
    s_nop 0
    v_cos_f32 v74, v72
    v_sin_f32 v75, v72
    s_nop 0
    v_mul_f32 v74, v74, v71
    v_mul_f32 v75, v75, v71
    ds_write_b64 v70, v[74:75] offset:4096
L_gated_mix__ssm_conv_s5__dense_activation_squared_relu__prompt_kernel_c2_1:
    s_cmp_lg_u32 s83, 2
    s_cbranch_scc1 L_gated_mix__ssm_conv_s5__dense_activation_squared_relu__prompt_kernel_c2_2
    v_mul_f32 v71, 0x42a00000, v68
    v_mul_f32 v72, 0x42a00000, v69
    v_exp_f32 v71, v71
    v_fract_f32 v72, v72
    s_nop 0
    v_cos_f32 v74, v72
    v_sin_f32 v75, v72
    s_nop 0
    v_mul_f32 v74, v74, v71
    v_mul_f32 v75, v75, v71
    ds_write_b64 v70, v[74:75] offset:5120
L_gated_mix__ssm_conv_s5__dense_activation_squared_relu__prompt_kernel_c2_2:
    s_cmp_lg_u32 s83, 3
    s_cbranch_scc1 L_gated_mix__ssm_conv_s5__dense_activation_squared_relu__prompt_kernel_c2_3
    v_mul_f32 v71, 0x42e00000, v68
    v_mul_f32 v72, 0x42e00000, v69
    v_exp_f32 v71, v71
    v_fract_f32 v72, v72
    s_nop 0
    v_cos_f32 v74, v72
    v_sin_f32 v75, v72
    s_nop 0
    v_mul_f32 v74, v74, v71
    v_mul_f32 v75, v75, v71
    ds_write_b64 v70, v[74:75] offset:6144
L_gated_mix__ssm_conv_s5__dense_activation_squared_relu__prompt_kernel_c2_3:
    s_waitcnt vmcnt(16)
    s_barrier
    s_add_u32 m0, s97, 45056
    s_nop 0
    buffer_load_dwordx4 v6, s[12:15], s91 offen offset:0  lds
    buffer_load_dwordx4 v7, s[12:15], s91 offen offset:1024  lds
    buffer_load_dwordx4 v8, s[12:15], s91 offen offset:2048  lds
    buffer_load_dwordx4 v9, s[12:15], s91 offen offset:3072  lds
    s_add_u32 m0, s97, 61440
    s_add_u32 s91, s91, 128
    buffer_load_dwordx4 v2, s[20:23], s92 offen offset:0  lds
    buffer_load_dwordx4 v3, s[20:23], s92 offen offset:1024  lds
    buffer_load_dwordx4 v4, s[20:23], s92 offen offset:2048  lds
    buffer_load_dwordx4 v5, s[20:23], s92 offen offset:3072  lds
    s_add_u32 s92, s92, 128
    s_cmp_lg_u32 s83, 0
    s_cbranch_scc1 L_gated_mix__ssm_conv_s5__dense_activation_squared_relu__prompt_kernel_c3_0
    v_add_f32 v76, -1.0, v82
    v_mul_f32 v77, v56, v56
    v_fmac_f32 v77, v57, v57
    v_rcp_f32 v77, v77
    v_mul_f32 v78, v76, v56
    v_fmac_f32 v78, v83, v57
    v_mul_f32 v79, v83, v56
    v_mul_f32 v80, v76, v57
    v_sub_f32 v79, v79, v80
    v_mul_f32 v78, v78, v77
    v_mul_f32 v79, v79, v77
    ds_write_b64 v70, v[78:79] offset:2048
L_gated_mix__ssm_conv_s5__dense_activation_squared_relu__prompt_kernel_c3_0:
    s_cmp_lg_u32 s83, 1
    s_cbranch_scc1 L_gated_mix__ssm_conv_s5__dense_activation_squared_relu__prompt_kernel_c3_1
    v_mul_f32 v71, 0x44000000, v68
    v_mul_f32 v72, 0x44000000, v69
    v_exp_f32 v71, v71
    v_fract_f32 v72, v72
    s_nop 0
    v_cos_f32 v74, v72
    v_sin_f32 v75, v72
    s_nop 0
    v_mul_f32 v74, v74, v71
    v_mul_f32 v75, v75, v71
    ds_write_b64 v70, v[74:75] offset:6656
L_gated_mix__ssm_conv_s5__dense_activation_squared_relu__prompt_kernel_c3_1:
    s_cmp_lg_u32 s83, 2
    s_cbranch_scc1 L_gated_mix__ssm_conv_s5__dense_activation_squared_relu__prompt_kernel_c3_2
    v_mul_f32 v71, 0x44800000, v68
    v_mul_f32 v72, 0x44800000, v69
    v_exp_f32 v71, v71
    v_fract_f32 v72, v72
    s_nop 0
    v_cos_f32 v74, v72
    v_sin_f32 v75, v72
    s_nop 0
    v_mul_f32 v74, v74, v71
    v_mul_f32 v75, v75, v71
    ds_write_b64 v70, v[74:75] offset:7168
L_gated_mix__ssm_conv_s5__dense_activation_squared_relu__prompt_kernel_c3_2:
    s_cmp_lg_u32 s83, 3
    s_cbranch_scc1 L_gated_mix__ssm_conv_s5__dense_activation_squared_relu__prompt_kernel_c3_3
    v_mul_f32 v71, 0x44c00000, v68
    v_mul_f32 v72, 0x44c00000, v69
    v_exp_f32 v71, v71
    v_fract_f32 v72, v72
    s_nop 0
    v_cos_f32 v74, v72
    v_sin_f32 v75, v72
    s_nop 0
    v_mul_f32 v74, v74, v71
    v_mul_f32 v75, v75, v71
    ds_write_b64 v70, v[74:75] offset:7680
L_gated_mix__ssm_conv_s5__dense_activation_squared_relu__prompt_kernel_c3_3:
    s_waitcnt lgkmcnt(0)
    s_waitcnt vmcnt(16)
    s_barrier
    s_add_u32 m0, s97, 90112
    s_nop 0
    buffer_load_dwordx4 v6, s[12:15], s91 offen offset:0  lds
    buffer_load_dwordx4 v7, s[12:15], s91 offen offset:1024  lds
    buffer_load_dwordx4 v8, s[12:15], s91 offen offset:2048  lds
    buffer_load_dwordx4 v9, s[12:15], s91 offen offset:3072  lds
    s_add_u32 m0, s97, 106496
    s_add_u32 s91, s91, 128
    buffer_load_dwordx4 v2, s[20:23], s92 offen offset:0  lds
    buffer_load_dwordx4 v3, s[20:23], s92 offen offset:1024  lds
    buffer_load_dwordx4 v4, s[20:23], s92 offen offset:2048  lds
    buffer_load_dwordx4 v5, s[20:23], s92 offen offset:3072  lds
    s_add_u32 s92, s92, 128
    s_waitcnt vmcnt(16)
    s_barrier
    s_add_u32 m0, s97, 0
    s_nop 0
    buffer_load_dwordx4 v6, s[12:15], s91 offen offset:0  lds
    buffer_load_dwordx4 v7, s[12:15], s91 offen offset:1024  lds
    buffer_load_dwordx4 v8, s[12:15], s91 offen offset:2048  lds
    buffer_load_dwordx4 v9, s[12:15], s91 offen offset:3072  lds
    s_add_u32 m0, s97, 16384
    s_add_u32 s91, s91, 128
    buffer_load_dwordx4 v2, s[20:23], s92 offen offset:0  lds
    buffer_load_dwordx4 v3, s[20:23], s92 offen offset:1024  lds
    buffer_load_dwordx4 v4, s[20:23], s92 offen offset:2048  lds
    buffer_load_dwordx4 v5, s[20:23], s92 offen offset:3072  lds
    s_add_u32 s92, s92, 128
    s_waitcnt vmcnt(16)
    s_barrier
    s_add_u32 m0, s97, 122880
    s_nop 0
    buffer_load_dwordx4 v6, s[12:15], s91 offen offset:0  lds
    buffer_load_dwordx4 v7, s[12:15], s91 offen offset:1024  lds
    buffer_load_dwordx4 v8, s[12:15], s91 offen offset:2048  lds
    buffer_load_dwordx4 v9, s[12:15], s91 offen offset:3072  lds
    s_add_u32 m0, s97, 139264
    s_add_u32 s91, s91, 128
    buffer_load_dwordx4 v2, s[20:23], s92 offen offset:0  lds
    buffer_load_dwordx4 v3, s[20:23], s92 offen offset:1024  lds
    buffer_load_dwordx4 v4, s[20:23], s92 offen offset:2048  lds
    buffer_load_dwordx4 v5, s[20:23], s92 offen offset:3072  lds
    s_add_u32 s92, s92, 128
    s_waitcnt vmcnt(16)
    s_barrier
    s_cmp_lg_u32 s83, 0
    s_cbranch_scc1 L_gated_mix__ssm_conv_s5__dense_activation_squared_relu__prompt_kernel_sf0
    s_lshl_b32 s85, s80, 1
    s_add_u32 s85, s85, s82
    s_lshl_b32 s85, s85, 7
    s_lshl_b32 s86, s81, 2
    s_add_u32 s85, s85, s86
    s_add_u32 s85, s85, 34603008
    v_mov_b32 v84, s99
    v_mov_b32 v85, 0
    s_mov_b64 exec, 1
    buffer_store_dword v84, v85, s[8:11], s85 offen sc1
    s_mov_b64 exec, -1
L_gated_mix__ssm_conv_s5__dense_activation_squared_relu__prompt_kernel_sf0:
    s_mul_i32 s89, s81, 7
    s_add_u32 s89, s89, 1
    s_lshr_b32 s89, s89, 1
    s_lshl_b32 s85, s89, 14
    s_add_u32 s93, s93, s85
    s_lshl_b32 s85, s89, 17
    s_add_u32 s94, s94, s85
    s_add_u32 m0, s97, 45056
    s_nop 0
    buffer_load_dwordx4 v17, s[8:11], s93 offen offset:0 sc1 lds
    buffer_load_dwordx4 v17, s[8:11], s93 offen offset:1024 sc1 lds
    buffer_load_dwordx4 v17, s[8:11], s93 offen offset:2048 sc1 lds
    buffer_load_dwordx4 v17, s[8:11], s93 offen offset:3072 sc1 lds
    s_add_u32 m0, s97, 61440
    s_add_u32 s93, s93, 16384
    buffer_load_dwordx4 v18, s[24:27], s94 offen offset:0  lds
    buffer_load_dwordx4 v19, s[24:27], s94 offen offset:1024  lds
    buffer_load_dwordx4 v24, s[24:27], s94 offen offset:2048  lds
    buffer_load_dwordx4 v25, s[24:27], s94 offen offset:3072  lds
    s_add_u32 s94, s94, 131072
    s_add_u32 s89, s89, 1
    s_cmp_eq_u32 s89, 28
    s_cselect_b32 s85, 458752, 0
    s_cselect_b32 s86, 3670016, 0
    s_cselect_b32 s89, 0, s89
    s_sub_u32 s93, s93, s85
    s_sub_u32 s94, s94, s86
    s_waitcnt vmcnt(16)
    s_barrier
    s_add_u32 m0, s97, 90112
    s_nop 0
    buffer_load_dwordx4 v17, s[8:11], s93 offen offset:0 sc1 lds
    buffer_load_dwordx4 v17, s[8:11], s93 offen offset:1024 sc1 lds
    buffer_load_dwordx4 v17, s[8:11], s93 offen offset:2048 sc1 lds
    buffer_load_dwordx4 v17, s[8:11], s93 offen offset:3072 sc1 lds
    s_add_u32 m0, s97, 106496
    s_add_u32 s93, s93, 16384
    buffer_load_dwordx4 v18, s[24:27], s94 offen offset:0  lds
    buffer_load_dwordx4 v19, s[24:27], s94 offen offset:1024  lds
    buffer_load_dwordx4 v24, s[24:27], s94 offen offset:2048  lds
    buffer_load_dwordx4 v25, s[24:27], s94 offen offset:3072  lds
    s_add_u32 s94, s94, 131072
    s_add_u32 s89, s89, 1
    s_cmp_eq_u32 s89, 28
    s_cselect_b32 s85, 458752, 0
    s_cselect_b32 s86, 3670016, 0
    s_cselect_b32 s89, 0, s89
    s_sub_u32 s93, s93, s85
    s_sub_u32 s94, s94, s86
    s_waitcnt vmcnt(16)
    s_barrier
    s_add_u32 m0, s97, 0
    s_nop 0
    buffer_load_dwordx4 v17, s[8:11], s93 offen offset:0 sc1 lds
    buffer_load_dwordx4 v17, s[8:11], s93 offen offset:1024 sc1 lds
    buffer_load_dwordx4 v17, s[8:11], s93 offen offset:2048 sc1 lds
    buffer_load_dwordx4 v17, s[8:11], s93 offen offset:3072 sc1 lds
    s_add_u32 m0, s97, 16384
    s_add_u32 s93, s93, 16384
    buffer_load_dwordx4 v18, s[24:27], s94 offen offset:0  lds
    buffer_load_dwordx4 v19, s[24:27], s94 offen offset:1024  lds
    buffer_load_dwordx4 v24, s[24:27], s94 offen offset:2048  lds
    buffer_load_dwordx4 v25, s[24:27], s94 offen offset:3072  lds
    s_add_u32 s94, s94, 131072
    s_add_u32 s89, s89, 1
    s_cmp_eq_u32 s89, 28
    s_cselect_b32 s85, 458752, 0
    s_cselect_b32 s86, 3670016, 0
    s_cselect_b32 s89, 0, s89
    s_sub_u32 s93, s93, s85
    s_sub_u32 s94, s94, s86
    s_lshl_b32 s85, s80, 1
    s_add_u32 s85, s85, s82
    s_lshl_b32 s85, s85, 7
    s_add_u32 s85, s85, 34603008
    v_and_b32 v85, 7, v0
    v_lshlrev_b32 v85, 2, v85
    buffer_load_dword v84, v85, s[8:11], s85 offen sc1
    s_barrier
    v_and_b32 v86, 7, v0
    v_subrev_u32 v86, s81, v86
    v_and_b32 v86, 7, v86
    v_cmp_ge_u32 s[62:63], 1, v86
    s_waitcnt vmcnt(0)
    s_mov_b32 s6, 262144
L_gated_mix__ssm_conv_s5__dense_activation_squared_relu__prompt_kernel_pc0pollB1:
    v_cmp_ne_u32 vcc, s99, v84
    s_nop 1
    s_and_b64 vcc, vcc, s[62:63]
    s_cmp_eq_u64 vcc, 0
    s_cbranch_scc1 L_gated_mix__ssm_conv_s5__dense_activation_squared_relu__prompt_kernel_pc0pollB1_ok
    s_sub_u32 s6, s6, 1
    s_cbranch_scc1 L_gated_mix__ssm_conv_s5__dense_activation_squared_relu__prompt_kernel_pc0pollB1_ok
    s_sleep 1
    s_lshl_b32 s85, s80, 1
    s_add_u32 s85, s85, s82
    s_lshl_b32 s85, s85, 7
    s_add_u32 s85, s85, 34603008
    buffer_load_dword v84, v85, s[8:11], s85 offen sc1
    s_waitcnt vmcnt(0)
    s_branch L_gated_mix__ssm_conv_s5__dense_activation_squared_relu__prompt_kernel_pc0pollB1
L_gated_mix__ssm_conv_s5__dense_activation_squared_relu__prompt_kernel_pc0pollB1_ok:
    s_add_u32 m0, s97, 122880
    s_nop 0
    buffer_load_dwordx4 v17, s[8:11], s93 offen offset:0 sc1 lds
    buffer_load_dwordx4 v17, s[8:11], s93 offen offset:1024 sc1 lds
    buffer_load_dwordx4 v17, s[8:11], s93 offen offset:2048 sc1 lds
    buffer_load_dwordx4 v17, s[8:11], s93 offen offset:3072 sc1 lds
    s_add_u32 m0, s97, 139264
    s_add_u32 s93, s93, 16384
    buffer_load_dwordx4 v18, s[24:27], s94 offen offset:0  lds
    buffer_load_dwordx4 v19, s[24:27], s94 offen offset:1024  lds
    buffer_load_dwordx4 v24, s[24:27], s94 offen offset:2048  lds
    buffer_load_dwordx4 v25, s[24:27], s94 offen offset:3072  lds
    s_add_u32 s94, s94, 131072
    s_add_u32 s89, s89, 1
    s_cmp_eq_u32 s89, 28
    s_cselect_b32 s85, 458752, 0
    s_cselect_b32 s86, 3670016, 0
    s_cselect_b32 s89, 0, s89
    s_sub_u32 s93, s93, s85
    s_sub_u32 s94, s94, s86
    s_lshl_b32 s85, s80, 1
    s_add_u32 s85, s85, s82
    s_lshl_b32 s85, s85, 7
    s_add_u32 s85, s85, 34603008
    v_and_b32 v85, 7, v0
    v_lshlrev_b32 v85, 2, v85
    buffer_load_dword v84, v85, s[8:11], s85 offen sc1
    s_waitcnt vmcnt(26)
    s_barrier
    s_waitcnt vmcnt(18)
    s_barrier
    s_add_u32 m0, s97, 45056
    s_nop 0
    buffer_load_dwordx4 v17, s[8:11], s93 offen offset:0 sc1 lds
    buffer_load_dwordx4 v17, s[8:11], s93 offen offset:1024 sc1 lds
    buffer_load_dwordx4 v17, s[8:11], s93 offen offset:2048 sc1 lds
    buffer_load_dwordx4 v17, s[8:11], s93 offen offset:3072 sc1 lds
    s_add_u32 m0, s97, 61440
    s_add_u32 s93, s93, 16384
    buffer_load_dwordx4 v18, s[24:27], s94 offen offset:0  lds
    buffer_load_dwordx4 v19, s[24:27], s94 offen offset:1024  lds
    buffer_load_dwordx4 v24, s[24:27], s94 offen offset:2048  lds
    buffer_load_dwordx4 v25, s[24:27], s94 offen offset:3072  lds
    s_add_u32 s94, s94, 131072
    s_add_u32 s89, s89, 1
    s_cmp_eq_u32 s89, 28
    s_cselect_b32 s85, 458752, 0
    s_cselect_b32 s86, 3670016, 0
    s_cselect_b32 s89, 0, s89
    s_sub_u32 s93, s93, s85
    s_sub_u32 s94, s94, s86
    s_waitcnt vmcnt(18)
    s_barrier
    s_add_u32 m0, s97, 90112
    s_nop 0
    buffer_load_dwordx4 v17, s[8:11], s93 offen offset:0 sc1 lds
    buffer_load_dwordx4 v17, s[8:11], s93 offen offset:1024 sc1 lds
    buffer_load_dwordx4 v17, s[8:11], s93 offen offset:2048 sc1 lds
    buffer_load_dwordx4 v17, s[8:11], s93 offen offset:3072 sc1 lds
    s_add_u32 m0, s97, 106496
    s_add_u32 s93, s93, 16384
    buffer_load_dwordx4 v18, s[24:27], s94 offen offset:0  lds
    buffer_load_dwordx4 v19, s[24:27], s94 offen offset:1024  lds
    buffer_load_dwordx4 v24, s[24:27], s94 offen offset:2048  lds
    buffer_load_dwordx4 v25, s[24:27], s94 offen offset:3072  lds
    s_add_u32 s94, s94, 131072
    s_add_u32 s89, s89, 1
    s_cmp_eq_u32 s89, 28
    s_cselect_b32 s85, 458752, 0
    s_cselect_b32 s86, 3670016, 0
    s_cselect_b32 s89, 0, s89
    s_sub_u32 s93, s93, s85
    s_sub_u32 s94, s94, s86
    s_waitcnt vmcnt(17)
    s_barrier
    v_and_b32 v86, 7, v0
    v_subrev_u32 v86, s81, v86
    v_and_b32 v86, 7, v86
    v_cmp_ge_u32 s[62:63], 7, v86
    s_waitcnt vmcnt(16)
    s_mov_b32 s6, 262144
L_gated_mix__ssm_conv_s5__dense_activation_squared_relu__prompt_kernel_pc0pollB:
    v_cmp_ne_u32 vcc, s99, v84
    s_nop 1
    s_and_b64 vcc, vcc, s[62:63]
    s_cmp_eq_u64 vcc, 0
    s_cbranch_scc1 L_gated_mix__ssm_conv_s5__dense_activation_squared_relu__prompt_kernel_pc0pollB_ok
    s_sub_u32 s6, s6, 1
    s_cbranch_scc1 L_gated_mix__ssm_conv_s5__dense_activation_squared_relu__prompt_kernel_pc0pollB_ok
    s_sleep 1
    s_lshl_b32 s85, s80, 1
    s_add_u32 s85, s85, s82
    s_lshl_b32 s85, s85, 7
    s_add_u32 s85, s85, 34603008
    buffer_load_dword v84, v85, s[8:11], s85 offen sc1
    s_waitcnt vmcnt(0)
    s_branch L_gated_mix__ssm_conv_s5__dense_activation_squared_relu__prompt_kernel_pc0pollB
L_gated_mix__ssm_conv_s5__dense_activation_squared_relu__prompt_kernel_pc0pollB_ok:
    s_add_u32 m0, s97, 0
    s_nop 0
    buffer_load_dwordx4 v17, s[8:11], s93 offen offset:0 sc1 lds
    buffer_load_dwordx4 v17, s[8:11], s93 offen offset:1024 sc1 lds
    buffer_load_dwordx4 v17, s[8:11], s93 offen offset:2048 sc1 lds
    buffer_load_dwordx4 v17, s[8:11], s93 offen offset:3072 sc1 lds
    s_add_u32 m0, s97, 16384
    s_add_u32 s93, s93, 16384
    buffer_load_dwordx4 v18, s[24:27], s94 offen offset:0  lds
    buffer_load_dwordx4 v19, s[24:27], s94 offen offset:1024  lds
    buffer_load_dwordx4 v24, s[24:27], s94 offen offset:2048  lds
    buffer_load_dwordx4 v25, s[24:27], s94 offen offset:3072  lds
    s_add_u32 s94, s94, 131072
    s_add_u32 s89, s89, 1
    s_cmp_eq_u32 s89, 28
    s_cselect_b32 s85, 458752, 0
    s_cselect_b32 s86, 3670016, 0
    s_cselect_b32 s89, 0, s89
    s_sub_u32 s93, s93, s85
    s_sub_u32 s94, s94, s86
    s_waitcnt vmcnt(16)
    s_barrier
    s_add_u32 m0, s97, 122880
    s_nop 0
    buffer_load_dwordx4 v17, s[8:11], s93 offen offset:0 sc1 lds
    buffer_load_dwordx4 v17, s[8:11], s93 offen offset:1024 sc1 lds
    buffer_load_dwordx4 v17, s[8:11], s93 offen offset:2048 sc1 lds
    buffer_load_dwordx4 v17, s[8:11], s93 offen offset:3072 sc1 lds
    s_add_u32 m0, s97, 139264
    s_add_u32 s93, s93, 16384
    buffer_load_dwordx4 v18, s[24:27], s94 offen offset:0  lds
    buffer_load_dwordx4 v19, s[24:27], s94 offen offset:1024  lds
    buffer_load_dwordx4 v24, s[24:27], s94 offen offset:2048  lds
    buffer_load_dwordx4 v25, s[24:27], s94 offen offset:3072  lds
    s_add_u32 s94, s94, 131072
    s_add_u32 s89, s89, 1
    s_cmp_eq_u32 s89, 28
    s_cselect_b32 s85, 458752, 0
    s_cselect_b32 s86, 3670016, 0
    s_cselect_b32 s89, 0, s89
    s_sub_u32 s93, s93, s85
    s_sub_u32 s94, s94, s86
    s_waitcnt vmcnt(16)
    s_barrier
    s_add_u32 m0, s97, 45056
    s_nop 0
    buffer_load_dwordx4 v17, s[8:11], s93 offen offset:0 sc1 lds
    buffer_load_dwordx4 v17, s[8:11], s93 offen offset:1024 sc1 lds
    buffer_load_dwordx4 v17, s[8:11], s93 offen offset:2048 sc1 lds
    buffer_load_dwordx4 v17, s[8:11], s93 offen offset:3072 sc1 lds
    s_add_u32 m0, s97, 61440
    s_add_u32 s93, s93, 16384
    buffer_load_dwordx4 v18, s[24:27], s94 offen offset:0  lds
    buffer_load_dwordx4 v19, s[24:27], s94 offen offset:1024  lds
    buffer_load_dwordx4 v24, s[24:27], s94 offen offset:2048  lds
    buffer_load_dwordx4 v25, s[24:27], s94 offen offset:3072  lds
    s_add_u32 s94, s94, 131072
    s_add_u32 s89, s89, 1
    s_cmp_eq_u32 s89, 28
    s_cselect_b32 s85, 458752, 0
    s_cselect_b32 s86, 3670016, 0
    s_cselect_b32 s89, 0, s89
    s_sub_u32 s93, s93, s85
    s_sub_u32 s94, s94, s86
    s_waitcnt vmcnt(16)
    s_barrier
    s_add_u32 m0, s97, 90112
    s_nop 0
    buffer_load_dwordx4 v17, s[8:11], s93 offen offset:0 sc1 lds
    buffer_load_dwordx4 v17, s[8:11], s93 offen offset:1024 sc1 lds
    buffer_load_dwordx4 v17, s[8:11], s93 offen offset:2048 sc1 lds
    buffer_load_dwordx4 v17, s[8:11], s93 offen offset:3072 sc1 lds
    s_add_u32 m0, s97, 106496
    s_add_u32 s93, s93, 16384
    buffer_load_dwordx4 v18, s[24:27], s94 offen offset:0  lds
    buffer_load_dwordx4 v19, s[24:27], s94 offen offset:1024  lds
    buffer_load_dwordx4 v24, s[24:27], s94 offen offset:2048  lds
    buffer_load_dwordx4 v25, s[24:27], s94 offen offset:3072  lds
    s_add_u32 s94, s94, 131072
    s_add_u32 s89, s89, 1
    s_cmp_eq_u32 s89, 28
    s_cselect_b32 s85, 458752, 0
    s_cselect_b32 s86, 3670016, 0
    s_cselect_b32 s89, 0, s89
    s_sub_u32 s93, s93, s85
    s_sub_u32 s94, s94, s86
    s_waitcnt vmcnt(16)
    s_barrier
    s_add_u32 m0, s97, 0
    s_nop 0
    buffer_load_dwordx4 v17, s[8:11], s93 offen offset:0 sc1 lds
    buffer_load_dwordx4 v17, s[8:11], s93 offen offset:1024 sc1 lds
    buffer_load_dwordx4 v17, s[8:11], s93 offen offset:2048 sc1 lds
    buffer_load_dwordx4 v17, s[8:11], s93 offen offset:3072 sc1 lds
    s_add_u32 m0, s97, 16384
    s_add_u32 s93, s93, 16384
    buffer_load_dwordx4 v18, s[24:27], s94 offen offset:0  lds
    buffer_load_dwordx4 v19, s[24:27], s94 offen offset:1024  lds
    buffer_load_dwordx4 v24, s[24:27], s94 offen offset:2048  lds
    buffer_load_dwordx4 v25, s[24:27], s94 offen offset:3072  lds
    s_add_u32 s94, s94, 131072
    s_add_u32 s89, s89, 1
    s_cmp_eq_u32 s89, 28
    s_cselect_b32 s85, 458752, 0
    s_cselect_b32 s86, 3670016, 0
    s_cselect_b32 s89, 0, s89
    s_sub_u32 s93, s93, s85
    s_sub_u32 s94, s94, s86
    s_waitcnt vmcnt(16)
    s_barrier
    s_add_u32 m0, s97, 122880
    s_nop 0
    buffer_load_dwordx4 v17, s[8:11], s93 offen offset:0 sc1 lds
    buffer_load_dwordx4 v17, s[8:11], s93 offen offset:1024 sc1 lds
    buffer_load_dwordx4 v17, s[8:11], s93 offen offset:2048 sc1 lds
    buffer_load_dwordx4 v17, s[8:11], s93 offen offset:3072 sc1 lds
    s_add_u32 m0, s97, 139264
    s_add_u32 s93, s93, 16384
    buffer_load_dwordx4 v18, s[24:27], s94 offen offset:0  lds
    buffer_load_dwordx4 v19, s[24:27], s94 offen offset:1024  lds
    buffer_load_dwordx4 v24, s[24:27], s94 offen offset:2048  lds
    buffer_load_dwordx4 v25, s[24:27], s94 offen offset:3072  lds
    s_add_u32 s94, s94, 131072
    s_add_u32 s89, s89, 1
    s_cmp_eq_u32 s89, 28
    s_cselect_b32 s85, 458752, 0
    s_cselect_b32 s86, 3670016, 0
    s_cselect_b32 s89, 0, s89
    s_sub_u32 s93, s93, s85
    s_sub_u32 s94, s94, s86
    s_waitcnt vmcnt(16)
    s_barrier
    s_add_u32 m0, s97, 45056
    s_nop 0
    buffer_load_dwordx4 v17, s[8:11], s93 offen offset:0 sc1 lds
    buffer_load_dwordx4 v17, s[8:11], s93 offen offset:1024 sc1 lds
    buffer_load_dwordx4 v17, s[8:11], s93 offen offset:2048 sc1 lds
    buffer_load_dwordx4 v17, s[8:11], s93 offen offset:3072 sc1 lds
    s_add_u32 m0, s97, 61440
    s_add_u32 s93, s93, 16384
    buffer_load_dwordx4 v18, s[24:27], s94 offen offset:0  lds
    buffer_load_dwordx4 v19, s[24:27], s94 offen offset:1024  lds
    buffer_load_dwordx4 v24, s[24:27], s94 offen offset:2048  lds
    buffer_load_dwordx4 v25, s[24:27], s94 offen offset:3072  lds
    s_add_u32 s94, s94, 131072
    s_add_u32 s89, s89, 1
    s_cmp_eq_u32 s89, 28
    s_cselect_b32 s85, 458752, 0
    s_cselect_b32 s86, 3670016, 0
    s_cselect_b32 s89, 0, s89
    s_sub_u32 s93, s93, s85
    s_sub_u32 s94, s94, s86
    s_waitcnt vmcnt(16)
    s_barrier
    s_add_u32 m0, s97, 90112
    s_nop 0
    buffer_load_dwordx4 v17, s[8:11], s93 offen offset:0 sc1 lds
    buffer_load_dwordx4 v17, s[8:11], s93 offen offset:1024 sc1 lds
    buffer_load_dwordx4 v17, s[8:11], s93 offen offset:2048 sc1 lds
    buffer_load_dwordx4 v17, s[8:11], s93 offen offset:3072 sc1 lds
    s_add_u32 m0, s97, 106496
    s_add_u32 s93, s93, 16384
    buffer_load_dwordx4 v18, s[24:27], s94 offen offset:0  lds
    buffer_load_dwordx4 v19, s[24:27], s94 offen offset:1024  lds
    buffer_load_dwordx4 v24, s[24:27], s94 offen offset:2048  lds
    buffer_load_dwordx4 v25, s[24:27], s94 offen offset:3072  lds
    s_add_u32 s94, s94, 131072
    s_add_u32 s89, s89, 1
    s_cmp_eq_u32 s89, 28
    s_cselect_b32 s85, 458752, 0
    s_cselect_b32 s86, 3670016, 0
    s_cselect_b32 s89, 0, s89
    s_sub_u32 s93, s93, s85
    s_sub_u32 s94, s94, s86
    s_waitcnt vmcnt(16)
    s_barrier
    s_add_u32 m0, s97, 0
    s_nop 0
    buffer_load_dwordx4 v17, s[8:11], s93 offen offset:0 sc1 lds
    buffer_load_dwordx4 v17, s[8:11], s93 offen offset:1024 sc1 lds
    buffer_load_dwordx4 v17, s[8:11], s93 offen offset:2048 sc1 lds
    buffer_load_dwordx4 v17, s[8:11], s93 offen offset:3072 sc1 lds
    s_add_u32 m0, s97, 16384
    s_add_u32 s93, s93, 16384
    buffer_load_dwordx4 v18, s[24:27], s94 offen offset:0  lds
    buffer_load_dwordx4 v19, s[24:27], s94 offen offset:1024  lds
    buffer_load_dwordx4 v24, s[24:27], s94 offen offset:2048  lds
    buffer_load_dwordx4 v25, s[24:27], s94 offen offset:3072  lds
    s_add_u32 s94, s94, 131072
    s_add_u32 s89, s89, 1
    s_cmp_eq_u32 s89, 28
    s_cselect_b32 s85, 458752, 0
    s_cselect_b32 s86, 3670016, 0
    s_cselect_b32 s89, 0, s89
    s_sub_u32 s93, s93, s85
    s_sub_u32 s94, s94, s86
    s_waitcnt vmcnt(16)
    s_barrier
    s_add_u32 m0, s97, 122880
    s_nop 0
    buffer_load_dwordx4 v17, s[8:11], s93 offen offset:0 sc1 lds
    buffer_load_dwordx4 v17, s[8:11], s93 offen offset:1024 sc1 lds
    buffer_load_dwordx4 v17, s[8:11], s93 offen offset:2048 sc1 lds
    buffer_load_dwordx4 v17, s[8:11], s93 offen offset:3072 sc1 lds
    s_add_u32 m0, s97, 139264
    s_add_u32 s93, s93, 16384
    buffer_load_dwordx4 v18, s[24:27], s94 offen offset:0  lds
    buffer_load_dwordx4 v19, s[24:27], s94 offen offset:1024  lds
    buffer_load_dwordx4 v24, s[24:27], s94 offen offset:2048  lds
    buffer_load_dwordx4 v25, s[24:27], s94 offen offset:3072  lds
    s_add_u32 s94, s94, 131072
    s_add_u32 s89, s89, 1
    s_cmp_eq_u32 s89, 28
    s_cselect_b32 s85, 458752, 0
    s_cselect_b32 s86, 3670016, 0
    s_cselect_b32 s89, 0, s89
    s_sub_u32 s93, s93, s85
    s_sub_u32 s94, s94, s86
    s_waitcnt vmcnt(16)
    s_barrier
    s_add_u32 m0, s97, 45056
    s_nop 0
    buffer_load_dwordx4 v17, s[8:11], s93 offen offset:0 sc1 lds
    buffer_load_dwordx4 v17, s[8:11], s93 offen offset:1024 sc1 lds
    buffer_load_dwordx4 v17, s[8:11], s93 offen offset:2048 sc1 lds
    buffer_load_dwordx4 v17, s[8:11], s93 offen offset:3072 sc1 lds
    s_add_u32 m0, s97, 61440
    s_add_u32 s93, s93, 16384
    buffer_load_dwordx4 v18, s[24:27], s94 offen offset:0  lds
    buffer_load_dwordx4 v19, s[24:27], s94 offen offset:1024  lds
    buffer_load_dwordx4 v24, s[24:27], s94 offen offset:2048  lds
    buffer_load_dwordx4 v25, s[24:27], s94 offen offset:3072  lds
    s_add_u32 s94, s94, 131072
    s_add_u32 s89, s89, 1
    s_cmp_eq_u32 s89, 28
    s_cselect_b32 s85, 458752, 0
    s_cselect_b32 s86, 3670016, 0
    s_cselect_b32 s89, 0, s89
    s_sub_u32 s93, s93, s85
    s_sub_u32 s94, s94, s86
    s_waitcnt vmcnt(16)
    s_barrier
    s_add_u32 m0, s97, 90112
    s_nop 0
    buffer_load_dwordx4 v17, s[8:11], s93 offen offset:0 sc1 lds
    buffer_load_dwordx4 v17, s[8:11], s93 offen offset:1024 sc1 lds
    buffer_load_dwordx4 v17, s[8:11], s93 offen offset:2048 sc1 lds
    buffer_load_dwordx4 v17, s[8:11], s93 offen offset:3072 sc1 lds
    s_add_u32 m0, s97, 106496
    s_add_u32 s93, s93, 16384
    buffer_load_dwordx4 v18, s[24:27], s94 offen offset:0  lds
    buffer_load_dwordx4 v19, s[24:27], s94 offen offset:1024  lds
    buffer_load_dwordx4 v24, s[24:27], s94 offen offset:2048  lds
    buffer_load_dwordx4 v25, s[24:27], s94 offen offset:3072  lds
    s_add_u32 s94, s94, 131072
    s_add_u32 s89, s89, 1
    s_cmp_eq_u32 s89, 28
    s_cselect_b32 s85, 458752, 0
    s_cselect_b32 s86, 3670016, 0
    s_cselect_b32 s89, 0, s89
    s_sub_u32 s93, s93, s85
    s_sub_u32 s94, s94, s86
    s_waitcnt vmcnt(16)
    s_barrier
    s_add_u32 m0, s97, 0
    s_nop 0
    buffer_load_dwordx4 v17, s[8:11], s93 offen offset:0 sc1 lds
    buffer_load_dwordx4 v17, s[8:11], s93 offen offset:1024 sc1 lds
    buffer_load_dwordx4 v17, s[8:11], s93 offen offset:2048 sc1 lds
    buffer_load_dwordx4 v17, s[8:11], s93 offen offset:3072 sc1 lds
    s_add_u32 m0, s97, 16384
    s_add_u32 s93, s93, 16384
    buffer_load_dwordx4 v18, s[24:27], s94 offen offset:0  lds
    buffer_load_dwordx4 v19, s[24:27], s94 offen offset:1024  lds
    buffer_load_dwordx4 v24, s[24:27], s94 offen offset:2048  lds
    buffer_load_dwordx4 v25, s[24:27], s94 offen offset:3072  lds
    s_add_u32 s94, s94, 131072
    s_add_u32 s89, s89, 1
    s_cmp_eq_u32 s89, 28
    s_cselect_b32 s85, 458752, 0
    s_cselect_b32 s86, 3670016, 0
    s_cselect_b32 s89, 0, s89
    s_sub_u32 s93, s93, s85
    s_sub_u32 s94, s94, s86
    s_waitcnt vmcnt(16)
    s_barrier
    s_add_u32 m0, s97, 122880
    s_nop 0
    buffer_load_dwordx4 v17, s[8:11], s93 offen offset:0 sc1 lds
    buffer_load_dwordx4 v17, s[8:11], s93 offen offset:1024 sc1 lds
    buffer_load_dwordx4 v17, s[8:11], s93 offen offset:2048 sc1 lds
    buffer_load_dwordx4 v17, s[8:11], s93 offen offset:3072 sc1 lds
    s_add_u32 m0, s97, 139264
    s_add_u32 s93, s93, 16384
    buffer_load_dwordx4 v18, s[24:27], s94 offen offset:0  lds
    buffer_load_dwordx4 v19, s[24:27], s94 offen offset:1024  lds
    buffer_load_dwordx4 v24, s[24:27], s94 offen offset:2048  lds
    buffer_load_dwordx4 v25, s[24:27], s94 offen offset:3072  lds
    s_add_u32 s94, s94, 131072
    s_add_u32 s89, s89, 1
    s_cmp_eq_u32 s89, 28
    s_cselect_b32 s85, 458752, 0
    s_cselect_b32 s86, 3670016, 0
    s_cselect_b32 s89, 0, s89
    s_sub_u32 s93, s93, s85
    s_sub_u32 s94, s94, s86
    s_waitcnt vmcnt(16)
    s_barrier
    s_add_u32 m0, s97, 45056
    s_nop 0
    buffer_load_dwordx4 v17, s[8:11], s93 offen offset:0 sc1 lds
    buffer_load_dwordx4 v17, s[8:11], s93 offen offset:1024 sc1 lds
    buffer_load_dwordx4 v17, s[8:11], s93 offen offset:2048 sc1 lds
    buffer_load_dwordx4 v17, s[8:11], s93 offen offset:3072 sc1 lds
    s_add_u32 m0, s97, 61440
    s_add_u32 s93, s93, 16384
    buffer_load_dwordx4 v18, s[24:27], s94 offen offset:0  lds
    buffer_load_dwordx4 v19, s[24:27], s94 offen offset:1024  lds
    buffer_load_dwordx4 v24, s[24:27], s94 offen offset:2048  lds
    buffer_load_dwordx4 v25, s[24:27], s94 offen offset:3072  lds
    s_add_u32 s94, s94, 131072
    s_add_u32 s89, s89, 1
    s_cmp_eq_u32 s89, 28
    s_cselect_b32 s85, 458752, 0
    s_cselect_b32 s86, 3670016, 0
    s_cselect_b32 s89, 0, s89
    s_sub_u32 s93, s93, s85
    s_sub_u32 s94, s94, s86
    s_waitcnt vmcnt(16)
    s_barrier
    s_add_u32 m0, s97, 90112
    s_nop 0
    buffer_load_dwordx4 v17, s[8:11], s93 offen offset:0 sc1 lds
    buffer_load_dwordx4 v17, s[8:11], s93 offen offset:1024 sc1 lds
    buffer_load_dwordx4 v17, s[8:11], s93 offen offset:2048 sc1 lds
    buffer_load_dwordx4 v17, s[8:11], s93 offen offset:3072 sc1 lds
    s_add_u32 m0, s97, 106496
    s_add_u32 s93, s93, 16384
    buffer_load_dwordx4 v18, s[24:27], s94 offen offset:0  lds
    buffer_load_dwordx4 v19, s[24:27], s94 offen offset:1024  lds
    buffer_load_dwordx4 v24, s[24:27], s94 offen offset:2048  lds
    buffer_load_dwordx4 v25, s[24:27], s94 offen offset:3072  lds
    s_add_u32 s94, s94, 131072
    s_add_u32 s89, s89, 1
    s_cmp_eq_u32 s89, 28
    s_cselect_b32 s85, 458752, 0
    s_cselect_b32 s86, 3670016, 0
    s_cselect_b32 s89, 0, s89
    s_sub_u32 s93, s93, s85
    s_sub_u32 s94, s94, s86
    s_waitcnt vmcnt(16)
    s_barrier
    s_add_u32 m0, s97, 0
    s_nop 0
    buffer_load_dwordx4 v17, s[8:11], s93 offen offset:0 sc1 lds
    buffer_load_dwordx4 v17, s[8:11], s93 offen offset:1024 sc1 lds
    buffer_load_dwordx4 v17, s[8:11], s93 offen offset:2048 sc1 lds
    buffer_load_dwordx4 v17, s[8:11], s93 offen offset:3072 sc1 lds
    s_add_u32 m0, s97, 16384
    s_add_u32 s93, s93, 16384
    buffer_load_dwordx4 v18, s[24:27], s94 offen offset:0  lds
    buffer_load_dwordx4 v19, s[24:27], s94 offen offset:1024  lds
    buffer_load_dwordx4 v24, s[24:27], s94 offen offset:2048  lds
    buffer_load_dwordx4 v25, s[24:27], s94 offen offset:3072  lds
    s_add_u32 s94, s94, 131072
    s_add_u32 s89, s89, 1
    s_cmp_eq_u32 s89, 28
    s_cselect_b32 s85, 458752, 0
    s_cselect_b32 s86, 3670016, 0
    s_cselect_b32 s89, 0, s89
    s_sub_u32 s93, s93, s85
    s_sub_u32 s94, s94, s86
    s_waitcnt vmcnt(16)
    s_barrier
    s_cmp_lg_u32 s83, 0
    s_cbranch_scc1 L_gated_mix__ssm_conv_s5__dense_activation_squared_relu__prompt_kernel_sf4096
    s_lshl_b32 s85, s80, 1
    s_add_u32 s85, s85, s82
    s_lshl_b32 s85, s85, 7
    s_lshl_b32 s86, s81, 2
    s_add_u32 s85, s85, s86
    s_add_u32 s85, s85, 34607104
    v_mov_b32 v84, s99
    v_mov_b32 v85, 0
    s_mov_b64 exec, 1
    buffer_store_dword v84, v85, s[8:11], s85 offen sc1
    s_mov_b64 exec, -1
L_gated_mix__ssm_conv_s5__dense_activation_squared_relu__prompt_kernel_sf4096:
    s_add_u32 m0, s97, 122880
    s_nop 0
    buffer_load_dwordx4 v17, s[8:11], s93 offen offset:0 sc1 lds
    buffer_load_dwordx4 v17, s[8:11], s93 offen offset:1024 sc1 lds
    buffer_load_dwordx4 v17, s[8:11], s93 offen offset:2048 sc1 lds
    buffer_load_dwordx4 v17, s[8:11], s93 offen offset:3072 sc1 lds
    s_add_u32 m0, s97, 139264
    s_add_u32 s93, s93, 16384
    buffer_load_dwordx4 v18, s[24:27], s94 offen offset:0  lds
    buffer_load_dwordx4 v19, s[24:27], s94 offen offset:1024  lds
    buffer_load_dwordx4 v24, s[24:27], s94 offen offset:2048  lds
    buffer_load_dwordx4 v25, s[24:27], s94 offen offset:3072  lds
    s_add_u32 s94, s94, 131072
    s_add_u32 s89, s89, 1
    s_cmp_eq_u32 s89, 28
    s_cselect_b32 s85, 458752, 0
    s_cselect_b32 s86, 3670016, 0
    s_cselect_b32 s89, 0, s89
    s_sub_u32 s93, s93, s85
    s_sub_u32 s94, s94, s86
    s_waitcnt vmcnt(16)
    s_barrier
    s_add_u32 m0, s97, 45056
    s_nop 0
    buffer_load_dwordx4 v17, s[8:11], s93 offen offset:0 sc1 lds
    buffer_load_dwordx4 v17, s[8:11], s93 offen offset:1024 sc1 lds
    buffer_load_dwordx4 v17, s[8:11], s93 offen offset:2048 sc1 lds
    buffer_load_dwordx4 v17, s[8:11], s93 offen offset:3072 sc1 lds
    s_add_u32 m0, s97, 61440
    s_add_u32 s93, s93, 16384
    buffer_load_dwordx4 v18, s[24:27], s94 offen offset:0  lds
    buffer_load_dwordx4 v19, s[24:27], s94 offen offset:1024  lds
    buffer_load_dwordx4 v24, s[24:27], s94 offen offset:2048  lds
    buffer_load_dwordx4 v25, s[24:27], s94 offen offset:3072  lds
    s_add_u32 s94, s94, 131072
    s_add_u32 s89, s89, 1
    s_cmp_eq_u32 s89, 28
    s_cselect_b32 s85, 458752, 0
    s_cselect_b32 s86, 3670016, 0
    s_cselect_b32 s89, 0, s89
    s_sub_u32 s93, s93, s85
    s_sub_u32 s94, s94, s86
    s_waitcnt vmcnt(16)
    s_barrier
    s_add_u32 m0, s97, 90112
    s_nop 0
    buffer_load_dwordx4 v17, s[8:11], s93 offen offset:0 sc1 lds
    buffer_load_dwordx4 v17, s[8:11], s93 offen offset:1024 sc1 lds
    buffer_load_dwordx4 v17, s[8:11], s93 offen offset:2048 sc1 lds
    buffer_load_dwordx4 v17, s[8:11], s93 offen offset:3072 sc1 lds
    s_add_u32 m0, s97, 106496
    s_add_u32 s93, s93, 16384
    buffer_load_dwordx4 v18, s[24:27], s94 offen offset:0  lds
    buffer_load_dwordx4 v19, s[24:27], s94 offen offset:1024  lds
    buffer_load_dwordx4 v24, s[24:27], s94 offen offset:2048  lds
    buffer_load_dwordx4 v25, s[24:27], s94 offen offset:3072  lds
    s_add_u32 s94, s94, 131072
    s_add_u32 s89, s89, 1
    s_cmp_eq_u32 s89, 28
    s_cselect_b32 s85, 458752, 0
    s_cselect_b32 s86, 3670016, 0
    s_cselect_b32 s89, 0, s89
    s_sub_u32 s93, s93, s85
    s_sub_u32 s94, s94, s86
    s_waitcnt vmcnt(16)
    s_barrier
    s_lshl_b32 s85, s80, 1
    s_add_u32 s85, s85, s82
    s_lshl_b32 s85, s85, 7
    s_add_u32 s85, s85, 34607104
    v_and_b32 v85, 7, v0
    v_lshlrev_b32 v85, 2, v85
    buffer_load_dword v84, v85, s[8:11], s85 offen sc1
    s_add_u32 m0, s97, 0
    s_nop 0
    buffer_load_dwordx4 v17, s[8:11], s93 offen offset:0 sc1 lds
    buffer_load_dwordx4 v17, s[8:11], s93 offen offset:1024 sc1 lds
    buffer_load_dwordx4 v17, s[8:11], s93 offen offset:2048 sc1 lds
    buffer_load_dwordx4 v17, s[8:11], s93 offen offset:3072 sc1 lds
    s_add_u32 m0, s97, 16384
    s_add_u32 s93, s93, 16384
    buffer_load_dwordx4 v18, s[24:27], s94 offen offset:0  lds
    buffer_load_dwordx4 v19, s[24:27], s94 offen offset:1024  lds
    buffer_load_dwordx4 v24, s[24:27], s94 offen offset:2048  lds
    buffer_load_dwordx4 v25, s[24:27], s94 offen offset:3072  lds
    s_add_u32 s94, s94, 131072
    s_add_u32 s89, s89, 1
    s_cmp_eq_u32 s89, 28
    s_cselect_b32 s85, 458752, 0
    s_cselect_b32 s86, 3670016, 0
    s_cselect_b32 s89, 0, s89
    s_sub_u32 s93, s93, s85
    s_sub_u32 s94, s94, s86
    s_waitcnt vmcnt(17)
    s_barrier
    s_add_u32 m0, s97, 122880
    s_nop 0
    buffer_load_dwordx4 v17, s[8:11], s93 offen offset:0 sc1 lds
    buffer_load_dwordx4 v17, s[8:11], s93 offen offset:1024 sc1 lds
    buffer_load_dwordx4 v17, s[8:11], s93 offen offset:2048 sc1 lds
    buffer_load_dwordx4 v17, s[8:11], s93 offen offset:3072 sc1 lds
    s_add_u32 m0, s97, 139264
    s_add_u32 s93, s93, 16384
    buffer_load_dwordx4 v18, s[24:27], s94 offen offset:0  lds
    buffer_load_dwordx4 v19, s[24:27], s94 offen offset:1024  lds
    buffer_load_dwordx4 v24, s[24:27], s94 offen offset:2048  lds
    buffer_load_dwordx4 v25, s[24:27], s94 offen offset:3072  lds
    s_add_u32 s94, s94, 131072
    s_add_u32 s89, s89, 1
    s_cmp_eq_u32 s89, 28
    s_cselect_b32 s85, 458752, 0
    s_cselect_b32 s86, 3670016, 0
    s_cselect_b32 s89, 0, s89
    s_sub_u32 s93, s93, s85
    s_sub_u32 s94, s94, s86
    s_waitcnt vmcnt(17)
    s_barrier
    v_and_b32 v86, 7, v0
    v_subrev_u32 v86, s81, v86
    v_and_b32 v86, 7, v86
    v_cmp_ge_u32 s[62:63], 7, v86
    s_waitcnt vmcnt(16)
    s_mov_b32 s6, 262144
L_gated_mix__ssm_conv_s5__dense_activation_squared_relu__prompt_kernel_pc4096pollH:
    v_cmp_ne_u32 vcc, s99, v84
    s_nop 1
    s_and_b64 vcc, vcc, s[62:63]
    s_cmp_eq_u64 vcc, 0
    s_cbranch_scc1 L_gated_mix__ssm_conv_s5__dense_activation_squared_relu__prompt_kernel_pc4096pollH_ok
    s_sub_u32 s6, s6, 1
    s_cbranch_scc1 L_gated_mix__ssm_conv_s5__dense_activation_squared_relu__prompt_kernel_pc4096pollH_ok
    s_sleep 1
    s_lshl_b32 s85, s80, 1
    s_add_u32 s85, s85, s82
    s_lshl_b32 s85, s85, 7
    s_add_u32 s85, s85, 34607104
    buffer_load_dword v84, v85, s[8:11], s85 offen sc1
    s_waitcnt vmcnt(0)
    s_branch L_gated_mix__ssm_conv_s5__dense_activation_squared_relu__prompt_kernel_pc4096pollH
L_gated_mix__ssm_conv_s5__dense_activation_squared_relu__prompt_kernel_pc4096pollH_ok:
    s_add_u32 m0, s97, 45056
    s_nop 0
    buffer_load_dwordx4 v17, s[8:11], s95 offen offset:0 sc1 lds
    buffer_load_dwordx4 v17, s[8:11], s95 offen offset:1024 sc1 lds
    buffer_load_dwordx4 v17, s[8:11], s95 offen offset:2048 sc1 lds
    buffer_load_dwordx4 v17, s[8:11], s95 offen offset:3072 sc1 lds
    s_add_u32 m0, s97, 61440
    s_add_u32 s95, s95, 16384
    buffer_load_dwordx4 v2, s[28:31], s96 offen offset:0  lds
    buffer_load_dwordx4 v3, s[28:31], s96 offen offset:1024  lds
    buffer_load_dwordx4 v4, s[28:31], s96 offen offset:2048  lds
    buffer_load_dwordx4 v5, s[28:31], s96 offen offset:3072  lds
    s_waitcnt vmcnt(16)
    s_barrier
    s_add_u32 m0, s97, 90112
    s_nop 0
    buffer_load_dwordx4 v17, s[8:11], s95 offen offset:0 sc1 lds
    buffer_load_dwordx4 v17, s[8:11], s95 offen offset:1024 sc1 lds
    buffer_load_dwordx4 v17, s[8:11], s95 offen offset:2048 sc1 lds
    buffer_load_dwordx4 v17, s[8:11], s95 offen offset:3072 sc1 lds
    s_add_u32 m0, s97, 106496
    s_add_u32 s95, s95, 16384
    buffer_load_dwordx4 v2, s[32:35], s96 offen offset:0  lds
    buffer_load_dwordx4 v3, s[32:35], s96 offen offset:1024  lds
    buffer_load_dwordx4 v4, s[32:35], s96 offen offset:2048  lds
    buffer_load_dwordx4 v5, s[32:35], s96 offen offset:3072  lds
    s_add_u32 s96, s96, 128
    s_waitcnt vmcnt(16)
    s_barrier
    s_add_u32 m0, s97, 0
    s_nop 0
    buffer_load_dwordx4 v17, s[8:11], s95 offen offset:0 sc1 lds
    buffer_load_dwordx4 v17, s[8:11], s95 offen offset:1024 sc1 lds
    buffer_load_dwordx4 v17, s[8:11], s95 offen offset:2048 sc1 lds
    buffer_load_dwordx4 v17, s[8:11], s95 offen offset:3072 sc1 lds
    s_add_u32 m0, s97, 16384
    s_add_u32 s95, s95, 16384
    buffer_load_dwordx4 v2, s[28:31], s96 offen offset:0  lds
    buffer_load_dwordx4 v3, s[28:31], s96 offen offset:1024  lds
    buffer_load_dwordx4 v4, s[28:31], s96 offen offset:2048  lds
    buffer_load_dwordx4 v5, s[28:31], s96 offen offset:3072  lds
    s_waitcnt vmcnt(16)
    s_barrier
    s_add_u32 m0, s97, 122880
    s_nop 0
    buffer_load_dwordx4 v17, s[8:11], s95 offen offset:0 sc1 lds
    buffer_load_dwordx4 v17, s[8:11], s95 offen offset:1024 sc1 lds
    buffer_load_dwordx4 v17, s[8:11], s95 offen offset:2048 sc1 lds
    buffer_load_dwordx4 v17, s[8:11], s95 offen offset:3072 sc1 lds
    s_add_u32 m0, s97, 139264
    s_add_u32 s95, s95, 16384
    buffer_load_dwordx4 v2, s[32:35], s96 offen offset:0  lds
    buffer_load_dwordx4 v3, s[32:35], s96 offen offset:1024  lds
    buffer_load_dwordx4 v4, s[32:35], s96 offen offset:2048  lds
    buffer_load_dwordx4 v5, s[32:35], s96 offen offset:3072  lds
    s_add_u32 s96, s96, 128
    s_waitcnt vmcnt(16)
    s_barrier
    s_add_u32 m0, s97, 45056
    s_nop 0
    buffer_load_dwordx4 v17, s[8:11], s95 offen offset:0 sc1 lds
    buffer_load_dwordx4 v17, s[8:11], s95 offen offset:1024 sc1 lds
    buffer_load_dwordx4 v17, s[8:11], s95 offen offset:2048 sc1 lds
    buffer_load_dwordx4 v17, s[8:11], s95 offen offset:3072 sc1 lds
    s_add_u32 m0, s97, 61440
    s_add_u32 s95, s95, 16384
    buffer_load_dwordx4 v2, s[28:31], s96 offen offset:0  lds
    buffer_load_dwordx4 v3, s[28:31], s96 offen offset:1024  lds
    buffer_load_dwordx4 v4, s[28:31], s96 offen offset:2048  lds
    buffer_load_dwordx4 v5, s[28:31], s96 offen offset:3072  lds
    s_waitcnt vmcnt(16)
    s_barrier
    s_add_u32 m0, s97, 90112
    s_nop 0
    buffer_load_dwordx4 v17, s[8:11], s95 offen offset:0 sc1 lds
    buffer_load_dwordx4 v17, s[8:11], s95 offen offset:1024 sc1 lds
    buffer_load_dwordx4 v17, s[8:11], s95 offen offset:2048 sc1 lds
    buffer_load_dwordx4 v17, s[8:11], s95 offen offset:3072 sc1 lds
    s_add_u32 m0, s97, 106496
    s_add_u32 s95, s95, 16384
    buffer_load_dwordx4 v2, s[32:35], s96 offen offset:0  lds
    buffer_load_dwordx4 v3, s[32:35], s96 offen offset:1024  lds
    buffer_load_dwordx4 v4, s[32:35], s96 offen offset:2048  lds
    buffer_load_dwordx4 v5, s[32:35], s96 offen offset:3072  lds
    s_add_u32 s96, s96, 128
    s_waitcnt vmcnt(16)
    s_barrier
    s_add_u32 m0, s97, 0
    s_nop 0
    buffer_load_dwordx4 v17, s[8:11], s95 offen offset:0 sc1 lds
    buffer_load_dwordx4 v17, s[8:11], s95 offen offset:1024 sc1 lds
    buffer_load_dwordx4 v17, s[8:11], s95 offen offset:2048 sc1 lds
    buffer_load_dwordx4 v17, s[8:11], s95 offen offset:3072 sc1 lds
    s_add_u32 m0, s97, 16384
    s_add_u32 s95, s95, 16384
    buffer_load_dwordx4 v2, s[28:31], s96 offen offset:0  lds
    buffer_load_dwordx4 v3, s[28:31], s96 offen offset:1024  lds
    buffer_load_dwordx4 v4, s[28:31], s96 offen offset:2048  lds
    buffer_load_dwordx4 v5, s[28:31], s96 offen offset:3072  lds
    s_waitcnt vmcnt(16)
    s_barrier
    s_add_u32 m0, s97, 122880
    s_nop 0
    buffer_load_dwordx4 v17, s[8:11], s95 offen offset:0 sc1 lds
    buffer_load_dwordx4 v17, s[8:11], s95 offen offset:1024 sc1 lds
    buffer_load_dwordx4 v17, s[8:11], s95 offen offset:2048 sc1 lds
    buffer_load_dwordx4 v17, s[8:11], s95 offen offset:3072 sc1 lds
    s_add_u32 m0, s97, 139264
    s_add_u32 s95, s95, 16384
    buffer_load_dwordx4 v2, s[32:35], s96 offen offset:0  lds
    buffer_load_dwordx4 v3, s[32:35], s96 offen offset:1024  lds
    buffer_load_dwordx4 v4, s[32:35], s96 offen offset:2048  lds
    buffer_load_dwordx4 v5, s[32:35], s96 offen offset:3072  lds
    s_add_u32 s96, s96, 128
    s_waitcnt vmcnt(16)
    s_barrier
    s_lshl_b32 s85, s80, 11
    s_lshl_b32 s86, s83, 9
    s_add_u32 s85, s85, s86
    s_add_u32 s85, s85, 25165824
    s_add_u32 m0, s86, 32768
    s_mov_b32 exec_hi, 0
    buffer_load_dwordx4 v17, s[8:11], s85 offen sc1 lds
    s_cmp_eq_u32 s83, 0
    s_cselect_b32 s36, s56, s70
    s_cselect_b32 s37, s57, s71
    s_and_b32 s37, s37, 0xffff
    s_mov_b32 s38, 2048
    s_mov_b32 s39, 0x20000
    s_lshl_b32 s85, s81, 8
    s_cmp_ge_u32 s83, 2
    s_cselect_b32 s85, 0x7ff00000, s85
    s_lshl_b32 s86, s83, 8
    s_add_u32 m0, s86, 34816
    s_mov_b32 exec_lo, 0xffff
    buffer_load_dwordx4 v17, s[36:39], s85 offen lds
    s_mov_b64 exec, -1
    s_add_u32 m0, s97, 45056
    s_nop 0
    buffer_load_dwordx4 v17, s[8:11], s95 offen offset:0 sc1 lds
    buffer_load_dwordx4 v17, s[8:11], s95 offen offset:1024 sc1 lds
    buffer_load_dwordx4 v17, s[8:11], s95 offen offset:2048 sc1 lds
    buffer_load_dwordx4 v17, s[8:11], s95 offen offset:3072 sc1 lds
    s_add_u32 m0, s97, 61440
    s_add_u32 s95, s95, 16384
    buffer_load_dwordx4 v2, s[28:31], s96 offen offset:0  lds
    buffer_load_dwordx4 v3, s[28:31], s96 offen offset:1024  lds
    buffer_load_dwordx4 v4, s[28:31], s96 offen offset:2048  lds
    buffer_load_dwordx4 v5, s[28:31], s96 offen offset:3072  lds
    s_waitcnt vmcnt(18)
    s_barrier
    s_add_u32 m0, s97, 90112
    s_nop 0
    buffer_load_dwordx4 v17, s[8:11], s95 offen offset:0 sc1 lds
    buffer_load_dwordx4 v17, s[8:11], s95 offen offset:1024 sc1 lds
    buffer_load_dwordx4 v17, s[8:11], s95 offen offset:2048 sc1 lds
    buffer_load_dwordx4 v17, s[8:11], s95 offen offset:3072 sc1 lds
    s_add_u32 m0, s97, 106496
    s_add_u32 s95, s95, 16384
    buffer_load_dwordx4 v2, s[32:35], s96 offen offset:0  lds
    buffer_load_dwordx4 v3, s[32:35], s96 offen offset:1024  lds
    buffer_load_dwordx4 v4, s[32:35], s96 offen offset:2048  lds
    buffer_load_dwordx4 v5, s[32:35], s96 offen offset:3072  lds
    s_add_u32 s96, s96, 128
    s_waitcnt vmcnt(18)
    s_barrier
    s_add_u32 m0, s97, 0
    s_nop 0
    buffer_load_dwordx4 v17, s[8:11], s95 offen offset:0 sc1 lds
    buffer_load_dwordx4 v17, s[8:11], s95 offen offset:1024 sc1 lds
    buffer_load_dwordx4 v17, s[8:11], s95 offen offset:2048 sc1 lds
    buffer_load_dwordx4 v17, s[8:11], s95 offen offset:3072 sc1 lds
    s_add_u32 m0, s97, 16384
    s_add_u32 s95, s95, 16384
    buffer_load_dwordx4 v2, s[28:31], s96 offen offset:0  lds
    buffer_load_dwordx4 v3, s[28:31], s96 offen offset:1024  lds
    buffer_load_dwordx4 v4, s[28:31], s96 offen offset:2048  lds
    buffer_load_dwordx4 v5, s[28:31], s96 offen offset:3072  lds
    s_waitcnt vmcnt(16)
    s_barrier
    s_add_u32 m0, s97, 122880
    s_nop 0
    buffer_load_dwordx4 v17, s[8:11], s95 offen offset:0 sc1 lds
    buffer_load_dwordx4 v17, s[8:11], s95 offen offset:1024 sc1 lds
    buffer_load_dwordx4 v17, s[8:11], s95 offen offset:2048 sc1 lds
    buffer_load_dwordx4 v17, s[8:11], s95 offen offset:3072 sc1 lds
    s_add_u32 m0, s97, 139264
    s_add_u32 s95, s95, 16384
    buffer_load_dwordx4 v2, s[32:35], s96 offen offset:0  lds
    buffer_load_dwordx4 v3, s[32:35], s96 offen offset:1024  lds
    buffer_load_dwordx4 v4, s[32:35], s96 offen offset:2048  lds
    buffer_load_dwordx4 v5, s[32:35], s96 offen offset:3072  lds
    s_add_u32 s96, s96, 128
    s_waitcnt vmcnt(16)
    s_barrier
    s_add_u32 m0, s97, 45056
    s_nop 0
    buffer_load_dwordx4 v17, s[8:11], s95 offen offset:0 sc1 lds
    buffer_load_dwordx4 v17, s[8:11], s95 offen offset:1024 sc1 lds
    buffer_load_dwordx4 v17, s[8:11], s95 offen offset:2048 sc1 lds
    buffer_load_dwordx4 v17, s[8:11], s95 offen offset:3072 sc1 lds
    s_add_u32 m0, s97, 61440
    s_add_u32 s95, s95, 16384
    buffer_load_dwordx4 v2, s[28:31], s96 offen offset:0  lds
    buffer_load_dwordx4 v3, s[28:31], s96 offen offset:1024  lds
    buffer_load_dwordx4 v4, s[28:31], s96 offen offset:2048  lds
    buffer_load_dwordx4 v5, s[28:31], s96 offen offset:3072  lds
    s_waitcnt vmcnt(16)
    s_barrier
    s_add_u32 m0, s97, 90112
    s_nop 0
    buffer_load_dwordx4 v17, s[8:11], s95 offen offset:0 sc1 lds
    buffer_load_dwordx4 v17, s[8:11], s95 offen offset:1024 sc1 lds
    buffer_load_dwordx4 v17, s[8:11], s95 offen offset:2048 sc1 lds
    buffer_load_dwordx4 v17, s[8:11], s95 offen offset:3072 sc1 lds
    s_add_u32 m0, s97, 106496
    s_add_u32 s95, s95, 16384
    buffer_load_dwordx4 v2, s[32:35], s96 offen offset:0  lds
    buffer_load_dwordx4 v3, s[32:35], s96 offen offset:1024  lds
    buffer_load_dwordx4 v4, s[32:35], s96 offen offset:2048  lds
    buffer_load_dwordx4 v5, s[32:35], s96 offen offset:3072  lds
    s_add_u32 s96, s96, 128
    s_waitcnt vmcnt(16)
    s_barrier
    s_add_u32 m0, s97, 0
    s_nop 0
    buffer_load_dwordx4 v17, s[8:11], s95 offen offset:0 sc1 lds
    buffer_load_dwordx4 v17, s[8:11], s95 offen offset:1024 sc1 lds
    buffer_load_dwordx4 v17, s[8:11], s95 offen offset:2048 sc1 lds
    buffer_load_dwordx4 v17, s[8:11], s95 offen offset:3072 sc1 lds
    s_add_u32 m0, s97, 16384
    s_add_u32 s95, s95, 16384
    buffer_load_dwordx4 v2, s[28:31], s96 offen offset:0  lds
    buffer_load_dwordx4 v3, s[28:31], s96 offen offset:1024  lds
    buffer_load_dwordx4 v4, s[28:31], s96 offen offset:2048  lds
    buffer_load_dwordx4 v5, s[28:31], s96 offen offset:3072  lds
    s_waitcnt vmcnt(16)
    s_barrier
    s_add_u32 m0, s97, 122880
    s_nop 0
    buffer_load_dwordx4 v17, s[8:11], s95 offen offset:0 sc1 lds
    buffer_load_dwordx4 v17, s[8:11], s95 offen offset:1024 sc1 lds
    buffer_load_dwordx4 v17, s[8:11], s95 offen offset:2048 sc1 lds
    buffer_load_dwordx4 v17, s[8:11], s95 offen offset:3072 sc1 lds
    s_add_u32 m0, s97, 139264
    s_add_u32 s95, s95, 16384
    buffer_load_dwordx4 v2, s[32:35], s96 offen offset:0  lds
    buffer_load_dwordx4 v3, s[32:35], s96 offen offset:1024  lds
    buffer_load_dwordx4 v4, s[32:35], s96 offen offset:2048  lds
    buffer_load_dwordx4 v5, s[32:35], s96 offen offset:3072  lds
    s_add_u32 s96, s96, 128
    s_waitcnt vmcnt(16)
    s_barrier
    s_lshl_b32 s85, s80, 7
    s_lshr_b32 s86, s83, 1
    s_lshl_b32 s86, s86, 6
    s_add_u32 s85, s85, s86
    s_lshl_b32 s86, s82, 5
    s_add_u32 s85, s85, s86
    s_and_b32 s86, s83, 1
    s_lshl_b32 s86, s86, 4
    s_add_u32 s85, s85, s86
    s_lshl_b32 s85, s85, 11
    s_lshl_b32 s86, s81, 8
    s_add_u32 s85, s85, s86
    s_add_u32 m0, s97, 45056
    s_nop 0
    buffer_load_dwordx4 v18, s[12:15], s85 offen offset:0 lds
    buffer_load_dwordx4 v19, s[12:15], s85 offen offset:1024 lds
    buffer_load_dwordx4 v24, s[12:15], s85 offen offset:2048 lds
    buffer_load_dwordx4 v25, s[12:15], s85 offen offset:3072 lds
    s_waitcnt vmcnt(12)
    s_barrier
    s_waitcnt vmcnt(4)
    s_waitcnt vmcnt(0)
    s_barrier
    s_endpgm
L_gated_mix__ssm_conv_s5__dense_activation_squared_relu__prompt_kernel_cons:
    s_setprio 2
    v_lshrrev_b32 v40, 4, v0
    v_and_b32 v41, 15, v0
    v_lshrrev_b32 v42, 2, v0
    v_and_b32 v42, 3, v42
    v_and_b32 v43, 3, v0
    s_lshr_b32 s89, s83, 1
    s_and_b32 s90, s83, 1
    v_lshrrev_b32 v44, 1, v41
    v_lshlrev_b32 v45, 7, v41
    s_lshl_b32 s85, s89, 13
    s_lshl_b32 s86, s90, 12
    s_add_u32 s87, s85, s86
    s_xor_b32 s88, s86, 4096
    s_add_u32 s88, s88, s85
    v_or_b32 v46, 0, v40
    v_xor_b32 v46, v46, v44
    v_lshlrev_b32 v46, 4, v46
    v_add_u32 v46, v46, v45
    v_add_u32 v16, s87, v46
    v_add_u32 v18, s88, v46
    v_add_u32 v2, s85, v46
    v_add_u32 v4, s86, v46
    v_add_u32 v2, 45056, v2
    v_add_u32 v4, 61440, v4
    v_or_b32 v46, 4, v40
    v_xor_b32 v46, v46, v44
    v_lshlrev_b32 v46, 4, v46
    v_add_u32 v46, v46, v45
    v_add_u32 v17, s87, v46
    v_add_u32 v19, s88, v46
    v_add_u32 v3, s85, v46
    v_add_u32 v5, s86, v46
    v_add_u32 v3, 45056, v3
    v_add_u32 v5, 61440, v5
    v_lshlrev_b32 v44, 3, v40
    v_add_u32 v44, v44, v42
    v_mul_u32_u24 v44, 448, v44
    v_lshlrev_b32 v45, 3, v43
    v_add_u32 v44, v44, v45
    v_add_u32 v44, 16384, v44
    v_and_b32 v45, 1, v40
    v_lshlrev_b32 v45, 5, v45
    v_add_u32 v22, v44, v45
    v_sub_u32 v23, v44, v45
    s_lshl_b32 s85, s90, 8
    v_add_u32 v20, s85, v22
    v_add_u32 v21, s85, v23
    v_lshlrev_b32 v44, 4, v0
    s_lshl_b32 s85, s90, 11
    v_add_u32 v6, s85, v44
    s_xor_b32 s85, s85, 2048
    v_add_u32 v7, s85, v44
    s_waitcnt lgkmcnt(0)
    s_mov_b32 s20, s66
    s_and_b32 s21, s67, 0xffff
    s_mov_b32 s22, 7168
    s_mov_b32 s23, 0x20000
    s_mov_b32 s32, s76
    s_and_b32 s33, s77, 0xffff
    s_mov_b32 s34, 256
    s_mov_b32 s35, 0x20000
    s_mov_b32 s8, s78
    s_and_b32 s9, s79, 0xffff
    s_mov_b32 s10, 37748736
    s_mov_b32 s11, 0x20000
    s_mul_i32 s85, s84, 448
    s_lshl_b32 s86, s90, 8
    s_add_u32 s86, s86, s85
    v_lshlrev_b32 v44, 3, v40
    buffer_load_dwordx2 v[24:25], v44, s[20:23], s86 offen offset:0
    buffer_load_dwordx2 v[26:27], v44, s[20:23], s86 offen offset:32
    buffer_load_dwordx2 v[28:29], v44, s[20:23], s86 offen offset:64
    buffer_load_dwordx2 v[30:31], v44, s[20:23], s86 offen offset:96
    buffer_load_dwordx2 v[32:33], v44, s[20:23], s86 offen offset:128
    buffer_load_dwordx2 v[34:35], v44, s[20:23], s86 offen offset:160
    buffer_load_dwordx2 v[36:37], v44, s[20:23], s85 offen offset:192
    buffer_load_dwordx2 v[38:39], v44, s[20:23], s85 offen offset:224
    s_or_b32 s85, s2, s83
    s_cmp_lg_u32 s85, 0
    s_cbranch_scc1 L_gated_mix__ssm_conv_s5__dense_activation_squared_relu__prompt_kernel_nn
    s_memrealtime s[92:93]
    s_waitcnt lgkmcnt(0)
    s_lshl_b32 s93, s93, 20
    s_xor_b32 s92, s92, s93
    s_or_b32 s92, s92, 1
    v_mov_b32 v45, s92
    v_mov_b32 v46, 0
    s_mov_b64 exec, 1
    buffer_store_dword v45, v46, s[32:35], 0 offen sc1
    s_mov_b64 exec, -1
L_gated_mix__ssm_conv_s5__dense_activation_squared_relu__prompt_kernel_nn:
    s_mov_b32 s12, s40
    s_and_b32 s13, s41, 0xffff
    s_mov_b32 s14, 4194304
    s_mov_b32 s15, 0x20000
    s_mov_b32 s16, s74
    s_and_b32 s17, s75, 0xffff
    s_mov_b32 s18, 8388608
    s_mov_b32 s19, 0x20000
    s_mov_b32 s24, s56
    s_and_b32 s25, s57, 0xffff
    s_mov_b32 s26, 2048
    s_mov_b32 s27, 0x20000
    s_mov_b32 s28, s70
    s_and_b32 s29, s71, 0xffff
    s_mov_b32 s30, 2048
    s_mov_b32 s31, 0x20000
    s_waitcnt vmcnt(0)
    v_lshlrev_b32 v44, 16, v24
    v_and_b32 v45, 0xffff0000, v24
    v_mov_b32 v144, v44
    v_mov_b32 v145, v45
    v_mov_b32 v148, v44
    v_mov_b32 v149, v45
    v_mov_b32 v152, v44
    v_mov_b32 v153, v45
    v_mov_b32 v156, v44
    v_mov_b32 v157, v45
    v_lshlrev_b32 v44, 16, v25
    v_and_b32 v45, 0xffff0000, v25
    v_mov_b32 v146, v44
    v_mov_b32 v147, v45
    v_mov_b32 v150, v44
    v_mov_b32 v151, v45
    v_mov_b32 v154, v44
    v_mov_b32 v155, v45
    v_mov_b32 v158, v44
    v_mov_b32 v159, v45
    v_lshlrev_b32 v44, 16, v26
    v_and_b32 v45, 0xffff0000, v26
    v_mov_b32 v160, v44
    v_mov_b32 v161, v45
    v_mov_b32 v164, v44
    v_mov_b32 v165, v45
    v_mov_b32 v168, v44
    v_mov_b32 v169, v45
    v_mov_b32 v172, v44
    v_mov_b32 v173, v45
    v_lshlrev_b32 v44, 16, v27
    v_and_b32 v45, 0xffff0000, v27
    v_mov_b32 v162, v44
    v_mov_b32 v163, v45
    v_mov_b32 v166, v44
    v_mov_b32 v167, v45
    v_mov_b32 v170, v44
    v_mov_b32 v171, v45
    v_mov_b32 v174, v44
    v_mov_b32 v175, v45
    v_lshlrev_b32 v44, 16, v28
    v_and_b32 v45, 0xffff0000, v28
    v_mov_b32 v176, v44
    v_mov_b32 v177, v45
    v_mov_b32 v180, v44
    v_mov_b32 v181, v45
    v_mov_b32 v184, v44
    v_mov_b32 v185, v45
    v_mov_b32 v188, v44
    v_mov_b32 v189, v45
    v_lshlrev_b32 v44, 16, v29
    v_and_b32 v45, 0xffff0000, v29
    v_mov_b32 v178, v44
    v_mov_b32 v179, v45
    v_mov_b32 v182, v44
    v_mov_b32 v183, v45
    v_mov_b32 v186, v44
    v_mov_b32 v187, v45
    v_mov_b32 v190, v44
    v_mov_b32 v191, v45
    v_lshlrev_b32 v44, 16, v30
    v_and_b32 v45, 0xffff0000, v30
    v_mov_b32 v192, v44
    v_mov_b32 v193, v45
    v_mov_b32 v196, v44
    v_mov_b32 v197, v45
    v_mov_b32 v200, v44
    v_mov_b32 v201, v45
    v_mov_b32 v204, v44
    v_mov_b32 v205, v45
    v_lshlrev_b32 v44, 16, v31
    v_and_b32 v45, 0xffff0000, v31
    v_mov_b32 v194, v44
    v_mov_b32 v195, v45
    v_mov_b32 v198, v44
    v_mov_b32 v199, v45
    v_mov_b32 v202, v44
    v_mov_b32 v203, v45
    v_mov_b32 v206, v44
    v_mov_b32 v207, v45
    v_lshlrev_b32 v44, 16, v32
    v_and_b32 v45, 0xffff0000, v32
    v_mov_b32 v208, v44
    v_mov_b32 v209, v45
    v_mov_b32 v212, v44
    v_mov_b32 v213, v45
    v_mov_b32 v216, v44
    v_mov_b32 v217, v45
    v_mov_b32 v220, v44
    v_mov_b32 v221, v45
    v_lshlrev_b32 v44, 16, v33
    v_and_b32 v45, 0xffff0000, v33
    v_mov_b32 v210, v44
    v_mov_b32 v211, v45
    v_mov_b32 v214, v44
    v_mov_b32 v215, v45
    v_mov_b32 v218, v44
    v_mov_b32 v219, v45
    v_mov_b32 v222, v44
    v_mov_b32 v223, v45
    v_lshlrev_b32 v44, 16, v34
    v_and_b32 v45, 0xffff0000, v34
    v_mov_b32 v224, v44
    v_mov_b32 v225, v45
    v_mov_b32 v228, v44
    v_mov_b32 v229, v45
    v_mov_b32 v232, v44
    v_mov_b32 v233, v45
    v_mov_b32 v236, v44
    v_mov_b32 v237, v45
    v_lshlrev_b32 v44, 16, v35
    v_and_b32 v45, 0xffff0000, v35
    v_mov_b32 v226, v44
    v_mov_b32 v227, v45
    v_mov_b32 v230, v44
    v_mov_b32 v231, v45
    v_mov_b32 v234, v44
    v_mov_b32 v235, v45
    v_mov_b32 v238, v44
    v_mov_b32 v239, v45
    v_lshlrev_b32 v44, 16, v36
    v_and_b32 v45, 0xffff0000, v36
    v_mov_b32 v240, v44
    v_mov_b32 v241, v45
    v_mov_b32 v244, v44
    v_mov_b32 v245, v45
    v_lshlrev_b32 v44, 16, v37
    v_and_b32 v45, 0xffff0000, v37
    v_mov_b32 v242, v44
    v_mov_b32 v243, v45
    v_mov_b32 v246, v44
    v_mov_b32 v247, v45
    v_lshlrev_b32 v44, 16, v38
    v_and_b32 v45, 0xffff0000, v38
    v_mov_b32 v248, v44
    v_mov_b32 v249, v45
    v_mov_b32 v252, v44
    v_mov_b32 v253, v45
    v_lshlrev_b32 v44, 16, v39
    v_and_b32 v45, 0xffff0000, v39
    v_mov_b32 v250, v44
    v_mov_b32 v251, v45
    v_mov_b32 v254, v44
    v_mov_b32 v255, v45
    s_barrier
    ds_read_b128 v[96:99], v16 offset:0
    ds_read_b64_tr_b16 v[112:113], v20 offset:0
    ds_read_b64_tr_b16 v[114:115], v20 offset:1792
    ds_read_b128 v[100:103], v16 offset:2048
    ds_read_b128 v[104:107], v18 offset:0
    ds_read_b128 v[108:111], v18 offset:2048
    ds_read_b64_tr_b16 v[116:117], v21 offset:32
    ds_read_b64_tr_b16 v[118:119], v21 offset:1824
    ds_read_b64_tr_b16 v[120:121], v20 offset:64
    ds_read_b64_tr_b16 v[122:123], v20 offset:1856
    ds_read_b64_tr_b16 v[124:125], v21 offset:96
    ds_read_b64_tr_b16 v[126:127], v21 offset:1888
    ds_read_b64_tr_b16 v[128:129], v20 offset:128
    ds_read_b64_tr_b16 v[130:131], v20 offset:1920
    ds_read_b64_tr_b16 v[132:133], v21 offset:160
    ds_read_b64_tr_b16 v[134:135], v21 offset:1952
    ds_read_b64_tr_b16 v[136:137], v22 offset:192
    ds_read_b64_tr_b16 v[138:139], v22 offset:1984
    ds_read_b64_tr_b16 v[140:141], v23 offset:224
    ds_read_b64_tr_b16 v[142:143], v23 offset:2016
    s_waitcnt lgkmcnt(0)
    v_mfma_f32_16x16x32_bf16 v[144:147], v[112:115], v[96:99], v[144:147]
    ds_read_b128 v[48:51], v17 offset:0
    v_mfma_f32_16x16x32_bf16 v[148:151], v[112:115], v[100:103], v[148:151]
    ds_read_b64_tr_b16 v[64:65], v20 offset:14336
    v_mfma_f32_16x16x32_bf16 v[152:155], v[112:115], v[104:107], v[152:155]
    ds_read_b64_tr_b16 v[66:67], v20 offset:16128
    v_mfma_f32_16x16x32_bf16 v[156:159], v[112:115], v[108:111], v[156:159]
    ds_read_b128 v[52:55], v17 offset:2048
    v_mfma_f32_16x16x32_bf16 v[160:163], v[116:119], v[96:99], v[160:163]
    ds_read_b128 v[56:59], v19 offset:0
    v_mfma_f32_16x16x32_bf16 v[164:167], v[116:119], v[100:103], v[164:167]
    ds_read_b128 v[60:63], v19 offset:2048
    v_mfma_f32_16x16x32_bf16 v[168:171], v[116:119], v[104:107], v[168:171]
    ds_read_b64_tr_b16 v[68:69], v21 offset:14368
    v_mfma_f32_16x16x32_bf16 v[172:175], v[116:119], v[108:111], v[172:175]
    ds_read_b64_tr_b16 v[70:71], v21 offset:16160
    v_mfma_f32_16x16x32_bf16 v[176:179], v[120:123], v[96:99], v[176:179]
    ds_read_b64_tr_b16 v[72:73], v20 offset:14400
    v_mfma_f32_16x16x32_bf16 v[180:183], v[120:123], v[100:103], v[180:183]
    ds_read_b64_tr_b16 v[74:75], v20 offset:16192
    v_mfma_f32_16x16x32_bf16 v[184:187], v[120:123], v[104:107], v[184:187]
    ds_read_b64_tr_b16 v[76:77], v21 offset:14432
    v_mfma_f32_16x16x32_bf16 v[188:191], v[120:123], v[108:111], v[188:191]
    ds_read_b64_tr_b16 v[78:79], v21 offset:16224
    v_mfma_f32_16x16x32_bf16 v[192:195], v[124:127], v[96:99], v[192:195]
    ds_read_b64_tr_b16 v[80:81], v20 offset:14464
    v_mfma_f32_16x16x32_bf16 v[196:199], v[124:127], v[100:103], v[196:199]
    ds_read_b64_tr_b16 v[82:83], v20 offset:16256
    v_mfma_f32_16x16x32_bf16 v[200:203], v[124:127], v[104:107], v[200:203]
    ds_read_b64_tr_b16 v[84:85], v21 offset:14496
    v_mfma_f32_16x16x32_bf16 v[204:207], v[124:127], v[108:111], v[204:207]
    ds_read_b64_tr_b16 v[86:87], v21 offset:16288
    v_mfma_f32_16x16x32_bf16 v[208:211], v[128:131], v[96:99], v[208:211]
    ds_read_b64_tr_b16 v[88:89], v22 offset:14528
    v_mfma_f32_16x16x32_bf16 v[212:215], v[128:131], v[100:103], v[212:215]
    ds_read_b64_tr_b16 v[90:91], v22 offset:16320
    v_mfma_f32_16x16x32_bf16 v[216:219], v[128:131], v[104:107], v[216:219]
    ds_read_b64_tr_b16 v[92:93], v23 offset:14560
    v_mfma_f32_16x16x32_bf16 v[220:223], v[128:131], v[108:111], v[220:223]
    ds_read_b64_tr_b16 v[94:95], v23 offset:16352
    v_mfma_f32_16x16x32_bf16 v[224:227], v[132:135], v[96:99], v[224:227]
    v_add_u32 v16, 45056, v16
    v_mfma_f32_16x16x32_bf16 v[228:231], v[132:135], v[100:103], v[228:231]
    v_add_u32 v18, 45056, v18
    v_mfma_f32_16x16x32_bf16 v[232:235], v[132:135], v[104:107], v[232:235]
    v_mfma_f32_16x16x32_bf16 v[236:239], v[132:135], v[108:111], v[236:239]
    v_mfma_f32_16x16x32_bf16 v[240:243], v[136:139], v[96:99], v[240:243]
    v_mfma_f32_16x16x32_bf16 v[244:247], v[136:139], v[100:103], v[244:247]
    v_mfma_f32_16x16x32_bf16 v[248:251], v[140:143], v[96:99], v[248:251]
    v_mfma_f32_16x16x32_bf16 v[252:255], v[140:143], v[100:103], v[252:255]
    s_waitcnt lgkmcnt(0)
    s_barrier
    v_mfma_f32_16x16x32_bf16 v[144:147], v[64:67], v[48:51], v[144:147]
    ds_read_b128 v[96:99], v16 offset:0
    v_mfma_f32_16x16x32_bf16 v[148:151], v[64:67], v[52:55], v[148:151]
    v_add_u32 v20, 45056, v20
    v_mfma_f32_16x16x32_bf16 v[152:155], v[64:67], v[56:59], v[152:155]
    v_add_u32 v21, 45056, v21
    v_mfma_f32_16x16x32_bf16 v[156:159], v[64:67], v[60:63], v[156:159]
    v_add_u32 v22, 45056, v22
    v_mfma_f32_16x16x32_bf16 v[160:163], v[68:71], v[48:51], v[160:163]
    v_add_u32 v23, 45056, v23
    v_mfma_f32_16x16x32_bf16 v[164:167], v[68:71], v[52:55], v[164:167]
    ds_read_b64_tr_b16 v[112:113], v20 offset:0
    v_mfma_f32_16x16x32_bf16 v[168:171], v[68:71], v[56:59], v[168:171]
    ds_read_b64_tr_b16 v[114:115], v20 offset:1792
    v_mfma_f32_16x16x32_bf16 v[172:175], v[68:71], v[60:63], v[172:175]
    ds_read_b128 v[100:103], v16 offset:2048
    v_mfma_f32_16x16x32_bf16 v[176:179], v[72:75], v[48:51], v[176:179]
    ds_read_b128 v[104:107], v18 offset:0
    v_mfma_f32_16x16x32_bf16 v[180:183], v[72:75], v[52:55], v[180:183]
    ds_read_b128 v[108:111], v18 offset:2048
    v_mfma_f32_16x16x32_bf16 v[184:187], v[72:75], v[56:59], v[184:187]
    ds_read_b64_tr_b16 v[116:117], v21 offset:32
    v_mfma_f32_16x16x32_bf16 v[188:191], v[72:75], v[60:63], v[188:191]
    ds_read_b64_tr_b16 v[118:119], v21 offset:1824
    v_mfma_f32_16x16x32_bf16 v[192:195], v[76:79], v[48:51], v[192:195]
    ds_read_b64_tr_b16 v[120:121], v20 offset:64
    v_mfma_f32_16x16x32_bf16 v[196:199], v[76:79], v[52:55], v[196:199]
    ds_read_b64_tr_b16 v[122:123], v20 offset:1856
    v_mfma_f32_16x16x32_bf16 v[200:203], v[76:79], v[56:59], v[200:203]
    ds_read_b64_tr_b16 v[124:125], v21 offset:96
    v_mfma_f32_16x16x32_bf16 v[204:207], v[76:79], v[60:63], v[204:207]
    ds_read_b64_tr_b16 v[126:127], v21 offset:1888
    v_mfma_f32_16x16x32_bf16 v[208:211], v[80:83], v[48:51], v[208:211]
    ds_read_b64_tr_b16 v[128:129], v20 offset:128
    v_mfma_f32_16x16x32_bf16 v[212:215], v[80:83], v[52:55], v[212:215]
    ds_read_b64_tr_b16 v[130:131], v20 offset:1920
    v_mfma_f32_16x16x32_bf16 v[216:219], v[80:83], v[56:59], v[216:219]
    ds_read_b64_tr_b16 v[132:133], v21 offset:160
    v_mfma_f32_16x16x32_bf16 v[220:223], v[80:83], v[60:63], v[220:223]
    ds_read_b64_tr_b16 v[134:135], v21 offset:1952
    v_mfma_f32_16x16x32_bf16 v[224:227], v[84:87], v[48:51], v[224:227]
    ds_read_b64_tr_b16 v[136:137], v22 offset:192
    v_mfma_f32_16x16x32_bf16 v[228:231], v[84:87], v[52:55], v[228:231]
    ds_read_b64_tr_b16 v[138:139], v22 offset:1984
    v_mfma_f32_16x16x32_bf16 v[232:235], v[84:87], v[56:59], v[232:235]
    ds_read_b64_tr_b16 v[140:141], v23 offset:224
    v_mfma_f32_16x16x32_bf16 v[236:239], v[84:87], v[60:63], v[236:239]
    ds_read_b64_tr_b16 v[142:143], v23 offset:2016
    v_mfma_f32_16x16x32_bf16 v[240:243], v[88:91], v[48:51], v[240:243]
    v_add_u32 v17, 45056, v17
    v_mfma_f32_16x16x32_bf16 v[244:247], v[88:91], v[52:55], v[244:247]
    v_add_u32 v19, 45056, v19
    v_mfma_f32_16x16x32_bf16 v[248:251], v[92:95], v[48:51], v[248:251]
    v_mfma_f32_16x16x32_bf16 v[252:255], v[92:95], v[52:55], v[252:255]
    s_waitcnt lgkmcnt(0)
    v_mfma_f32_16x16x32_bf16 v[144:147], v[112:115], v[96:99], v[144:147]
    ds_read_b128 v[48:51], v17 offset:0
    v_mfma_f32_16x16x32_bf16 v[148:151], v[112:115], v[100:103], v[148:151]
    ds_read_b64_tr_b16 v[64:65], v20 offset:14336
    v_mfma_f32_16x16x32_bf16 v[152:155], v[112:115], v[104:107], v[152:155]
    ds_read_b64_tr_b16 v[66:67], v20 offset:16128
    v_mfma_f32_16x16x32_bf16 v[156:159], v[112:115], v[108:111], v[156:159]
    ds_read_b128 v[52:55], v17 offset:2048
    v_mfma_f32_16x16x32_bf16 v[160:163], v[116:119], v[96:99], v[160:163]
    ds_read_b128 v[56:59], v19 offset:0
    v_mfma_f32_16x16x32_bf16 v[164:167], v[116:119], v[100:103], v[164:167]
    ds_read_b128 v[60:63], v19 offset:2048
    v_mfma_f32_16x16x32_bf16 v[168:171], v[116:119], v[104:107], v[168:171]
    ds_read_b64_tr_b16 v[68:69], v21 offset:14368
    v_mfma_f32_16x16x32_bf16 v[172:175], v[116:119], v[108:111], v[172:175]
    ds_read_b64_tr_b16 v[70:71], v21 offset:16160
    v_mfma_f32_16x16x32_bf16 v[176:179], v[120:123], v[96:99], v[176:179]
    ds_read_b64_tr_b16 v[72:73], v20 offset:14400
    v_mfma_f32_16x16x32_bf16 v[180:183], v[120:123], v[100:103], v[180:183]
    ds_read_b64_tr_b16 v[74:75], v20 offset:16192
    v_mfma_f32_16x16x32_bf16 v[184:187], v[120:123], v[104:107], v[184:187]
    ds_read_b64_tr_b16 v[76:77], v21 offset:14432
    v_mfma_f32_16x16x32_bf16 v[188:191], v[120:123], v[108:111], v[188:191]
    ds_read_b64_tr_b16 v[78:79], v21 offset:16224
    v_mfma_f32_16x16x32_bf16 v[192:195], v[124:127], v[96:99], v[192:195]
    ds_read_b64_tr_b16 v[80:81], v20 offset:14464
    v_mfma_f32_16x16x32_bf16 v[196:199], v[124:127], v[100:103], v[196:199]
    ds_read_b64_tr_b16 v[82:83], v20 offset:16256
    v_mfma_f32_16x16x32_bf16 v[200:203], v[124:127], v[104:107], v[200:203]
    ds_read_b64_tr_b16 v[84:85], v21 offset:14496
    v_mfma_f32_16x16x32_bf16 v[204:207], v[124:127], v[108:111], v[204:207]
    ds_read_b64_tr_b16 v[86:87], v21 offset:16288
    v_mfma_f32_16x16x32_bf16 v[208:211], v[128:131], v[96:99], v[208:211]
    ds_read_b64_tr_b16 v[88:89], v22 offset:14528
    v_mfma_f32_16x16x32_bf16 v[212:215], v[128:131], v[100:103], v[212:215]
    ds_read_b64_tr_b16 v[90:91], v22 offset:16320
    v_mfma_f32_16x16x32_bf16 v[216:219], v[128:131], v[104:107], v[216:219]
    ds_read_b64_tr_b16 v[92:93], v23 offset:14560
    v_mfma_f32_16x16x32_bf16 v[220:223], v[128:131], v[108:111], v[220:223]
    ds_read_b64_tr_b16 v[94:95], v23 offset:16352
    v_mfma_f32_16x16x32_bf16 v[224:227], v[132:135], v[96:99], v[224:227]
    v_add_u32 v16, 45056, v16
    v_mfma_f32_16x16x32_bf16 v[228:231], v[132:135], v[100:103], v[228:231]
    v_add_u32 v18, 45056, v18
    v_mfma_f32_16x16x32_bf16 v[232:235], v[132:135], v[104:107], v[232:235]
    v_mfma_f32_16x16x32_bf16 v[236:239], v[132:135], v[108:111], v[236:239]
    v_mfma_f32_16x16x32_bf16 v[240:243], v[136:139], v[96:99], v[240:243]
    v_mfma_f32_16x16x32_bf16 v[244:247], v[136:139], v[100:103], v[244:247]
    v_mfma_f32_16x16x32_bf16 v[248:251], v[140:143], v[96:99], v[248:251]
    v_mfma_f32_16x16x32_bf16 v[252:255], v[140:143], v[100:103], v[252:255]
    s_waitcnt lgkmcnt(0)
    s_barrier
    v_mfma_f32_16x16x32_bf16 v[144:147], v[64:67], v[48:51], v[144:147]
    ds_read_b128 v[96:99], v16 offset:0
    v_mfma_f32_16x16x32_bf16 v[148:151], v[64:67], v[52:55], v[148:151]
    v_add_u32 v20, 45056, v20
    v_mfma_f32_16x16x32_bf16 v[152:155], v[64:67], v[56:59], v[152:155]
    v_add_u32 v21, 45056, v21
    v_mfma_f32_16x16x32_bf16 v[156:159], v[64:67], v[60:63], v[156:159]
    v_add_u32 v22, 45056, v22
    v_mfma_f32_16x16x32_bf16 v[160:163], v[68:71], v[48:51], v[160:163]
    v_add_u32 v23, 45056, v23
    v_mfma_f32_16x16x32_bf16 v[164:167], v[68:71], v[52:55], v[164:167]
    ds_read_b64_tr_b16 v[112:113], v20 offset:0
    v_mfma_f32_16x16x32_bf16 v[168:171], v[68:71], v[56:59], v[168:171]
    ds_read_b64_tr_b16 v[114:115], v20 offset:1792
    v_mfma_f32_16x16x32_bf16 v[172:175], v[68:71], v[60:63], v[172:175]
    ds_read_b128 v[100:103], v16 offset:2048
    v_mfma_f32_16x16x32_bf16 v[176:179], v[72:75], v[48:51], v[176:179]
    ds_read_b128 v[104:107], v18 offset:0
    v_mfma_f32_16x16x32_bf16 v[180:183], v[72:75], v[52:55], v[180:183]
    ds_read_b128 v[108:111], v18 offset:2048
    v_mfma_f32_16x16x32_bf16 v[184:187], v[72:75], v[56:59], v[184:187]
    ds_read_b64_tr_b16 v[116:117], v21 offset:32
    v_mfma_f32_16x16x32_bf16 v[188:191], v[72:75], v[60:63], v[188:191]
    ds_read_b64_tr_b16 v[118:119], v21 offset:1824
    v_mfma_f32_16x16x32_bf16 v[192:195], v[76:79], v[48:51], v[192:195]
    ds_read_b64_tr_b16 v[120:121], v20 offset:64
    v_mfma_f32_16x16x32_bf16 v[196:199], v[76:79], v[52:55], v[196:199]
    ds_read_b64_tr_b16 v[122:123], v20 offset:1856
    v_mfma_f32_16x16x32_bf16 v[200:203], v[76:79], v[56:59], v[200:203]
    ds_read_b64_tr_b16 v[124:125], v21 offset:96
    v_mfma_f32_16x16x32_bf16 v[204:207], v[76:79], v[60:63], v[204:207]
    ds_read_b64_tr_b16 v[126:127], v21 offset:1888
    v_mfma_f32_16x16x32_bf16 v[208:211], v[80:83], v[48:51], v[208:211]
    ds_read_b64_tr_b16 v[128:129], v20 offset:128
    v_mfma_f32_16x16x32_bf16 v[212:215], v[80:83], v[52:55], v[212:215]
    ds_read_b64_tr_b16 v[130:131], v20 offset:1920
    v_mfma_f32_16x16x32_bf16 v[216:219], v[80:83], v[56:59], v[216:219]
    ds_read_b64_tr_b16 v[132:133], v21 offset:160
    v_mfma_f32_16x16x32_bf16 v[220:223], v[80:83], v[60:63], v[220:223]
    ds_read_b64_tr_b16 v[134:135], v21 offset:1952
    v_mfma_f32_16x16x32_bf16 v[224:227], v[84:87], v[48:51], v[224:227]
    ds_read_b64_tr_b16 v[136:137], v22 offset:192
    v_mfma_f32_16x16x32_bf16 v[228:231], v[84:87], v[52:55], v[228:231]
    ds_read_b64_tr_b16 v[138:139], v22 offset:1984
    v_mfma_f32_16x16x32_bf16 v[232:235], v[84:87], v[56:59], v[232:235]
    ds_read_b64_tr_b16 v[140:141], v23 offset:224
    v_mfma_f32_16x16x32_bf16 v[236:239], v[84:87], v[60:63], v[236:239]
    ds_read_b64_tr_b16 v[142:143], v23 offset:2016
    v_mfma_f32_16x16x32_bf16 v[240:243], v[88:91], v[48:51], v[240:243]
    v_add_u32 v17, 45056, v17
    v_mfma_f32_16x16x32_bf16 v[244:247], v[88:91], v[52:55], v[244:247]
    v_add_u32 v19, 45056, v19
    v_mfma_f32_16x16x32_bf16 v[248:251], v[92:95], v[48:51], v[248:251]
    v_mfma_f32_16x16x32_bf16 v[252:255], v[92:95], v[52:55], v[252:255]
    s_waitcnt lgkmcnt(0)
    v_mfma_f32_16x16x32_bf16 v[144:147], v[112:115], v[96:99], v[144:147]
    ds_read_b128 v[48:51], v17 offset:0
    v_mfma_f32_16x16x32_bf16 v[148:151], v[112:115], v[100:103], v[148:151]
    ds_read_b64_tr_b16 v[64:65], v20 offset:14336
    v_mfma_f32_16x16x32_bf16 v[152:155], v[112:115], v[104:107], v[152:155]
    ds_read_b64_tr_b16 v[66:67], v20 offset:16128
    v_mfma_f32_16x16x32_bf16 v[156:159], v[112:115], v[108:111], v[156:159]
    ds_read_b128 v[52:55], v17 offset:2048
    v_mfma_f32_16x16x32_bf16 v[160:163], v[116:119], v[96:99], v[160:163]
    ds_read_b128 v[56:59], v19 offset:0
    v_mfma_f32_16x16x32_bf16 v[164:167], v[116:119], v[100:103], v[164:167]
    ds_read_b128 v[60:63], v19 offset:2048
    v_mfma_f32_16x16x32_bf16 v[168:171], v[116:119], v[104:107], v[168:171]
    ds_read_b64_tr_b16 v[68:69], v21 offset:14368
    v_mfma_f32_16x16x32_bf16 v[172:175], v[116:119], v[108:111], v[172:175]
    ds_read_b64_tr_b16 v[70:71], v21 offset:16160
    v_mfma_f32_16x16x32_bf16 v[176:179], v[120:123], v[96:99], v[176:179]
    ds_read_b64_tr_b16 v[72:73], v20 offset:14400
    v_mfma_f32_16x16x32_bf16 v[180:183], v[120:123], v[100:103], v[180:183]
    ds_read_b64_tr_b16 v[74:75], v20 offset:16192
    v_mfma_f32_16x16x32_bf16 v[184:187], v[120:123], v[104:107], v[184:187]
    ds_read_b64_tr_b16 v[76:77], v21 offset:14432
    v_mfma_f32_16x16x32_bf16 v[188:191], v[120:123], v[108:111], v[188:191]
    ds_read_b64_tr_b16 v[78:79], v21 offset:16224
    v_mfma_f32_16x16x32_bf16 v[192:195], v[124:127], v[96:99], v[192:195]
    ds_read_b64_tr_b16 v[80:81], v20 offset:14464
    v_mfma_f32_16x16x32_bf16 v[196:199], v[124:127], v[100:103], v[196:199]
    ds_read_b64_tr_b16 v[82:83], v20 offset:16256
    v_mfma_f32_16x16x32_bf16 v[200:203], v[124:127], v[104:107], v[200:203]
    ds_read_b64_tr_b16 v[84:85], v21 offset:14496
    v_mfma_f32_16x16x32_bf16 v[204:207], v[124:127], v[108:111], v[204:207]
    ds_read_b64_tr_b16 v[86:87], v21 offset:16288
    v_mfma_f32_16x16x32_bf16 v[208:211], v[128:131], v[96:99], v[208:211]
    ds_read_b64_tr_b16 v[88:89], v22 offset:14528
    v_mfma_f32_16x16x32_bf16 v[212:215], v[128:131], v[100:103], v[212:215]
    ds_read_b64_tr_b16 v[90:91], v22 offset:16320
    v_mfma_f32_16x16x32_bf16 v[216:219], v[128:131], v[104:107], v[216:219]
    ds_read_b64_tr_b16 v[92:93], v23 offset:14560
    v_mfma_f32_16x16x32_bf16 v[220:223], v[128:131], v[108:111], v[220:223]
    ds_read_b64_tr_b16 v[94:95], v23 offset:16352
    v_mfma_f32_16x16x32_bf16 v[224:227], v[132:135], v[96:99], v[224:227]
    v_add_u32 v16, 4294877184, v16
    v_mfma_f32_16x16x32_bf16 v[228:231], v[132:135], v[100:103], v[228:231]
    v_add_u32 v18, 4294877184, v18
    v_mfma_f32_16x16x32_bf16 v[232:235], v[132:135], v[104:107], v[232:235]
    v_mfma_f32_16x16x32_bf16 v[236:239], v[132:135], v[108:111], v[236:239]
    v_mfma_f32_16x16x32_bf16 v[240:243], v[136:139], v[96:99], v[240:243]
    v_mfma_f32_16x16x32_bf16 v[244:247], v[136:139], v[100:103], v[244:247]
    v_mfma_f32_16x16x32_bf16 v[248:251], v[140:143], v[96:99], v[248:251]
    v_mfma_f32_16x16x32_bf16 v[252:255], v[140:143], v[100:103], v[252:255]
    s_waitcnt lgkmcnt(0)
    s_barrier
    v_mfma_f32_16x16x32_bf16 v[144:147], v[64:67], v[48:51], v[144:147]
    ds_read_b128 v[96:99], v16 offset:0
    v_mfma_f32_16x16x32_bf16 v[148:151], v[64:67], v[52:55], v[148:151]
    v_add_u32 v20, 4294877184, v20
    v_mfma_f32_16x16x32_bf16 v[152:155], v[64:67], v[56:59], v[152:155]
    v_add_u32 v21, 4294877184, v21
    v_mfma_f32_16x16x32_bf16 v[156:159], v[64:67], v[60:63], v[156:159]
    v_add_u32 v22, 4294877184, v22
    v_mfma_f32_16x16x32_bf16 v[160:163], v[68:71], v[48:51], v[160:163]
    v_add_u32 v23, 4294877184, v23
    v_mfma_f32_16x16x32_bf16 v[164:167], v[68:71], v[52:55], v[164:167]
    ds_read_b64_tr_b16 v[112:113], v20 offset:0
    v_mfma_f32_16x16x32_bf16 v[168:171], v[68:71], v[56:59], v[168:171]
    ds_read_b64_tr_b16 v[114:115], v20 offset:1792
    v_mfma_f32_16x16x32_bf16 v[172:175], v[68:71], v[60:63], v[172:175]
    ds_read_b128 v[100:103], v16 offset:2048
    v_mfma_f32_16x16x32_bf16 v[176:179], v[72:75], v[48:51], v[176:179]
    ds_read_b128 v[104:107], v18 offset:0
    v_mfma_f32_16x16x32_bf16 v[180:183], v[72:75], v[52:55], v[180:183]
    ds_read_b128 v[108:111], v18 offset:2048
    v_mfma_f32_16x16x32_bf16 v[184:187], v[72:75], v[56:59], v[184:187]
    ds_read_b64_tr_b16 v[116:117], v21 offset:32
    v_mfma_f32_16x16x32_bf16 v[188:191], v[72:75], v[60:63], v[188:191]
    ds_read_b64_tr_b16 v[118:119], v21 offset:1824
    v_mfma_f32_16x16x32_bf16 v[192:195], v[76:79], v[48:51], v[192:195]
    ds_read_b64_tr_b16 v[120:121], v20 offset:64
    v_mfma_f32_16x16x32_bf16 v[196:199], v[76:79], v[52:55], v[196:199]
    ds_read_b64_tr_b16 v[122:123], v20 offset:1856
    v_mfma_f32_16x16x32_bf16 v[200:203], v[76:79], v[56:59], v[200:203]
    ds_read_b64_tr_b16 v[124:125], v21 offset:96
    v_mfma_f32_16x16x32_bf16 v[204:207], v[76:79], v[60:63], v[204:207]
    ds_read_b64_tr_b16 v[126:127], v21 offset:1888
    v_mfma_f32_16x16x32_bf16 v[208:211], v[80:83], v[48:51], v[208:211]
    ds_read_b64_tr_b16 v[128:129], v20 offset:128
    v_mfma_f32_16x16x32_bf16 v[212:215], v[80:83], v[52:55], v[212:215]
    ds_read_b64_tr_b16 v[130:131], v20 offset:1920
    v_mfma_f32_16x16x32_bf16 v[216:219], v[80:83], v[56:59], v[216:219]
    ds_read_b64_tr_b16 v[132:133], v21 offset:160
    v_mfma_f32_16x16x32_bf16 v[220:223], v[80:83], v[60:63], v[220:223]
    ds_read_b64_tr_b16 v[134:135], v21 offset:1952
    v_mfma_f32_16x16x32_bf16 v[224:227], v[84:87], v[48:51], v[224:227]
    ds_read_b64_tr_b16 v[136:137], v22 offset:192
    v_mfma_f32_16x16x32_bf16 v[228:231], v[84:87], v[52:55], v[228:231]
    ds_read_b64_tr_b16 v[138:139], v22 offset:1984
    v_mfma_f32_16x16x32_bf16 v[232:235], v[84:87], v[56:59], v[232:235]
    ds_read_b64_tr_b16 v[140:141], v23 offset:224
    v_mfma_f32_16x16x32_bf16 v[236:239], v[84:87], v[60:63], v[236:239]
    ds_read_b64_tr_b16 v[142:143], v23 offset:2016
    v_mfma_f32_16x16x32_bf16 v[240:243], v[88:91], v[48:51], v[240:243]
    v_add_u32 v17, 4294877184, v17
    v_mfma_f32_16x16x32_bf16 v[244:247], v[88:91], v[52:55], v[244:247]
    v_add_u32 v19, 4294877184, v19
    v_mfma_f32_16x16x32_bf16 v[248:251], v[92:95], v[48:51], v[248:251]
    v_mfma_f32_16x16x32_bf16 v[252:255], v[92:95], v[52:55], v[252:255]
    s_waitcnt lgkmcnt(0)
    v_mfma_f32_16x16x32_bf16 v[144:147], v[112:115], v[96:99], v[144:147]
    ds_read_b128 v[48:51], v17 offset:0
    v_mfma_f32_16x16x32_bf16 v[148:151], v[112:115], v[100:103], v[148:151]
    ds_read_b64_tr_b16 v[64:65], v20 offset:14336
    v_mfma_f32_16x16x32_bf16 v[152:155], v[112:115], v[104:107], v[152:155]
    ds_read_b64_tr_b16 v[66:67], v20 offset:16128
    v_mfma_f32_16x16x32_bf16 v[156:159], v[112:115], v[108:111], v[156:159]
    ds_read_b128 v[52:55], v17 offset:2048
    v_mfma_f32_16x16x32_bf16 v[160:163], v[116:119], v[96:99], v[160:163]
    ds_read_b128 v[56:59], v19 offset:0
    v_mfma_f32_16x16x32_bf16 v[164:167], v[116:119], v[100:103], v[164:167]
    ds_read_b128 v[60:63], v19 offset:2048
    v_mfma_f32_16x16x32_bf16 v[168:171], v[116:119], v[104:107], v[168:171]
    ds_read_b64_tr_b16 v[68:69], v21 offset:14368
    v_mfma_f32_16x16x32_bf16 v[172:175], v[116:119], v[108:111], v[172:175]
    ds_read_b64_tr_b16 v[70:71], v21 offset:16160
    v_mfma_f32_16x16x32_bf16 v[176:179], v[120:123], v[96:99], v[176:179]
    ds_read_b64_tr_b16 v[72:73], v20 offset:14400
    v_mfma_f32_16x16x32_bf16 v[180:183], v[120:123], v[100:103], v[180:183]
    ds_read_b64_tr_b16 v[74:75], v20 offset:16192
    v_mfma_f32_16x16x32_bf16 v[184:187], v[120:123], v[104:107], v[184:187]
    ds_read_b64_tr_b16 v[76:77], v21 offset:14432
    v_mfma_f32_16x16x32_bf16 v[188:191], v[120:123], v[108:111], v[188:191]
    ds_read_b64_tr_b16 v[78:79], v21 offset:16224
    v_mfma_f32_16x16x32_bf16 v[192:195], v[124:127], v[96:99], v[192:195]
    ds_read_b64_tr_b16 v[80:81], v20 offset:14464
    v_mfma_f32_16x16x32_bf16 v[196:199], v[124:127], v[100:103], v[196:199]
    ds_read_b64_tr_b16 v[82:83], v20 offset:16256
    v_mfma_f32_16x16x32_bf16 v[200:203], v[124:127], v[104:107], v[200:203]
    ds_read_b64_tr_b16 v[84:85], v21 offset:14496
    v_mfma_f32_16x16x32_bf16 v[204:207], v[124:127], v[108:111], v[204:207]
    ds_read_b64_tr_b16 v[86:87], v21 offset:16288
    v_mfma_f32_16x16x32_bf16 v[208:211], v[128:131], v[96:99], v[208:211]
    ds_read_b64_tr_b16 v[88:89], v22 offset:14528
    v_mfma_f32_16x16x32_bf16 v[212:215], v[128:131], v[100:103], v[212:215]
    ds_read_b64_tr_b16 v[90:91], v22 offset:16320
    v_mfma_f32_16x16x32_bf16 v[216:219], v[128:131], v[104:107], v[216:219]
    ds_read_b64_tr_b16 v[92:93], v23 offset:14560
    v_mfma_f32_16x16x32_bf16 v[220:223], v[128:131], v[108:111], v[220:223]
    ds_read_b64_tr_b16 v[94:95], v23 offset:16352
    v_mfma_f32_16x16x32_bf16 v[224:227], v[132:135], v[96:99], v[224:227]
    v_add_u32 v16, 45056, v16
    v_mfma_f32_16x16x32_bf16 v[228:231], v[132:135], v[100:103], v[228:231]
    v_add_u32 v18, 45056, v18
    v_mfma_f32_16x16x32_bf16 v[232:235], v[132:135], v[104:107], v[232:235]
    v_mfma_f32_16x16x32_bf16 v[236:239], v[132:135], v[108:111], v[236:239]
    v_mfma_f32_16x16x32_bf16 v[240:243], v[136:139], v[96:99], v[240:243]
    v_mfma_f32_16x16x32_bf16 v[244:247], v[136:139], v[100:103], v[244:247]
    v_mfma_f32_16x16x32_bf16 v[248:251], v[140:143], v[96:99], v[248:251]
    v_mfma_f32_16x16x32_bf16 v[252:255], v[140:143], v[100:103], v[252:255]
    s_waitcnt lgkmcnt(0)
    s_barrier
    v_mfma_f32_16x16x32_bf16 v[144:147], v[64:67], v[48:51], v[144:147]
    ds_read_b128 v[96:99], v16 offset:0
    v_mfma_f32_16x16x32_bf16 v[148:151], v[64:67], v[52:55], v[148:151]
    v_add_u32 v20, 45056, v20
    v_mfma_f32_16x16x32_bf16 v[152:155], v[64:67], v[56:59], v[152:155]
    v_add_u32 v21, 45056, v21
    v_mfma_f32_16x16x32_bf16 v[156:159], v[64:67], v[60:63], v[156:159]
    v_add_u32 v22, 45056, v22
    v_mfma_f32_16x16x32_bf16 v[160:163], v[68:71], v[48:51], v[160:163]
    v_add_u32 v23, 45056, v23
    v_mfma_f32_16x16x32_bf16 v[164:167], v[68:71], v[52:55], v[164:167]
    ds_read_b64_tr_b16 v[112:113], v20 offset:0
    v_mfma_f32_16x16x32_bf16 v[168:171], v[68:71], v[56:59], v[168:171]
    ds_read_b64_tr_b16 v[114:115], v20 offset:1792
    v_mfma_f32_16x16x32_bf16 v[172:175], v[68:71], v[60:63], v[172:175]
    ds_read_b128 v[100:103], v16 offset:2048
    v_mfma_f32_16x16x32_bf16 v[176:179], v[72:75], v[48:51], v[176:179]
    ds_read_b128 v[104:107], v18 offset:0
    v_mfma_f32_16x16x32_bf16 v[180:183], v[72:75], v[52:55], v[180:183]
    ds_read_b128 v[108:111], v18 offset:2048
    v_mfma_f32_16x16x32_bf16 v[184:187], v[72:75], v[56:59], v[184:187]
    ds_read_b64_tr_b16 v[116:117], v21 offset:32
    v_mfma_f32_16x16x32_bf16 v[188:191], v[72:75], v[60:63], v[188:191]
    ds_read_b64_tr_b16 v[118:119], v21 offset:1824
    v_mfma_f32_16x16x32_bf16 v[192:195], v[76:79], v[48:51], v[192:195]
    ds_read_b64_tr_b16 v[120:121], v20 offset:64
    v_mfma_f32_16x16x32_bf16 v[196:199], v[76:79], v[52:55], v[196:199]
    ds_read_b64_tr_b16 v[122:123], v20 offset:1856
    v_mfma_f32_16x16x32_bf16 v[200:203], v[76:79], v[56:59], v[200:203]
    ds_read_b64_tr_b16 v[124:125], v21 offset:96
    v_mfma_f32_16x16x32_bf16 v[204:207], v[76:79], v[60:63], v[204:207]
    ds_read_b64_tr_b16 v[126:127], v21 offset:1888
    v_mfma_f32_16x16x32_bf16 v[208:211], v[80:83], v[48:51], v[208:211]
    ds_read_b64_tr_b16 v[128:129], v20 offset:128
    v_mfma_f32_16x16x32_bf16 v[212:215], v[80:83], v[52:55], v[212:215]
    ds_read_b64_tr_b16 v[130:131], v20 offset:1920
    v_mfma_f32_16x16x32_bf16 v[216:219], v[80:83], v[56:59], v[216:219]
    ds_read_b64_tr_b16 v[132:133], v21 offset:160
    v_mfma_f32_16x16x32_bf16 v[220:223], v[80:83], v[60:63], v[220:223]
    ds_read_b64_tr_b16 v[134:135], v21 offset:1952
    v_mfma_f32_16x16x32_bf16 v[224:227], v[84:87], v[48:51], v[224:227]
    ds_read_b64_tr_b16 v[136:137], v22 offset:192
    v_mfma_f32_16x16x32_bf16 v[228:231], v[84:87], v[52:55], v[228:231]
    ds_read_b64_tr_b16 v[138:139], v22 offset:1984
    v_mfma_f32_16x16x32_bf16 v[232:235], v[84:87], v[56:59], v[232:235]
    ds_read_b64_tr_b16 v[140:141], v23 offset:224
    v_mfma_f32_16x16x32_bf16 v[236:239], v[84:87], v[60:63], v[236:239]
    ds_read_b64_tr_b16 v[142:143], v23 offset:2016
    v_mfma_f32_16x16x32_bf16 v[240:243], v[88:91], v[48:51], v[240:243]
    v_add_u32 v17, 45056, v17
    v_mfma_f32_16x16x32_bf16 v[244:247], v[88:91], v[52:55], v[244:247]
    v_add_u32 v19, 45056, v19
    v_mfma_f32_16x16x32_bf16 v[248:251], v[92:95], v[48:51], v[248:251]
    v_mfma_f32_16x16x32_bf16 v[252:255], v[92:95], v[52:55], v[252:255]
    s_waitcnt lgkmcnt(0)
    v_mfma_f32_16x16x32_bf16 v[144:147], v[112:115], v[96:99], v[144:147]
    ds_read_b128 v[48:51], v17 offset:0
    v_mfma_f32_16x16x32_bf16 v[148:151], v[112:115], v[100:103], v[148:151]
    ds_read_b64_tr_b16 v[64:65], v20 offset:14336
    v_mfma_f32_16x16x32_bf16 v[152:155], v[112:115], v[104:107], v[152:155]
    ds_read_b64_tr_b16 v[66:67], v20 offset:16128
    v_mfma_f32_16x16x32_bf16 v[156:159], v[112:115], v[108:111], v[156:159]
    ds_read_b128 v[52:55], v17 offset:2048
    v_mfma_f32_16x16x32_bf16 v[160:163], v[116:119], v[96:99], v[160:163]
    ds_read_b128 v[56:59], v19 offset:0
    v_mfma_f32_16x16x32_bf16 v[164:167], v[116:119], v[100:103], v[164:167]
    ds_read_b128 v[60:63], v19 offset:2048
    v_mfma_f32_16x16x32_bf16 v[168:171], v[116:119], v[104:107], v[168:171]
    ds_read_b64_tr_b16 v[68:69], v21 offset:14368
    v_mfma_f32_16x16x32_bf16 v[172:175], v[116:119], v[108:111], v[172:175]
    ds_read_b64_tr_b16 v[70:71], v21 offset:16160
    v_mfma_f32_16x16x32_bf16 v[176:179], v[120:123], v[96:99], v[176:179]
    ds_read_b64_tr_b16 v[72:73], v20 offset:14400
    v_mfma_f32_16x16x32_bf16 v[180:183], v[120:123], v[100:103], v[180:183]
    ds_read_b64_tr_b16 v[74:75], v20 offset:16192
    v_mfma_f32_16x16x32_bf16 v[184:187], v[120:123], v[104:107], v[184:187]
    ds_read_b64_tr_b16 v[76:77], v21 offset:14432
    v_mfma_f32_16x16x32_bf16 v[188:191], v[120:123], v[108:111], v[188:191]
    ds_read_b64_tr_b16 v[78:79], v21 offset:16224
    v_mfma_f32_16x16x32_bf16 v[192:195], v[124:127], v[96:99], v[192:195]
    ds_read_b64_tr_b16 v[80:81], v20 offset:14464
    v_mfma_f32_16x16x32_bf16 v[196:199], v[124:127], v[100:103], v[196:199]
    ds_read_b64_tr_b16 v[82:83], v20 offset:16256
    v_mfma_f32_16x16x32_bf16 v[200:203], v[124:127], v[104:107], v[200:203]
    ds_read_b64_tr_b16 v[84:85], v21 offset:14496
    v_mfma_f32_16x16x32_bf16 v[204:207], v[124:127], v[108:111], v[204:207]
    ds_read_b64_tr_b16 v[86:87], v21 offset:16288
    v_mfma_f32_16x16x32_bf16 v[208:211], v[128:131], v[96:99], v[208:211]
    ds_read_b64_tr_b16 v[88:89], v22 offset:14528
    v_mfma_f32_16x16x32_bf16 v[212:215], v[128:131], v[100:103], v[212:215]
    ds_read_b64_tr_b16 v[90:91], v22 offset:16320
    v_mfma_f32_16x16x32_bf16 v[216:219], v[128:131], v[104:107], v[216:219]
    ds_read_b64_tr_b16 v[92:93], v23 offset:14560
    v_mfma_f32_16x16x32_bf16 v[220:223], v[128:131], v[108:111], v[220:223]
    ds_read_b64_tr_b16 v[94:95], v23 offset:16352
    v_mfma_f32_16x16x32_bf16 v[224:227], v[132:135], v[96:99], v[224:227]
    v_add_u32 v16, 45056, v16
    v_mfma_f32_16x16x32_bf16 v[228:231], v[132:135], v[100:103], v[228:231]
    v_add_u32 v18, 45056, v18
    v_mfma_f32_16x16x32_bf16 v[232:235], v[132:135], v[104:107], v[232:235]
    v_mfma_f32_16x16x32_bf16 v[236:239], v[132:135], v[108:111], v[236:239]
    v_mfma_f32_16x16x32_bf16 v[240:243], v[136:139], v[96:99], v[240:243]
    v_mfma_f32_16x16x32_bf16 v[244:247], v[136:139], v[100:103], v[244:247]
    v_mfma_f32_16x16x32_bf16 v[248:251], v[140:143], v[96:99], v[248:251]
    v_mfma_f32_16x16x32_bf16 v[252:255], v[140:143], v[100:103], v[252:255]
    s_waitcnt lgkmcnt(0)
    s_barrier
    v_mfma_f32_16x16x32_bf16 v[144:147], v[64:67], v[48:51], v[144:147]
    ds_read_b128 v[96:99], v16 offset:0
    v_mfma_f32_16x16x32_bf16 v[148:151], v[64:67], v[52:55], v[148:151]
    v_add_u32 v20, 45056, v20
    v_mfma_f32_16x16x32_bf16 v[152:155], v[64:67], v[56:59], v[152:155]
    v_add_u32 v21, 45056, v21
    v_mfma_f32_16x16x32_bf16 v[156:159], v[64:67], v[60:63], v[156:159]
    v_add_u32 v22, 45056, v22
    v_mfma_f32_16x16x32_bf16 v[160:163], v[68:71], v[48:51], v[160:163]
    v_add_u32 v23, 45056, v23
    v_mfma_f32_16x16x32_bf16 v[164:167], v[68:71], v[52:55], v[164:167]
    ds_read_b64_tr_b16 v[112:113], v20 offset:0
    v_mfma_f32_16x16x32_bf16 v[168:171], v[68:71], v[56:59], v[168:171]
    ds_read_b64_tr_b16 v[114:115], v20 offset:1792
    v_mfma_f32_16x16x32_bf16 v[172:175], v[68:71], v[60:63], v[172:175]
    ds_read_b128 v[100:103], v16 offset:2048
    v_mfma_f32_16x16x32_bf16 v[176:179], v[72:75], v[48:51], v[176:179]
    ds_read_b128 v[104:107], v18 offset:0
    v_mfma_f32_16x16x32_bf16 v[180:183], v[72:75], v[52:55], v[180:183]
    ds_read_b128 v[108:111], v18 offset:2048
    v_mfma_f32_16x16x32_bf16 v[184:187], v[72:75], v[56:59], v[184:187]
    ds_read_b64_tr_b16 v[116:117], v21 offset:32
    v_mfma_f32_16x16x32_bf16 v[188:191], v[72:75], v[60:63], v[188:191]
    ds_read_b64_tr_b16 v[118:119], v21 offset:1824
    v_mfma_f32_16x16x32_bf16 v[192:195], v[76:79], v[48:51], v[192:195]
    ds_read_b64_tr_b16 v[120:121], v20 offset:64
    v_mfma_f32_16x16x32_bf16 v[196:199], v[76:79], v[52:55], v[196:199]
    ds_read_b64_tr_b16 v[122:123], v20 offset:1856
    v_mfma_f32_16x16x32_bf16 v[200:203], v[76:79], v[56:59], v[200:203]
    ds_read_b64_tr_b16 v[124:125], v21 offset:96
    v_mfma_f32_16x16x32_bf16 v[204:207], v[76:79], v[60:63], v[204:207]
    ds_read_b64_tr_b16 v[126:127], v21 offset:1888
    v_mfma_f32_16x16x32_bf16 v[208:211], v[80:83], v[48:51], v[208:211]
    ds_read_b64_tr_b16 v[128:129], v20 offset:128
    v_mfma_f32_16x16x32_bf16 v[212:215], v[80:83], v[52:55], v[212:215]
    ds_read_b64_tr_b16 v[130:131], v20 offset:1920
    v_mfma_f32_16x16x32_bf16 v[216:219], v[80:83], v[56:59], v[216:219]
    ds_read_b64_tr_b16 v[132:133], v21 offset:160
    v_mfma_f32_16x16x32_bf16 v[220:223], v[80:83], v[60:63], v[220:223]
    ds_read_b64_tr_b16 v[134:135], v21 offset:1952
    v_mfma_f32_16x16x32_bf16 v[224:227], v[84:87], v[48:51], v[224:227]
    ds_read_b64_tr_b16 v[136:137], v22 offset:192
    v_mfma_f32_16x16x32_bf16 v[228:231], v[84:87], v[52:55], v[228:231]
    ds_read_b64_tr_b16 v[138:139], v22 offset:1984
    v_mfma_f32_16x16x32_bf16 v[232:235], v[84:87], v[56:59], v[232:235]
    ds_read_b64_tr_b16 v[140:141], v23 offset:224
    v_mfma_f32_16x16x32_bf16 v[236:239], v[84:87], v[60:63], v[236:239]
    ds_read_b64_tr_b16 v[142:143], v23 offset:2016
    v_mfma_f32_16x16x32_bf16 v[240:243], v[88:91], v[48:51], v[240:243]
    v_add_u32 v17, 45056, v17
    v_mfma_f32_16x16x32_bf16 v[244:247], v[88:91], v[52:55], v[244:247]
    v_add_u32 v19, 45056, v19
    v_mfma_f32_16x16x32_bf16 v[248:251], v[92:95], v[48:51], v[248:251]
    v_mfma_f32_16x16x32_bf16 v[252:255], v[92:95], v[52:55], v[252:255]
    s_waitcnt lgkmcnt(0)
    v_mfma_f32_16x16x32_bf16 v[144:147], v[112:115], v[96:99], v[144:147]
    ds_read_b128 v[48:51], v17 offset:0
    v_mfma_f32_16x16x32_bf16 v[148:151], v[112:115], v[100:103], v[148:151]
    ds_read_b64_tr_b16 v[64:65], v20 offset:14336
    v_mfma_f32_16x16x32_bf16 v[152:155], v[112:115], v[104:107], v[152:155]
    ds_read_b64_tr_b16 v[66:67], v20 offset:16128
    v_mfma_f32_16x16x32_bf16 v[156:159], v[112:115], v[108:111], v[156:159]
    ds_read_b128 v[52:55], v17 offset:2048
    v_mfma_f32_16x16x32_bf16 v[160:163], v[116:119], v[96:99], v[160:163]
    ds_read_b128 v[56:59], v19 offset:0
    v_mfma_f32_16x16x32_bf16 v[164:167], v[116:119], v[100:103], v[164:167]
    ds_read_b128 v[60:63], v19 offset:2048
    v_mfma_f32_16x16x32_bf16 v[168:171], v[116:119], v[104:107], v[168:171]
    ds_read_b64_tr_b16 v[68:69], v21 offset:14368
    v_mfma_f32_16x16x32_bf16 v[172:175], v[116:119], v[108:111], v[172:175]
    ds_read_b64_tr_b16 v[70:71], v21 offset:16160
    v_mfma_f32_16x16x32_bf16 v[176:179], v[120:123], v[96:99], v[176:179]
    ds_read_b64_tr_b16 v[72:73], v20 offset:14400
    v_mfma_f32_16x16x32_bf16 v[180:183], v[120:123], v[100:103], v[180:183]
    ds_read_b64_tr_b16 v[74:75], v20 offset:16192
    v_mfma_f32_16x16x32_bf16 v[184:187], v[120:123], v[104:107], v[184:187]
    ds_read_b64_tr_b16 v[76:77], v21 offset:14432
    v_mfma_f32_16x16x32_bf16 v[188:191], v[120:123], v[108:111], v[188:191]
    ds_read_b64_tr_b16 v[78:79], v21 offset:16224
    v_mfma_f32_16x16x32_bf16 v[192:195], v[124:127], v[96:99], v[192:195]
    ds_read_b64_tr_b16 v[80:81], v20 offset:14464
    v_mfma_f32_16x16x32_bf16 v[196:199], v[124:127], v[100:103], v[196:199]
    ds_read_b64_tr_b16 v[82:83], v20 offset:16256
    v_mfma_f32_16x16x32_bf16 v[200:203], v[124:127], v[104:107], v[200:203]
    ds_read_b64_tr_b16 v[84:85], v21 offset:14496
    v_mfma_f32_16x16x32_bf16 v[204:207], v[124:127], v[108:111], v[204:207]
    ds_read_b64_tr_b16 v[86:87], v21 offset:16288
    v_mfma_f32_16x16x32_bf16 v[208:211], v[128:131], v[96:99], v[208:211]
    ds_read_b64_tr_b16 v[88:89], v22 offset:14528
    v_mfma_f32_16x16x32_bf16 v[212:215], v[128:131], v[100:103], v[212:215]
    ds_read_b64_tr_b16 v[90:91], v22 offset:16320
    v_mfma_f32_16x16x32_bf16 v[216:219], v[128:131], v[104:107], v[216:219]
    ds_read_b64_tr_b16 v[92:93], v23 offset:14560
    v_mfma_f32_16x16x32_bf16 v[220:223], v[128:131], v[108:111], v[220:223]
    ds_read_b64_tr_b16 v[94:95], v23 offset:16352
    v_mfma_f32_16x16x32_bf16 v[224:227], v[132:135], v[96:99], v[224:227]
    v_add_u32 v16, 4294877184, v16
    v_mfma_f32_16x16x32_bf16 v[228:231], v[132:135], v[100:103], v[228:231]
    v_add_u32 v18, 4294877184, v18
    v_mfma_f32_16x16x32_bf16 v[232:235], v[132:135], v[104:107], v[232:235]
    v_mfma_f32_16x16x32_bf16 v[236:239], v[132:135], v[108:111], v[236:239]
    v_mfma_f32_16x16x32_bf16 v[240:243], v[136:139], v[96:99], v[240:243]
    v_mfma_f32_16x16x32_bf16 v[244:247], v[136:139], v[100:103], v[244:247]
    v_mfma_f32_16x16x32_bf16 v[248:251], v[140:143], v[96:99], v[248:251]
    v_mfma_f32_16x16x32_bf16 v[252:255], v[140:143], v[100:103], v[252:255]
    s_waitcnt lgkmcnt(0)
    s_barrier
    v_mfma_f32_16x16x32_bf16 v[144:147], v[64:67], v[48:51], v[144:147]
    ds_read_b128 v[96:99], v16 offset:0
    v_mfma_f32_16x16x32_bf16 v[148:151], v[64:67], v[52:55], v[148:151]
    v_add_u32 v20, 4294877184, v20
    v_mfma_f32_16x16x32_bf16 v[152:155], v[64:67], v[56:59], v[152:155]
    v_add_u32 v21, 4294877184, v21
    v_mfma_f32_16x16x32_bf16 v[156:159], v[64:67], v[60:63], v[156:159]
    v_add_u32 v22, 4294877184, v22
    v_mfma_f32_16x16x32_bf16 v[160:163], v[68:71], v[48:51], v[160:163]
    v_add_u32 v23, 4294877184, v23
    v_mfma_f32_16x16x32_bf16 v[164:167], v[68:71], v[52:55], v[164:167]
    ds_read_b64_tr_b16 v[112:113], v20 offset:0
    v_mfma_f32_16x16x32_bf16 v[168:171], v[68:71], v[56:59], v[168:171]
    ds_read_b64_tr_b16 v[114:115], v20 offset:1792
    v_mfma_f32_16x16x32_bf16 v[172:175], v[68:71], v[60:63], v[172:175]
    ds_read_b128 v[100:103], v16 offset:2048
    v_mfma_f32_16x16x32_bf16 v[176:179], v[72:75], v[48:51], v[176:179]
    ds_read_b128 v[104:107], v18 offset:0
    v_mfma_f32_16x16x32_bf16 v[180:183], v[72:75], v[52:55], v[180:183]
    ds_read_b128 v[108:111], v18 offset:2048
    v_mfma_f32_16x16x32_bf16 v[184:187], v[72:75], v[56:59], v[184:187]
    ds_read_b64_tr_b16 v[116:117], v21 offset:32
    v_mfma_f32_16x16x32_bf16 v[188:191], v[72:75], v[60:63], v[188:191]
    ds_read_b64_tr_b16 v[118:119], v21 offset:1824
    v_mfma_f32_16x16x32_bf16 v[192:195], v[76:79], v[48:51], v[192:195]
    ds_read_b64_tr_b16 v[120:121], v20 offset:64
    v_mfma_f32_16x16x32_bf16 v[196:199], v[76:79], v[52:55], v[196:199]
    ds_read_b64_tr_b16 v[122:123], v20 offset:1856
    v_mfma_f32_16x16x32_bf16 v[200:203], v[76:79], v[56:59], v[200:203]
    ds_read_b64_tr_b16 v[124:125], v21 offset:96
    v_mfma_f32_16x16x32_bf16 v[204:207], v[76:79], v[60:63], v[204:207]
    ds_read_b64_tr_b16 v[126:127], v21 offset:1888
    v_mfma_f32_16x16x32_bf16 v[208:211], v[80:83], v[48:51], v[208:211]
    ds_read_b64_tr_b16 v[128:129], v20 offset:128
    v_mfma_f32_16x16x32_bf16 v[212:215], v[80:83], v[52:55], v[212:215]
    ds_read_b64_tr_b16 v[130:131], v20 offset:1920
    v_mfma_f32_16x16x32_bf16 v[216:219], v[80:83], v[56:59], v[216:219]
    ds_read_b64_tr_b16 v[132:133], v21 offset:160
    v_mfma_f32_16x16x32_bf16 v[220:223], v[80:83], v[60:63], v[220:223]
    ds_read_b64_tr_b16 v[134:135], v21 offset:1952
    v_mfma_f32_16x16x32_bf16 v[224:227], v[84:87], v[48:51], v[224:227]
    ds_read_b64_tr_b16 v[136:137], v22 offset:192
    v_mfma_f32_16x16x32_bf16 v[228:231], v[84:87], v[52:55], v[228:231]
    ds_read_b64_tr_b16 v[138:139], v22 offset:1984
    v_mfma_f32_16x16x32_bf16 v[232:235], v[84:87], v[56:59], v[232:235]
    ds_read_b64_tr_b16 v[140:141], v23 offset:224
    v_mfma_f32_16x16x32_bf16 v[236:239], v[84:87], v[60:63], v[236:239]
    ds_read_b64_tr_b16 v[142:143], v23 offset:2016
    v_mfma_f32_16x16x32_bf16 v[240:243], v[88:91], v[48:51], v[240:243]
    v_add_u32 v17, 4294877184, v17
    v_mfma_f32_16x16x32_bf16 v[244:247], v[88:91], v[52:55], v[244:247]
    v_add_u32 v19, 4294877184, v19
    v_mfma_f32_16x16x32_bf16 v[248:251], v[92:95], v[48:51], v[248:251]
    v_mfma_f32_16x16x32_bf16 v[252:255], v[92:95], v[52:55], v[252:255]
    s_waitcnt lgkmcnt(0)
    v_mfma_f32_16x16x32_bf16 v[144:147], v[112:115], v[96:99], v[144:147]
    ds_read_b128 v[48:51], v17 offset:0
    v_mfma_f32_16x16x32_bf16 v[148:151], v[112:115], v[100:103], v[148:151]
    ds_read_b64_tr_b16 v[64:65], v20 offset:14336
    v_mfma_f32_16x16x32_bf16 v[152:155], v[112:115], v[104:107], v[152:155]
    ds_read_b64_tr_b16 v[66:67], v20 offset:16128
    v_mfma_f32_16x16x32_bf16 v[156:159], v[112:115], v[108:111], v[156:159]
    ds_read_b128 v[52:55], v17 offset:2048
    v_mfma_f32_16x16x32_bf16 v[160:163], v[116:119], v[96:99], v[160:163]
    ds_read_b128 v[56:59], v19 offset:0
    v_mfma_f32_16x16x32_bf16 v[164:167], v[116:119], v[100:103], v[164:167]
    ds_read_b128 v[60:63], v19 offset:2048
    v_mfma_f32_16x16x32_bf16 v[168:171], v[116:119], v[104:107], v[168:171]
    ds_read_b64_tr_b16 v[68:69], v21 offset:14368
    v_mfma_f32_16x16x32_bf16 v[172:175], v[116:119], v[108:111], v[172:175]
    ds_read_b64_tr_b16 v[70:71], v21 offset:16160
    v_mfma_f32_16x16x32_bf16 v[176:179], v[120:123], v[96:99], v[176:179]
    ds_read_b64_tr_b16 v[72:73], v20 offset:14400
    v_mfma_f32_16x16x32_bf16 v[180:183], v[120:123], v[100:103], v[180:183]
    ds_read_b64_tr_b16 v[74:75], v20 offset:16192
    v_mfma_f32_16x16x32_bf16 v[184:187], v[120:123], v[104:107], v[184:187]
    ds_read_b64_tr_b16 v[76:77], v21 offset:14432
    v_mfma_f32_16x16x32_bf16 v[188:191], v[120:123], v[108:111], v[188:191]
    ds_read_b64_tr_b16 v[78:79], v21 offset:16224
    v_mfma_f32_16x16x32_bf16 v[192:195], v[124:127], v[96:99], v[192:195]
    ds_read_b64_tr_b16 v[80:81], v20 offset:14464
    v_mfma_f32_16x16x32_bf16 v[196:199], v[124:127], v[100:103], v[196:199]
    ds_read_b64_tr_b16 v[82:83], v20 offset:16256
    v_mfma_f32_16x16x32_bf16 v[200:203], v[124:127], v[104:107], v[200:203]
    ds_read_b64_tr_b16 v[84:85], v21 offset:14496
    v_mfma_f32_16x16x32_bf16 v[204:207], v[124:127], v[108:111], v[204:207]
    ds_read_b64_tr_b16 v[86:87], v21 offset:16288
    v_mfma_f32_16x16x32_bf16 v[208:211], v[128:131], v[96:99], v[208:211]
    ds_read_b64_tr_b16 v[88:89], v22 offset:14528
    v_mfma_f32_16x16x32_bf16 v[212:215], v[128:131], v[100:103], v[212:215]
    ds_read_b64_tr_b16 v[90:91], v22 offset:16320
    v_mfma_f32_16x16x32_bf16 v[216:219], v[128:131], v[104:107], v[216:219]
    ds_read_b64_tr_b16 v[92:93], v23 offset:14560
    v_mfma_f32_16x16x32_bf16 v[220:223], v[128:131], v[108:111], v[220:223]
    ds_read_b64_tr_b16 v[94:95], v23 offset:16352
    v_mfma_f32_16x16x32_bf16 v[224:227], v[132:135], v[96:99], v[224:227]
    v_add_u32 v16, 45056, v16
    v_mfma_f32_16x16x32_bf16 v[228:231], v[132:135], v[100:103], v[228:231]
    v_add_u32 v18, 45056, v18
    v_mfma_f32_16x16x32_bf16 v[232:235], v[132:135], v[104:107], v[232:235]
    v_mfma_f32_16x16x32_bf16 v[236:239], v[132:135], v[108:111], v[236:239]
    v_mfma_f32_16x16x32_bf16 v[240:243], v[136:139], v[96:99], v[240:243]
    v_mfma_f32_16x16x32_bf16 v[244:247], v[136:139], v[100:103], v[244:247]
    v_mfma_f32_16x16x32_bf16 v[248:251], v[140:143], v[96:99], v[248:251]
    v_mfma_f32_16x16x32_bf16 v[252:255], v[140:143], v[100:103], v[252:255]
    s_waitcnt lgkmcnt(0)
    s_barrier
    v_mfma_f32_16x16x32_bf16 v[144:147], v[64:67], v[48:51], v[144:147]
    ds_read_b128 v[96:99], v16 offset:0
    v_mfma_f32_16x16x32_bf16 v[148:151], v[64:67], v[52:55], v[148:151]
    v_add_u32 v20, 45056, v20
    v_mfma_f32_16x16x32_bf16 v[152:155], v[64:67], v[56:59], v[152:155]
    v_add_u32 v21, 45056, v21
    v_mfma_f32_16x16x32_bf16 v[156:159], v[64:67], v[60:63], v[156:159]
    v_add_u32 v22, 45056, v22
    v_mfma_f32_16x16x32_bf16 v[160:163], v[68:71], v[48:51], v[160:163]
    v_add_u32 v23, 45056, v23
    v_mfma_f32_16x16x32_bf16 v[164:167], v[68:71], v[52:55], v[164:167]
    ds_read_b64_tr_b16 v[112:113], v20 offset:0
    v_mfma_f32_16x16x32_bf16 v[168:171], v[68:71], v[56:59], v[168:171]
    ds_read_b64_tr_b16 v[114:115], v20 offset:1792
    v_mfma_f32_16x16x32_bf16 v[172:175], v[68:71], v[60:63], v[172:175]
    ds_read_b128 v[100:103], v16 offset:2048
    v_mfma_f32_16x16x32_bf16 v[176:179], v[72:75], v[48:51], v[176:179]
    ds_read_b128 v[104:107], v18 offset:0
    v_mfma_f32_16x16x32_bf16 v[180:183], v[72:75], v[52:55], v[180:183]
    ds_read_b128 v[108:111], v18 offset:2048
    v_mfma_f32_16x16x32_bf16 v[184:187], v[72:75], v[56:59], v[184:187]
    ds_read_b64_tr_b16 v[116:117], v21 offset:32
    v_mfma_f32_16x16x32_bf16 v[188:191], v[72:75], v[60:63], v[188:191]
    ds_read_b64_tr_b16 v[118:119], v21 offset:1824
    v_mfma_f32_16x16x32_bf16 v[192:195], v[76:79], v[48:51], v[192:195]
    ds_read_b64_tr_b16 v[120:121], v20 offset:64
    v_mfma_f32_16x16x32_bf16 v[196:199], v[76:79], v[52:55], v[196:199]
    ds_read_b64_tr_b16 v[122:123], v20 offset:1856
    v_mfma_f32_16x16x32_bf16 v[200:203], v[76:79], v[56:59], v[200:203]
    ds_read_b64_tr_b16 v[124:125], v21 offset:96
    v_mfma_f32_16x16x32_bf16 v[204:207], v[76:79], v[60:63], v[204:207]
    ds_read_b64_tr_b16 v[126:127], v21 offset:1888
    v_mfma_f32_16x16x32_bf16 v[208:211], v[80:83], v[48:51], v[208:211]
    ds_read_b64_tr_b16 v[128:129], v20 offset:128
    v_mfma_f32_16x16x32_bf16 v[212:215], v[80:83], v[52:55], v[212:215]
    ds_read_b64_tr_b16 v[130:131], v20 offset:1920
    v_mfma_f32_16x16x32_bf16 v[216:219], v[80:83], v[56:59], v[216:219]
    ds_read_b64_tr_b16 v[132:133], v21 offset:160
    v_mfma_f32_16x16x32_bf16 v[220:223], v[80:83], v[60:63], v[220:223]
    ds_read_b64_tr_b16 v[134:135], v21 offset:1952
    v_mfma_f32_16x16x32_bf16 v[224:227], v[84:87], v[48:51], v[224:227]
    ds_read_b64_tr_b16 v[136:137], v22 offset:192
    v_mfma_f32_16x16x32_bf16 v[228:231], v[84:87], v[52:55], v[228:231]
    ds_read_b64_tr_b16 v[138:139], v22 offset:1984
    v_mfma_f32_16x16x32_bf16 v[232:235], v[84:87], v[56:59], v[232:235]
    ds_read_b64_tr_b16 v[140:141], v23 offset:224
    v_mfma_f32_16x16x32_bf16 v[236:239], v[84:87], v[60:63], v[236:239]
    ds_read_b64_tr_b16 v[142:143], v23 offset:2016
    v_mfma_f32_16x16x32_bf16 v[240:243], v[88:91], v[48:51], v[240:243]
    v_add_u32 v17, 45056, v17
    v_mfma_f32_16x16x32_bf16 v[244:247], v[88:91], v[52:55], v[244:247]
    v_add_u32 v19, 45056, v19
    v_mfma_f32_16x16x32_bf16 v[248:251], v[92:95], v[48:51], v[248:251]
    v_mfma_f32_16x16x32_bf16 v[252:255], v[92:95], v[52:55], v[252:255]
    s_waitcnt lgkmcnt(0)
    v_mfma_f32_16x16x32_bf16 v[144:147], v[112:115], v[96:99], v[144:147]
    ds_read_b128 v[48:51], v17 offset:0
    v_mfma_f32_16x16x32_bf16 v[148:151], v[112:115], v[100:103], v[148:151]
    ds_read_b64_tr_b16 v[64:65], v20 offset:14336
    v_mfma_f32_16x16x32_bf16 v[152:155], v[112:115], v[104:107], v[152:155]
    ds_read_b64_tr_b16 v[66:67], v20 offset:16128
    v_mfma_f32_16x16x32_bf16 v[156:159], v[112:115], v[108:111], v[156:159]
    ds_read_b128 v[52:55], v17 offset:2048
    v_mfma_f32_16x16x32_bf16 v[160:163], v[116:119], v[96:99], v[160:163]
    ds_read_b128 v[56:59], v19 offset:0
    v_mfma_f32_16x16x32_bf16 v[164:167], v[116:119], v[100:103], v[164:167]
    ds_read_b128 v[60:63], v19 offset:2048
    v_mfma_f32_16x16x32_bf16 v[168:171], v[116:119], v[104:107], v[168:171]
    ds_read_b64_tr_b16 v[68:69], v21 offset:14368
    v_mfma_f32_16x16x32_bf16 v[172:175], v[116:119], v[108:111], v[172:175]
    ds_read_b64_tr_b16 v[70:71], v21 offset:16160
    v_mfma_f32_16x16x32_bf16 v[176:179], v[120:123], v[96:99], v[176:179]
    ds_read_b64_tr_b16 v[72:73], v20 offset:14400
    v_mfma_f32_16x16x32_bf16 v[180:183], v[120:123], v[100:103], v[180:183]
    ds_read_b64_tr_b16 v[74:75], v20 offset:16192
    v_mfma_f32_16x16x32_bf16 v[184:187], v[120:123], v[104:107], v[184:187]
    ds_read_b64_tr_b16 v[76:77], v21 offset:14432
    v_mfma_f32_16x16x32_bf16 v[188:191], v[120:123], v[108:111], v[188:191]
    ds_read_b64_tr_b16 v[78:79], v21 offset:16224
    v_mfma_f32_16x16x32_bf16 v[192:195], v[124:127], v[96:99], v[192:195]
    ds_read_b64_tr_b16 v[80:81], v20 offset:14464
    v_mfma_f32_16x16x32_bf16 v[196:199], v[124:127], v[100:103], v[196:199]
    ds_read_b64_tr_b16 v[82:83], v20 offset:16256
    v_mfma_f32_16x16x32_bf16 v[200:203], v[124:127], v[104:107], v[200:203]
    ds_read_b64_tr_b16 v[84:85], v21 offset:14496
    v_mfma_f32_16x16x32_bf16 v[204:207], v[124:127], v[108:111], v[204:207]
    ds_read_b64_tr_b16 v[86:87], v21 offset:16288
    v_mfma_f32_16x16x32_bf16 v[208:211], v[128:131], v[96:99], v[208:211]
    ds_read_b64_tr_b16 v[88:89], v22 offset:14528
    v_mfma_f32_16x16x32_bf16 v[212:215], v[128:131], v[100:103], v[212:215]
    ds_read_b64_tr_b16 v[90:91], v22 offset:16320
    v_mfma_f32_16x16x32_bf16 v[216:219], v[128:131], v[104:107], v[216:219]
    ds_read_b64_tr_b16 v[92:93], v23 offset:14560
    v_mfma_f32_16x16x32_bf16 v[220:223], v[128:131], v[108:111], v[220:223]
    ds_read_b64_tr_b16 v[94:95], v23 offset:16352
    v_mfma_f32_16x16x32_bf16 v[224:227], v[132:135], v[96:99], v[224:227]
    v_add_u32 v16, 45056, v16
    v_mfma_f32_16x16x32_bf16 v[228:231], v[132:135], v[100:103], v[228:231]
    v_add_u32 v18, 45056, v18
    v_mfma_f32_16x16x32_bf16 v[232:235], v[132:135], v[104:107], v[232:235]
    v_mfma_f32_16x16x32_bf16 v[236:239], v[132:135], v[108:111], v[236:239]
    v_mfma_f32_16x16x32_bf16 v[240:243], v[136:139], v[96:99], v[240:243]
    v_mfma_f32_16x16x32_bf16 v[244:247], v[136:139], v[100:103], v[244:247]
    v_mfma_f32_16x16x32_bf16 v[248:251], v[140:143], v[96:99], v[248:251]
    v_mfma_f32_16x16x32_bf16 v[252:255], v[140:143], v[100:103], v[252:255]
    s_waitcnt lgkmcnt(0)
    s_barrier
    v_mfma_f32_16x16x32_bf16 v[144:147], v[64:67], v[48:51], v[144:147]
    ds_read_b128 v[96:99], v16 offset:0
    v_mfma_f32_16x16x32_bf16 v[148:151], v[64:67], v[52:55], v[148:151]
    v_add_u32 v20, 45056, v20
    v_mfma_f32_16x16x32_bf16 v[152:155], v[64:67], v[56:59], v[152:155]
    v_add_u32 v21, 45056, v21
    v_mfma_f32_16x16x32_bf16 v[156:159], v[64:67], v[60:63], v[156:159]
    v_add_u32 v22, 45056, v22
    v_mfma_f32_16x16x32_bf16 v[160:163], v[68:71], v[48:51], v[160:163]
    v_add_u32 v23, 45056, v23
    v_mfma_f32_16x16x32_bf16 v[164:167], v[68:71], v[52:55], v[164:167]
    ds_read_b64_tr_b16 v[112:113], v20 offset:0
    v_mfma_f32_16x16x32_bf16 v[168:171], v[68:71], v[56:59], v[168:171]
    ds_read_b64_tr_b16 v[114:115], v20 offset:1792
    v_mfma_f32_16x16x32_bf16 v[172:175], v[68:71], v[60:63], v[172:175]
    ds_read_b128 v[100:103], v16 offset:2048
    v_mfma_f32_16x16x32_bf16 v[176:179], v[72:75], v[48:51], v[176:179]
    ds_read_b128 v[104:107], v18 offset:0
    v_mfma_f32_16x16x32_bf16 v[180:183], v[72:75], v[52:55], v[180:183]
    ds_read_b128 v[108:111], v18 offset:2048
    v_mfma_f32_16x16x32_bf16 v[184:187], v[72:75], v[56:59], v[184:187]
    ds_read_b64_tr_b16 v[116:117], v21 offset:32
    v_mfma_f32_16x16x32_bf16 v[188:191], v[72:75], v[60:63], v[188:191]
    ds_read_b64_tr_b16 v[118:119], v21 offset:1824
    v_mfma_f32_16x16x32_bf16 v[192:195], v[76:79], v[48:51], v[192:195]
    ds_read_b64_tr_b16 v[120:121], v20 offset:64
    v_mfma_f32_16x16x32_bf16 v[196:199], v[76:79], v[52:55], v[196:199]
    ds_read_b64_tr_b16 v[122:123], v20 offset:1856
    v_mfma_f32_16x16x32_bf16 v[200:203], v[76:79], v[56:59], v[200:203]
    ds_read_b64_tr_b16 v[124:125], v21 offset:96
    v_mfma_f32_16x16x32_bf16 v[204:207], v[76:79], v[60:63], v[204:207]
    ds_read_b64_tr_b16 v[126:127], v21 offset:1888
    v_mfma_f32_16x16x32_bf16 v[208:211], v[80:83], v[48:51], v[208:211]
    ds_read_b64_tr_b16 v[128:129], v20 offset:128
    v_mfma_f32_16x16x32_bf16 v[212:215], v[80:83], v[52:55], v[212:215]
    ds_read_b64_tr_b16 v[130:131], v20 offset:1920
    v_mfma_f32_16x16x32_bf16 v[216:219], v[80:83], v[56:59], v[216:219]
    ds_read_b64_tr_b16 v[132:133], v21 offset:160
    v_mfma_f32_16x16x32_bf16 v[220:223], v[80:83], v[60:63], v[220:223]
    ds_read_b64_tr_b16 v[134:135], v21 offset:1952
    v_mfma_f32_16x16x32_bf16 v[224:227], v[84:87], v[48:51], v[224:227]
    ds_read_b64_tr_b16 v[136:137], v22 offset:192
    v_mfma_f32_16x16x32_bf16 v[228:231], v[84:87], v[52:55], v[228:231]
    ds_read_b64_tr_b16 v[138:139], v22 offset:1984
    v_mfma_f32_16x16x32_bf16 v[232:235], v[84:87], v[56:59], v[232:235]
    ds_read_b64_tr_b16 v[140:141], v23 offset:224
    v_mfma_f32_16x16x32_bf16 v[236:239], v[84:87], v[60:63], v[236:239]
    ds_read_b64_tr_b16 v[142:143], v23 offset:2016
    v_mfma_f32_16x16x32_bf16 v[240:243], v[88:91], v[48:51], v[240:243]
    v_add_u32 v17, 45056, v17
    v_mfma_f32_16x16x32_bf16 v[244:247], v[88:91], v[52:55], v[244:247]
    v_add_u32 v19, 45056, v19
    v_mfma_f32_16x16x32_bf16 v[248:251], v[92:95], v[48:51], v[248:251]
    v_mfma_f32_16x16x32_bf16 v[252:255], v[92:95], v[52:55], v[252:255]
    s_waitcnt lgkmcnt(0)
    v_mfma_f32_16x16x32_bf16 v[144:147], v[112:115], v[96:99], v[144:147]
    ds_read_b128 v[48:51], v17 offset:0
    v_mfma_f32_16x16x32_bf16 v[148:151], v[112:115], v[100:103], v[148:151]
    ds_read_b64_tr_b16 v[64:65], v20 offset:14336
    v_mfma_f32_16x16x32_bf16 v[152:155], v[112:115], v[104:107], v[152:155]
    ds_read_b64_tr_b16 v[66:67], v20 offset:16128
    v_mfma_f32_16x16x32_bf16 v[156:159], v[112:115], v[108:111], v[156:159]
    ds_read_b128 v[52:55], v17 offset:2048
    v_mfma_f32_16x16x32_bf16 v[160:163], v[116:119], v[96:99], v[160:163]
    ds_read_b128 v[56:59], v19 offset:0
    v_mfma_f32_16x16x32_bf16 v[164:167], v[116:119], v[100:103], v[164:167]
    ds_read_b128 v[60:63], v19 offset:2048
    v_mfma_f32_16x16x32_bf16 v[168:171], v[116:119], v[104:107], v[168:171]
    ds_read_b64_tr_b16 v[68:69], v21 offset:14368
    v_mfma_f32_16x16x32_bf16 v[172:175], v[116:119], v[108:111], v[172:175]
    ds_read_b64_tr_b16 v[70:71], v21 offset:16160
    v_mfma_f32_16x16x32_bf16 v[176:179], v[120:123], v[96:99], v[176:179]
    ds_read_b64_tr_b16 v[72:73], v20 offset:14400
    v_mfma_f32_16x16x32_bf16 v[180:183], v[120:123], v[100:103], v[180:183]
    ds_read_b64_tr_b16 v[74:75], v20 offset:16192
    v_mfma_f32_16x16x32_bf16 v[184:187], v[120:123], v[104:107], v[184:187]
    ds_read_b64_tr_b16 v[76:77], v21 offset:14432
    v_mfma_f32_16x16x32_bf16 v[188:191], v[120:123], v[108:111], v[188:191]
    ds_read_b64_tr_b16 v[78:79], v21 offset:16224
    v_mfma_f32_16x16x32_bf16 v[192:195], v[124:127], v[96:99], v[192:195]
    ds_read_b64_tr_b16 v[80:81], v20 offset:14464
    v_mfma_f32_16x16x32_bf16 v[196:199], v[124:127], v[100:103], v[196:199]
    ds_read_b64_tr_b16 v[82:83], v20 offset:16256
    v_mfma_f32_16x16x32_bf16 v[200:203], v[124:127], v[104:107], v[200:203]
    ds_read_b64_tr_b16 v[84:85], v21 offset:14496
    v_mfma_f32_16x16x32_bf16 v[204:207], v[124:127], v[108:111], v[204:207]
    ds_read_b64_tr_b16 v[86:87], v21 offset:16288
    v_mfma_f32_16x16x32_bf16 v[208:211], v[128:131], v[96:99], v[208:211]
    ds_read_b64_tr_b16 v[88:89], v22 offset:14528
    v_mfma_f32_16x16x32_bf16 v[212:215], v[128:131], v[100:103], v[212:215]
    ds_read_b64_tr_b16 v[90:91], v22 offset:16320
    v_mfma_f32_16x16x32_bf16 v[216:219], v[128:131], v[104:107], v[216:219]
    ds_read_b64_tr_b16 v[92:93], v23 offset:14560
    v_mfma_f32_16x16x32_bf16 v[220:223], v[128:131], v[108:111], v[220:223]
    ds_read_b64_tr_b16 v[94:95], v23 offset:16352
    v_mfma_f32_16x16x32_bf16 v[224:227], v[132:135], v[96:99], v[224:227]
    v_add_u32 v16, 4294877184, v16
    v_mfma_f32_16x16x32_bf16 v[228:231], v[132:135], v[100:103], v[228:231]
    v_add_u32 v18, 4294877184, v18
    v_mfma_f32_16x16x32_bf16 v[232:235], v[132:135], v[104:107], v[232:235]
    v_mfma_f32_16x16x32_bf16 v[236:239], v[132:135], v[108:111], v[236:239]
    v_mfma_f32_16x16x32_bf16 v[240:243], v[136:139], v[96:99], v[240:243]
    v_mfma_f32_16x16x32_bf16 v[244:247], v[136:139], v[100:103], v[244:247]
    v_mfma_f32_16x16x32_bf16 v[248:251], v[140:143], v[96:99], v[248:251]
    v_mfma_f32_16x16x32_bf16 v[252:255], v[140:143], v[100:103], v[252:255]
    s_waitcnt lgkmcnt(0)
    s_barrier
    v_mfma_f32_16x16x32_bf16 v[144:147], v[64:67], v[48:51], v[144:147]
    ds_read_b128 v[96:99], v16 offset:0
    v_mfma_f32_16x16x32_bf16 v[148:151], v[64:67], v[52:55], v[148:151]
    v_add_u32 v20, 4294877184, v20
    v_mfma_f32_16x16x32_bf16 v[152:155], v[64:67], v[56:59], v[152:155]
    v_add_u32 v21, 4294877184, v21
    v_mfma_f32_16x16x32_bf16 v[156:159], v[64:67], v[60:63], v[156:159]
    v_add_u32 v22, 4294877184, v22
    v_mfma_f32_16x16x32_bf16 v[160:163], v[68:71], v[48:51], v[160:163]
    v_add_u32 v23, 4294877184, v23
    v_mfma_f32_16x16x32_bf16 v[164:167], v[68:71], v[52:55], v[164:167]
    ds_read_b64_tr_b16 v[112:113], v20 offset:0
    v_mfma_f32_16x16x32_bf16 v[168:171], v[68:71], v[56:59], v[168:171]
    ds_read_b64_tr_b16 v[114:115], v20 offset:1792
    v_mfma_f32_16x16x32_bf16 v[172:175], v[68:71], v[60:63], v[172:175]
    ds_read_b128 v[100:103], v16 offset:2048
    v_mfma_f32_16x16x32_bf16 v[176:179], v[72:75], v[48:51], v[176:179]
    ds_read_b128 v[104:107], v18 offset:0
    v_mfma_f32_16x16x32_bf16 v[180:183], v[72:75], v[52:55], v[180:183]
    ds_read_b128 v[108:111], v18 offset:2048
    v_mfma_f32_16x16x32_bf16 v[184:187], v[72:75], v[56:59], v[184:187]
    ds_read_b64_tr_b16 v[116:117], v21 offset:32
    v_mfma_f32_16x16x32_bf16 v[188:191], v[72:75], v[60:63], v[188:191]
    ds_read_b64_tr_b16 v[118:119], v21 offset:1824
    v_mfma_f32_16x16x32_bf16 v[192:195], v[76:79], v[48:51], v[192:195]
    ds_read_b64_tr_b16 v[120:121], v20 offset:64
    v_mfma_f32_16x16x32_bf16 v[196:199], v[76:79], v[52:55], v[196:199]
    ds_read_b64_tr_b16 v[122:123], v20 offset:1856
    v_mfma_f32_16x16x32_bf16 v[200:203], v[76:79], v[56:59], v[200:203]
    ds_read_b64_tr_b16 v[124:125], v21 offset:96
    v_mfma_f32_16x16x32_bf16 v[204:207], v[76:79], v[60:63], v[204:207]
    ds_read_b64_tr_b16 v[126:127], v21 offset:1888
    v_mfma_f32_16x16x32_bf16 v[208:211], v[80:83], v[48:51], v[208:211]
    ds_read_b64_tr_b16 v[128:129], v20 offset:128
    v_mfma_f32_16x16x32_bf16 v[212:215], v[80:83], v[52:55], v[212:215]
    ds_read_b64_tr_b16 v[130:131], v20 offset:1920
    v_mfma_f32_16x16x32_bf16 v[216:219], v[80:83], v[56:59], v[216:219]
    ds_read_b64_tr_b16 v[132:133], v21 offset:160
    v_mfma_f32_16x16x32_bf16 v[220:223], v[80:83], v[60:63], v[220:223]
    ds_read_b64_tr_b16 v[134:135], v21 offset:1952
    v_mfma_f32_16x16x32_bf16 v[224:227], v[84:87], v[48:51], v[224:227]
    ds_read_b64_tr_b16 v[136:137], v22 offset:192
    v_mfma_f32_16x16x32_bf16 v[228:231], v[84:87], v[52:55], v[228:231]
    ds_read_b64_tr_b16 v[138:139], v22 offset:1984
    v_mfma_f32_16x16x32_bf16 v[232:235], v[84:87], v[56:59], v[232:235]
    ds_read_b64_tr_b16 v[140:141], v23 offset:224
    v_mfma_f32_16x16x32_bf16 v[236:239], v[84:87], v[60:63], v[236:239]
    ds_read_b64_tr_b16 v[142:143], v23 offset:2016
    v_mfma_f32_16x16x32_bf16 v[240:243], v[88:91], v[48:51], v[240:243]
    v_add_u32 v17, 4294877184, v17
    v_mfma_f32_16x16x32_bf16 v[244:247], v[88:91], v[52:55], v[244:247]
    v_add_u32 v19, 4294877184, v19
    v_mfma_f32_16x16x32_bf16 v[248:251], v[92:95], v[48:51], v[248:251]
    v_mfma_f32_16x16x32_bf16 v[252:255], v[92:95], v[52:55], v[252:255]
    s_waitcnt lgkmcnt(0)
    v_mfma_f32_16x16x32_bf16 v[144:147], v[112:115], v[96:99], v[144:147]
    ds_read_b128 v[48:51], v17 offset:0
    v_mfma_f32_16x16x32_bf16 v[148:151], v[112:115], v[100:103], v[148:151]
    ds_read_b64_tr_b16 v[64:65], v20 offset:14336
    v_mfma_f32_16x16x32_bf16 v[152:155], v[112:115], v[104:107], v[152:155]
    ds_read_b64_tr_b16 v[66:67], v20 offset:16128
    v_mfma_f32_16x16x32_bf16 v[156:159], v[112:115], v[108:111], v[156:159]
    ds_read_b128 v[52:55], v17 offset:2048
    v_mfma_f32_16x16x32_bf16 v[160:163], v[116:119], v[96:99], v[160:163]
    ds_read_b128 v[56:59], v19 offset:0
    v_mfma_f32_16x16x32_bf16 v[164:167], v[116:119], v[100:103], v[164:167]
    ds_read_b128 v[60:63], v19 offset:2048
    v_mfma_f32_16x16x32_bf16 v[168:171], v[116:119], v[104:107], v[168:171]
    ds_read_b64_tr_b16 v[68:69], v21 offset:14368
    v_mfma_f32_16x16x32_bf16 v[172:175], v[116:119], v[108:111], v[172:175]
    ds_read_b64_tr_b16 v[70:71], v21 offset:16160
    v_mfma_f32_16x16x32_bf16 v[176:179], v[120:123], v[96:99], v[176:179]
    ds_read_b64_tr_b16 v[72:73], v20 offset:14400
    v_mfma_f32_16x16x32_bf16 v[180:183], v[120:123], v[100:103], v[180:183]
    ds_read_b64_tr_b16 v[74:75], v20 offset:16192
    v_mfma_f32_16x16x32_bf16 v[184:187], v[120:123], v[104:107], v[184:187]
    ds_read_b64_tr_b16 v[76:77], v21 offset:14432
    v_mfma_f32_16x16x32_bf16 v[188:191], v[120:123], v[108:111], v[188:191]
    ds_read_b64_tr_b16 v[78:79], v21 offset:16224
    v_mfma_f32_16x16x32_bf16 v[192:195], v[124:127], v[96:99], v[192:195]
    ds_read_b64_tr_b16 v[80:81], v20 offset:14464
    v_mfma_f32_16x16x32_bf16 v[196:199], v[124:127], v[100:103], v[196:199]
    ds_read_b64_tr_b16 v[82:83], v20 offset:16256
    v_mfma_f32_16x16x32_bf16 v[200:203], v[124:127], v[104:107], v[200:203]
    ds_read_b64_tr_b16 v[84:85], v21 offset:14496
    v_mfma_f32_16x16x32_bf16 v[204:207], v[124:127], v[108:111], v[204:207]
    ds_read_b64_tr_b16 v[86:87], v21 offset:16288
    v_mfma_f32_16x16x32_bf16 v[208:211], v[128:131], v[96:99], v[208:211]
    ds_read_b64_tr_b16 v[88:89], v22 offset:14528
    v_mfma_f32_16x16x32_bf16 v[212:215], v[128:131], v[100:103], v[212:215]
    ds_read_b64_tr_b16 v[90:91], v22 offset:16320
    v_mfma_f32_16x16x32_bf16 v[216:219], v[128:131], v[104:107], v[216:219]
    ds_read_b64_tr_b16 v[92:93], v23 offset:14560
    v_mfma_f32_16x16x32_bf16 v[220:223], v[128:131], v[108:111], v[220:223]
    ds_read_b64_tr_b16 v[94:95], v23 offset:16352
    v_mfma_f32_16x16x32_bf16 v[224:227], v[132:135], v[96:99], v[224:227]
    v_add_u32 v16, 45056, v16
    v_mfma_f32_16x16x32_bf16 v[228:231], v[132:135], v[100:103], v[228:231]
    v_add_u32 v18, 45056, v18
    v_mfma_f32_16x16x32_bf16 v[232:235], v[132:135], v[104:107], v[232:235]
    v_mfma_f32_16x16x32_bf16 v[236:239], v[132:135], v[108:111], v[236:239]
    v_mfma_f32_16x16x32_bf16 v[240:243], v[136:139], v[96:99], v[240:243]
    v_mfma_f32_16x16x32_bf16 v[244:247], v[136:139], v[100:103], v[244:247]
    v_mfma_f32_16x16x32_bf16 v[248:251], v[140:143], v[96:99], v[248:251]
    v_mfma_f32_16x16x32_bf16 v[252:255], v[140:143], v[100:103], v[252:255]
    s_waitcnt lgkmcnt(0)
    s_barrier
    v_mfma_f32_16x16x32_bf16 v[144:147], v[64:67], v[48:51], v[144:147]
    ds_read_b128 v[96:99], v16 offset:0
    v_mfma_f32_16x16x32_bf16 v[148:151], v[64:67], v[52:55], v[148:151]
    v_add_u32 v20, 45056, v20
    v_mfma_f32_16x16x32_bf16 v[152:155], v[64:67], v[56:59], v[152:155]
    v_add_u32 v21, 45056, v21
    v_mfma_f32_16x16x32_bf16 v[156:159], v[64:67], v[60:63], v[156:159]
    v_add_u32 v22, 45056, v22
    v_mfma_f32_16x16x32_bf16 v[160:163], v[68:71], v[48:51], v[160:163]
    v_add_u32 v23, 45056, v23
    v_mfma_f32_16x16x32_bf16 v[164:167], v[68:71], v[52:55], v[164:167]
    ds_read_b64_tr_b16 v[112:113], v20 offset:0
    v_mfma_f32_16x16x32_bf16 v[168:171], v[68:71], v[56:59], v[168:171]
    ds_read_b64_tr_b16 v[114:115], v20 offset:1792
    v_mfma_f32_16x16x32_bf16 v[172:175], v[68:71], v[60:63], v[172:175]
    ds_read_b128 v[100:103], v16 offset:2048
    v_mfma_f32_16x16x32_bf16 v[176:179], v[72:75], v[48:51], v[176:179]
    ds_read_b128 v[104:107], v18 offset:0
    v_mfma_f32_16x16x32_bf16 v[180:183], v[72:75], v[52:55], v[180:183]
    ds_read_b128 v[108:111], v18 offset:2048
    v_mfma_f32_16x16x32_bf16 v[184:187], v[72:75], v[56:59], v[184:187]
    ds_read_b64_tr_b16 v[116:117], v21 offset:32
    v_mfma_f32_16x16x32_bf16 v[188:191], v[72:75], v[60:63], v[188:191]
    ds_read_b64_tr_b16 v[118:119], v21 offset:1824
    v_mfma_f32_16x16x32_bf16 v[192:195], v[76:79], v[48:51], v[192:195]
    ds_read_b64_tr_b16 v[120:121], v20 offset:64
    v_mfma_f32_16x16x32_bf16 v[196:199], v[76:79], v[52:55], v[196:199]
    ds_read_b64_tr_b16 v[122:123], v20 offset:1856
    v_mfma_f32_16x16x32_bf16 v[200:203], v[76:79], v[56:59], v[200:203]
    ds_read_b64_tr_b16 v[124:125], v21 offset:96
    v_mfma_f32_16x16x32_bf16 v[204:207], v[76:79], v[60:63], v[204:207]
    ds_read_b64_tr_b16 v[126:127], v21 offset:1888
    v_mfma_f32_16x16x32_bf16 v[208:211], v[80:83], v[48:51], v[208:211]
    ds_read_b64_tr_b16 v[128:129], v20 offset:128
    v_mfma_f32_16x16x32_bf16 v[212:215], v[80:83], v[52:55], v[212:215]
    ds_read_b64_tr_b16 v[130:131], v20 offset:1920
    v_mfma_f32_16x16x32_bf16 v[216:219], v[80:83], v[56:59], v[216:219]
    ds_read_b64_tr_b16 v[132:133], v21 offset:160
    v_mfma_f32_16x16x32_bf16 v[220:223], v[80:83], v[60:63], v[220:223]
    ds_read_b64_tr_b16 v[134:135], v21 offset:1952
    v_mfma_f32_16x16x32_bf16 v[224:227], v[84:87], v[48:51], v[224:227]
    ds_read_b64_tr_b16 v[136:137], v22 offset:192
    v_mfma_f32_16x16x32_bf16 v[228:231], v[84:87], v[52:55], v[228:231]
    ds_read_b64_tr_b16 v[138:139], v22 offset:1984
    v_mfma_f32_16x16x32_bf16 v[232:235], v[84:87], v[56:59], v[232:235]
    ds_read_b64_tr_b16 v[140:141], v23 offset:224
    v_mfma_f32_16x16x32_bf16 v[236:239], v[84:87], v[60:63], v[236:239]
    ds_read_b64_tr_b16 v[142:143], v23 offset:2016
    v_mfma_f32_16x16x32_bf16 v[240:243], v[88:91], v[48:51], v[240:243]
    v_add_u32 v17, 45056, v17
    v_mfma_f32_16x16x32_bf16 v[244:247], v[88:91], v[52:55], v[244:247]
    v_add_u32 v19, 45056, v19
    v_mfma_f32_16x16x32_bf16 v[248:251], v[92:95], v[48:51], v[248:251]
    v_mfma_f32_16x16x32_bf16 v[252:255], v[92:95], v[52:55], v[252:255]
    s_waitcnt lgkmcnt(0)
    v_mfma_f32_16x16x32_bf16 v[144:147], v[112:115], v[96:99], v[144:147]
    ds_read_b128 v[48:51], v17 offset:0
    v_mfma_f32_16x16x32_bf16 v[148:151], v[112:115], v[100:103], v[148:151]
    ds_read_b64_tr_b16 v[64:65], v20 offset:14336
    v_mfma_f32_16x16x32_bf16 v[152:155], v[112:115], v[104:107], v[152:155]
    ds_read_b64_tr_b16 v[66:67], v20 offset:16128
    v_mfma_f32_16x16x32_bf16 v[156:159], v[112:115], v[108:111], v[156:159]
    ds_read_b128 v[52:55], v17 offset:2048
    v_mfma_f32_16x16x32_bf16 v[160:163], v[116:119], v[96:99], v[160:163]
    ds_read_b128 v[56:59], v19 offset:0
    v_mfma_f32_16x16x32_bf16 v[164:167], v[116:119], v[100:103], v[164:167]
    ds_read_b128 v[60:63], v19 offset:2048
    v_mfma_f32_16x16x32_bf16 v[168:171], v[116:119], v[104:107], v[168:171]
    ds_read_b64_tr_b16 v[68:69], v21 offset:14368
    v_mfma_f32_16x16x32_bf16 v[172:175], v[116:119], v[108:111], v[172:175]
    ds_read_b64_tr_b16 v[70:71], v21 offset:16160
    v_mfma_f32_16x16x32_bf16 v[176:179], v[120:123], v[96:99], v[176:179]
    ds_read_b64_tr_b16 v[72:73], v20 offset:14400
    v_mfma_f32_16x16x32_bf16 v[180:183], v[120:123], v[100:103], v[180:183]
    ds_read_b64_tr_b16 v[74:75], v20 offset:16192
    v_mfma_f32_16x16x32_bf16 v[184:187], v[120:123], v[104:107], v[184:187]
    ds_read_b64_tr_b16 v[76:77], v21 offset:14432
    v_mfma_f32_16x16x32_bf16 v[188:191], v[120:123], v[108:111], v[188:191]
    ds_read_b64_tr_b16 v[78:79], v21 offset:16224
    v_mfma_f32_16x16x32_bf16 v[192:195], v[124:127], v[96:99], v[192:195]
    ds_read_b64_tr_b16 v[80:81], v20 offset:14464
    v_mfma_f32_16x16x32_bf16 v[196:199], v[124:127], v[100:103], v[196:199]
    ds_read_b64_tr_b16 v[82:83], v20 offset:16256
    v_mfma_f32_16x16x32_bf16 v[200:203], v[124:127], v[104:107], v[200:203]
    ds_read_b64_tr_b16 v[84:85], v21 offset:14496
    v_mfma_f32_16x16x32_bf16 v[204:207], v[124:127], v[108:111], v[204:207]
    ds_read_b64_tr_b16 v[86:87], v21 offset:16288
    v_mfma_f32_16x16x32_bf16 v[208:211], v[128:131], v[96:99], v[208:211]
    ds_read_b64_tr_b16 v[88:89], v22 offset:14528
    v_mfma_f32_16x16x32_bf16 v[212:215], v[128:131], v[100:103], v[212:215]
    ds_read_b64_tr_b16 v[90:91], v22 offset:16320
    v_mfma_f32_16x16x32_bf16 v[216:219], v[128:131], v[104:107], v[216:219]
    ds_read_b64_tr_b16 v[92:93], v23 offset:14560
    v_mfma_f32_16x16x32_bf16 v[220:223], v[128:131], v[108:111], v[220:223]
    ds_read_b64_tr_b16 v[94:95], v23 offset:16352
    v_mfma_f32_16x16x32_bf16 v[224:227], v[132:135], v[96:99], v[224:227]
    v_add_u32 v16, 45056, v16
    v_mfma_f32_16x16x32_bf16 v[228:231], v[132:135], v[100:103], v[228:231]
    v_add_u32 v18, 45056, v18
    v_mfma_f32_16x16x32_bf16 v[232:235], v[132:135], v[104:107], v[232:235]
    v_mfma_f32_16x16x32_bf16 v[236:239], v[132:135], v[108:111], v[236:239]
    v_mfma_f32_16x16x32_bf16 v[240:243], v[136:139], v[96:99], v[240:243]
    v_mfma_f32_16x16x32_bf16 v[244:247], v[136:139], v[100:103], v[244:247]
    v_mfma_f32_16x16x32_bf16 v[248:251], v[140:143], v[96:99], v[248:251]
    v_mfma_f32_16x16x32_bf16 v[252:255], v[140:143], v[100:103], v[252:255]
    s_waitcnt lgkmcnt(0)
    s_barrier
    v_mfma_f32_16x16x32_bf16 v[144:147], v[64:67], v[48:51], v[144:147]
    ds_read_b128 v[96:99], v16 offset:0
    v_mfma_f32_16x16x32_bf16 v[148:151], v[64:67], v[52:55], v[148:151]
    v_add_u32 v20, 45056, v20
    v_mfma_f32_16x16x32_bf16 v[152:155], v[64:67], v[56:59], v[152:155]
    v_add_u32 v21, 45056, v21
    v_mfma_f32_16x16x32_bf16 v[156:159], v[64:67], v[60:63], v[156:159]
    v_add_u32 v22, 45056, v22
    v_mfma_f32_16x16x32_bf16 v[160:163], v[68:71], v[48:51], v[160:163]
    v_add_u32 v23, 45056, v23
    v_mfma_f32_16x16x32_bf16 v[164:167], v[68:71], v[52:55], v[164:167]
    ds_read_b64_tr_b16 v[112:113], v20 offset:0
    v_mfma_f32_16x16x32_bf16 v[168:171], v[68:71], v[56:59], v[168:171]
    ds_read_b64_tr_b16 v[114:115], v20 offset:1792
    v_mfma_f32_16x16x32_bf16 v[172:175], v[68:71], v[60:63], v[172:175]
    ds_read_b128 v[100:103], v16 offset:2048
    v_mfma_f32_16x16x32_bf16 v[176:179], v[72:75], v[48:51], v[176:179]
    ds_read_b128 v[104:107], v18 offset:0
    v_mfma_f32_16x16x32_bf16 v[180:183], v[72:75], v[52:55], v[180:183]
    ds_read_b128 v[108:111], v18 offset:2048
    v_mfma_f32_16x16x32_bf16 v[184:187], v[72:75], v[56:59], v[184:187]
    ds_read_b64_tr_b16 v[116:117], v21 offset:32
    v_mfma_f32_16x16x32_bf16 v[188:191], v[72:75], v[60:63], v[188:191]
    ds_read_b64_tr_b16 v[118:119], v21 offset:1824
    v_mfma_f32_16x16x32_bf16 v[192:195], v[76:79], v[48:51], v[192:195]
    ds_read_b64_tr_b16 v[120:121], v20 offset:64
    v_mfma_f32_16x16x32_bf16 v[196:199], v[76:79], v[52:55], v[196:199]
    ds_read_b64_tr_b16 v[122:123], v20 offset:1856
    v_mfma_f32_16x16x32_bf16 v[200:203], v[76:79], v[56:59], v[200:203]
    ds_read_b64_tr_b16 v[124:125], v21 offset:96
    v_mfma_f32_16x16x32_bf16 v[204:207], v[76:79], v[60:63], v[204:207]
    ds_read_b64_tr_b16 v[126:127], v21 offset:1888
    v_mfma_f32_16x16x32_bf16 v[208:211], v[80:83], v[48:51], v[208:211]
    ds_read_b64_tr_b16 v[128:129], v20 offset:128
    v_mfma_f32_16x16x32_bf16 v[212:215], v[80:83], v[52:55], v[212:215]
    ds_read_b64_tr_b16 v[130:131], v20 offset:1920
    v_mfma_f32_16x16x32_bf16 v[216:219], v[80:83], v[56:59], v[216:219]
    ds_read_b64_tr_b16 v[132:133], v21 offset:160
    v_mfma_f32_16x16x32_bf16 v[220:223], v[80:83], v[60:63], v[220:223]
    ds_read_b64_tr_b16 v[134:135], v21 offset:1952
    v_mfma_f32_16x16x32_bf16 v[224:227], v[84:87], v[48:51], v[224:227]
    ds_read_b64_tr_b16 v[136:137], v22 offset:192
    v_mfma_f32_16x16x32_bf16 v[228:231], v[84:87], v[52:55], v[228:231]
    ds_read_b64_tr_b16 v[138:139], v22 offset:1984
    v_mfma_f32_16x16x32_bf16 v[232:235], v[84:87], v[56:59], v[232:235]
    ds_read_b64_tr_b16 v[140:141], v23 offset:224
    v_mfma_f32_16x16x32_bf16 v[236:239], v[84:87], v[60:63], v[236:239]
    ds_read_b64_tr_b16 v[142:143], v23 offset:2016
    v_mfma_f32_16x16x32_bf16 v[240:243], v[88:91], v[48:51], v[240:243]
    v_add_u32 v17, 45056, v17
    v_mfma_f32_16x16x32_bf16 v[244:247], v[88:91], v[52:55], v[244:247]
    v_add_u32 v19, 45056, v19
    v_mfma_f32_16x16x32_bf16 v[248:251], v[92:95], v[48:51], v[248:251]
    v_mfma_f32_16x16x32_bf16 v[252:255], v[92:95], v[52:55], v[252:255]
    s_waitcnt lgkmcnt(0)
    v_mfma_f32_16x16x32_bf16 v[144:147], v[112:115], v[96:99], v[144:147]
    ds_read_b128 v[48:51], v17 offset:0
    v_mfma_f32_16x16x32_bf16 v[148:151], v[112:115], v[100:103], v[148:151]
    ds_read_b64_tr_b16 v[64:65], v20 offset:14336
    v_mfma_f32_16x16x32_bf16 v[152:155], v[112:115], v[104:107], v[152:155]
    ds_read_b64_tr_b16 v[66:67], v20 offset:16128
    v_mfma_f32_16x16x32_bf16 v[156:159], v[112:115], v[108:111], v[156:159]
    ds_read_b128 v[52:55], v17 offset:2048
    v_mfma_f32_16x16x32_bf16 v[160:163], v[116:119], v[96:99], v[160:163]
    ds_read_b128 v[56:59], v19 offset:0
    v_mfma_f32_16x16x32_bf16 v[164:167], v[116:119], v[100:103], v[164:167]
    ds_read_b128 v[60:63], v19 offset:2048
    v_mfma_f32_16x16x32_bf16 v[168:171], v[116:119], v[104:107], v[168:171]
    ds_read_b64_tr_b16 v[68:69], v21 offset:14368
    v_mfma_f32_16x16x32_bf16 v[172:175], v[116:119], v[108:111], v[172:175]
    ds_read_b64_tr_b16 v[70:71], v21 offset:16160
    v_mfma_f32_16x16x32_bf16 v[176:179], v[120:123], v[96:99], v[176:179]
    ds_read_b64_tr_b16 v[72:73], v20 offset:14400
    v_mfma_f32_16x16x32_bf16 v[180:183], v[120:123], v[100:103], v[180:183]
    ds_read_b64_tr_b16 v[74:75], v20 offset:16192
    v_mfma_f32_16x16x32_bf16 v[184:187], v[120:123], v[104:107], v[184:187]
    ds_read_b64_tr_b16 v[76:77], v21 offset:14432
    v_mfma_f32_16x16x32_bf16 v[188:191], v[120:123], v[108:111], v[188:191]
    ds_read_b64_tr_b16 v[78:79], v21 offset:16224
    v_mfma_f32_16x16x32_bf16 v[192:195], v[124:127], v[96:99], v[192:195]
    ds_read_b64_tr_b16 v[80:81], v20 offset:14464
    v_mfma_f32_16x16x32_bf16 v[196:199], v[124:127], v[100:103], v[196:199]
    ds_read_b64_tr_b16 v[82:83], v20 offset:16256
    v_mfma_f32_16x16x32_bf16 v[200:203], v[124:127], v[104:107], v[200:203]
    ds_read_b64_tr_b16 v[84:85], v21 offset:14496
    v_mfma_f32_16x16x32_bf16 v[204:207], v[124:127], v[108:111], v[204:207]
    ds_read_b64_tr_b16 v[86:87], v21 offset:16288
    v_mfma_f32_16x16x32_bf16 v[208:211], v[128:131], v[96:99], v[208:211]
    ds_read_b64_tr_b16 v[88:89], v22 offset:14528
    v_mfma_f32_16x16x32_bf16 v[212:215], v[128:131], v[100:103], v[212:215]
    ds_read_b64_tr_b16 v[90:91], v22 offset:16320
    v_mfma_f32_16x16x32_bf16 v[216:219], v[128:131], v[104:107], v[216:219]
    ds_read_b64_tr_b16 v[92:93], v23 offset:14560
    v_mfma_f32_16x16x32_bf16 v[220:223], v[128:131], v[108:111], v[220:223]
    ds_read_b64_tr_b16 v[94:95], v23 offset:16352
    v_mfma_f32_16x16x32_bf16 v[224:227], v[132:135], v[96:99], v[224:227]
    v_add_u32 v16, 4294877184, v16
    v_mfma_f32_16x16x32_bf16 v[228:231], v[132:135], v[100:103], v[228:231]
    v_add_u32 v18, 4294877184, v18
    v_mfma_f32_16x16x32_bf16 v[232:235], v[132:135], v[104:107], v[232:235]
    v_mfma_f32_16x16x32_bf16 v[236:239], v[132:135], v[108:111], v[236:239]
    v_mfma_f32_16x16x32_bf16 v[240:243], v[136:139], v[96:99], v[240:243]
    v_mfma_f32_16x16x32_bf16 v[244:247], v[136:139], v[100:103], v[244:247]
    v_mfma_f32_16x16x32_bf16 v[248:251], v[140:143], v[96:99], v[248:251]
    v_mfma_f32_16x16x32_bf16 v[252:255], v[140:143], v[100:103], v[252:255]
    s_waitcnt lgkmcnt(0)
    s_barrier
    v_mfma_f32_16x16x32_bf16 v[144:147], v[64:67], v[48:51], v[144:147]
    ds_read_b128 v[96:99], v16 offset:0
    v_mfma_f32_16x16x32_bf16 v[148:151], v[64:67], v[52:55], v[148:151]
    v_add_u32 v20, 4294877184, v20
    v_mfma_f32_16x16x32_bf16 v[152:155], v[64:67], v[56:59], v[152:155]
    v_add_u32 v21, 4294877184, v21
    v_mfma_f32_16x16x32_bf16 v[156:159], v[64:67], v[60:63], v[156:159]
    v_add_u32 v22, 4294877184, v22
    v_mfma_f32_16x16x32_bf16 v[160:163], v[68:71], v[48:51], v[160:163]
    v_add_u32 v23, 4294877184, v23
    v_mfma_f32_16x16x32_bf16 v[164:167], v[68:71], v[52:55], v[164:167]
    ds_read_b64_tr_b16 v[112:113], v20 offset:0
    v_mfma_f32_16x16x32_bf16 v[168:171], v[68:71], v[56:59], v[168:171]
    ds_read_b64_tr_b16 v[114:115], v20 offset:1792
    v_mfma_f32_16x16x32_bf16 v[172:175], v[68:71], v[60:63], v[172:175]
    ds_read_b128 v[100:103], v16 offset:2048
    v_mfma_f32_16x16x32_bf16 v[176:179], v[72:75], v[48:51], v[176:179]
    ds_read_b128 v[104:107], v18 offset:0
    v_mfma_f32_16x16x32_bf16 v[180:183], v[72:75], v[52:55], v[180:183]
    ds_read_b128 v[108:111], v18 offset:2048
    v_mfma_f32_16x16x32_bf16 v[184:187], v[72:75], v[56:59], v[184:187]
    ds_read_b64_tr_b16 v[116:117], v21 offset:32
    v_mfma_f32_16x16x32_bf16 v[188:191], v[72:75], v[60:63], v[188:191]
    ds_read_b64_tr_b16 v[118:119], v21 offset:1824
    v_mfma_f32_16x16x32_bf16 v[192:195], v[76:79], v[48:51], v[192:195]
    ds_read_b64_tr_b16 v[120:121], v20 offset:64
    v_mfma_f32_16x16x32_bf16 v[196:199], v[76:79], v[52:55], v[196:199]
    ds_read_b64_tr_b16 v[122:123], v20 offset:1856
    v_mfma_f32_16x16x32_bf16 v[200:203], v[76:79], v[56:59], v[200:203]
    ds_read_b64_tr_b16 v[124:125], v21 offset:96
    v_mfma_f32_16x16x32_bf16 v[204:207], v[76:79], v[60:63], v[204:207]
    ds_read_b64_tr_b16 v[126:127], v21 offset:1888
    v_mfma_f32_16x16x32_bf16 v[208:211], v[80:83], v[48:51], v[208:211]
    ds_read_b64_tr_b16 v[128:129], v20 offset:128
    v_mfma_f32_16x16x32_bf16 v[212:215], v[80:83], v[52:55], v[212:215]
    ds_read_b64_tr_b16 v[130:131], v20 offset:1920
    v_mfma_f32_16x16x32_bf16 v[216:219], v[80:83], v[56:59], v[216:219]
    ds_read_b64_tr_b16 v[132:133], v21 offset:160
    v_mfma_f32_16x16x32_bf16 v[220:223], v[80:83], v[60:63], v[220:223]
    ds_read_b64_tr_b16 v[134:135], v21 offset:1952
    v_mfma_f32_16x16x32_bf16 v[224:227], v[84:87], v[48:51], v[224:227]
    ds_read_b64_tr_b16 v[136:137], v22 offset:192
    v_mfma_f32_16x16x32_bf16 v[228:231], v[84:87], v[52:55], v[228:231]
    ds_read_b64_tr_b16 v[138:139], v22 offset:1984
    v_mfma_f32_16x16x32_bf16 v[232:235], v[84:87], v[56:59], v[232:235]
    ds_read_b64_tr_b16 v[140:141], v23 offset:224
    v_mfma_f32_16x16x32_bf16 v[236:239], v[84:87], v[60:63], v[236:239]
    ds_read_b64_tr_b16 v[142:143], v23 offset:2016
    v_mfma_f32_16x16x32_bf16 v[240:243], v[88:91], v[48:51], v[240:243]
    v_add_u32 v17, 4294877184, v17
    v_mfma_f32_16x16x32_bf16 v[244:247], v[88:91], v[52:55], v[244:247]
    v_add_u32 v19, 4294877184, v19
    v_mfma_f32_16x16x32_bf16 v[248:251], v[92:95], v[48:51], v[248:251]
    v_mfma_f32_16x16x32_bf16 v[252:255], v[92:95], v[52:55], v[252:255]
    s_waitcnt lgkmcnt(0)
    v_mfma_f32_16x16x32_bf16 v[144:147], v[112:115], v[96:99], v[144:147]
    ds_read_b128 v[48:51], v17 offset:0
    v_mfma_f32_16x16x32_bf16 v[148:151], v[112:115], v[100:103], v[148:151]
    ds_read_b64_tr_b16 v[64:65], v20 offset:14336
    v_mfma_f32_16x16x32_bf16 v[152:155], v[112:115], v[104:107], v[152:155]
    ds_read_b64_tr_b16 v[66:67], v20 offset:16128
    v_mfma_f32_16x16x32_bf16 v[156:159], v[112:115], v[108:111], v[156:159]
    ds_read_b128 v[52:55], v17 offset:2048
    v_mfma_f32_16x16x32_bf16 v[160:163], v[116:119], v[96:99], v[160:163]
    ds_read_b128 v[56:59], v19 offset:0
    v_mfma_f32_16x16x32_bf16 v[164:167], v[116:119], v[100:103], v[164:167]
    ds_read_b128 v[60:63], v19 offset:2048
    v_mfma_f32_16x16x32_bf16 v[168:171], v[116:119], v[104:107], v[168:171]
    ds_read_b64_tr_b16 v[68:69], v21 offset:14368
    v_mfma_f32_16x16x32_bf16 v[172:175], v[116:119], v[108:111], v[172:175]
    ds_read_b64_tr_b16 v[70:71], v21 offset:16160
    v_mfma_f32_16x16x32_bf16 v[176:179], v[120:123], v[96:99], v[176:179]
    ds_read_b64_tr_b16 v[72:73], v20 offset:14400
    v_mfma_f32_16x16x32_bf16 v[180:183], v[120:123], v[100:103], v[180:183]
    ds_read_b64_tr_b16 v[74:75], v20 offset:16192
    v_mfma_f32_16x16x32_bf16 v[184:187], v[120:123], v[104:107], v[184:187]
    ds_read_b64_tr_b16 v[76:77], v21 offset:14432
    v_mfma_f32_16x16x32_bf16 v[188:191], v[120:123], v[108:111], v[188:191]
    ds_read_b64_tr_b16 v[78:79], v21 offset:16224
    v_mfma_f32_16x16x32_bf16 v[192:195], v[124:127], v[96:99], v[192:195]
    ds_read_b64_tr_b16 v[80:81], v20 offset:14464
    v_mfma_f32_16x16x32_bf16 v[196:199], v[124:127], v[100:103], v[196:199]
    ds_read_b64_tr_b16 v[82:83], v20 offset:16256
    v_mfma_f32_16x16x32_bf16 v[200:203], v[124:127], v[104:107], v[200:203]
    ds_read_b64_tr_b16 v[84:85], v21 offset:14496
    v_mfma_f32_16x16x32_bf16 v[204:207], v[124:127], v[108:111], v[204:207]
    ds_read_b64_tr_b16 v[86:87], v21 offset:16288
    v_mfma_f32_16x16x32_bf16 v[208:211], v[128:131], v[96:99], v[208:211]
    ds_read_b64_tr_b16 v[88:89], v22 offset:14528
    v_mfma_f32_16x16x32_bf16 v[212:215], v[128:131], v[100:103], v[212:215]
    ds_read_b64_tr_b16 v[90:91], v22 offset:16320
    v_mfma_f32_16x16x32_bf16 v[216:219], v[128:131], v[104:107], v[216:219]
    ds_read_b64_tr_b16 v[92:93], v23 offset:14560
    v_mfma_f32_16x16x32_bf16 v[220:223], v[128:131], v[108:111], v[220:223]
    ds_read_b64_tr_b16 v[94:95], v23 offset:16352
    v_mfma_f32_16x16x32_bf16 v[224:227], v[132:135], v[96:99], v[224:227]
    v_add_u32 v16, 45056, v16
    v_mfma_f32_16x16x32_bf16 v[228:231], v[132:135], v[100:103], v[228:231]
    v_add_u32 v18, 45056, v18
    v_mfma_f32_16x16x32_bf16 v[232:235], v[132:135], v[104:107], v[232:235]
    v_mfma_f32_16x16x32_bf16 v[236:239], v[132:135], v[108:111], v[236:239]
    v_mfma_f32_16x16x32_bf16 v[240:243], v[136:139], v[96:99], v[240:243]
    v_mfma_f32_16x16x32_bf16 v[244:247], v[136:139], v[100:103], v[244:247]
    v_mfma_f32_16x16x32_bf16 v[248:251], v[140:143], v[96:99], v[248:251]
    v_mfma_f32_16x16x32_bf16 v[252:255], v[140:143], v[100:103], v[252:255]
    s_waitcnt lgkmcnt(0)
    s_barrier
    v_mfma_f32_16x16x32_bf16 v[144:147], v[64:67], v[48:51], v[144:147]
    ds_read_b128 v[96:99], v16 offset:0
    v_mfma_f32_16x16x32_bf16 v[148:151], v[64:67], v[52:55], v[148:151]
    v_add_u32 v20, 45056, v20
    v_mfma_f32_16x16x32_bf16 v[152:155], v[64:67], v[56:59], v[152:155]
    v_add_u32 v21, 45056, v21
    v_mfma_f32_16x16x32_bf16 v[156:159], v[64:67], v[60:63], v[156:159]
    v_add_u32 v22, 45056, v22
    v_mfma_f32_16x16x32_bf16 v[160:163], v[68:71], v[48:51], v[160:163]
    v_add_u32 v23, 45056, v23
    v_mfma_f32_16x16x32_bf16 v[164:167], v[68:71], v[52:55], v[164:167]
    ds_read_b64_tr_b16 v[112:113], v20 offset:0
    v_mfma_f32_16x16x32_bf16 v[168:171], v[68:71], v[56:59], v[168:171]
    ds_read_b64_tr_b16 v[114:115], v20 offset:1792
    v_mfma_f32_16x16x32_bf16 v[172:175], v[68:71], v[60:63], v[172:175]
    ds_read_b128 v[100:103], v16 offset:2048
    v_mfma_f32_16x16x32_bf16 v[176:179], v[72:75], v[48:51], v[176:179]
    ds_read_b128 v[104:107], v18 offset:0
    v_mfma_f32_16x16x32_bf16 v[180:183], v[72:75], v[52:55], v[180:183]
    ds_read_b128 v[108:111], v18 offset:2048
    v_mfma_f32_16x16x32_bf16 v[184:187], v[72:75], v[56:59], v[184:187]
    ds_read_b64_tr_b16 v[116:117], v21 offset:32
    v_mfma_f32_16x16x32_bf16 v[188:191], v[72:75], v[60:63], v[188:191]
    ds_read_b64_tr_b16 v[118:119], v21 offset:1824
    v_mfma_f32_16x16x32_bf16 v[192:195], v[76:79], v[48:51], v[192:195]
    ds_read_b64_tr_b16 v[120:121], v20 offset:64
    v_mfma_f32_16x16x32_bf16 v[196:199], v[76:79], v[52:55], v[196:199]
    ds_read_b64_tr_b16 v[122:123], v20 offset:1856
    v_mfma_f32_16x16x32_bf16 v[200:203], v[76:79], v[56:59], v[200:203]
    ds_read_b64_tr_b16 v[124:125], v21 offset:96
    v_mfma_f32_16x16x32_bf16 v[204:207], v[76:79], v[60:63], v[204:207]
    ds_read_b64_tr_b16 v[126:127], v21 offset:1888
    v_mfma_f32_16x16x32_bf16 v[208:211], v[80:83], v[48:51], v[208:211]
    ds_read_b64_tr_b16 v[128:129], v20 offset:128
    v_mfma_f32_16x16x32_bf16 v[212:215], v[80:83], v[52:55], v[212:215]
    ds_read_b64_tr_b16 v[130:131], v20 offset:1920
    v_mfma_f32_16x16x32_bf16 v[216:219], v[80:83], v[56:59], v[216:219]
    ds_read_b64_tr_b16 v[132:133], v21 offset:160
    v_mfma_f32_16x16x32_bf16 v[220:223], v[80:83], v[60:63], v[220:223]
    ds_read_b64_tr_b16 v[134:135], v21 offset:1952
    v_mfma_f32_16x16x32_bf16 v[224:227], v[84:87], v[48:51], v[224:227]
    ds_read_b64_tr_b16 v[136:137], v22 offset:192
    v_mfma_f32_16x16x32_bf16 v[228:231], v[84:87], v[52:55], v[228:231]
    ds_read_b64_tr_b16 v[138:139], v22 offset:1984
    v_mfma_f32_16x16x32_bf16 v[232:235], v[84:87], v[56:59], v[232:235]
    ds_read_b64_tr_b16 v[140:141], v23 offset:224
    v_mfma_f32_16x16x32_bf16 v[236:239], v[84:87], v[60:63], v[236:239]
    ds_read_b64_tr_b16 v[142:143], v23 offset:2016
    v_mfma_f32_16x16x32_bf16 v[240:243], v[88:91], v[48:51], v[240:243]
    v_add_u32 v17, 45056, v17
    v_mfma_f32_16x16x32_bf16 v[244:247], v[88:91], v[52:55], v[244:247]
    v_add_u32 v19, 45056, v19
    v_mfma_f32_16x16x32_bf16 v[248:251], v[92:95], v[48:51], v[248:251]
    v_mfma_f32_16x16x32_bf16 v[252:255], v[92:95], v[52:55], v[252:255]
    s_waitcnt lgkmcnt(0)
    v_mfma_f32_16x16x32_bf16 v[144:147], v[112:115], v[96:99], v[144:147]
    ds_read_b128 v[48:51], v17 offset:0
    v_mfma_f32_16x16x32_bf16 v[148:151], v[112:115], v[100:103], v[148:151]
    ds_read_b64_tr_b16 v[64:65], v20 offset:14336
    v_mfma_f32_16x16x32_bf16 v[152:155], v[112:115], v[104:107], v[152:155]
    ds_read_b64_tr_b16 v[66:67], v20 offset:16128
    v_mfma_f32_16x16x32_bf16 v[156:159], v[112:115], v[108:111], v[156:159]
    ds_read_b128 v[52:55], v17 offset:2048
    v_mfma_f32_16x16x32_bf16 v[160:163], v[116:119], v[96:99], v[160:163]
    ds_read_b128 v[56:59], v19 offset:0
    v_mfma_f32_16x16x32_bf16 v[164:167], v[116:119], v[100:103], v[164:167]
    ds_read_b128 v[60:63], v19 offset:2048
    v_mfma_f32_16x16x32_bf16 v[168:171], v[116:119], v[104:107], v[168:171]
    ds_read_b64_tr_b16 v[68:69], v21 offset:14368
    v_mfma_f32_16x16x32_bf16 v[172:175], v[116:119], v[108:111], v[172:175]
    ds_read_b64_tr_b16 v[70:71], v21 offset:16160
    v_mfma_f32_16x16x32_bf16 v[176:179], v[120:123], v[96:99], v[176:179]
    ds_read_b64_tr_b16 v[72:73], v20 offset:14400
    v_mfma_f32_16x16x32_bf16 v[180:183], v[120:123], v[100:103], v[180:183]
    ds_read_b64_tr_b16 v[74:75], v20 offset:16192
    v_mfma_f32_16x16x32_bf16 v[184:187], v[120:123], v[104:107], v[184:187]
    ds_read_b64_tr_b16 v[76:77], v21 offset:14432
    v_mfma_f32_16x16x32_bf16 v[188:191], v[120:123], v[108:111], v[188:191]
    ds_read_b64_tr_b16 v[78:79], v21 offset:16224
    v_mfma_f32_16x16x32_bf16 v[192:195], v[124:127], v[96:99], v[192:195]
    ds_read_b64_tr_b16 v[80:81], v20 offset:14464
    v_mfma_f32_16x16x32_bf16 v[196:199], v[124:127], v[100:103], v[196:199]
    ds_read_b64_tr_b16 v[82:83], v20 offset:16256
    v_mfma_f32_16x16x32_bf16 v[200:203], v[124:127], v[104:107], v[200:203]
    ds_read_b64_tr_b16 v[84:85], v21 offset:14496
    v_mfma_f32_16x16x32_bf16 v[204:207], v[124:127], v[108:111], v[204:207]
    ds_read_b64_tr_b16 v[86:87], v21 offset:16288
    v_mfma_f32_16x16x32_bf16 v[208:211], v[128:131], v[96:99], v[208:211]
    ds_read_b64_tr_b16 v[88:89], v22 offset:14528
    v_mfma_f32_16x16x32_bf16 v[212:215], v[128:131], v[100:103], v[212:215]
    ds_read_b64_tr_b16 v[90:91], v22 offset:16320
    v_mfma_f32_16x16x32_bf16 v[216:219], v[128:131], v[104:107], v[216:219]
    ds_read_b64_tr_b16 v[92:93], v23 offset:14560
    v_mfma_f32_16x16x32_bf16 v[220:223], v[128:131], v[108:111], v[220:223]
    ds_read_b64_tr_b16 v[94:95], v23 offset:16352
    v_mfma_f32_16x16x32_bf16 v[224:227], v[132:135], v[96:99], v[224:227]
    v_add_u32 v16, 45056, v16
    v_mfma_f32_16x16x32_bf16 v[228:231], v[132:135], v[100:103], v[228:231]
    v_add_u32 v18, 45056, v18
    v_mfma_f32_16x16x32_bf16 v[232:235], v[132:135], v[104:107], v[232:235]
    v_mfma_f32_16x16x32_bf16 v[236:239], v[132:135], v[108:111], v[236:239]
    v_mfma_f32_16x16x32_bf16 v[240:243], v[136:139], v[96:99], v[240:243]
    v_mfma_f32_16x16x32_bf16 v[244:247], v[136:139], v[100:103], v[244:247]
    v_mfma_f32_16x16x32_bf16 v[248:251], v[140:143], v[96:99], v[248:251]
    v_mfma_f32_16x16x32_bf16 v[252:255], v[140:143], v[100:103], v[252:255]
    s_waitcnt lgkmcnt(0)
    s_barrier
    v_mfma_f32_16x16x32_bf16 v[144:147], v[64:67], v[48:51], v[144:147]
    ds_read_b128 v[96:99], v16 offset:0
    v_mfma_f32_16x16x32_bf16 v[148:151], v[64:67], v[52:55], v[148:151]
    v_add_u32 v20, 45056, v20
    v_mfma_f32_16x16x32_bf16 v[152:155], v[64:67], v[56:59], v[152:155]
    v_add_u32 v21, 45056, v21
    v_mfma_f32_16x16x32_bf16 v[156:159], v[64:67], v[60:63], v[156:159]
    v_add_u32 v22, 45056, v22
    v_mfma_f32_16x16x32_bf16 v[160:163], v[68:71], v[48:51], v[160:163]
    v_add_u32 v23, 45056, v23
    v_mfma_f32_16x16x32_bf16 v[164:167], v[68:71], v[52:55], v[164:167]
    ds_read_b64_tr_b16 v[112:113], v20 offset:0
    v_mfma_f32_16x16x32_bf16 v[168:171], v[68:71], v[56:59], v[168:171]
    ds_read_b64_tr_b16 v[114:115], v20 offset:1792
    v_mfma_f32_16x16x32_bf16 v[172:175], v[68:71], v[60:63], v[172:175]
    ds_read_b128 v[100:103], v16 offset:2048
    v_mfma_f32_16x16x32_bf16 v[176:179], v[72:75], v[48:51], v[176:179]
    ds_read_b128 v[104:107], v18 offset:0
    v_mfma_f32_16x16x32_bf16 v[180:183], v[72:75], v[52:55], v[180:183]
    ds_read_b128 v[108:111], v18 offset:2048
    v_mfma_f32_16x16x32_bf16 v[184:187], v[72:75], v[56:59], v[184:187]
    ds_read_b64_tr_b16 v[116:117], v21 offset:32
    v_mfma_f32_16x16x32_bf16 v[188:191], v[72:75], v[60:63], v[188:191]
    ds_read_b64_tr_b16 v[118:119], v21 offset:1824
    v_mfma_f32_16x16x32_bf16 v[192:195], v[76:79], v[48:51], v[192:195]
    ds_read_b64_tr_b16 v[120:121], v20 offset:64
    v_mfma_f32_16x16x32_bf16 v[196:199], v[76:79], v[52:55], v[196:199]
    ds_read_b64_tr_b16 v[122:123], v20 offset:1856
    v_mfma_f32_16x16x32_bf16 v[200:203], v[76:79], v[56:59], v[200:203]
    ds_read_b64_tr_b16 v[124:125], v21 offset:96
    v_mfma_f32_16x16x32_bf16 v[204:207], v[76:79], v[60:63], v[204:207]
    ds_read_b64_tr_b16 v[126:127], v21 offset:1888
    v_mfma_f32_16x16x32_bf16 v[208:211], v[80:83], v[48:51], v[208:211]
    ds_read_b64_tr_b16 v[128:129], v20 offset:128
    v_mfma_f32_16x16x32_bf16 v[212:215], v[80:83], v[52:55], v[212:215]
    ds_read_b64_tr_b16 v[130:131], v20 offset:1920
    v_mfma_f32_16x16x32_bf16 v[216:219], v[80:83], v[56:59], v[216:219]
    ds_read_b64_tr_b16 v[132:133], v21 offset:160
    v_mfma_f32_16x16x32_bf16 v[220:223], v[80:83], v[60:63], v[220:223]
    ds_read_b64_tr_b16 v[134:135], v21 offset:1952
    v_mfma_f32_16x16x32_bf16 v[224:227], v[84:87], v[48:51], v[224:227]
    ds_read_b64_tr_b16 v[136:137], v22 offset:192
    v_mfma_f32_16x16x32_bf16 v[228:231], v[84:87], v[52:55], v[228:231]
    ds_read_b64_tr_b16 v[138:139], v22 offset:1984
    v_mfma_f32_16x16x32_bf16 v[232:235], v[84:87], v[56:59], v[232:235]
    ds_read_b64_tr_b16 v[140:141], v23 offset:224
    v_mfma_f32_16x16x32_bf16 v[236:239], v[84:87], v[60:63], v[236:239]
    ds_read_b64_tr_b16 v[142:143], v23 offset:2016
    v_mfma_f32_16x16x32_bf16 v[240:243], v[88:91], v[48:51], v[240:243]
    v_add_u32 v17, 45056, v17
    v_mfma_f32_16x16x32_bf16 v[244:247], v[88:91], v[52:55], v[244:247]
    v_add_u32 v19, 45056, v19
    v_mfma_f32_16x16x32_bf16 v[248:251], v[92:95], v[48:51], v[248:251]
    v_mfma_f32_16x16x32_bf16 v[252:255], v[92:95], v[52:55], v[252:255]
    s_waitcnt lgkmcnt(0)
    v_mfma_f32_16x16x32_bf16 v[144:147], v[112:115], v[96:99], v[144:147]
    ds_read_b128 v[48:51], v17 offset:0
    v_mfma_f32_16x16x32_bf16 v[148:151], v[112:115], v[100:103], v[148:151]
    ds_read_b64_tr_b16 v[64:65], v20 offset:14336
    v_mfma_f32_16x16x32_bf16 v[152:155], v[112:115], v[104:107], v[152:155]
    ds_read_b64_tr_b16 v[66:67], v20 offset:16128
    v_mfma_f32_16x16x32_bf16 v[156:159], v[112:115], v[108:111], v[156:159]
    ds_read_b128 v[52:55], v17 offset:2048
    v_mfma_f32_16x16x32_bf16 v[160:163], v[116:119], v[96:99], v[160:163]
    ds_read_b128 v[56:59], v19 offset:0
    v_mfma_f32_16x16x32_bf16 v[164:167], v[116:119], v[100:103], v[164:167]
    ds_read_b128 v[60:63], v19 offset:2048
    v_mfma_f32_16x16x32_bf16 v[168:171], v[116:119], v[104:107], v[168:171]
    ds_read_b64_tr_b16 v[68:69], v21 offset:14368
    v_mfma_f32_16x16x32_bf16 v[172:175], v[116:119], v[108:111], v[172:175]
    ds_read_b64_tr_b16 v[70:71], v21 offset:16160
    v_mfma_f32_16x16x32_bf16 v[176:179], v[120:123], v[96:99], v[176:179]
    ds_read_b64_tr_b16 v[72:73], v20 offset:14400
    v_mfma_f32_16x16x32_bf16 v[180:183], v[120:123], v[100:103], v[180:183]
    ds_read_b64_tr_b16 v[74:75], v20 offset:16192
    v_mfma_f32_16x16x32_bf16 v[184:187], v[120:123], v[104:107], v[184:187]
    ds_read_b64_tr_b16 v[76:77], v21 offset:14432
    v_mfma_f32_16x16x32_bf16 v[188:191], v[120:123], v[108:111], v[188:191]
    ds_read_b64_tr_b16 v[78:79], v21 offset:16224
    v_mfma_f32_16x16x32_bf16 v[192:195], v[124:127], v[96:99], v[192:195]
    ds_read_b64_tr_b16 v[80:81], v20 offset:14464
    v_mfma_f32_16x16x32_bf16 v[196:199], v[124:127], v[100:103], v[196:199]
    ds_read_b64_tr_b16 v[82:83], v20 offset:16256
    v_mfma_f32_16x16x32_bf16 v[200:203], v[124:127], v[104:107], v[200:203]
    ds_read_b64_tr_b16 v[84:85], v21 offset:14496
    v_mfma_f32_16x16x32_bf16 v[204:207], v[124:127], v[108:111], v[204:207]
    ds_read_b64_tr_b16 v[86:87], v21 offset:16288
    v_mfma_f32_16x16x32_bf16 v[208:211], v[128:131], v[96:99], v[208:211]
    ds_read_b64_tr_b16 v[88:89], v22 offset:14528
    v_mfma_f32_16x16x32_bf16 v[212:215], v[128:131], v[100:103], v[212:215]
    ds_read_b64_tr_b16 v[90:91], v22 offset:16320
    v_mfma_f32_16x16x32_bf16 v[216:219], v[128:131], v[104:107], v[216:219]
    ds_read_b64_tr_b16 v[92:93], v23 offset:14560
    v_mfma_f32_16x16x32_bf16 v[220:223], v[128:131], v[108:111], v[220:223]
    ds_read_b64_tr_b16 v[94:95], v23 offset:16352
    v_mfma_f32_16x16x32_bf16 v[224:227], v[132:135], v[96:99], v[224:227]
    v_add_u32 v16, 4294877184, v16
    v_mfma_f32_16x16x32_bf16 v[228:231], v[132:135], v[100:103], v[228:231]
    v_add_u32 v18, 4294877184, v18
    v_mfma_f32_16x16x32_bf16 v[232:235], v[132:135], v[104:107], v[232:235]
    v_mfma_f32_16x16x32_bf16 v[236:239], v[132:135], v[108:111], v[236:239]
    v_mfma_f32_16x16x32_bf16 v[240:243], v[136:139], v[96:99], v[240:243]
    v_mfma_f32_16x16x32_bf16 v[244:247], v[136:139], v[100:103], v[244:247]
    v_mfma_f32_16x16x32_bf16 v[248:251], v[140:143], v[96:99], v[248:251]
    v_mfma_f32_16x16x32_bf16 v[252:255], v[140:143], v[100:103], v[252:255]
    s_waitcnt lgkmcnt(0)
    s_barrier
    v_mfma_f32_16x16x32_bf16 v[144:147], v[64:67], v[48:51], v[144:147]
    ds_read_b128 v[96:99], v16 offset:0
    v_mfma_f32_16x16x32_bf16 v[148:151], v[64:67], v[52:55], v[148:151]
    v_add_u32 v20, 4294877184, v20
    v_mfma_f32_16x16x32_bf16 v[152:155], v[64:67], v[56:59], v[152:155]
    v_add_u32 v21, 4294877184, v21
    v_mfma_f32_16x16x32_bf16 v[156:159], v[64:67], v[60:63], v[156:159]
    v_add_u32 v22, 4294877184, v22
    v_mfma_f32_16x16x32_bf16 v[160:163], v[68:71], v[48:51], v[160:163]
    v_add_u32 v23, 4294877184, v23
    v_mfma_f32_16x16x32_bf16 v[164:167], v[68:71], v[52:55], v[164:167]
    ds_read_b64_tr_b16 v[112:113], v20 offset:0
    v_mfma_f32_16x16x32_bf16 v[168:171], v[68:71], v[56:59], v[168:171]
    ds_read_b64_tr_b16 v[114:115], v20 offset:1792
    v_mfma_f32_16x16x32_bf16 v[172:175], v[68:71], v[60:63], v[172:175]
    ds_read_b128 v[100:103], v16 offset:2048
    v_mfma_f32_16x16x32_bf16 v[176:179], v[72:75], v[48:51], v[176:179]
    ds_read_b128 v[104:107], v18 offset:0
    v_mfma_f32_16x16x32_bf16 v[180:183], v[72:75], v[52:55], v[180:183]
    ds_read_b128 v[108:111], v18 offset:2048
    v_mfma_f32_16x16x32_bf16 v[184:187], v[72:75], v[56:59], v[184:187]
    ds_read_b64_tr_b16 v[116:117], v21 offset:32
    v_mfma_f32_16x16x32_bf16 v[188:191], v[72:75], v[60:63], v[188:191]
    ds_read_b64_tr_b16 v[118:119], v21 offset:1824
    v_mfma_f32_16x16x32_bf16 v[192:195], v[76:79], v[48:51], v[192:195]
    ds_read_b64_tr_b16 v[120:121], v20 offset:64
    v_mfma_f32_16x16x32_bf16 v[196:199], v[76:79], v[52:55], v[196:199]
    ds_read_b64_tr_b16 v[122:123], v20 offset:1856
    v_mfma_f32_16x16x32_bf16 v[200:203], v[76:79], v[56:59], v[200:203]
    ds_read_b64_tr_b16 v[124:125], v21 offset:96
    v_mfma_f32_16x16x32_bf16 v[204:207], v[76:79], v[60:63], v[204:207]
    ds_read_b64_tr_b16 v[126:127], v21 offset:1888
    v_mfma_f32_16x16x32_bf16 v[208:211], v[80:83], v[48:51], v[208:211]
    ds_read_b64_tr_b16 v[128:129], v20 offset:128
    v_mfma_f32_16x16x32_bf16 v[212:215], v[80:83], v[52:55], v[212:215]
    ds_read_b64_tr_b16 v[130:131], v20 offset:1920
    v_mfma_f32_16x16x32_bf16 v[216:219], v[80:83], v[56:59], v[216:219]
    ds_read_b64_tr_b16 v[132:133], v21 offset:160
    v_mfma_f32_16x16x32_bf16 v[220:223], v[80:83], v[60:63], v[220:223]
    ds_read_b64_tr_b16 v[134:135], v21 offset:1952
    v_mfma_f32_16x16x32_bf16 v[224:227], v[84:87], v[48:51], v[224:227]
    ds_read_b64_tr_b16 v[136:137], v22 offset:192
    v_mfma_f32_16x16x32_bf16 v[228:231], v[84:87], v[52:55], v[228:231]
    ds_read_b64_tr_b16 v[138:139], v22 offset:1984
    v_mfma_f32_16x16x32_bf16 v[232:235], v[84:87], v[56:59], v[232:235]
    ds_read_b64_tr_b16 v[140:141], v23 offset:224
    v_mfma_f32_16x16x32_bf16 v[236:239], v[84:87], v[60:63], v[236:239]
    ds_read_b64_tr_b16 v[142:143], v23 offset:2016
    v_mfma_f32_16x16x32_bf16 v[240:243], v[88:91], v[48:51], v[240:243]
    v_add_u32 v17, 4294877184, v17
    v_mfma_f32_16x16x32_bf16 v[244:247], v[88:91], v[52:55], v[244:247]
    v_add_u32 v19, 4294877184, v19
    v_mfma_f32_16x16x32_bf16 v[248:251], v[92:95], v[48:51], v[248:251]
    v_mfma_f32_16x16x32_bf16 v[252:255], v[92:95], v[52:55], v[252:255]
    s_waitcnt lgkmcnt(0)
    v_mfma_f32_16x16x32_bf16 v[144:147], v[112:115], v[96:99], v[144:147]
    ds_read_b128 v[48:51], v17 offset:0
    v_mfma_f32_16x16x32_bf16 v[148:151], v[112:115], v[100:103], v[148:151]
    ds_read_b64_tr_b16 v[64:65], v20 offset:14336
    v_mfma_f32_16x16x32_bf16 v[152:155], v[112:115], v[104:107], v[152:155]
    ds_read_b64_tr_b16 v[66:67], v20 offset:16128
    v_mfma_f32_16x16x32_bf16 v[156:159], v[112:115], v[108:111], v[156:159]
    ds_read_b128 v[52:55], v17 offset:2048
    v_mfma_f32_16x16x32_bf16 v[160:163], v[116:119], v[96:99], v[160:163]
    ds_read_b128 v[56:59], v19 offset:0
    v_mfma_f32_16x16x32_bf16 v[164:167], v[116:119], v[100:103], v[164:167]
    ds_read_b128 v[60:63], v19 offset:2048
    v_mfma_f32_16x16x32_bf16 v[168:171], v[116:119], v[104:107], v[168:171]
    ds_read_b64_tr_b16 v[68:69], v21 offset:14368
    v_mfma_f32_16x16x32_bf16 v[172:175], v[116:119], v[108:111], v[172:175]
    ds_read_b64_tr_b16 v[70:71], v21 offset:16160
    v_mfma_f32_16x16x32_bf16 v[176:179], v[120:123], v[96:99], v[176:179]
    ds_read_b64_tr_b16 v[72:73], v20 offset:14400
    v_mfma_f32_16x16x32_bf16 v[180:183], v[120:123], v[100:103], v[180:183]
    ds_read_b64_tr_b16 v[74:75], v20 offset:16192
    v_mfma_f32_16x16x32_bf16 v[184:187], v[120:123], v[104:107], v[184:187]
    ds_read_b64_tr_b16 v[76:77], v21 offset:14432
    v_mfma_f32_16x16x32_bf16 v[188:191], v[120:123], v[108:111], v[188:191]
    ds_read_b64_tr_b16 v[78:79], v21 offset:16224
    v_mfma_f32_16x16x32_bf16 v[192:195], v[124:127], v[96:99], v[192:195]
    ds_read_b64_tr_b16 v[80:81], v20 offset:14464
    v_mfma_f32_16x16x32_bf16 v[196:199], v[124:127], v[100:103], v[196:199]
    ds_read_b64_tr_b16 v[82:83], v20 offset:16256
    v_mfma_f32_16x16x32_bf16 v[200:203], v[124:127], v[104:107], v[200:203]
    ds_read_b64_tr_b16 v[84:85], v21 offset:14496
    v_mfma_f32_16x16x32_bf16 v[204:207], v[124:127], v[108:111], v[204:207]
    ds_read_b64_tr_b16 v[86:87], v21 offset:16288
    v_mfma_f32_16x16x32_bf16 v[208:211], v[128:131], v[96:99], v[208:211]
    ds_read_b64_tr_b16 v[88:89], v22 offset:14528
    v_mfma_f32_16x16x32_bf16 v[212:215], v[128:131], v[100:103], v[212:215]
    ds_read_b64_tr_b16 v[90:91], v22 offset:16320
    v_mfma_f32_16x16x32_bf16 v[216:219], v[128:131], v[104:107], v[216:219]
    ds_read_b64_tr_b16 v[92:93], v23 offset:14560
    v_mfma_f32_16x16x32_bf16 v[220:223], v[128:131], v[108:111], v[220:223]
    ds_read_b64_tr_b16 v[94:95], v23 offset:16352
    v_mfma_f32_16x16x32_bf16 v[224:227], v[132:135], v[96:99], v[224:227]
    v_mfma_f32_16x16x32_bf16 v[228:231], v[132:135], v[100:103], v[228:231]
    v_mfma_f32_16x16x32_bf16 v[232:235], v[132:135], v[104:107], v[232:235]
    v_mfma_f32_16x16x32_bf16 v[236:239], v[132:135], v[108:111], v[236:239]
    v_mfma_f32_16x16x32_bf16 v[240:243], v[136:139], v[96:99], v[240:243]
    v_mfma_f32_16x16x32_bf16 v[244:247], v[136:139], v[100:103], v[244:247]
    v_mfma_f32_16x16x32_bf16 v[248:251], v[140:143], v[96:99], v[248:251]
    v_mfma_f32_16x16x32_bf16 v[252:255], v[140:143], v[100:103], v[252:255]
    s_waitcnt lgkmcnt(0)
    s_barrier
    v_mfma_f32_16x16x32_bf16 v[144:147], v[64:67], v[48:51], v[144:147]
    ds_read_b128 v[112:115], v2 offset:0
    v_mfma_f32_16x16x32_bf16 v[148:151], v[64:67], v[52:55], v[148:151]
    ds_read_b128 v[128:131], v4 offset:0
    v_mfma_f32_16x16x32_bf16 v[152:155], v[64:67], v[56:59], v[152:155]
    ds_read_b128 v[132:135], v4 offset:8192
    v_mfma_f32_16x16x32_bf16 v[156:159], v[64:67], v[60:63], v[156:159]
    ds_read_b128 v[136:139], v4 offset:2048
    v_mfma_f32_16x16x32_bf16 v[160:163], v[68:71], v[48:51], v[160:163]
    ds_read_b128 v[140:143], v4 offset:10240
    v_mfma_f32_16x16x32_bf16 v[164:167], v[68:71], v[52:55], v[164:167]
    ds_read_b128 v[116:119], v2 offset:2048
    v_mfma_f32_16x16x32_bf16 v[168:171], v[68:71], v[56:59], v[168:171]
    ds_read_b128 v[120:123], v2 offset:4096
    v_mfma_f32_16x16x32_bf16 v[172:175], v[68:71], v[60:63], v[172:175]
    ds_read_b128 v[124:127], v2 offset:6144
    v_mfma_f32_16x16x32_bf16 v[176:179], v[72:75], v[48:51], v[176:179]
    v_mfma_f32_16x16x32_bf16 v[180:183], v[72:75], v[52:55], v[180:183]
    v_mfma_f32_16x16x32_bf16 v[184:187], v[72:75], v[56:59], v[184:187]
    v_mfma_f32_16x16x32_bf16 v[188:191], v[72:75], v[60:63], v[188:191]
    v_mfma_f32_16x16x32_bf16 v[192:195], v[76:79], v[48:51], v[192:195]
    v_mfma_f32_16x16x32_bf16 v[196:199], v[76:79], v[52:55], v[196:199]
    v_mfma_f32_16x16x32_bf16 v[200:203], v[76:79], v[56:59], v[200:203]
    v_mfma_f32_16x16x32_bf16 v[204:207], v[76:79], v[60:63], v[204:207]
    v_mfma_f32_16x16x32_bf16 v[208:211], v[80:83], v[48:51], v[208:211]
    v_mfma_f32_16x16x32_bf16 v[212:215], v[80:83], v[52:55], v[212:215]
    v_mfma_f32_16x16x32_bf16 v[216:219], v[80:83], v[56:59], v[216:219]
    v_mfma_f32_16x16x32_bf16 v[220:223], v[80:83], v[60:63], v[220:223]
    v_mfma_f32_16x16x32_bf16 v[224:227], v[84:87], v[48:51], v[224:227]
    v_mfma_f32_16x16x32_bf16 v[228:231], v[84:87], v[52:55], v[228:231]
    v_mfma_f32_16x16x32_bf16 v[232:235], v[84:87], v[56:59], v[232:235]
    v_mfma_f32_16x16x32_bf16 v[236:239], v[84:87], v[60:63], v[236:239]
    v_mfma_f32_16x16x32_bf16 v[240:243], v[88:91], v[48:51], v[240:243]
    v_mfma_f32_16x16x32_bf16 v[244:247], v[88:91], v[52:55], v[244:247]
    v_mfma_f32_16x16x32_bf16 v[248:251], v[92:95], v[48:51], v[248:251]
    v_mfma_f32_16x16x32_bf16 v[252:255], v[92:95], v[52:55], v[252:255]
    s_mul_i32 s91, s80, 112
    s_mul_i32 s85, s84, 7
    s_add_u32 s91, s91, s85
    s_lshl_b32 s91, s91, 13
    s_lshl_b32 s85, s89, 12
    s_add_u32 s91, s91, s85
    s_add_u32 s92, s91, 24576
    s_lshl_b32 s85, s90, 15
    s_add_u32 s91, s91, s85
    s_add_u32 s93, s91, 8192
    s_add_u32 s94, s91, 16384
    s_nop 4
    s_waitcnt lgkmcnt(0)
    v_mfma_f32_16x16x32_bf16 v[16:19], v[112:115], v[128:131], 0
    ds_read_b128 v[80:83], v3 offset:0
    v_mfma_f32_16x16x32_bf16 v[20:23], v[112:115], v[132:135], 0
    ds_read_b128 v[96:99], v5 offset:0
    v_mfma_f32_16x16x32_bf16 v[24:27], v[112:115], v[136:139], 0
    ds_read_b128 v[100:103], v5 offset:8192
    v_mfma_f32_16x16x32_bf16 v[28:31], v[112:115], v[140:143], 0
    ds_read_b128 v[104:107], v5 offset:2048
    v_mfma_f32_16x16x32_bf16 v[32:35], v[116:119], v[128:131], 0
    ds_read_b128 v[108:111], v5 offset:10240
    v_mfma_f32_16x16x32_bf16 v[36:39], v[116:119], v[132:135], 0
    ds_read_b128 v[84:87], v3 offset:2048
    v_mfma_f32_16x16x32_bf16 v[40:43], v[116:119], v[136:139], 0
    ds_read_b128 v[88:91], v3 offset:4096
    v_mfma_f32_16x16x32_bf16 v[44:47], v[116:119], v[140:143], 0
    ds_read_b128 v[92:95], v3 offset:6144
    v_max_f32 v144, 0, v144
    v_mfma_f32_16x16x32_bf16 v[48:51], v[120:123], v[128:131], 0
    v_add_u32 v2, 45056, v2
    v_max_f32 v145, 0, v145
    v_mfma_f32_16x16x32_bf16 v[52:55], v[120:123], v[132:135], 0
    v_add_u32 v4, 45056, v4
    v_max_f32 v146, 0, v146
    v_mfma_f32_16x16x32_bf16 v[56:59], v[120:123], v[136:139], 0
    v_max_f32 v147, 0, v147
    v_max_f32 v160, 0, v160
    v_mfma_f32_16x16x32_bf16 v[60:63], v[120:123], v[140:143], 0
    v_max_f32 v161, 0, v161
    v_max_f32 v162, 0, v162
    v_mfma_f32_16x16x32_bf16 v[64:67], v[124:127], v[128:131], 0
    v_max_f32 v163, 0, v163
    v_mul_f32 v144, v144, v144
    v_mfma_f32_16x16x32_bf16 v[68:71], v[124:127], v[132:135], 0
    v_mul_f32 v145, v145, v145
    v_mul_f32 v146, v146, v146
    v_mfma_f32_16x16x32_bf16 v[72:75], v[124:127], v[136:139], 0
    v_mul_f32 v147, v147, v147
    v_mul_f32 v160, v160, v160
    v_mfma_f32_16x16x32_bf16 v[76:79], v[124:127], v[140:143], 0
    v_mul_f32 v161, v161, v161
    v_mul_f32 v162, v162, v162
    s_waitcnt lgkmcnt(0)
    s_barrier
    v_mfma_f32_16x16x32_bf16 v[16:19], v[80:83], v[96:99], v[16:19]
    ds_read_b128 v[112:115], v2 offset:0
    v_mfma_f32_16x16x32_bf16 v[20:23], v[80:83], v[100:103], v[20:23]
    ds_read_b128 v[128:131], v4 offset:0
    v_mfma_f32_16x16x32_bf16 v[24:27], v[80:83], v[104:107], v[24:27]
    ds_read_b128 v[132:135], v4 offset:8192
    v_mfma_f32_16x16x32_bf16 v[28:31], v[80:83], v[108:111], v[28:31]
    ds_read_b128 v[136:139], v4 offset:2048
    v_mfma_f32_16x16x32_bf16 v[32:35], v[84:87], v[96:99], v[32:35]
    ds_read_b128 v[140:143], v4 offset:10240
    v_mfma_f32_16x16x32_bf16 v[36:39], v[84:87], v[100:103], v[36:39]
    ds_read_b128 v[116:119], v2 offset:2048
    v_mfma_f32_16x16x32_bf16 v[40:43], v[84:87], v[104:107], v[40:43]
    ds_read_b128 v[120:123], v2 offset:4096
    v_mfma_f32_16x16x32_bf16 v[44:47], v[84:87], v[108:111], v[44:47]
    ds_read_b128 v[124:127], v2 offset:6144
    v_mul_f32 v163, v163, v163
    v_mfma_f32_16x16x32_bf16 v[48:51], v[88:91], v[96:99], v[48:51]
    v_add_u32 v3, 45056, v3
    v_cvt_pk_bf16_f32 v144, v144, v145
    v_mfma_f32_16x16x32_bf16 v[52:55], v[88:91], v[100:103], v[52:55]
    v_add_u32 v5, 45056, v5
    v_cvt_pk_bf16_f32 v145, v146, v147
    v_mfma_f32_16x16x32_bf16 v[56:59], v[88:91], v[104:107], v[56:59]
    v_cvt_pk_bf16_f32 v146, v160, v161
    v_cvt_pk_bf16_f32 v147, v162, v163
    v_mfma_f32_16x16x32_bf16 v[60:63], v[88:91], v[108:111], v[60:63]
    v_max_f32 v148, 0, v148
    v_max_f32 v149, 0, v149
    v_mfma_f32_16x16x32_bf16 v[64:67], v[92:95], v[96:99], v[64:67]
    v_max_f32 v150, 0, v150
    v_max_f32 v151, 0, v151
    v_mfma_f32_16x16x32_bf16 v[68:71], v[92:95], v[100:103], v[68:71]
    v_max_f32 v164, 0, v164
    v_max_f32 v165, 0, v165
    v_mfma_f32_16x16x32_bf16 v[72:75], v[92:95], v[104:107], v[72:75]
    v_max_f32 v166, 0, v166
    v_max_f32 v167, 0, v167
    v_mfma_f32_16x16x32_bf16 v[76:79], v[92:95], v[108:111], v[76:79]
    v_mul_f32 v148, v148, v148
    v_mul_f32 v149, v149, v149
    s_waitcnt lgkmcnt(0)
    v_mfma_f32_16x16x32_bf16 v[16:19], v[112:115], v[128:131], v[16:19]
    ds_read_b128 v[80:83], v3 offset:0
    v_mfma_f32_16x16x32_bf16 v[20:23], v[112:115], v[132:135], v[20:23]
    ds_read_b128 v[96:99], v5 offset:0
    v_mfma_f32_16x16x32_bf16 v[24:27], v[112:115], v[136:139], v[24:27]
    ds_read_b128 v[100:103], v5 offset:8192
    v_mfma_f32_16x16x32_bf16 v[28:31], v[112:115], v[140:143], v[28:31]
    ds_read_b128 v[104:107], v5 offset:2048
    v_mfma_f32_16x16x32_bf16 v[32:35], v[116:119], v[128:131], v[32:35]
    ds_read_b128 v[108:111], v5 offset:10240
    v_mfma_f32_16x16x32_bf16 v[36:39], v[116:119], v[132:135], v[36:39]
    ds_read_b128 v[84:87], v3 offset:2048
    v_mfma_f32_16x16x32_bf16 v[40:43], v[116:119], v[136:139], v[40:43]
    ds_read_b128 v[88:91], v3 offset:4096
    v_mfma_f32_16x16x32_bf16 v[44:47], v[116:119], v[140:143], v[44:47]
    ds_read_b128 v[92:95], v3 offset:6144
    v_mul_f32 v150, v150, v150
    v_mfma_f32_16x16x32_bf16 v[48:51], v[120:123], v[128:131], v[48:51]
    v_add_u32 v2, 4294877184, v2
    v_mul_f32 v151, v151, v151
    v_mfma_f32_16x16x32_bf16 v[52:55], v[120:123], v[132:135], v[52:55]
    v_add_u32 v4, 4294877184, v4
    v_mul_f32 v164, v164, v164
    v_mfma_f32_16x16x32_bf16 v[56:59], v[120:123], v[136:139], v[56:59]
    v_mul_f32 v165, v165, v165
    v_mul_f32 v166, v166, v166
    v_mfma_f32_16x16x32_bf16 v[60:63], v[120:123], v[140:143], v[60:63]
    v_mul_f32 v167, v167, v167
    v_cvt_pk_bf16_f32 v148, v148, v149
    v_mfma_f32_16x16x32_bf16 v[64:67], v[124:127], v[128:131], v[64:67]
    v_cvt_pk_bf16_f32 v149, v150, v151
    v_cvt_pk_bf16_f32 v150, v164, v165
    v_mfma_f32_16x16x32_bf16 v[68:71], v[124:127], v[132:135], v[68:71]
    v_cvt_pk_bf16_f32 v151, v166, v167
    v_max_f32 v152, 0, v152
    v_mfma_f32_16x16x32_bf16 v[72:75], v[124:127], v[136:139], v[72:75]
    v_max_f32 v153, 0, v153
    v_max_f32 v154, 0, v154
    v_mfma_f32_16x16x32_bf16 v[76:79], v[124:127], v[140:143], v[76:79]
    v_max_f32 v155, 0, v155
    v_max_f32 v168, 0, v168
    s_waitcnt lgkmcnt(0)
    s_barrier
    v_mfma_f32_16x16x32_bf16 v[16:19], v[80:83], v[96:99], v[16:19]
    ds_read_b128 v[112:115], v2 offset:0
    v_mfma_f32_16x16x32_bf16 v[20:23], v[80:83], v[100:103], v[20:23]
    ds_read_b128 v[128:131], v4 offset:0
    v_mfma_f32_16x16x32_bf16 v[24:27], v[80:83], v[104:107], v[24:27]
    ds_read_b128 v[132:135], v4 offset:8192
    v_mfma_f32_16x16x32_bf16 v[28:31], v[80:83], v[108:111], v[28:31]
    ds_read_b128 v[136:139], v4 offset:2048
    v_mfma_f32_16x16x32_bf16 v[32:35], v[84:87], v[96:99], v[32:35]
    ds_read_b128 v[140:143], v4 offset:10240
    v_mfma_f32_16x16x32_bf16 v[36:39], v[84:87], v[100:103], v[36:39]
    ds_read_b128 v[116:119], v2 offset:2048
    v_mfma_f32_16x16x32_bf16 v[40:43], v[84:87], v[104:107], v[40:43]
    ds_read_b128 v[120:123], v2 offset:4096
    v_mfma_f32_16x16x32_bf16 v[44:47], v[84:87], v[108:111], v[44:47]
    ds_read_b128 v[124:127], v2 offset:6144
    v_max_f32 v169, 0, v169
    v_mfma_f32_16x16x32_bf16 v[48:51], v[88:91], v[96:99], v[48:51]
    v_add_u32 v3, 4294877184, v3
    v_max_f32 v170, 0, v170
    v_mfma_f32_16x16x32_bf16 v[52:55], v[88:91], v[100:103], v[52:55]
    v_add_u32 v5, 4294877184, v5
    v_max_f32 v171, 0, v171
    v_mfma_f32_16x16x32_bf16 v[56:59], v[88:91], v[104:107], v[56:59]
    v_mul_f32 v152, v152, v152
    v_mul_f32 v153, v153, v153
    v_mfma_f32_16x16x32_bf16 v[60:63], v[88:91], v[108:111], v[60:63]
    v_mul_f32 v154, v154, v154
    v_mul_f32 v155, v155, v155
    v_mfma_f32_16x16x32_bf16 v[64:67], v[92:95], v[96:99], v[64:67]
    v_mul_f32 v168, v168, v168
    v_mul_f32 v169, v169, v169
    v_mfma_f32_16x16x32_bf16 v[68:71], v[92:95], v[100:103], v[68:71]
    v_mul_f32 v170, v170, v170
    v_mul_f32 v171, v171, v171
    v_mfma_f32_16x16x32_bf16 v[72:75], v[92:95], v[104:107], v[72:75]
    v_cvt_pk_bf16_f32 v152, v152, v153
    v_cvt_pk_bf16_f32 v153, v154, v155
    v_mfma_f32_16x16x32_bf16 v[76:79], v[92:95], v[108:111], v[76:79]
    v_cvt_pk_bf16_f32 v154, v168, v169
    v_cvt_pk_bf16_f32 v155, v170, v171
    s_waitcnt lgkmcnt(0)
    v_mfma_f32_16x16x32_bf16 v[16:19], v[112:115], v[128:131], v[16:19]
    ds_read_b128 v[80:83], v3 offset:0
    v_mfma_f32_16x16x32_bf16 v[20:23], v[112:115], v[132:135], v[20:23]
    ds_read_b128 v[96:99], v5 offset:0
    v_mfma_f32_16x16x32_bf16 v[24:27], v[112:115], v[136:139], v[24:27]
    ds_read_b128 v[100:103], v5 offset:8192
    v_mfma_f32_16x16x32_bf16 v[28:31], v[112:115], v[140:143], v[28:31]
    ds_read_b128 v[104:107], v5 offset:2048
    v_mfma_f32_16x16x32_bf16 v[32:35], v[116:119], v[128:131], v[32:35]
    ds_read_b128 v[108:111], v5 offset:10240
    v_mfma_f32_16x16x32_bf16 v[36:39], v[116:119], v[132:135], v[36:39]
    ds_read_b128 v[84:87], v3 offset:2048
    v_mfma_f32_16x16x32_bf16 v[40:43], v[116:119], v[136:139], v[40:43]
    ds_read_b128 v[88:91], v3 offset:4096
    v_mfma_f32_16x16x32_bf16 v[44:47], v[116:119], v[140:143], v[44:47]
    ds_read_b128 v[92:95], v3 offset:6144
    v_max_f32 v156, 0, v156
    v_mfma_f32_16x16x32_bf16 v[48:51], v[120:123], v[128:131], v[48:51]
    v_add_u32 v2, 122880, v2
    v_max_f32 v157, 0, v157
    v_mfma_f32_16x16x32_bf16 v[52:55], v[120:123], v[132:135], v[52:55]
    v_add_u32 v4, 122880, v4
    v_max_f32 v158, 0, v158
    v_mfma_f32_16x16x32_bf16 v[56:59], v[120:123], v[136:139], v[56:59]
    v_max_f32 v159, 0, v159
    v_max_f32 v172, 0, v172
    v_mfma_f32_16x16x32_bf16 v[60:63], v[120:123], v[140:143], v[60:63]
    v_max_f32 v173, 0, v173
    v_max_f32 v174, 0, v174
    v_mfma_f32_16x16x32_bf16 v[64:67], v[124:127], v[128:131], v[64:67]
    v_max_f32 v175, 0, v175
    v_mul_f32 v156, v156, v156
    v_mfma_f32_16x16x32_bf16 v[68:71], v[124:127], v[132:135], v[68:71]
    v_mul_f32 v157, v157, v157
    v_mul_f32 v158, v158, v158
    v_mfma_f32_16x16x32_bf16 v[72:75], v[124:127], v[136:139], v[72:75]
    v_mul_f32 v159, v159, v159
    v_mul_f32 v172, v172, v172
    v_mfma_f32_16x16x32_bf16 v[76:79], v[124:127], v[140:143], v[76:79]
    v_mul_f32 v173, v173, v173
    v_mul_f32 v174, v174, v174
    s_waitcnt lgkmcnt(0)
    s_barrier
    v_mfma_f32_16x16x32_bf16 v[16:19], v[80:83], v[96:99], v[16:19]
    ds_read_b128 v[112:115], v2 offset:0
    v_mfma_f32_16x16x32_bf16 v[20:23], v[80:83], v[100:103], v[20:23]
    ds_read_b128 v[128:131], v4 offset:0
    v_mfma_f32_16x16x32_bf16 v[24:27], v[80:83], v[104:107], v[24:27]
    ds_read_b128 v[132:135], v4 offset:8192
    v_mfma_f32_16x16x32_bf16 v[28:31], v[80:83], v[108:111], v[28:31]
    ds_read_b128 v[136:139], v4 offset:2048
    v_mfma_f32_16x16x32_bf16 v[32:35], v[84:87], v[96:99], v[32:35]
    ds_read_b128 v[140:143], v4 offset:10240
    v_mfma_f32_16x16x32_bf16 v[36:39], v[84:87], v[100:103], v[36:39]
    ds_read_b128 v[116:119], v2 offset:2048
    v_mfma_f32_16x16x32_bf16 v[40:43], v[84:87], v[104:107], v[40:43]
    ds_read_b128 v[120:123], v2 offset:4096
    v_mfma_f32_16x16x32_bf16 v[44:47], v[84:87], v[108:111], v[44:47]
    ds_read_b128 v[124:127], v2 offset:6144
    v_mul_f32 v175, v175, v175
    v_mfma_f32_16x16x32_bf16 v[48:51], v[88:91], v[96:99], v[48:51]
    v_add_u32 v3, 122880, v3
    v_cvt_pk_bf16_f32 v156, v156, v157
    v_mfma_f32_16x16x32_bf16 v[52:55], v[88:91], v[100:103], v[52:55]
    v_add_u32 v5, 122880, v5
    v_cvt_pk_bf16_f32 v157, v158, v159
    v_mfma_f32_16x16x32_bf16 v[56:59], v[88:91], v[104:107], v[56:59]
    v_cvt_pk_bf16_f32 v158, v172, v173
    v_cvt_pk_bf16_f32 v159, v174, v175
    v_mfma_f32_16x16x32_bf16 v[60:63], v[88:91], v[108:111], v[60:63]
    v_max_f32 v176, 0, v176
    v_max_f32 v177, 0, v177
    v_mfma_f32_16x16x32_bf16 v[64:67], v[92:95], v[96:99], v[64:67]
    v_max_f32 v178, 0, v178
    v_max_f32 v179, 0, v179
    v_mfma_f32_16x16x32_bf16 v[68:71], v[92:95], v[100:103], v[68:71]
    v_max_f32 v192, 0, v192
    v_max_f32 v193, 0, v193
    v_mfma_f32_16x16x32_bf16 v[72:75], v[92:95], v[104:107], v[72:75]
    v_max_f32 v194, 0, v194
    v_max_f32 v195, 0, v195
    v_mfma_f32_16x16x32_bf16 v[76:79], v[92:95], v[108:111], v[76:79]
    v_mul_f32 v176, v176, v176
    v_mul_f32 v177, v177, v177
    s_waitcnt lgkmcnt(0)
    v_mfma_f32_16x16x32_bf16 v[16:19], v[112:115], v[128:131], v[16:19]
    ds_read_b128 v[80:83], v3 offset:0
    v_mfma_f32_16x16x32_bf16 v[20:23], v[112:115], v[132:135], v[20:23]
    ds_read_b128 v[96:99], v5 offset:0
    v_mfma_f32_16x16x32_bf16 v[24:27], v[112:115], v[136:139], v[24:27]
    ds_read_b128 v[100:103], v5 offset:8192
    v_mfma_f32_16x16x32_bf16 v[28:31], v[112:115], v[140:143], v[28:31]
    ds_read_b128 v[104:107], v5 offset:2048
    v_mfma_f32_16x16x32_bf16 v[32:35], v[116:119], v[128:131], v[32:35]
    ds_read_b128 v[108:111], v5 offset:10240
    v_mfma_f32_16x16x32_bf16 v[36:39], v[116:119], v[132:135], v[36:39]
    ds_read_b128 v[84:87], v3 offset:2048
    v_mfma_f32_16x16x32_bf16 v[40:43], v[116:119], v[136:139], v[40:43]
    ds_read_b128 v[88:91], v3 offset:4096
    v_mfma_f32_16x16x32_bf16 v[44:47], v[116:119], v[140:143], v[44:47]
    ds_read_b128 v[92:95], v3 offset:6144
    v_mfma_f32_16x16x32_bf16 v[48:51], v[120:123], v[128:131], v[48:51]
    v_add_u32 v2, 4294889472, v2
    v_mfma_f32_16x16x32_bf16 v[52:55], v[120:123], v[132:135], v[52:55]
    v_add_u32 v4, 4294889472, v4
    v_mfma_f32_16x16x32_bf16 v[56:59], v[120:123], v[136:139], v[56:59]
    v_mul_f32 v178, v178, v178
    v_mul_f32 v179, v179, v179
    v_mfma_f32_16x16x32_bf16 v[60:63], v[120:123], v[140:143], v[60:63]
    v_mul_f32 v192, v192, v192
    v_mul_f32 v193, v193, v193
    v_mfma_f32_16x16x32_bf16 v[64:67], v[124:127], v[128:131], v[64:67]
    v_mul_f32 v194, v194, v194
    v_mul_f32 v195, v195, v195
    v_mfma_f32_16x16x32_bf16 v[68:71], v[124:127], v[132:135], v[68:71]
    v_cvt_pk_bf16_f32 v176, v176, v177
    v_cvt_pk_bf16_f32 v177, v178, v179
    v_mfma_f32_16x16x32_bf16 v[72:75], v[124:127], v[136:139], v[72:75]
    v_cvt_pk_bf16_f32 v178, v192, v193
    v_mfma_f32_16x16x32_bf16 v[76:79], v[124:127], v[140:143], v[76:79]
    v_cvt_pk_bf16_f32 v179, v194, v195
    s_waitcnt lgkmcnt(0)
    s_barrier
    v_mfma_f32_16x16x32_bf16 v[16:19], v[80:83], v[96:99], v[16:19]
    ds_read_b128 v[112:115], v2 offset:0
    v_mfma_f32_16x16x32_bf16 v[20:23], v[80:83], v[100:103], v[20:23]
    ds_read_b128 v[128:131], v4 offset:0
    v_mfma_f32_16x16x32_bf16 v[24:27], v[80:83], v[104:107], v[24:27]
    ds_read_b128 v[132:135], v4 offset:8192
    v_mfma_f32_16x16x32_bf16 v[28:31], v[80:83], v[108:111], v[28:31]
    ds_read_b128 v[136:139], v4 offset:2048
    v_mfma_f32_16x16x32_bf16 v[32:35], v[84:87], v[96:99], v[32:35]
    ds_read_b128 v[140:143], v4 offset:10240
    v_mfma_f32_16x16x32_bf16 v[36:39], v[84:87], v[100:103], v[36:39]
    ds_read_b128 v[116:119], v2 offset:2048
    v_mfma_f32_16x16x32_bf16 v[40:43], v[84:87], v[104:107], v[40:43]
    ds_read_b128 v[120:123], v2 offset:4096
    v_mfma_f32_16x16x32_bf16 v[44:47], v[84:87], v[108:111], v[44:47]
    ds_read_b128 v[124:127], v2 offset:6144
    v_mfma_f32_16x16x32_bf16 v[48:51], v[88:91], v[96:99], v[48:51]
    v_add_u32 v3, 4294889472, v3
    v_mfma_f32_16x16x32_bf16 v[52:55], v[88:91], v[100:103], v[52:55]
    v_add_u32 v5, 4294889472, v5
    v_mfma_f32_16x16x32_bf16 v[56:59], v[88:91], v[104:107], v[56:59]
    buffer_store_dwordx4 v[144:147], v6, s[8:11], s91 offen offset:0 sc1
    v_mfma_f32_16x16x32_bf16 v[60:63], v[88:91], v[108:111], v[60:63]
    buffer_store_dwordx4 v[148:151], v6, s[8:11], s91 offen offset:1024 sc1
    v_mfma_f32_16x16x32_bf16 v[64:67], v[92:95], v[96:99], v[64:67]
    buffer_store_dwordx4 v[152:155], v7, s[8:11], s91 offen offset:0 sc1
    v_mfma_f32_16x16x32_bf16 v[68:71], v[92:95], v[100:103], v[68:71]
    buffer_store_dwordx4 v[156:159], v7, s[8:11], s91 offen offset:1024 sc1
    v_mfma_f32_16x16x32_bf16 v[72:75], v[92:95], v[104:107], v[72:75]
    buffer_store_dwordx4 v[176:179], v6, s[8:11], s93 offen offset:0 sc1
    v_mfma_f32_16x16x32_bf16 v[76:79], v[92:95], v[108:111], v[76:79]
    s_waitcnt lgkmcnt(0)
    v_mfma_f32_16x16x32_bf16 v[16:19], v[112:115], v[128:131], v[16:19]
    ds_read_b128 v[80:83], v3 offset:0
    v_mfma_f32_16x16x32_bf16 v[20:23], v[112:115], v[132:135], v[20:23]
    ds_read_b128 v[96:99], v5 offset:0
    v_mfma_f32_16x16x32_bf16 v[24:27], v[112:115], v[136:139], v[24:27]
    ds_read_b128 v[100:103], v5 offset:8192
    v_mfma_f32_16x16x32_bf16 v[28:31], v[112:115], v[140:143], v[28:31]
    ds_read_b128 v[104:107], v5 offset:2048
    v_mfma_f32_16x16x32_bf16 v[32:35], v[116:119], v[128:131], v[32:35]
    ds_read_b128 v[108:111], v5 offset:10240
    v_mfma_f32_16x16x32_bf16 v[36:39], v[116:119], v[132:135], v[36:39]
    ds_read_b128 v[84:87], v3 offset:2048
    v_mfma_f32_16x16x32_bf16 v[40:43], v[116:119], v[136:139], v[40:43]
    ds_read_b128 v[88:91], v3 offset:4096
    v_mfma_f32_16x16x32_bf16 v[44:47], v[116:119], v[140:143], v[44:47]
    ds_read_b128 v[92:95], v3 offset:6144
    v_max_f32 v180, 0, v180
    v_mfma_f32_16x16x32_bf16 v[48:51], v[120:123], v[128:131], v[48:51]
    v_add_u32 v2, 45056, v2
    v_max_f32 v181, 0, v181
    v_mfma_f32_16x16x32_bf16 v[52:55], v[120:123], v[132:135], v[52:55]
    v_add_u32 v4, 45056, v4
    v_max_f32 v182, 0, v182
    v_mfma_f32_16x16x32_bf16 v[56:59], v[120:123], v[136:139], v[56:59]
    v_max_f32 v183, 0, v183
    v_max_f32 v196, 0, v196
    v_mfma_f32_16x16x32_bf16 v[60:63], v[120:123], v[140:143], v[60:63]
    v_max_f32 v197, 0, v197
    v_max_f32 v198, 0, v198
    v_mfma_f32_16x16x32_bf16 v[64:67], v[124:127], v[128:131], v[64:67]
    v_max_f32 v199, 0, v199
    v_mul_f32 v180, v180, v180
    v_mfma_f32_16x16x32_bf16 v[68:71], v[124:127], v[132:135], v[68:71]
    v_mul_f32 v181, v181, v181
    v_mul_f32 v182, v182, v182
    v_mfma_f32_16x16x32_bf16 v[72:75], v[124:127], v[136:139], v[72:75]
    v_mul_f32 v183, v183, v183
    v_mul_f32 v196, v196, v196
    v_mfma_f32_16x16x32_bf16 v[76:79], v[124:127], v[140:143], v[76:79]
    v_mul_f32 v197, v197, v197
    v_mul_f32 v198, v198, v198
    s_waitcnt lgkmcnt(0)
    s_barrier
    v_mfma_f32_16x16x32_bf16 v[16:19], v[80:83], v[96:99], v[16:19]
    ds_read_b128 v[112:115], v2 offset:0
    v_mfma_f32_16x16x32_bf16 v[20:23], v[80:83], v[100:103], v[20:23]
    ds_read_b128 v[128:131], v4 offset:0
    v_mfma_f32_16x16x32_bf16 v[24:27], v[80:83], v[104:107], v[24:27]
    ds_read_b128 v[132:135], v4 offset:8192
    v_mfma_f32_16x16x32_bf16 v[28:31], v[80:83], v[108:111], v[28:31]
    ds_read_b128 v[136:139], v4 offset:2048
    v_mfma_f32_16x16x32_bf16 v[32:35], v[84:87], v[96:99], v[32:35]
    ds_read_b128 v[140:143], v4 offset:10240
    v_mfma_f32_16x16x32_bf16 v[36:39], v[84:87], v[100:103], v[36:39]
    ds_read_b128 v[116:119], v2 offset:2048
    v_mfma_f32_16x16x32_bf16 v[40:43], v[84:87], v[104:107], v[40:43]
    ds_read_b128 v[120:123], v2 offset:4096
    v_mfma_f32_16x16x32_bf16 v[44:47], v[84:87], v[108:111], v[44:47]
    ds_read_b128 v[124:127], v2 offset:6144
    v_mul_f32 v199, v199, v199
    v_mfma_f32_16x16x32_bf16 v[48:51], v[88:91], v[96:99], v[48:51]
    v_add_u32 v3, 45056, v3
    v_cvt_pk_bf16_f32 v180, v180, v181
    v_mfma_f32_16x16x32_bf16 v[52:55], v[88:91], v[100:103], v[52:55]
    v_add_u32 v5, 45056, v5
    v_cvt_pk_bf16_f32 v181, v182, v183
    v_mfma_f32_16x16x32_bf16 v[56:59], v[88:91], v[104:107], v[56:59]
    v_cvt_pk_bf16_f32 v182, v196, v197
    v_cvt_pk_bf16_f32 v183, v198, v199
    v_mfma_f32_16x16x32_bf16 v[60:63], v[88:91], v[108:111], v[60:63]
    v_max_f32 v184, 0, v184
    v_max_f32 v185, 0, v185
    v_mfma_f32_16x16x32_bf16 v[64:67], v[92:95], v[96:99], v[64:67]
    v_max_f32 v186, 0, v186
    v_max_f32 v187, 0, v187
    v_mfma_f32_16x16x32_bf16 v[68:71], v[92:95], v[100:103], v[68:71]
    v_max_f32 v200, 0, v200
    v_max_f32 v201, 0, v201
    v_mfma_f32_16x16x32_bf16 v[72:75], v[92:95], v[104:107], v[72:75]
    v_max_f32 v202, 0, v202
    v_max_f32 v203, 0, v203
    v_mfma_f32_16x16x32_bf16 v[76:79], v[92:95], v[108:111], v[76:79]
    v_mul_f32 v184, v184, v184
    v_mul_f32 v185, v185, v185
    s_waitcnt lgkmcnt(0)
    v_mfma_f32_16x16x32_bf16 v[16:19], v[112:115], v[128:131], v[16:19]
    ds_read_b128 v[80:83], v3 offset:0
    v_mfma_f32_16x16x32_bf16 v[20:23], v[112:115], v[132:135], v[20:23]
    ds_read_b128 v[96:99], v5 offset:0
    v_mfma_f32_16x16x32_bf16 v[24:27], v[112:115], v[136:139], v[24:27]
    ds_read_b128 v[100:103], v5 offset:8192
    v_mfma_f32_16x16x32_bf16 v[28:31], v[112:115], v[140:143], v[28:31]
    ds_read_b128 v[104:107], v5 offset:2048
    v_mfma_f32_16x16x32_bf16 v[32:35], v[116:119], v[128:131], v[32:35]
    ds_read_b128 v[108:111], v5 offset:10240
    v_mfma_f32_16x16x32_bf16 v[36:39], v[116:119], v[132:135], v[36:39]
    ds_read_b128 v[84:87], v3 offset:2048
    v_mfma_f32_16x16x32_bf16 v[40:43], v[116:119], v[136:139], v[40:43]
    ds_read_b128 v[88:91], v3 offset:4096
    v_mfma_f32_16x16x32_bf16 v[44:47], v[116:119], v[140:143], v[44:47]
    ds_read_b128 v[92:95], v3 offset:6144
    v_mul_f32 v186, v186, v186
    v_mfma_f32_16x16x32_bf16 v[48:51], v[120:123], v[128:131], v[48:51]
    v_add_u32 v2, 4294877184, v2
    v_mul_f32 v187, v187, v187
    v_mfma_f32_16x16x32_bf16 v[52:55], v[120:123], v[132:135], v[52:55]
    v_add_u32 v4, 4294877184, v4
    v_mul_f32 v200, v200, v200
    v_mfma_f32_16x16x32_bf16 v[56:59], v[120:123], v[136:139], v[56:59]
    v_mul_f32 v201, v201, v201
    v_mul_f32 v202, v202, v202
    v_mfma_f32_16x16x32_bf16 v[60:63], v[120:123], v[140:143], v[60:63]
    v_mul_f32 v203, v203, v203
    v_cvt_pk_bf16_f32 v184, v184, v185
    v_mfma_f32_16x16x32_bf16 v[64:67], v[124:127], v[128:131], v[64:67]
    v_cvt_pk_bf16_f32 v185, v186, v187
    v_cvt_pk_bf16_f32 v186, v200, v201
    v_mfma_f32_16x16x32_bf16 v[68:71], v[124:127], v[132:135], v[68:71]
    v_cvt_pk_bf16_f32 v187, v202, v203
    v_max_f32 v188, 0, v188
    v_mfma_f32_16x16x32_bf16 v[72:75], v[124:127], v[136:139], v[72:75]
    v_max_f32 v189, 0, v189
    v_max_f32 v190, 0, v190
    v_mfma_f32_16x16x32_bf16 v[76:79], v[124:127], v[140:143], v[76:79]
    v_max_f32 v191, 0, v191
    v_max_f32 v204, 0, v204
    s_waitcnt lgkmcnt(0)
    s_barrier
    v_mfma_f32_16x16x32_bf16 v[16:19], v[80:83], v[96:99], v[16:19]
    ds_read_b128 v[112:115], v2 offset:0
    v_mfma_f32_16x16x32_bf16 v[20:23], v[80:83], v[100:103], v[20:23]
    ds_read_b128 v[128:131], v4 offset:0
    v_mfma_f32_16x16x32_bf16 v[24:27], v[80:83], v[104:107], v[24:27]
    ds_read_b128 v[132:135], v4 offset:8192
    v_mfma_f32_16x16x32_bf16 v[28:31], v[80:83], v[108:111], v[28:31]
    ds_read_b128 v[136:139], v4 offset:2048
    v_mfma_f32_16x16x32_bf16 v[32:35], v[84:87], v[96:99], v[32:35]
    ds_read_b128 v[140:143], v4 offset:10240
    v_mfma_f32_16x16x32_bf16 v[36:39], v[84:87], v[100:103], v[36:39]
    ds_read_b128 v[116:119], v2 offset:2048
    v_mfma_f32_16x16x32_bf16 v[40:43], v[84:87], v[104:107], v[40:43]
    ds_read_b128 v[120:123], v2 offset:4096
    v_mfma_f32_16x16x32_bf16 v[44:47], v[84:87], v[108:111], v[44:47]
    ds_read_b128 v[124:127], v2 offset:6144
    v_max_f32 v205, 0, v205
    v_mfma_f32_16x16x32_bf16 v[48:51], v[88:91], v[96:99], v[48:51]
    v_add_u32 v3, 4294877184, v3
    v_max_f32 v206, 0, v206
    v_mfma_f32_16x16x32_bf16 v[52:55], v[88:91], v[100:103], v[52:55]
    v_add_u32 v5, 4294877184, v5
    v_max_f32 v207, 0, v207
    v_mfma_f32_16x16x32_bf16 v[56:59], v[88:91], v[104:107], v[56:59]
    v_mul_f32 v188, v188, v188
    v_mul_f32 v189, v189, v189
    v_mfma_f32_16x16x32_bf16 v[60:63], v[88:91], v[108:111], v[60:63]
    v_mul_f32 v190, v190, v190
    v_mul_f32 v191, v191, v191
    v_mfma_f32_16x16x32_bf16 v[64:67], v[92:95], v[96:99], v[64:67]
    v_mul_f32 v204, v204, v204
    v_mul_f32 v205, v205, v205
    v_mfma_f32_16x16x32_bf16 v[68:71], v[92:95], v[100:103], v[68:71]
    v_mul_f32 v206, v206, v206
    v_mul_f32 v207, v207, v207
    v_mfma_f32_16x16x32_bf16 v[72:75], v[92:95], v[104:107], v[72:75]
    v_cvt_pk_bf16_f32 v188, v188, v189
    v_cvt_pk_bf16_f32 v189, v190, v191
    v_mfma_f32_16x16x32_bf16 v[76:79], v[92:95], v[108:111], v[76:79]
    v_cvt_pk_bf16_f32 v190, v204, v205
    v_cvt_pk_bf16_f32 v191, v206, v207
    s_waitcnt lgkmcnt(0)
    v_mfma_f32_16x16x32_bf16 v[16:19], v[112:115], v[128:131], v[16:19]
    ds_read_b128 v[80:83], v3 offset:0
    v_mfma_f32_16x16x32_bf16 v[20:23], v[112:115], v[132:135], v[20:23]
    ds_read_b128 v[96:99], v5 offset:0
    v_mfma_f32_16x16x32_bf16 v[24:27], v[112:115], v[136:139], v[24:27]
    ds_read_b128 v[100:103], v5 offset:8192
    v_mfma_f32_16x16x32_bf16 v[28:31], v[112:115], v[140:143], v[28:31]
    ds_read_b128 v[104:107], v5 offset:2048
    v_mfma_f32_16x16x32_bf16 v[32:35], v[116:119], v[128:131], v[32:35]
    ds_read_b128 v[108:111], v5 offset:10240
    v_mfma_f32_16x16x32_bf16 v[36:39], v[116:119], v[132:135], v[36:39]
    ds_read_b128 v[84:87], v3 offset:2048
    v_mfma_f32_16x16x32_bf16 v[40:43], v[116:119], v[136:139], v[40:43]
    ds_read_b128 v[88:91], v3 offset:4096
    v_mfma_f32_16x16x32_bf16 v[44:47], v[116:119], v[140:143], v[44:47]
    ds_read_b128 v[92:95], v3 offset:6144
    v_max_f32 v208, 0, v208
    v_mfma_f32_16x16x32_bf16 v[48:51], v[120:123], v[128:131], v[48:51]
    v_add_u32 v2, 122880, v2
    v_max_f32 v209, 0, v209
    v_mfma_f32_16x16x32_bf16 v[52:55], v[120:123], v[132:135], v[52:55]
    v_add_u32 v4, 122880, v4
    v_max_f32 v210, 0, v210
    v_mfma_f32_16x16x32_bf16 v[56:59], v[120:123], v[136:139], v[56:59]
    v_max_f32 v211, 0, v211
    v_max_f32 v224, 0, v224
    v_mfma_f32_16x16x32_bf16 v[60:63], v[120:123], v[140:143], v[60:63]
    v_max_f32 v225, 0, v225
    v_max_f32 v226, 0, v226
    v_mfma_f32_16x16x32_bf16 v[64:67], v[124:127], v[128:131], v[64:67]
    v_max_f32 v227, 0, v227
    v_mul_f32 v208, v208, v208
    v_mfma_f32_16x16x32_bf16 v[68:71], v[124:127], v[132:135], v[68:71]
    v_mul_f32 v209, v209, v209
    v_mul_f32 v210, v210, v210
    v_mfma_f32_16x16x32_bf16 v[72:75], v[124:127], v[136:139], v[72:75]
    v_mul_f32 v211, v211, v211
    v_mul_f32 v224, v224, v224
    v_mfma_f32_16x16x32_bf16 v[76:79], v[124:127], v[140:143], v[76:79]
    v_mul_f32 v225, v225, v225
    v_mul_f32 v226, v226, v226
    s_waitcnt lgkmcnt(0)
    s_barrier
    v_mfma_f32_16x16x32_bf16 v[16:19], v[80:83], v[96:99], v[16:19]
    ds_read_b128 v[112:115], v2 offset:0
    v_mfma_f32_16x16x32_bf16 v[20:23], v[80:83], v[100:103], v[20:23]
    ds_read_b128 v[128:131], v4 offset:0
    v_mfma_f32_16x16x32_bf16 v[24:27], v[80:83], v[104:107], v[24:27]
    ds_read_b128 v[132:135], v4 offset:8192
    v_mfma_f32_16x16x32_bf16 v[28:31], v[80:83], v[108:111], v[28:31]
    ds_read_b128 v[136:139], v4 offset:2048
    v_mfma_f32_16x16x32_bf16 v[32:35], v[84:87], v[96:99], v[32:35]
    ds_read_b128 v[140:143], v4 offset:10240
    v_mfma_f32_16x16x32_bf16 v[36:39], v[84:87], v[100:103], v[36:39]
    ds_read_b128 v[116:119], v2 offset:2048
    v_mfma_f32_16x16x32_bf16 v[40:43], v[84:87], v[104:107], v[40:43]
    ds_read_b128 v[120:123], v2 offset:4096
    v_mfma_f32_16x16x32_bf16 v[44:47], v[84:87], v[108:111], v[44:47]
    ds_read_b128 v[124:127], v2 offset:6144
    v_mul_f32 v227, v227, v227
    v_mfma_f32_16x16x32_bf16 v[48:51], v[88:91], v[96:99], v[48:51]
    v_add_u32 v3, 122880, v3
    v_cvt_pk_bf16_f32 v208, v208, v209
    v_mfma_f32_16x16x32_bf16 v[52:55], v[88:91], v[100:103], v[52:55]
    v_add_u32 v5, 122880, v5
    v_cvt_pk_bf16_f32 v209, v210, v211
    v_mfma_f32_16x16x32_bf16 v[56:59], v[88:91], v[104:107], v[56:59]
    v_cvt_pk_bf16_f32 v210, v224, v225
    v_cvt_pk_bf16_f32 v211, v226, v227
    v_mfma_f32_16x16x32_bf16 v[60:63], v[88:91], v[108:111], v[60:63]
    v_max_f32 v212, 0, v212
    v_max_f32 v213, 0, v213
    v_mfma_f32_16x16x32_bf16 v[64:67], v[92:95], v[96:99], v[64:67]
    v_max_f32 v214, 0, v214
    v_max_f32 v215, 0, v215
    v_mfma_f32_16x16x32_bf16 v[68:71], v[92:95], v[100:103], v[68:71]
    v_max_f32 v228, 0, v228
    v_max_f32 v229, 0, v229
    v_mfma_f32_16x16x32_bf16 v[72:75], v[92:95], v[104:107], v[72:75]
    v_max_f32 v230, 0, v230
    v_max_f32 v231, 0, v231
    v_mfma_f32_16x16x32_bf16 v[76:79], v[92:95], v[108:111], v[76:79]
    v_mul_f32 v212, v212, v212
    v_mul_f32 v213, v213, v213
    s_waitcnt lgkmcnt(0)
    v_mfma_f32_16x16x32_bf16 v[16:19], v[112:115], v[128:131], v[16:19]
    ds_read_b128 v[80:83], v3 offset:0
    v_mfma_f32_16x16x32_bf16 v[20:23], v[112:115], v[132:135], v[20:23]
    ds_read_b128 v[96:99], v5 offset:0
    v_mfma_f32_16x16x32_bf16 v[24:27], v[112:115], v[136:139], v[24:27]
    ds_read_b128 v[100:103], v5 offset:8192
    v_mfma_f32_16x16x32_bf16 v[28:31], v[112:115], v[140:143], v[28:31]
    ds_read_b128 v[104:107], v5 offset:2048
    v_mfma_f32_16x16x32_bf16 v[32:35], v[116:119], v[128:131], v[32:35]
    ds_read_b128 v[108:111], v5 offset:10240
    v_mfma_f32_16x16x32_bf16 v[36:39], v[116:119], v[132:135], v[36:39]
    ds_read_b128 v[84:87], v3 offset:2048
    v_mfma_f32_16x16x32_bf16 v[40:43], v[116:119], v[136:139], v[40:43]
    ds_read_b128 v[88:91], v3 offset:4096
    v_mfma_f32_16x16x32_bf16 v[44:47], v[116:119], v[140:143], v[44:47]
    ds_read_b128 v[92:95], v3 offset:6144
    v_mfma_f32_16x16x32_bf16 v[48:51], v[120:123], v[128:131], v[48:51]
    v_add_u32 v2, 4294889472, v2
    v_mfma_f32_16x16x32_bf16 v[52:55], v[120:123], v[132:135], v[52:55]
    v_add_u32 v4, 4294889472, v4
    v_mfma_f32_16x16x32_bf16 v[56:59], v[120:123], v[136:139], v[56:59]
    v_mul_f32 v214, v214, v214
    v_mul_f32 v215, v215, v215
    v_mfma_f32_16x16x32_bf16 v[60:63], v[120:123], v[140:143], v[60:63]
    v_mul_f32 v228, v228, v228
    v_mul_f32 v229, v229, v229
    v_mfma_f32_16x16x32_bf16 v[64:67], v[124:127], v[128:131], v[64:67]
    v_mul_f32 v230, v230, v230
    v_mul_f32 v231, v231, v231
    v_mfma_f32_16x16x32_bf16 v[68:71], v[124:127], v[132:135], v[68:71]
    v_cvt_pk_bf16_f32 v212, v212, v213
    v_cvt_pk_bf16_f32 v213, v214, v215
    v_mfma_f32_16x16x32_bf16 v[72:75], v[124:127], v[136:139], v[72:75]
    v_cvt_pk_bf16_f32 v214, v228, v229
    v_mfma_f32_16x16x32_bf16 v[76:79], v[124:127], v[140:143], v[76:79]
    v_cvt_pk_bf16_f32 v215, v230, v231
    s_waitcnt lgkmcnt(0)
    s_barrier
    v_mfma_f32_16x16x32_bf16 v[16:19], v[80:83], v[96:99], v[16:19]
    ds_read_b128 v[112:115], v2 offset:0
    v_mfma_f32_16x16x32_bf16 v[20:23], v[80:83], v[100:103], v[20:23]
    ds_read_b128 v[128:131], v4 offset:0
    v_mfma_f32_16x16x32_bf16 v[24:27], v[80:83], v[104:107], v[24:27]
    ds_read_b128 v[132:135], v4 offset:8192
    v_mfma_f32_16x16x32_bf16 v[28:31], v[80:83], v[108:111], v[28:31]
    ds_read_b128 v[136:139], v4 offset:2048
    v_mfma_f32_16x16x32_bf16 v[32:35], v[84:87], v[96:99], v[32:35]
    ds_read_b128 v[140:143], v4 offset:10240
    v_mfma_f32_16x16x32_bf16 v[36:39], v[84:87], v[100:103], v[36:39]
    ds_read_b128 v[116:119], v2 offset:2048
    v_mfma_f32_16x16x32_bf16 v[40:43], v[84:87], v[104:107], v[40:43]
    ds_read_b128 v[120:123], v2 offset:4096
    v_mfma_f32_16x16x32_bf16 v[44:47], v[84:87], v[108:111], v[44:47]
    ds_read_b128 v[124:127], v2 offset:6144
    v_mfma_f32_16x16x32_bf16 v[48:51], v[88:91], v[96:99], v[48:51]
    v_add_u32 v3, 4294889472, v3
    v_mfma_f32_16x16x32_bf16 v[52:55], v[88:91], v[100:103], v[52:55]
    v_add_u32 v5, 4294889472, v5
    v_mfma_f32_16x16x32_bf16 v[56:59], v[88:91], v[104:107], v[56:59]
    buffer_store_dwordx4 v[180:183], v6, s[8:11], s93 offen offset:1024 sc1
    v_mfma_f32_16x16x32_bf16 v[60:63], v[88:91], v[108:111], v[60:63]
    buffer_store_dwordx4 v[184:187], v7, s[8:11], s93 offen offset:0 sc1
    v_mfma_f32_16x16x32_bf16 v[64:67], v[92:95], v[96:99], v[64:67]
    buffer_store_dwordx4 v[188:191], v7, s[8:11], s93 offen offset:1024 sc1
    v_mfma_f32_16x16x32_bf16 v[68:71], v[92:95], v[100:103], v[68:71]
    buffer_store_dwordx4 v[208:211], v6, s[8:11], s94 offen offset:0 sc1
    v_mfma_f32_16x16x32_bf16 v[72:75], v[92:95], v[104:107], v[72:75]
    buffer_store_dwordx4 v[212:215], v6, s[8:11], s94 offen offset:1024 sc1
    v_mfma_f32_16x16x32_bf16 v[76:79], v[92:95], v[108:111], v[76:79]
    s_waitcnt lgkmcnt(0)
    v_mfma_f32_16x16x32_bf16 v[16:19], v[112:115], v[128:131], v[16:19]
    ds_read_b128 v[80:83], v3 offset:0
    v_mfma_f32_16x16x32_bf16 v[20:23], v[112:115], v[132:135], v[20:23]
    ds_read_b128 v[96:99], v5 offset:0
    v_mfma_f32_16x16x32_bf16 v[24:27], v[112:115], v[136:139], v[24:27]
    ds_read_b128 v[100:103], v5 offset:8192
    v_mfma_f32_16x16x32_bf16 v[28:31], v[112:115], v[140:143], v[28:31]
    ds_read_b128 v[104:107], v5 offset:2048
    v_mfma_f32_16x16x32_bf16 v[32:35], v[116:119], v[128:131], v[32:35]
    ds_read_b128 v[108:111], v5 offset:10240
    v_mfma_f32_16x16x32_bf16 v[36:39], v[116:119], v[132:135], v[36:39]
    ds_read_b128 v[84:87], v3 offset:2048
    v_mfma_f32_16x16x32_bf16 v[40:43], v[116:119], v[136:139], v[40:43]
    ds_read_b128 v[88:91], v3 offset:4096
    v_mfma_f32_16x16x32_bf16 v[44:47], v[116:119], v[140:143], v[44:47]
    ds_read_b128 v[92:95], v3 offset:6144
    v_max_f32 v216, 0, v216
    v_mfma_f32_16x16x32_bf16 v[48:51], v[120:123], v[128:131], v[48:51]
    v_add_u32 v2, 45056, v2
    v_max_f32 v217, 0, v217
    v_mfma_f32_16x16x32_bf16 v[52:55], v[120:123], v[132:135], v[52:55]
    v_add_u32 v4, 45056, v4
    v_max_f32 v218, 0, v218
    v_mfma_f32_16x16x32_bf16 v[56:59], v[120:123], v[136:139], v[56:59]
    v_max_f32 v219, 0, v219
    v_max_f32 v232, 0, v232
    v_mfma_f32_16x16x32_bf16 v[60:63], v[120:123], v[140:143], v[60:63]
    v_max_f32 v233, 0, v233
    v_max_f32 v234, 0, v234
    v_mfma_f32_16x16x32_bf16 v[64:67], v[124:127], v[128:131], v[64:67]
    v_max_f32 v235, 0, v235
    v_mul_f32 v216, v216, v216
    v_mfma_f32_16x16x32_bf16 v[68:71], v[124:127], v[132:135], v[68:71]
    v_mul_f32 v217, v217, v217
    v_mul_f32 v218, v218, v218
    v_mfma_f32_16x16x32_bf16 v[72:75], v[124:127], v[136:139], v[72:75]
    v_mul_f32 v219, v219, v219
    v_mul_f32 v232, v232, v232
    v_mfma_f32_16x16x32_bf16 v[76:79], v[124:127], v[140:143], v[76:79]
    v_mul_f32 v233, v233, v233
    v_mul_f32 v234, v234, v234
    s_waitcnt lgkmcnt(0)
    s_barrier
    v_mfma_f32_16x16x32_bf16 v[16:19], v[80:83], v[96:99], v[16:19]
    ds_read_b128 v[112:115], v2 offset:0
    v_mfma_f32_16x16x32_bf16 v[20:23], v[80:83], v[100:103], v[20:23]
    ds_read_b128 v[128:131], v4 offset:0
    v_mfma_f32_16x16x32_bf16 v[24:27], v[80:83], v[104:107], v[24:27]
    ds_read_b128 v[132:135], v4 offset:8192
    v_mfma_f32_16x16x32_bf16 v[28:31], v[80:83], v[108:111], v[28:31]
    ds_read_b128 v[136:139], v4 offset:2048
    v_mfma_f32_16x16x32_bf16 v[32:35], v[84:87], v[96:99], v[32:35]
    ds_read_b128 v[140:143], v4 offset:10240
    v_mfma_f32_16x16x32_bf16 v[36:39], v[84:87], v[100:103], v[36:39]
    ds_read_b128 v[116:119], v2 offset:2048
    v_mfma_f32_16x16x32_bf16 v[40:43], v[84:87], v[104:107], v[40:43]
    ds_read_b128 v[120:123], v2 offset:4096
    v_mfma_f32_16x16x32_bf16 v[44:47], v[84:87], v[108:111], v[44:47]
    ds_read_b128 v[124:127], v2 offset:6144
    v_mul_f32 v235, v235, v235
    v_mfma_f32_16x16x32_bf16 v[48:51], v[88:91], v[96:99], v[48:51]
    v_add_u32 v3, 45056, v3
    v_cvt_pk_bf16_f32 v216, v216, v217
    v_mfma_f32_16x16x32_bf16 v[52:55], v[88:91], v[100:103], v[52:55]
    v_add_u32 v5, 45056, v5
    v_cvt_pk_bf16_f32 v217, v218, v219
    v_mfma_f32_16x16x32_bf16 v[56:59], v[88:91], v[104:107], v[56:59]
    v_cvt_pk_bf16_f32 v218, v232, v233
    v_cvt_pk_bf16_f32 v219, v234, v235
    v_mfma_f32_16x16x32_bf16 v[60:63], v[88:91], v[108:111], v[60:63]
    v_max_f32 v220, 0, v220
    v_max_f32 v221, 0, v221
    v_mfma_f32_16x16x32_bf16 v[64:67], v[92:95], v[96:99], v[64:67]
    v_max_f32 v222, 0, v222
    v_max_f32 v223, 0, v223
    v_mfma_f32_16x16x32_bf16 v[68:71], v[92:95], v[100:103], v[68:71]
    v_max_f32 v236, 0, v236
    v_max_f32 v237, 0, v237
    v_mfma_f32_16x16x32_bf16 v[72:75], v[92:95], v[104:107], v[72:75]
    v_max_f32 v238, 0, v238
    v_max_f32 v239, 0, v239
    v_mfma_f32_16x16x32_bf16 v[76:79], v[92:95], v[108:111], v[76:79]
    v_mul_f32 v220, v220, v220
    v_mul_f32 v221, v221, v221
    s_waitcnt lgkmcnt(0)
    v_mfma_f32_16x16x32_bf16 v[16:19], v[112:115], v[128:131], v[16:19]
    ds_read_b128 v[80:83], v3 offset:0
    v_mfma_f32_16x16x32_bf16 v[20:23], v[112:115], v[132:135], v[20:23]
    ds_read_b128 v[96:99], v5 offset:0
    v_mfma_f32_16x16x32_bf16 v[24:27], v[112:115], v[136:139], v[24:27]
    ds_read_b128 v[100:103], v5 offset:8192
    v_mfma_f32_16x16x32_bf16 v[28:31], v[112:115], v[140:143], v[28:31]
    ds_read_b128 v[104:107], v5 offset:2048
    v_mfma_f32_16x16x32_bf16 v[32:35], v[116:119], v[128:131], v[32:35]
    ds_read_b128 v[108:111], v5 offset:10240
    v_mfma_f32_16x16x32_bf16 v[36:39], v[116:119], v[132:135], v[36:39]
    ds_read_b128 v[84:87], v3 offset:2048
    v_mfma_f32_16x16x32_bf16 v[40:43], v[116:119], v[136:139], v[40:43]
    ds_read_b128 v[88:91], v3 offset:4096
    v_mfma_f32_16x16x32_bf16 v[44:47], v[116:119], v[140:143], v[44:47]
    ds_read_b128 v[92:95], v3 offset:6144
    v_mul_f32 v222, v222, v222
    v_mfma_f32_16x16x32_bf16 v[48:51], v[120:123], v[128:131], v[48:51]
    v_add_u32 v2, 4294877184, v2
    v_mul_f32 v223, v223, v223
    v_mfma_f32_16x16x32_bf16 v[52:55], v[120:123], v[132:135], v[52:55]
    v_add_u32 v4, 4294877184, v4
    v_mul_f32 v236, v236, v236
    v_mfma_f32_16x16x32_bf16 v[56:59], v[120:123], v[136:139], v[56:59]
    v_mul_f32 v237, v237, v237
    v_mul_f32 v238, v238, v238
    v_mfma_f32_16x16x32_bf16 v[60:63], v[120:123], v[140:143], v[60:63]
    v_mul_f32 v239, v239, v239
    v_cvt_pk_bf16_f32 v220, v220, v221
    v_mfma_f32_16x16x32_bf16 v[64:67], v[124:127], v[128:131], v[64:67]
    v_cvt_pk_bf16_f32 v221, v222, v223
    v_cvt_pk_bf16_f32 v222, v236, v237
    v_mfma_f32_16x16x32_bf16 v[68:71], v[124:127], v[132:135], v[68:71]
    v_cvt_pk_bf16_f32 v223, v238, v239
    v_max_f32 v240, 0, v240
    v_mfma_f32_16x16x32_bf16 v[72:75], v[124:127], v[136:139], v[72:75]
    v_max_f32 v241, 0, v241
    v_max_f32 v242, 0, v242
    v_mfma_f32_16x16x32_bf16 v[76:79], v[124:127], v[140:143], v[76:79]
    v_max_f32 v243, 0, v243
    v_max_f32 v248, 0, v248
    s_waitcnt lgkmcnt(0)
    s_barrier
    v_mfma_f32_16x16x32_bf16 v[16:19], v[80:83], v[96:99], v[16:19]
    ds_read_b128 v[112:115], v2 offset:0
    v_mfma_f32_16x16x32_bf16 v[20:23], v[80:83], v[100:103], v[20:23]
    ds_read_b128 v[128:131], v4 offset:0
    v_mfma_f32_16x16x32_bf16 v[24:27], v[80:83], v[104:107], v[24:27]
    ds_read_b128 v[132:135], v4 offset:8192
    v_mfma_f32_16x16x32_bf16 v[28:31], v[80:83], v[108:111], v[28:31]
    ds_read_b128 v[136:139], v4 offset:2048
    v_mfma_f32_16x16x32_bf16 v[32:35], v[84:87], v[96:99], v[32:35]
    ds_read_b128 v[140:143], v4 offset:10240
    v_mfma_f32_16x16x32_bf16 v[36:39], v[84:87], v[100:103], v[36:39]
    ds_read_b128 v[116:119], v2 offset:2048
    v_mfma_f32_16x16x32_bf16 v[40:43], v[84:87], v[104:107], v[40:43]
    ds_read_b128 v[120:123], v2 offset:4096
    v_mfma_f32_16x16x32_bf16 v[44:47], v[84:87], v[108:111], v[44:47]
    ds_read_b128 v[124:127], v2 offset:6144
    v_max_f32 v249, 0, v249
    v_mfma_f32_16x16x32_bf16 v[48:51], v[88:91], v[96:99], v[48:51]
    v_add_u32 v3, 4294877184, v3
    v_max_f32 v250, 0, v250
    v_mfma_f32_16x16x32_bf16 v[52:55], v[88:91], v[100:103], v[52:55]
    v_add_u32 v5, 4294877184, v5
    v_max_f32 v251, 0, v251
    v_mfma_f32_16x16x32_bf16 v[56:59], v[88:91], v[104:107], v[56:59]
    v_mul_f32 v240, v240, v240
    v_mul_f32 v241, v241, v241
    v_mfma_f32_16x16x32_bf16 v[60:63], v[88:91], v[108:111], v[60:63]
    v_mul_f32 v242, v242, v242
    v_mul_f32 v243, v243, v243
    v_mfma_f32_16x16x32_bf16 v[64:67], v[92:95], v[96:99], v[64:67]
    v_mul_f32 v248, v248, v248
    v_mul_f32 v249, v249, v249
    v_mfma_f32_16x16x32_bf16 v[68:71], v[92:95], v[100:103], v[68:71]
    v_mul_f32 v250, v250, v250
    v_mul_f32 v251, v251, v251
    v_mfma_f32_16x16x32_bf16 v[72:75], v[92:95], v[104:107], v[72:75]
    v_cvt_pk_bf16_f32 v240, v240, v241
    v_cvt_pk_bf16_f32 v241, v242, v243
    v_mfma_f32_16x16x32_bf16 v[76:79], v[92:95], v[108:111], v[76:79]
    v_cvt_pk_bf16_f32 v242, v248, v249
    v_cvt_pk_bf16_f32 v243, v250, v251
    s_waitcnt lgkmcnt(0)
    v_mfma_f32_16x16x32_bf16 v[16:19], v[112:115], v[128:131], v[16:19]
    ds_read_b128 v[80:83], v3 offset:0
    v_mfma_f32_16x16x32_bf16 v[20:23], v[112:115], v[132:135], v[20:23]
    ds_read_b128 v[96:99], v5 offset:0
    v_mfma_f32_16x16x32_bf16 v[24:27], v[112:115], v[136:139], v[24:27]
    ds_read_b128 v[100:103], v5 offset:8192
    v_mfma_f32_16x16x32_bf16 v[28:31], v[112:115], v[140:143], v[28:31]
    ds_read_b128 v[104:107], v5 offset:2048
    v_mfma_f32_16x16x32_bf16 v[32:35], v[116:119], v[128:131], v[32:35]
    ds_read_b128 v[108:111], v5 offset:10240
    v_mfma_f32_16x16x32_bf16 v[36:39], v[116:119], v[132:135], v[36:39]
    ds_read_b128 v[84:87], v3 offset:2048
    v_mfma_f32_16x16x32_bf16 v[40:43], v[116:119], v[136:139], v[40:43]
    ds_read_b128 v[88:91], v3 offset:4096
    v_mfma_f32_16x16x32_bf16 v[44:47], v[116:119], v[140:143], v[44:47]
    ds_read_b128 v[92:95], v3 offset:6144
    v_max_f32 v244, 0, v244
    v_mfma_f32_16x16x32_bf16 v[48:51], v[120:123], v[128:131], v[48:51]
    v_add_u32 v2, 122880, v2
    v_max_f32 v245, 0, v245
    v_mfma_f32_16x16x32_bf16 v[52:55], v[120:123], v[132:135], v[52:55]
    v_add_u32 v4, 122880, v4
    v_max_f32 v246, 0, v246
    v_mfma_f32_16x16x32_bf16 v[56:59], v[120:123], v[136:139], v[56:59]
    v_max_f32 v247, 0, v247
    v_max_f32 v252, 0, v252
    v_mfma_f32_16x16x32_bf16 v[60:63], v[120:123], v[140:143], v[60:63]
    v_max_f32 v253, 0, v253
    v_max_f32 v254, 0, v254
    v_mfma_f32_16x16x32_bf16 v[64:67], v[124:127], v[128:131], v[64:67]
    v_max_f32 v255, 0, v255
    v_mul_f32 v244, v244, v244
    v_mfma_f32_16x16x32_bf16 v[68:71], v[124:127], v[132:135], v[68:71]
    v_mul_f32 v245, v245, v245
    v_mul_f32 v246, v246, v246
    v_mfma_f32_16x16x32_bf16 v[72:75], v[124:127], v[136:139], v[72:75]
    v_mul_f32 v247, v247, v247
    v_mul_f32 v252, v252, v252
    v_mfma_f32_16x16x32_bf16 v[76:79], v[124:127], v[140:143], v[76:79]
    v_mul_f32 v253, v253, v253
    v_mul_f32 v254, v254, v254
    s_waitcnt lgkmcnt(0)
    s_barrier
    v_mfma_f32_16x16x32_bf16 v[16:19], v[80:83], v[96:99], v[16:19]
    ds_read_b128 v[112:115], v2 offset:0
    v_mfma_f32_16x16x32_bf16 v[20:23], v[80:83], v[100:103], v[20:23]
    ds_read_b128 v[128:131], v4 offset:0
    v_mfma_f32_16x16x32_bf16 v[24:27], v[80:83], v[104:107], v[24:27]
    ds_read_b128 v[132:135], v4 offset:8192
    v_mfma_f32_16x16x32_bf16 v[28:31], v[80:83], v[108:111], v[28:31]
    ds_read_b128 v[136:139], v4 offset:2048
    v_mfma_f32_16x16x32_bf16 v[32:35], v[84:87], v[96:99], v[32:35]
    ds_read_b128 v[140:143], v4 offset:10240
    v_mfma_f32_16x16x32_bf16 v[36:39], v[84:87], v[100:103], v[36:39]
    ds_read_b128 v[116:119], v2 offset:2048
    v_mfma_f32_16x16x32_bf16 v[40:43], v[84:87], v[104:107], v[40:43]
    ds_read_b128 v[120:123], v2 offset:4096
    v_mfma_f32_16x16x32_bf16 v[44:47], v[84:87], v[108:111], v[44:47]
    ds_read_b128 v[124:127], v2 offset:6144
    v_mfma_f32_16x16x32_bf16 v[48:51], v[88:91], v[96:99], v[48:51]
    v_add_u32 v3, 122880, v3
    v_mfma_f32_16x16x32_bf16 v[52:55], v[88:91], v[100:103], v[52:55]
    v_add_u32 v5, 122880, v5
    v_mfma_f32_16x16x32_bf16 v[56:59], v[88:91], v[104:107], v[56:59]
    v_mul_f32 v255, v255, v255
    v_mfma_f32_16x16x32_bf16 v[60:63], v[88:91], v[108:111], v[60:63]
    v_cvt_pk_bf16_f32 v244, v244, v245
    v_mfma_f32_16x16x32_bf16 v[64:67], v[92:95], v[96:99], v[64:67]
    v_cvt_pk_bf16_f32 v245, v246, v247
    v_mfma_f32_16x16x32_bf16 v[68:71], v[92:95], v[100:103], v[68:71]
    v_cvt_pk_bf16_f32 v246, v252, v253
    v_mfma_f32_16x16x32_bf16 v[72:75], v[92:95], v[104:107], v[72:75]
    v_cvt_pk_bf16_f32 v247, v254, v255
    v_mfma_f32_16x16x32_bf16 v[76:79], v[92:95], v[108:111], v[76:79]
    s_waitcnt lgkmcnt(0)
    v_mfma_f32_16x16x32_bf16 v[16:19], v[112:115], v[128:131], v[16:19]
    ds_read_b128 v[80:83], v3 offset:0
    v_mfma_f32_16x16x32_bf16 v[20:23], v[112:115], v[132:135], v[20:23]
    ds_read_b128 v[96:99], v5 offset:0
    v_mfma_f32_16x16x32_bf16 v[24:27], v[112:115], v[136:139], v[24:27]
    ds_read_b128 v[100:103], v5 offset:8192
    v_mfma_f32_16x16x32_bf16 v[28:31], v[112:115], v[140:143], v[28:31]
    ds_read_b128 v[104:107], v5 offset:2048
    v_mfma_f32_16x16x32_bf16 v[32:35], v[116:119], v[128:131], v[32:35]
    ds_read_b128 v[108:111], v5 offset:10240
    v_mfma_f32_16x16x32_bf16 v[36:39], v[116:119], v[132:135], v[36:39]
    ds_read_b128 v[84:87], v3 offset:2048
    v_mfma_f32_16x16x32_bf16 v[40:43], v[116:119], v[136:139], v[40:43]
    ds_read_b128 v[88:91], v3 offset:4096
    v_mfma_f32_16x16x32_bf16 v[44:47], v[116:119], v[140:143], v[44:47]
    ds_read_b128 v[92:95], v3 offset:6144
    v_mfma_f32_16x16x32_bf16 v[48:51], v[120:123], v[128:131], v[48:51]
    v_add_u32 v2, 4294889472, v2
    v_mfma_f32_16x16x32_bf16 v[52:55], v[120:123], v[132:135], v[52:55]
    v_add_u32 v4, 4294889472, v4
    v_mfma_f32_16x16x32_bf16 v[56:59], v[120:123], v[136:139], v[56:59]
    buffer_store_dwordx4 v[216:219], v7, s[8:11], s94 offen offset:0 sc1
    v_mfma_f32_16x16x32_bf16 v[60:63], v[120:123], v[140:143], v[60:63]
    buffer_store_dwordx4 v[220:223], v7, s[8:11], s94 offen offset:1024 sc1
    v_mfma_f32_16x16x32_bf16 v[64:67], v[124:127], v[128:131], v[64:67]
    buffer_store_dwordx4 v[240:243], v6, s[8:11], s92 offen offset:0 sc1
    v_mfma_f32_16x16x32_bf16 v[68:71], v[124:127], v[132:135], v[68:71]
    buffer_store_dwordx4 v[244:247], v6, s[8:11], s92 offen offset:1024 sc1
    v_mfma_f32_16x16x32_bf16 v[72:75], v[124:127], v[136:139], v[72:75]
    v_mfma_f32_16x16x32_bf16 v[76:79], v[124:127], v[140:143], v[76:79]
    s_waitcnt lgkmcnt(0)
    s_barrier
    v_mfma_f32_16x16x32_bf16 v[16:19], v[80:83], v[96:99], v[16:19]
    ds_read_b128 v[112:115], v2 offset:0
    v_mfma_f32_16x16x32_bf16 v[20:23], v[80:83], v[100:103], v[20:23]
    ds_read_b128 v[128:131], v4 offset:0
    v_mfma_f32_16x16x32_bf16 v[24:27], v[80:83], v[104:107], v[24:27]
    ds_read_b128 v[132:135], v4 offset:8192
    v_mfma_f32_16x16x32_bf16 v[28:31], v[80:83], v[108:111], v[28:31]
    ds_read_b128 v[136:139], v4 offset:2048
    v_mfma_f32_16x16x32_bf16 v[32:35], v[84:87], v[96:99], v[32:35]
    ds_read_b128 v[140:143], v4 offset:10240
    v_mfma_f32_16x16x32_bf16 v[36:39], v[84:87], v[100:103], v[36:39]
    ds_read_b128 v[116:119], v2 offset:2048
    v_mfma_f32_16x16x32_bf16 v[40:43], v[84:87], v[104:107], v[40:43]
    ds_read_b128 v[120:123], v2 offset:4096
    v_mfma_f32_16x16x32_bf16 v[44:47], v[84:87], v[108:111], v[44:47]
    ds_read_b128 v[124:127], v2 offset:6144
    v_mfma_f32_16x16x32_bf16 v[48:51], v[88:91], v[96:99], v[48:51]
    v_add_u32 v3, 4294889472, v3
    v_mfma_f32_16x16x32_bf16 v[52:55], v[88:91], v[100:103], v[52:55]
    v_add_u32 v5, 4294889472, v5
    v_mfma_f32_16x16x32_bf16 v[56:59], v[88:91], v[104:107], v[56:59]
    v_mfma_f32_16x16x32_bf16 v[60:63], v[88:91], v[108:111], v[60:63]
    v_mfma_f32_16x16x32_bf16 v[64:67], v[92:95], v[96:99], v[64:67]
    v_mfma_f32_16x16x32_bf16 v[68:71], v[92:95], v[100:103], v[68:71]
    v_mfma_f32_16x16x32_bf16 v[72:75], v[92:95], v[104:107], v[72:75]
    v_mfma_f32_16x16x32_bf16 v[76:79], v[92:95], v[108:111], v[76:79]
    s_waitcnt vmcnt(0)
    s_waitcnt lgkmcnt(0)
    v_mfma_f32_16x16x32_bf16 v[16:19], v[112:115], v[128:131], v[16:19]
    ds_read_b128 v[80:83], v3 offset:0
    v_mfma_f32_16x16x32_bf16 v[20:23], v[112:115], v[132:135], v[20:23]
    ds_read_b128 v[96:99], v5 offset:0
    v_mfma_f32_16x16x32_bf16 v[24:27], v[112:115], v[136:139], v[24:27]
    ds_read_b128 v[100:103], v5 offset:8192
    v_mfma_f32_16x16x32_bf16 v[28:31], v[112:115], v[140:143], v[28:31]
    ds_read_b128 v[104:107], v5 offset:2048
    v_mfma_f32_16x16x32_bf16 v[32:35], v[116:119], v[128:131], v[32:35]
    ds_read_b128 v[108:111], v5 offset:10240
    v_mfma_f32_16x16x32_bf16 v[36:39], v[116:119], v[132:135], v[36:39]
    ds_read_b128 v[84:87], v3 offset:2048
    v_mfma_f32_16x16x32_bf16 v[40:43], v[116:119], v[136:139], v[40:43]
    ds_read_b128 v[88:91], v3 offset:4096
    v_mfma_f32_16x16x32_bf16 v[44:47], v[116:119], v[140:143], v[44:47]
    ds_read_b128 v[92:95], v3 offset:6144
    v_lshrrev_b32 v220, 4, v0
    v_mfma_f32_16x16x32_bf16 v[48:51], v[120:123], v[128:131], v[48:51]
    v_add_u32 v2, 45056, v2
    v_lshrrev_b32 v221, 2, v0
    v_mfma_f32_16x16x32_bf16 v[52:55], v[120:123], v[132:135], v[52:55]
    v_add_u32 v4, 45056, v4
    v_and_b32 v221, 3, v221
    v_mfma_f32_16x16x32_bf16 v[56:59], v[120:123], v[136:139], v[56:59]
    v_and_b32 v222, 3, v0
    v_and_b32 v223, 15, v0
    v_mfma_f32_16x16x32_bf16 v[60:63], v[120:123], v[140:143], v[60:63]
    v_lshlrev_b32 v13, 4, v0
    s_lshl_b32 s87, s89, 12
    v_mfma_f32_16x16x32_bf16 v[64:67], v[124:127], v[128:131], v[64:67]
    s_add_u32 s87, s87, 45056
    v_add_u32 v8, s87, v13
    v_mfma_f32_16x16x32_bf16 v[68:71], v[124:127], v[132:135], v[68:71]
    v_and_b32 v216, 1, v220
    v_lshlrev_b32 v216, 2, v216
    v_mfma_f32_16x16x32_bf16 v[72:75], v[124:127], v[136:139], v[72:75]
    v_add_u32 v216, v216, v221
    v_lshlrev_b32 v217, 2, v220
    v_mfma_f32_16x16x32_bf16 v[76:79], v[124:127], v[140:143], v[76:79]
    v_add_u32 v217, v217, v221
    v_lshlrev_b32 v217, 8, v217
    s_waitcnt lgkmcnt(0)
    s_barrier
    v_mfma_f32_16x16x32_bf16 v[16:19], v[80:83], v[96:99], v[16:19]
    ds_read_b128 v[112:115], v2 offset:0
    v_mfma_f32_16x16x32_bf16 v[20:23], v[80:83], v[100:103], v[20:23]
    ds_read_b128 v[128:131], v4 offset:0
    v_mfma_f32_16x16x32_bf16 v[24:27], v[80:83], v[104:107], v[24:27]
    ds_read_b128 v[132:135], v4 offset:8192
    v_mfma_f32_16x16x32_bf16 v[28:31], v[80:83], v[108:111], v[28:31]
    ds_read_b128 v[136:139], v4 offset:2048
    v_mfma_f32_16x16x32_bf16 v[32:35], v[84:87], v[96:99], v[32:35]
    ds_read_b128 v[140:143], v4 offset:10240
    v_mfma_f32_16x16x32_bf16 v[36:39], v[84:87], v[100:103], v[36:39]
    ds_read_b128 v[116:119], v2 offset:2048
    v_mfma_f32_16x16x32_bf16 v[40:43], v[84:87], v[104:107], v[40:43]
    ds_read_b128 v[120:123], v2 offset:4096
    v_mfma_f32_16x16x32_bf16 v[44:47], v[84:87], v[108:111], v[44:47]
    ds_read_b128 v[124:127], v2 offset:6144
    v_lshlrev_b32 v218, 3, v222
    v_mfma_f32_16x16x32_bf16 v[48:51], v[88:91], v[96:99], v[48:51]
    v_add_u32 v3, 45056, v3
    v_add_u32 v217, v217, v218
    v_mfma_f32_16x16x32_bf16 v[52:55], v[88:91], v[100:103], v[52:55]
    v_add_u32 v5, 45056, v5
    v_add_u32 v217, 45056, v217
    v_mfma_f32_16x16x32_bf16 v[56:59], v[88:91], v[104:107], v[56:59]
    s_lshl_b32 s87, s90, 2
    s_add_u32 s88, s87, 0
    v_mfma_f32_16x16x32_bf16 v[60:63], v[88:91], v[108:111], v[60:63]
    v_xor_b32 v218, s88, v216
    v_lshlrev_b32 v218, 5, v218
    v_mfma_f32_16x16x32_bf16 v[64:67], v[92:95], v[96:99], v[64:67]
    v_add_u32 v9, v217, v218
    s_add_u32 s88, s87, 1
    v_mfma_f32_16x16x32_bf16 v[68:71], v[92:95], v[100:103], v[68:71]
    v_xor_b32 v218, s88, v216
    v_lshlrev_b32 v218, 5, v218
    v_mfma_f32_16x16x32_bf16 v[72:75], v[92:95], v[104:107], v[72:75]
    v_add_u32 v10, v217, v218
    s_add_u32 s88, s87, 2
    v_mfma_f32_16x16x32_bf16 v[76:79], v[92:95], v[108:111], v[76:79]
    v_xor_b32 v218, s88, v216
    v_lshlrev_b32 v218, 5, v218
    s_waitcnt lgkmcnt(0)
    v_mfma_f32_16x16x32_bf16 v[16:19], v[112:115], v[128:131], v[16:19]
    ds_read_b128 v[80:83], v3 offset:0
    v_mfma_f32_16x16x32_bf16 v[20:23], v[112:115], v[132:135], v[20:23]
    ds_read_b128 v[96:99], v5 offset:0
    v_mfma_f32_16x16x32_bf16 v[24:27], v[112:115], v[136:139], v[24:27]
    ds_read_b128 v[100:103], v5 offset:8192
    v_mfma_f32_16x16x32_bf16 v[28:31], v[112:115], v[140:143], v[28:31]
    ds_read_b128 v[104:107], v5 offset:2048
    v_mfma_f32_16x16x32_bf16 v[32:35], v[116:119], v[128:131], v[32:35]
    ds_read_b128 v[108:111], v5 offset:10240
    v_mfma_f32_16x16x32_bf16 v[36:39], v[116:119], v[132:135], v[36:39]
    ds_read_b128 v[84:87], v3 offset:2048
    v_mfma_f32_16x16x32_bf16 v[40:43], v[116:119], v[136:139], v[40:43]
    ds_read_b128 v[88:91], v3 offset:4096
    v_mfma_f32_16x16x32_bf16 v[44:47], v[116:119], v[140:143], v[44:47]
    ds_read_b128 v[92:95], v3 offset:6144
    v_mfma_f32_16x16x32_bf16 v[48:51], v[120:123], v[128:131], v[48:51]
    v_add_u32 v2, 4294877184, v2
    v_mfma_f32_16x16x32_bf16 v[52:55], v[120:123], v[132:135], v[52:55]
    v_add_u32 v4, 4294877184, v4
    v_mfma_f32_16x16x32_bf16 v[56:59], v[120:123], v[136:139], v[56:59]
    v_add_u32 v11, v217, v218
    v_mfma_f32_16x16x32_bf16 v[60:63], v[120:123], v[140:143], v[60:63]
    s_add_u32 s88, s87, 3
    v_mfma_f32_16x16x32_bf16 v[64:67], v[124:127], v[128:131], v[64:67]
    v_xor_b32 v218, s88, v216
    v_mfma_f32_16x16x32_bf16 v[68:71], v[124:127], v[132:135], v[68:71]
    v_lshlrev_b32 v218, 5, v218
    v_mfma_f32_16x16x32_bf16 v[72:75], v[124:127], v[136:139], v[72:75]
    v_add_u32 v12, v217, v218
    v_mfma_f32_16x16x32_bf16 v[76:79], v[124:127], v[140:143], v[76:79]
    s_waitcnt lgkmcnt(0)
    s_barrier
    v_mfma_f32_16x16x32_bf16 v[16:19], v[80:83], v[96:99], v[16:19]
    ds_read_b128 v[112:115], v2 offset:0
    v_mfma_f32_16x16x32_bf16 v[20:23], v[80:83], v[100:103], v[20:23]
    ds_read_b128 v[128:131], v4 offset:0
    v_mfma_f32_16x16x32_bf16 v[24:27], v[80:83], v[104:107], v[24:27]
    ds_read_b128 v[132:135], v4 offset:8192
    v_mfma_f32_16x16x32_bf16 v[28:31], v[80:83], v[108:111], v[28:31]
    ds_read_b128 v[136:139], v4 offset:2048
    v_mfma_f32_16x16x32_bf16 v[32:35], v[84:87], v[96:99], v[32:35]
    ds_read_b128 v[140:143], v4 offset:10240
    v_mfma_f32_16x16x32_bf16 v[36:39], v[84:87], v[100:103], v[36:39]
    ds_read_b128 v[116:119], v2 offset:2048
    v_mfma_f32_16x16x32_bf16 v[40:43], v[84:87], v[104:107], v[40:43]
    ds_read_b128 v[120:123], v2 offset:4096
    v_mfma_f32_16x16x32_bf16 v[44:47], v[84:87], v[108:111], v[44:47]
    ds_read_b128 v[124:127], v2 offset:6144
    v_mfma_f32_16x16x32_bf16 v[48:51], v[88:91], v[96:99], v[48:51]
    v_add_u32 v3, 4294877184, v3
    v_mfma_f32_16x16x32_bf16 v[52:55], v[88:91], v[100:103], v[52:55]
    v_add_u32 v5, 4294877184, v5
    v_mfma_f32_16x16x32_bf16 v[56:59], v[88:91], v[104:107], v[56:59]
    v_mfma_f32_16x16x32_bf16 v[60:63], v[88:91], v[108:111], v[60:63]
    v_mfma_f32_16x16x32_bf16 v[64:67], v[92:95], v[96:99], v[64:67]
    v_mfma_f32_16x16x32_bf16 v[68:71], v[92:95], v[100:103], v[68:71]
    v_mfma_f32_16x16x32_bf16 v[72:75], v[92:95], v[104:107], v[72:75]
    v_mfma_f32_16x16x32_bf16 v[76:79], v[92:95], v[108:111], v[76:79]
    s_waitcnt lgkmcnt(0)
    v_mfma_f32_16x16x32_bf16 v[16:19], v[112:115], v[128:131], v[16:19]
    ds_read_b128 v[80:83], v3 offset:0
    v_mfma_f32_16x16x32_bf16 v[20:23], v[112:115], v[132:135], v[20:23]
    ds_read_b128 v[96:99], v5 offset:0
    v_mfma_f32_16x16x32_bf16 v[24:27], v[112:115], v[136:139], v[24:27]
    ds_read_b128 v[100:103], v5 offset:8192
    v_mfma_f32_16x16x32_bf16 v[28:31], v[112:115], v[140:143], v[28:31]
    ds_read_b128 v[104:107], v5 offset:2048
    v_mfma_f32_16x16x32_bf16 v[32:35], v[116:119], v[128:131], v[32:35]
    ds_read_b128 v[108:111], v5 offset:10240
    v_mfma_f32_16x16x32_bf16 v[36:39], v[116:119], v[132:135], v[36:39]
    ds_read_b128 v[84:87], v3 offset:2048
    v_mfma_f32_16x16x32_bf16 v[40:43], v[116:119], v[136:139], v[40:43]
    ds_read_b128 v[88:91], v3 offset:4096
    v_mfma_f32_16x16x32_bf16 v[44:47], v[116:119], v[140:143], v[44:47]
    ds_read_b128 v[92:95], v3 offset:6144
    v_mfma_f32_16x16x32_bf16 v[48:51], v[120:123], v[128:131], v[48:51]
    v_add_u32 v2, 122880, v2
    v_mfma_f32_16x16x32_bf16 v[52:55], v[120:123], v[132:135], v[52:55]
    v_add_u32 v4, 122880, v4
    v_mfma_f32_16x16x32_bf16 v[56:59], v[120:123], v[136:139], v[56:59]
    v_mfma_f32_16x16x32_bf16 v[60:63], v[120:123], v[140:143], v[60:63]
    v_mfma_f32_16x16x32_bf16 v[64:67], v[124:127], v[128:131], v[64:67]
    v_mfma_f32_16x16x32_bf16 v[68:71], v[124:127], v[132:135], v[68:71]
    v_mfma_f32_16x16x32_bf16 v[72:75], v[124:127], v[136:139], v[72:75]
    v_mfma_f32_16x16x32_bf16 v[76:79], v[124:127], v[140:143], v[76:79]
    s_waitcnt lgkmcnt(0)
    s_barrier
    v_mfma_f32_16x16x32_bf16 v[16:19], v[80:83], v[96:99], v[16:19]
    ds_read_b128 v[112:115], v2 offset:0
    v_mfma_f32_16x16x32_bf16 v[20:23], v[80:83], v[100:103], v[20:23]
    ds_read_b128 v[128:131], v4 offset:0
    v_mfma_f32_16x16x32_bf16 v[24:27], v[80:83], v[104:107], v[24:27]
    ds_read_b128 v[132:135], v4 offset:8192
    v_mfma_f32_16x16x32_bf16 v[28:31], v[80:83], v[108:111], v[28:31]
    ds_read_b128 v[136:139], v4 offset:2048
    v_mfma_f32_16x16x32_bf16 v[32:35], v[84:87], v[96:99], v[32:35]
    ds_read_b128 v[140:143], v4 offset:10240
    v_mfma_f32_16x16x32_bf16 v[36:39], v[84:87], v[100:103], v[36:39]
    ds_read_b128 v[116:119], v2 offset:2048
    v_mfma_f32_16x16x32_bf16 v[40:43], v[84:87], v[104:107], v[40:43]
    ds_read_b128 v[120:123], v2 offset:4096
    v_mfma_f32_16x16x32_bf16 v[44:47], v[84:87], v[108:111], v[44:47]
    ds_read_b128 v[124:127], v2 offset:6144
    v_mfma_f32_16x16x32_bf16 v[48:51], v[88:91], v[96:99], v[48:51]
    v_add_u32 v3, 122880, v3
    v_mfma_f32_16x16x32_bf16 v[52:55], v[88:91], v[100:103], v[52:55]
    v_add_u32 v5, 122880, v5
    v_mfma_f32_16x16x32_bf16 v[56:59], v[88:91], v[104:107], v[56:59]
    v_mfma_f32_16x16x32_bf16 v[60:63], v[88:91], v[108:111], v[60:63]
    v_mfma_f32_16x16x32_bf16 v[64:67], v[92:95], v[96:99], v[64:67]
    v_mfma_f32_16x16x32_bf16 v[68:71], v[92:95], v[100:103], v[68:71]
    v_mfma_f32_16x16x32_bf16 v[72:75], v[92:95], v[104:107], v[72:75]
    v_mfma_f32_16x16x32_bf16 v[76:79], v[92:95], v[108:111], v[76:79]
    s_waitcnt lgkmcnt(0)
    v_mfma_f32_16x16x32_bf16 v[16:19], v[112:115], v[128:131], v[16:19]
    ds_read_b128 v[80:83], v3 offset:0
    v_mfma_f32_16x16x32_bf16 v[20:23], v[112:115], v[132:135], v[20:23]
    ds_read_b128 v[96:99], v5 offset:0
    v_mfma_f32_16x16x32_bf16 v[24:27], v[112:115], v[136:139], v[24:27]
    ds_read_b128 v[100:103], v5 offset:8192
    v_mfma_f32_16x16x32_bf16 v[28:31], v[112:115], v[140:143], v[28:31]
    ds_read_b128 v[104:107], v5 offset:2048
    v_mfma_f32_16x16x32_bf16 v[32:35], v[116:119], v[128:131], v[32:35]
    ds_read_b128 v[108:111], v5 offset:10240
    v_mfma_f32_16x16x32_bf16 v[36:39], v[116:119], v[132:135], v[36:39]
    ds_read_b128 v[84:87], v3 offset:2048
    v_mfma_f32_16x16x32_bf16 v[40:43], v[116:119], v[136:139], v[40:43]
    ds_read_b128 v[88:91], v3 offset:4096
    v_mfma_f32_16x16x32_bf16 v[44:47], v[116:119], v[140:143], v[44:47]
    ds_read_b128 v[92:95], v3 offset:6144
    v_mfma_f32_16x16x32_bf16 v[48:51], v[120:123], v[128:131], v[48:51]
    v_mfma_f32_16x16x32_bf16 v[52:55], v[120:123], v[132:135], v[52:55]
    v_mfma_f32_16x16x32_bf16 v[56:59], v[120:123], v[136:139], v[56:59]
    v_mfma_f32_16x16x32_bf16 v[60:63], v[120:123], v[140:143], v[60:63]
    v_mfma_f32_16x16x32_bf16 v[64:67], v[124:127], v[128:131], v[64:67]
    v_mfma_f32_16x16x32_bf16 v[68:71], v[124:127], v[132:135], v[68:71]
    v_mfma_f32_16x16x32_bf16 v[72:75], v[124:127], v[136:139], v[72:75]
    v_mfma_f32_16x16x32_bf16 v[76:79], v[124:127], v[140:143], v[76:79]
    s_waitcnt lgkmcnt(0)
    v_mfma_f32_16x16x32_bf16 v[16:19], v[80:83], v[96:99], v[16:19]
    v_mfma_f32_16x16x32_bf16 v[20:23], v[80:83], v[100:103], v[20:23]
    v_mfma_f32_16x16x32_bf16 v[24:27], v[80:83], v[104:107], v[24:27]
    v_mfma_f32_16x16x32_bf16 v[28:31], v[80:83], v[108:111], v[28:31]
    v_mfma_f32_16x16x32_bf16 v[32:35], v[84:87], v[96:99], v[32:35]
    v_mfma_f32_16x16x32_bf16 v[36:39], v[84:87], v[100:103], v[36:39]
    v_mfma_f32_16x16x32_bf16 v[40:43], v[84:87], v[104:107], v[40:43]
    v_mfma_f32_16x16x32_bf16 v[44:47], v[84:87], v[108:111], v[44:47]
    v_mfma_f32_16x16x32_bf16 v[48:51], v[88:91], v[96:99], v[48:51]
    v_mfma_f32_16x16x32_bf16 v[52:55], v[88:91], v[100:103], v[52:55]
    v_mfma_f32_16x16x32_bf16 v[56:59], v[88:91], v[104:107], v[56:59]
    v_mfma_f32_16x16x32_bf16 v[60:63], v[88:91], v[108:111], v[60:63]
    v_mfma_f32_16x16x32_bf16 v[64:67], v[92:95], v[96:99], v[64:67]
    v_mfma_f32_16x16x32_bf16 v[68:71], v[92:95], v[100:103], v[68:71]
    v_mfma_f32_16x16x32_bf16 v[72:75], v[92:95], v[104:107], v[72:75]
    v_mfma_f32_16x16x32_bf16 v[76:79], v[92:95], v[108:111], v[76:79]
    v_mov_b32 v4, 0
    buffer_load_dword v7, v4, s[32:35], 0 offen sc1
    v_lshrrev_b32 v2, 4, v0
    v_and_b32 v3, 15, v0
    s_lshl_b32 s85, s90, 8
    v_lshlrev_b32 v242, 3, v3
    v_add_u32 v242, s85, v242
    v_add_u32 v4, 155648, v242
    ds_read_b64 v[144:145], v4 offset:0
    ds_read_b64 v[148:149], v4 offset:512
    ds_read_b64 v[152:153], v4 offset:1024
    ds_read_b64 v[156:157], v4 offset:1536
    ds_read_b64 v[160:161], v4 offset:2048
    ds_read_b64 v[146:147], v4 offset:128
    ds_read_b64 v[150:151], v4 offset:640
    ds_read_b64 v[154:155], v4 offset:1152
    ds_read_b64 v[158:159], v4 offset:1664
    ds_read_b64 v[162:163], v4 offset:2176
    s_lshl_b32 s85, s89, 11
    v_lshlrev_b32 v6, 9, v2
    v_add_u32 v243, s85, v6
    v_add_u32 v243, v243, v242
    v_add_u32 v5, 158208, v243
    v_cmp_eq_u32 vcc, 0, v2
    v_add_u32 v6, 6144, v6
    v_mov_b32 v14, 2560
    v_cndmask_b32 v6, v6, v14, vcc
    v_add_u32 v6, v6, v4
    ds_read_b64 v[164:165], v5 offset:0
    ds_read_b64 v[168:169], v6 offset:0
    ds_read_b64 v[166:167], v5 offset:128
    ds_read_b64 v[170:171], v6 offset:128
    s_waitcnt lgkmcnt(0)
    s_nop 4
    v_mov_b32 v172, v16
    v_mov_b32 v173, v17
    v_mov_b32 v174, v20
    v_mov_b32 v175, v21
    v_mov_b32 v176, v24
    v_mov_b32 v177, v25
    v_mov_b32 v178, v28
    v_mov_b32 v179, v29
    v_pk_fma_f32 v[180:181], v[172:173], v[144:145], v[18:19] op_sel:[0,0,0] op_sel_hi:[1,0,1]
    v_pk_fma_f32 v[182:183], v[174:175], v[144:145], v[22:23] op_sel:[0,0,0] op_sel_hi:[1,0,1]
    v_pk_fma_f32 v[184:185], v[176:177], v[146:147], v[26:27] op_sel:[0,0,0] op_sel_hi:[1,0,1]
    v_pk_fma_f32 v[186:187], v[178:179], v[146:147], v[30:31] op_sel:[0,0,0] op_sel_hi:[1,0,1]
    v_pk_fma_f32 v[180:181], v[174:175], v[144:145], v[180:181] op_sel:[0,1,0] op_sel_hi:[1,1,1] neg_lo:[0,1,0] neg_hi:[0,1,0]
    v_pk_fma_f32 v[174:175], v[172:173], v[144:145], v[182:183] op_sel:[0,1,0] op_sel_hi:[1,1,1]
    v_pk_fma_f32 v[184:185], v[178:179], v[146:147], v[184:185] op_sel:[0,1,0] op_sel_hi:[1,1,1] neg_lo:[0,1,0] neg_hi:[0,1,0]
    v_pk_fma_f32 v[178:179], v[176:177], v[146:147], v[186:187] op_sel:[0,1,0] op_sel_hi:[1,1,1]
    v_pk_fma_f32 v[172:173], v[180:181], v[144:145], v[32:33] op_sel:[0,0,0] op_sel_hi:[1,0,1]
    v_pk_fma_f32 v[182:183], v[174:175], v[144:145], v[36:37] op_sel:[0,0,0] op_sel_hi:[1,0,1]
    v_pk_fma_f32 v[176:177], v[184:185], v[146:147], v[40:41] op_sel:[0,0,0] op_sel_hi:[1,0,1]
    v_pk_fma_f32 v[186:187], v[178:179], v[146:147], v[44:45] op_sel:[0,0,0] op_sel_hi:[1,0,1]
    v_pk_fma_f32 v[172:173], v[174:175], v[144:145], v[172:173] op_sel:[0,1,0] op_sel_hi:[1,1,1] neg_lo:[0,1,0] neg_hi:[0,1,0]
    v_pk_fma_f32 v[174:175], v[180:181], v[144:145], v[182:183] op_sel:[0,1,0] op_sel_hi:[1,1,1]
    v_pk_fma_f32 v[176:177], v[178:179], v[146:147], v[176:177] op_sel:[0,1,0] op_sel_hi:[1,1,1] neg_lo:[0,1,0] neg_hi:[0,1,0]
    v_pk_fma_f32 v[178:179], v[184:185], v[146:147], v[186:187] op_sel:[0,1,0] op_sel_hi:[1,1,1]
    v_pk_fma_f32 v[180:181], v[172:173], v[144:145], v[34:35] op_sel:[0,0,0] op_sel_hi:[1,0,1]
    v_pk_fma_f32 v[182:183], v[174:175], v[144:145], v[38:39] op_sel:[0,0,0] op_sel_hi:[1,0,1]
    v_pk_fma_f32 v[184:185], v[176:177], v[146:147], v[42:43] op_sel:[0,0,0] op_sel_hi:[1,0,1]
    v_pk_fma_f32 v[186:187], v[178:179], v[146:147], v[46:47] op_sel:[0,0,0] op_sel_hi:[1,0,1]
    v_pk_fma_f32 v[180:181], v[174:175], v[144:145], v[180:181] op_sel:[0,1,0] op_sel_hi:[1,1,1] neg_lo:[0,1,0] neg_hi:[0,1,0]
    v_pk_fma_f32 v[174:175], v[172:173], v[144:145], v[182:183] op_sel:[0,1,0] op_sel_hi:[1,1,1]
    v_pk_fma_f32 v[184:185], v[178:179], v[146:147], v[184:185] op_sel:[0,1,0] op_sel_hi:[1,1,1] neg_lo:[0,1,0] neg_hi:[0,1,0]
    v_pk_fma_f32 v[178:179], v[176:177], v[146:147], v[186:187] op_sel:[0,1,0] op_sel_hi:[1,1,1]
    v_pk_fma_f32 v[172:173], v[180:181], v[144:145], v[48:49] op_sel:[0,0,0] op_sel_hi:[1,0,1]
    v_pk_fma_f32 v[182:183], v[174:175], v[144:145], v[52:53] op_sel:[0,0,0] op_sel_hi:[1,0,1]
    v_pk_fma_f32 v[176:177], v[184:185], v[146:147], v[56:57] op_sel:[0,0,0] op_sel_hi:[1,0,1]
    v_pk_fma_f32 v[186:187], v[178:179], v[146:147], v[60:61] op_sel:[0,0,0] op_sel_hi:[1,0,1]
    v_pk_fma_f32 v[172:173], v[174:175], v[144:145], v[172:173] op_sel:[0,1,0] op_sel_hi:[1,1,1] neg_lo:[0,1,0] neg_hi:[0,1,0]
    v_pk_fma_f32 v[174:175], v[180:181], v[144:145], v[182:183] op_sel:[0,1,0] op_sel_hi:[1,1,1]
    v_pk_fma_f32 v[176:177], v[178:179], v[146:147], v[176:177] op_sel:[0,1,0] op_sel_hi:[1,1,1] neg_lo:[0,1,0] neg_hi:[0,1,0]
    v_pk_fma_f32 v[178:179], v[184:185], v[146:147], v[186:187] op_sel:[0,1,0] op_sel_hi:[1,1,1]
    v_pk_fma_f32 v[180:181], v[172:173], v[144:145], v[50:51] op_sel:[0,0,0] op_sel_hi:[1,0,1]
    v_pk_fma_f32 v[182:183], v[174:175], v[144:145], v[54:55] op_sel:[0,0,0] op_sel_hi:[1,0,1]
    v_pk_fma_f32 v[184:185], v[176:177], v[146:147], v[58:59] op_sel:[0,0,0] op_sel_hi:[1,0,1]
    v_pk_fma_f32 v[186:187], v[178:179], v[146:147], v[62:63] op_sel:[0,0,0] op_sel_hi:[1,0,1]
    v_pk_fma_f32 v[180:181], v[174:175], v[144:145], v[180:181] op_sel:[0,1,0] op_sel_hi:[1,1,1] neg_lo:[0,1,0] neg_hi:[0,1,0]
    v_pk_fma_f32 v[174:175], v[172:173], v[144:145], v[182:183] op_sel:[0,1,0] op_sel_hi:[1,1,1]
    v_pk_fma_f32 v[184:185], v[178:179], v[146:147], v[184:185] op_sel:[0,1,0] op_sel_hi:[1,1,1] neg_lo:[0,1,0] neg_hi:[0,1,0]
    v_pk_fma_f32 v[178:179], v[176:177], v[146:147], v[186:187] op_sel:[0,1,0] op_sel_hi:[1,1,1]
    v_pk_fma_f32 v[172:173], v[180:181], v[144:145], v[64:65] op_sel:[0,0,0] op_sel_hi:[1,0,1]
    v_pk_fma_f32 v[182:183], v[174:175], v[144:145], v[68:69] op_sel:[0,0,0] op_sel_hi:[1,0,1]
    v_pk_fma_f32 v[176:177], v[184:185], v[146:147], v[72:73] op_sel:[0,0,0] op_sel_hi:[1,0,1]
    v_pk_fma_f32 v[186:187], v[178:179], v[146:147], v[76:77] op_sel:[0,0,0] op_sel_hi:[1,0,1]
    v_pk_fma_f32 v[172:173], v[174:175], v[144:145], v[172:173] op_sel:[0,1,0] op_sel_hi:[1,1,1] neg_lo:[0,1,0] neg_hi:[0,1,0]
    v_pk_fma_f32 v[174:175], v[180:181], v[144:145], v[182:183] op_sel:[0,1,0] op_sel_hi:[1,1,1]
    v_pk_fma_f32 v[176:177], v[178:179], v[146:147], v[176:177] op_sel:[0,1,0] op_sel_hi:[1,1,1] neg_lo:[0,1,0] neg_hi:[0,1,0]
    v_pk_fma_f32 v[178:179], v[184:185], v[146:147], v[186:187] op_sel:[0,1,0] op_sel_hi:[1,1,1]
    v_pk_fma_f32 v[180:181], v[172:173], v[144:145], v[66:67] op_sel:[0,0,0] op_sel_hi:[1,0,1]
    v_pk_fma_f32 v[182:183], v[174:175], v[144:145], v[70:71] op_sel:[0,0,0] op_sel_hi:[1,0,1]
    v_pk_fma_f32 v[184:185], v[176:177], v[146:147], v[74:75] op_sel:[0,0,0] op_sel_hi:[1,0,1]
    v_pk_fma_f32 v[186:187], v[178:179], v[146:147], v[78:79] op_sel:[0,0,0] op_sel_hi:[1,0,1]
    v_pk_fma_f32 v[180:181], v[174:175], v[144:145], v[180:181] op_sel:[0,1,0] op_sel_hi:[1,1,1] neg_lo:[0,1,0] neg_hi:[0,1,0]
    v_pk_fma_f32 v[174:175], v[172:173], v[144:145], v[182:183] op_sel:[0,1,0] op_sel_hi:[1,1,1]
    v_pk_fma_f32 v[184:185], v[178:179], v[146:147], v[184:185] op_sel:[0,1,0] op_sel_hi:[1,1,1] neg_lo:[0,1,0] neg_hi:[0,1,0]
    v_pk_fma_f32 v[178:179], v[176:177], v[146:147], v[186:187] op_sel:[0,1,0] op_sel_hi:[1,1,1]
    v_mov_b32 v192, v180
    v_mov_b32 v193, v174
    v_mov_b32 v204, v181
    v_mov_b32 v205, v175
    v_mov_b32 v194, v184
    v_mov_b32 v195, v178
    v_mov_b32 v206, v185
    v_mov_b32 v207, v179
    v_pk_fma_f32 v[188:189], v[192:193], v[148:149], v[204:205] op_sel:[0,0,0] op_sel_hi:[1,0,1]
    v_pk_fma_f32 v[188:189], v[192:193], v[148:149], v[188:189] op_sel:[1,1,0] op_sel_hi:[0,1,1] neg_lo:[0,1,0]
    v_pk_fma_f32 v[190:191], v[194:195], v[150:151], v[206:207] op_sel:[0,0,0] op_sel_hi:[1,0,1]
    v_pk_fma_f32 v[190:191], v[194:195], v[150:151], v[190:191] op_sel:[1,1,0] op_sel_hi:[0,1,1] neg_lo:[0,1,0]
    v_add_u32 v4, 32768, v243
    ds_write_b64 v4, v[188:189] offset:0
    ds_write_b64 v4, v[190:191] offset:128
    s_waitcnt lgkmcnt(0)
    s_barrier
    v_add_u32 v4, 32768, v242
    ds_read_b64 v[208:209], v4 offset:0
    ds_read_b64 v[210:211], v4 offset:128
    ds_read_b64 v[212:213], v4 offset:512
    ds_read_b64 v[214:215], v4 offset:640
    ds_read_b64 v[216:217], v4 offset:1024
    ds_read_b64 v[218:219], v4 offset:1152
    ds_read_b64 v[220:221], v4 offset:1536
    ds_read_b64 v[222:223], v4 offset:1664
    ds_read_b64 v[224:225], v4 offset:2048
    ds_read_b64 v[226:227], v4 offset:2176
    ds_read_b64 v[228:229], v4 offset:2560
    ds_read_b64 v[230:231], v4 offset:2688
    ds_read_b64 v[232:233], v4 offset:3072
    ds_read_b64 v[234:235], v4 offset:3200
    v_mov_b32 v196, 0
    v_mov_b32 v197, 0
    v_mov_b32 v198, 0
    v_mov_b32 v199, 0
    s_waitcnt vmcnt(0)
    v_readfirstlane_b32 s99, v7
    s_mov_b32 s6, 262144
L_gated_mix__ssm_conv_s5__dense_activation_squared_relu__prompt_kernel_np:
    s_cmp_lg_u32 s99, 0
    s_cbranch_scc1 L_gated_mix__ssm_conv_s5__dense_activation_squared_relu__prompt_kernel_nok
    s_sub_u32 s6, s6, 1
    s_cbranch_scc1 L_gated_mix__ssm_conv_s5__dense_activation_squared_relu__prompt_kernel_nok
    s_sleep 2
    v_mov_b32 v5, 0
    buffer_load_dword v7, v5, s[32:35], 0 offen sc1
    s_waitcnt vmcnt(0)
    v_readfirstlane_b32 s99, v7
    s_branch L_gated_mix__ssm_conv_s5__dense_activation_squared_relu__prompt_kernel_np
L_gated_mix__ssm_conv_s5__dense_activation_squared_relu__prompt_kernel_nok:
    s_waitcnt lgkmcnt(0)
    s_lshl_b32 s93, s84, 14
    s_add_u32 s93, s93, 34668544
    v_lshlrev_b32 v244, 1, v242
    s_cmp_eq_u32 s89, 1
    s_cbranch_scc1 L_gated_mix__ssm_conv_s5__dense_activation_squared_relu__prompt_kernel_pf1
    s_mov_b32 exec_lo, 4294901760
    s_mov_b32 exec_hi, 4294967295
    v_pk_fma_f32 v[204:205], v[196:197], v[152:153], v[208:209] op_sel:[0,0,0] op_sel_hi:[1,0,1]
    v_pk_fma_f32 v[204:205], v[196:197], v[152:153], v[204:205] op_sel:[1,1,0] op_sel_hi:[0,1,1] neg_lo:[0,1,0]
    v_pk_fma_f32 v[206:207], v[198:199], v[154:155], v[210:211] op_sel:[0,0,0] op_sel_hi:[1,0,1]
    v_pk_fma_f32 v[206:207], v[198:199], v[154:155], v[206:207] op_sel:[1,1,0] op_sel_hi:[0,1,1] neg_lo:[0,1,0]
    v_mov_b32 v196, v204
    v_mov_b32 v197, v205
    v_mov_b32 v198, v206
    v_mov_b32 v199, v207
    s_mov_b32 exec_lo, 0
    s_mov_b32 exec_hi, 4294967295
    v_pk_fma_f32 v[204:205], v[196:197], v[152:153], v[212:213] op_sel:[0,0,0] op_sel_hi:[1,0,1]
    v_pk_fma_f32 v[204:205], v[196:197], v[152:153], v[204:205] op_sel:[1,1,0] op_sel_hi:[0,1,1] neg_lo:[0,1,0]
    v_pk_fma_f32 v[206:207], v[198:199], v[154:155], v[214:215] op_sel:[0,0,0] op_sel_hi:[1,0,1]
    v_pk_fma_f32 v[206:207], v[198:199], v[154:155], v[206:207] op_sel:[1,1,0] op_sel_hi:[0,1,1] neg_lo:[0,1,0]
    v_mov_b32 v196, v204
    v_mov_b32 v197, v205
    v_mov_b32 v198, v206
    v_mov_b32 v199, v207
    s_mov_b32 exec_lo, 0
    s_mov_b32 exec_hi, 4294901760
    v_pk_fma_f32 v[204:205], v[196:197], v[152:153], v[216:217] op_sel:[0,0,0] op_sel_hi:[1,0,1]
    v_pk_fma_f32 v[204:205], v[196:197], v[152:153], v[204:205] op_sel:[1,1,0] op_sel_hi:[0,1,1] neg_lo:[0,1,0]
    v_pk_fma_f32 v[206:207], v[198:199], v[154:155], v[218:219] op_sel:[0,0,0] op_sel_hi:[1,0,1]
    v_pk_fma_f32 v[206:207], v[198:199], v[154:155], v[206:207] op_sel:[1,1,0] op_sel_hi:[0,1,1] neg_lo:[0,1,0]
    v_mov_b32 v196, v204
    v_mov_b32 v197, v205
    v_mov_b32 v198, v206
    v_mov_b32 v199, v207
    s_mov_b64 exec, -1
    s_branch L_gated_mix__ssm_conv_s5__dense_activation_squared_relu__prompt_kernel_pfd
L_gated_mix__ssm_conv_s5__dense_activation_squared_relu__prompt_kernel_pf1:
    s_mov_b32 exec_lo, 4294967295
    s_mov_b32 exec_hi, 4294967295
    v_pk_fma_f32 v[204:205], v[196:197], v[152:153], v[208:209] op_sel:[0,0,0] op_sel_hi:[1,0,1]
    v_pk_fma_f32 v[204:205], v[196:197], v[152:153], v[204:205] op_sel:[1,1,0] op_sel_hi:[0,1,1] neg_lo:[0,1,0]
    v_pk_fma_f32 v[206:207], v[198:199], v[154:155], v[210:211] op_sel:[0,0,0] op_sel_hi:[1,0,1]
    v_pk_fma_f32 v[206:207], v[198:199], v[154:155], v[206:207] op_sel:[1,1,0] op_sel_hi:[0,1,1] neg_lo:[0,1,0]
    v_mov_b32 v196, v204
    v_mov_b32 v197, v205
    v_mov_b32 v198, v206
    v_mov_b32 v199, v207
    s_mov_b32 exec_lo, 4294967295
    s_mov_b32 exec_hi, 4294967295
    v_pk_fma_f32 v[204:205], v[196:197], v[152:153], v[212:213] op_sel:[0,0,0] op_sel_hi:[1,0,1]
    v_pk_fma_f32 v[204:205], v[196:197], v[152:153], v[204:205] op_sel:[1,1,0] op_sel_hi:[0,1,1] neg_lo:[0,1,0]
    v_pk_fma_f32 v[206:207], v[198:199], v[154:155], v[214:215] op_sel:[0,0,0] op_sel_hi:[1,0,1]
    v_pk_fma_f32 v[206:207], v[198:199], v[154:155], v[206:207] op_sel:[1,1,0] op_sel_hi:[0,1,1] neg_lo:[0,1,0]
    v_mov_b32 v196, v204
    v_mov_b32 v197, v205
    v_mov_b32 v198, v206
    v_mov_b32 v199, v207
    s_mov_b32 exec_lo, 4294967295
    s_mov_b32 exec_hi, 4294967295
    v_pk_fma_f32 v[204:205], v[196:197], v[152:153], v[216:217] op_sel:[0,0,0] op_sel_hi:[1,0,1]
    v_pk_fma_f32 v[204:205], v[196:197], v[152:153], v[204:205] op_sel:[1,1,0] op_sel_hi:[0,1,1] neg_lo:[0,1,0]
    v_pk_fma_f32 v[206:207], v[198:199], v[154:155], v[218:219] op_sel:[0,0,0] op_sel_hi:[1,0,1]
    v_pk_fma_f32 v[206:207], v[198:199], v[154:155], v[206:207] op_sel:[1,1,0] op_sel_hi:[0,1,1] neg_lo:[0,1,0]
    v_mov_b32 v196, v204
    v_mov_b32 v197, v205
    v_mov_b32 v198, v206
    v_mov_b32 v199, v207
    s_mov_b32 exec_lo, 4294967295
    s_mov_b32 exec_hi, 4294967295
    v_pk_fma_f32 v[204:205], v[196:197], v[152:153], v[220:221] op_sel:[0,0,0] op_sel_hi:[1,0,1]
    v_pk_fma_f32 v[204:205], v[196:197], v[152:153], v[204:205] op_sel:[1,1,0] op_sel_hi:[0,1,1] neg_lo:[0,1,0]
    v_pk_fma_f32 v[206:207], v[198:199], v[154:155], v[222:223] op_sel:[0,0,0] op_sel_hi:[1,0,1]
    v_pk_fma_f32 v[206:207], v[198:199], v[154:155], v[206:207] op_sel:[1,1,0] op_sel_hi:[0,1,1] neg_lo:[0,1,0]
    v_mov_b32 v196, v204
    v_mov_b32 v197, v205
    v_mov_b32 v198, v206
    v_mov_b32 v199, v207
    s_mov_b32 exec_lo, 4294901760
    s_mov_b32 exec_hi, 4294967295
    v_pk_fma_f32 v[204:205], v[196:197], v[152:153], v[224:225] op_sel:[0,0,0] op_sel_hi:[1,0,1]
    v_pk_fma_f32 v[204:205], v[196:197], v[152:153], v[204:205] op_sel:[1,1,0] op_sel_hi:[0,1,1] neg_lo:[0,1,0]
    v_pk_fma_f32 v[206:207], v[198:199], v[154:155], v[226:227] op_sel:[0,0,0] op_sel_hi:[1,0,1]
    v_pk_fma_f32 v[206:207], v[198:199], v[154:155], v[206:207] op_sel:[1,1,0] op_sel_hi:[0,1,1] neg_lo:[0,1,0]
    v_mov_b32 v196, v204
    v_mov_b32 v197, v205
    v_mov_b32 v198, v206
    v_mov_b32 v199, v207
    s_mov_b32 exec_lo, 0
    s_mov_b32 exec_hi, 4294967295
    v_pk_fma_f32 v[204:205], v[196:197], v[152:153], v[228:229] op_sel:[0,0,0] op_sel_hi:[1,0,1]
    v_pk_fma_f32 v[204:205], v[196:197], v[152:153], v[204:205] op_sel:[1,1,0] op_sel_hi:[0,1,1] neg_lo:[0,1,0]
    v_pk_fma_f32 v[206:207], v[198:199], v[154:155], v[230:231] op_sel:[0,0,0] op_sel_hi:[1,0,1]
    v_pk_fma_f32 v[206:207], v[198:199], v[154:155], v[206:207] op_sel:[1,1,0] op_sel_hi:[0,1,1] neg_lo:[0,1,0]
    v_mov_b32 v196, v204
    v_mov_b32 v197, v205
    v_mov_b32 v198, v206
    v_mov_b32 v199, v207
    s_mov_b32 exec_lo, 0
    s_mov_b32 exec_hi, 4294901760
    v_pk_fma_f32 v[204:205], v[196:197], v[152:153], v[232:233] op_sel:[0,0,0] op_sel_hi:[1,0,1]
    v_pk_fma_f32 v[204:205], v[196:197], v[152:153], v[204:205] op_sel:[1,1,0] op_sel_hi:[0,1,1] neg_lo:[0,1,0]
    v_pk_fma_f32 v[206:207], v[198:199], v[154:155], v[234:235] op_sel:[0,0,0] op_sel_hi:[1,0,1]
    v_pk_fma_f32 v[206:207], v[198:199], v[154:155], v[206:207] op_sel:[1,1,0] op_sel_hi:[0,1,1] neg_lo:[0,1,0]
    v_mov_b32 v196, v204
    v_mov_b32 v197, v205
    v_mov_b32 v198, v206
    v_mov_b32 v199, v207
    s_mov_b64 exec, -1
    v_pk_fma_f32 v[208:209], v[196:197], v[152:153], v[188:189] op_sel:[0,0,0] op_sel_hi:[1,0,1]
    v_pk_fma_f32 v[208:209], v[196:197], v[152:153], v[208:209] op_sel:[1,1,0] op_sel_hi:[0,1,1] neg_lo:[0,1,0]
    v_mov_b32 v210, s99
    v_mov_b32 v211, s99
    v_pk_fma_f32 v[212:213], v[198:199], v[154:155], v[190:191] op_sel:[0,0,0] op_sel_hi:[1,0,1]
    v_pk_fma_f32 v[212:213], v[198:199], v[154:155], v[212:213] op_sel:[1,1,0] op_sel_hi:[0,1,1] neg_lo:[0,1,0]
    v_mov_b32 v214, s99
    v_mov_b32 v215, s99
    s_lshl_b32 s85, s80, 10
    s_add_u32 s85, s85, s93
    s_mov_b32 exec_lo, 0
    s_mov_b32 exec_hi, 0xffff0000
    buffer_store_dwordx4 v[208:211], v244, s[8:11], s85 offen offset:0 sc1
    buffer_store_dwordx4 v[212:215], v244, s[8:11], s85 offen offset:256 sc1
    s_mov_b64 exec, -1
L_gated_mix__ssm_conv_s5__dense_activation_squared_relu__prompt_kernel_pfd:
    s_nop 1
    v_mov_b32 v208, v192
    v_mov_b32 v209, v193
    v_mov_b32 v212, v196
    v_mov_b32 v213, v197
    v_mov_b32 v210, v194
    v_mov_b32 v211, v195
    v_mov_b32 v214, v198
    v_mov_b32 v215, v199
    s_barrier
    ds_read_b128 v[112:115], v8 offset:0
    ds_read_b64_tr_b16 v[128:129], v9 offset:16384
    ds_read_b64_tr_b16 v[130:131], v9 offset:20480
    ds_read_b128 v[116:119], v8 offset:1024
    ds_read_b128 v[120:123], v8 offset:2048
    ds_read_b128 v[124:127], v8 offset:3072
    ds_read_b64_tr_b16 v[132:133], v10 offset:16384
    ds_read_b64_tr_b16 v[134:135], v10 offset:20480
    ds_read_b64_tr_b16 v[136:137], v11 offset:16384
    ds_read_b64_tr_b16 v[138:139], v11 offset:20480
    ds_read_b64_tr_b16 v[140:141], v12 offset:16384
    ds_read_b64_tr_b16 v[142:143], v12 offset:20480
    s_waitcnt lgkmcnt(0)
    v_mfma_f32_16x16x32_bf16 v[144:147], v[128:131], v[112:115], 0
    ds_read_b128 v[80:83], v8 offset:8192
    v_mfma_f32_16x16x32_bf16 v[148:151], v[128:131], v[116:119], 0
    ds_read_b64_tr_b16 v[96:97], v9 offset:24576
    v_mfma_f32_16x16x32_bf16 v[152:155], v[128:131], v[120:123], 0
    ds_read_b64_tr_b16 v[98:99], v9 offset:28672
    v_mfma_f32_16x16x32_bf16 v[156:159], v[128:131], v[124:127], 0
    ds_read_b128 v[84:87], v8 offset:9216
    v_mfma_f32_16x16x32_bf16 v[160:163], v[132:135], v[112:115], 0
    ds_read_b128 v[88:91], v8 offset:10240
    v_mfma_f32_16x16x32_bf16 v[164:167], v[132:135], v[116:119], 0
    ds_read_b128 v[92:95], v8 offset:11264
    v_mfma_f32_16x16x32_bf16 v[168:171], v[132:135], v[120:123], 0
    ds_read_b64_tr_b16 v[100:101], v10 offset:24576
    v_mfma_f32_16x16x32_bf16 v[172:175], v[132:135], v[124:127], 0
    ds_read_b64_tr_b16 v[102:103], v10 offset:28672
    v_mfma_f32_16x16x32_bf16 v[176:179], v[136:139], v[112:115], 0
    ds_read_b64_tr_b16 v[104:105], v11 offset:24576
    v_mfma_f32_16x16x32_bf16 v[180:183], v[136:139], v[116:119], 0
    ds_read_b64_tr_b16 v[106:107], v11 offset:28672
    v_mfma_f32_16x16x32_bf16 v[184:187], v[136:139], v[120:123], 0
    ds_read_b64_tr_b16 v[108:109], v12 offset:24576
    v_mfma_f32_16x16x32_bf16 v[188:191], v[136:139], v[124:127], 0
    ds_read_b64_tr_b16 v[110:111], v12 offset:28672
    v_mfma_f32_16x16x32_bf16 v[192:195], v[140:143], v[112:115], 0
    v_add_u32 v8, 45056, v8
    v_add_u32 v9, 45056, v9
    v_mfma_f32_16x16x32_bf16 v[196:199], v[140:143], v[116:119], 0
    v_add_u32 v10, 45056, v10
    v_add_u32 v11, 45056, v11
    v_mfma_f32_16x16x32_bf16 v[200:203], v[140:143], v[120:123], 0
    v_add_u32 v12, 45056, v12
    v_mfma_f32_16x16x32_bf16 v[204:207], v[140:143], v[124:127], 0
    s_waitcnt lgkmcnt(0)
    s_barrier
    v_mfma_f32_16x16x32_bf16 v[144:147], v[96:99], v[80:83], v[144:147]
    ds_read_b128 v[112:115], v8 offset:0
    v_mfma_f32_16x16x32_bf16 v[148:151], v[96:99], v[84:87], v[148:151]
    ds_read_b64_tr_b16 v[128:129], v9 offset:16384
    v_mfma_f32_16x16x32_bf16 v[152:155], v[96:99], v[88:91], v[152:155]
    ds_read_b64_tr_b16 v[130:131], v9 offset:20480
    v_mfma_f32_16x16x32_bf16 v[156:159], v[96:99], v[92:95], v[156:159]
    ds_read_b128 v[116:119], v8 offset:1024
    v_mfma_f32_16x16x32_bf16 v[160:163], v[100:103], v[80:83], v[160:163]
    ds_read_b128 v[120:123], v8 offset:2048
    v_mfma_f32_16x16x32_bf16 v[164:167], v[100:103], v[84:87], v[164:167]
    ds_read_b128 v[124:127], v8 offset:3072
    v_mfma_f32_16x16x32_bf16 v[168:171], v[100:103], v[88:91], v[168:171]
    ds_read_b64_tr_b16 v[132:133], v10 offset:16384
    v_mfma_f32_16x16x32_bf16 v[172:175], v[100:103], v[92:95], v[172:175]
    ds_read_b64_tr_b16 v[134:135], v10 offset:20480
    v_mfma_f32_16x16x32_bf16 v[176:179], v[104:107], v[80:83], v[176:179]
    ds_read_b64_tr_b16 v[136:137], v11 offset:16384
    v_mfma_f32_16x16x32_bf16 v[180:183], v[104:107], v[84:87], v[180:183]
    ds_read_b64_tr_b16 v[138:139], v11 offset:20480
    v_mfma_f32_16x16x32_bf16 v[184:187], v[104:107], v[88:91], v[184:187]
    ds_read_b64_tr_b16 v[140:141], v12 offset:16384
    v_mfma_f32_16x16x32_bf16 v[188:191], v[104:107], v[92:95], v[188:191]
    ds_read_b64_tr_b16 v[142:143], v12 offset:20480
    v_mfma_f32_16x16x32_bf16 v[192:195], v[108:111], v[80:83], v[192:195]
    v_mfma_f32_16x16x32_bf16 v[196:199], v[108:111], v[84:87], v[196:199]
    v_mfma_f32_16x16x32_bf16 v[200:203], v[108:111], v[88:91], v[200:203]
    v_mfma_f32_16x16x32_bf16 v[204:207], v[108:111], v[92:95], v[204:207]
    s_waitcnt lgkmcnt(0)
    v_mfma_f32_16x16x32_bf16 v[144:147], v[128:131], v[112:115], v[144:147]
    ds_read_b128 v[80:83], v8 offset:8192
    v_mfma_f32_16x16x32_bf16 v[148:151], v[128:131], v[116:119], v[148:151]
    ds_read_b64_tr_b16 v[96:97], v9 offset:24576
    v_mfma_f32_16x16x32_bf16 v[152:155], v[128:131], v[120:123], v[152:155]
    ds_read_b64_tr_b16 v[98:99], v9 offset:28672
    v_mfma_f32_16x16x32_bf16 v[156:159], v[128:131], v[124:127], v[156:159]
    ds_read_b128 v[84:87], v8 offset:9216
    v_mfma_f32_16x16x32_bf16 v[160:163], v[132:135], v[112:115], v[160:163]
    ds_read_b128 v[88:91], v8 offset:10240
    v_mfma_f32_16x16x32_bf16 v[164:167], v[132:135], v[116:119], v[164:167]
    ds_read_b128 v[92:95], v8 offset:11264
    v_mfma_f32_16x16x32_bf16 v[168:171], v[132:135], v[120:123], v[168:171]
    ds_read_b64_tr_b16 v[100:101], v10 offset:24576
    v_mfma_f32_16x16x32_bf16 v[172:175], v[132:135], v[124:127], v[172:175]
    ds_read_b64_tr_b16 v[102:103], v10 offset:28672
    v_mfma_f32_16x16x32_bf16 v[176:179], v[136:139], v[112:115], v[176:179]
    ds_read_b64_tr_b16 v[104:105], v11 offset:24576
    v_mfma_f32_16x16x32_bf16 v[180:183], v[136:139], v[116:119], v[180:183]
    ds_read_b64_tr_b16 v[106:107], v11 offset:28672
    v_mfma_f32_16x16x32_bf16 v[184:187], v[136:139], v[120:123], v[184:187]
    ds_read_b64_tr_b16 v[108:109], v12 offset:24576
    v_mfma_f32_16x16x32_bf16 v[188:191], v[136:139], v[124:127], v[188:191]
    ds_read_b64_tr_b16 v[110:111], v12 offset:28672
    v_mfma_f32_16x16x32_bf16 v[192:195], v[140:143], v[112:115], v[192:195]
    v_add_u32 v8, 4294877184, v8
    v_add_u32 v9, 4294877184, v9
    v_mfma_f32_16x16x32_bf16 v[196:199], v[140:143], v[116:119], v[196:199]
    v_add_u32 v10, 4294877184, v10
    v_add_u32 v11, 4294877184, v11
    v_mfma_f32_16x16x32_bf16 v[200:203], v[140:143], v[120:123], v[200:203]
    v_add_u32 v12, 4294877184, v12
    v_mfma_f32_16x16x32_bf16 v[204:207], v[140:143], v[124:127], v[204:207]
    s_waitcnt lgkmcnt(0)
    s_barrier
    v_mfma_f32_16x16x32_bf16 v[144:147], v[96:99], v[80:83], v[144:147]
    ds_read_b128 v[112:115], v8 offset:0
    v_mfma_f32_16x16x32_bf16 v[148:151], v[96:99], v[84:87], v[148:151]
    ds_read_b64_tr_b16 v[128:129], v9 offset:16384
    v_mfma_f32_16x16x32_bf16 v[152:155], v[96:99], v[88:91], v[152:155]
    ds_read_b64_tr_b16 v[130:131], v9 offset:20480
    v_mfma_f32_16x16x32_bf16 v[156:159], v[96:99], v[92:95], v[156:159]
    ds_read_b128 v[116:119], v8 offset:1024
    v_mfma_f32_16x16x32_bf16 v[160:163], v[100:103], v[80:83], v[160:163]
    ds_read_b128 v[120:123], v8 offset:2048
    v_mfma_f32_16x16x32_bf16 v[164:167], v[100:103], v[84:87], v[164:167]
    ds_read_b128 v[124:127], v8 offset:3072
    v_mfma_f32_16x16x32_bf16 v[168:171], v[100:103], v[88:91], v[168:171]
    ds_read_b64_tr_b16 v[132:133], v10 offset:16384
    v_mfma_f32_16x16x32_bf16 v[172:175], v[100:103], v[92:95], v[172:175]
    ds_read_b64_tr_b16 v[134:135], v10 offset:20480
    v_mfma_f32_16x16x32_bf16 v[176:179], v[104:107], v[80:83], v[176:179]
    ds_read_b64_tr_b16 v[136:137], v11 offset:16384
    v_mfma_f32_16x16x32_bf16 v[180:183], v[104:107], v[84:87], v[180:183]
    ds_read_b64_tr_b16 v[138:139], v11 offset:20480
    v_mfma_f32_16x16x32_bf16 v[184:187], v[104:107], v[88:91], v[184:187]
    ds_read_b64_tr_b16 v[140:141], v12 offset:16384
    v_mfma_f32_16x16x32_bf16 v[188:191], v[104:107], v[92:95], v[188:191]
    ds_read_b64_tr_b16 v[142:143], v12 offset:20480
    v_mfma_f32_16x16x32_bf16 v[192:195], v[108:111], v[80:83], v[192:195]
    v_mfma_f32_16x16x32_bf16 v[196:199], v[108:111], v[84:87], v[196:199]
    v_mfma_f32_16x16x32_bf16 v[200:203], v[108:111], v[88:91], v[200:203]
    v_mfma_f32_16x16x32_bf16 v[204:207], v[108:111], v[92:95], v[204:207]
    s_waitcnt lgkmcnt(0)
    v_mfma_f32_16x16x32_bf16 v[144:147], v[128:131], v[112:115], v[144:147]
    ds_read_b128 v[80:83], v8 offset:8192
    v_lshrrev_b32 v2, 4, v0
    v_mfma_f32_16x16x32_bf16 v[148:151], v[128:131], v[116:119], v[148:151]
    ds_read_b64_tr_b16 v[96:97], v9 offset:24576
    v_lshlrev_b32 v2, 2, v2
    v_mfma_f32_16x16x32_bf16 v[152:155], v[128:131], v[120:123], v[152:155]
    ds_read_b64_tr_b16 v[98:99], v9 offset:28672
    v_sub_u32 v2, s80, v2
    v_mfma_f32_16x16x32_bf16 v[156:159], v[128:131], v[124:127], v[156:159]
    ds_read_b128 v[84:87], v8 offset:9216
    v_and_b32 v3, 15, v0
    v_mfma_f32_16x16x32_bf16 v[160:163], v[132:135], v[112:115], v[160:163]
    ds_read_b128 v[88:91], v8 offset:10240
    v_lshlrev_b32 v3, 4, v3
    v_mfma_f32_16x16x32_bf16 v[164:167], v[132:135], v[116:119], v[164:167]
    ds_read_b128 v[92:95], v8 offset:11264
    s_lshl_b32 s85, s90, 9
    v_mfma_f32_16x16x32_bf16 v[168:171], v[132:135], v[120:123], v[168:171]
    ds_read_b64_tr_b16 v[100:101], v10 offset:24576
    v_add_u32 v3, s85, v3
    v_mfma_f32_16x16x32_bf16 v[172:175], v[132:135], v[124:127], v[172:175]
    ds_read_b64_tr_b16 v[102:103], v10 offset:28672
    v_mov_b32 v14, 0x7ff00000
    v_mfma_f32_16x16x32_bf16 v[176:179], v[136:139], v[112:115], v[176:179]
    ds_read_b64_tr_b16 v[104:105], v11 offset:24576
    v_mov_b32 v15, s99
    v_mfma_f32_16x16x32_bf16 v[180:183], v[136:139], v[116:119], v[180:183]
    ds_read_b64_tr_b16 v[106:107], v11 offset:28672
    v_mov_b32 v6, 0
    v_mfma_f32_16x16x32_bf16 v[184:187], v[136:139], v[120:123], v[184:187]
    ds_read_b64_tr_b16 v[108:109], v12 offset:24576
    v_subrev_u32 v4, 1, v2
    v_mfma_f32_16x16x32_bf16 v[188:191], v[136:139], v[124:127], v[188:191]
    ds_read_b64_tr_b16 v[110:111], v12 offset:28672
    v_cmp_gt_i32 vcc, 0, v4
    v_mfma_f32_16x16x32_bf16 v[192:195], v[140:143], v[112:115], v[192:195]
    v_add_u32 v8, 122880, v8
    v_add_u32 v9, 122880, v9
    v_lshlrev_b32 v5, 10, v4
    v_mfma_f32_16x16x32_bf16 v[196:199], v[140:143], v[116:119], v[196:199]
    v_add_u32 v10, 122880, v10
    v_add_u32 v11, 122880, v11
    v_add_u32 v5, v5, v3
    v_mfma_f32_16x16x32_bf16 v[200:203], v[140:143], v[120:123], v[200:203]
    v_add_u32 v12, 122880, v12
    v_cndmask_b32 v248, v5, v14, vcc
    v_mfma_f32_16x16x32_bf16 v[204:207], v[140:143], v[124:127], v[204:207]
    v_cndmask_b32 v252, v15, v6, vcc
    v_subrev_u32 v4, 2, v2
    s_waitcnt lgkmcnt(0)
    s_barrier
    v_mfma_f32_16x16x32_bf16 v[144:147], v[96:99], v[80:83], v[144:147]
    ds_read_b128 v[112:115], v8 offset:0
    v_cmp_gt_i32 vcc, 0, v4
    v_mfma_f32_16x16x32_bf16 v[148:151], v[96:99], v[84:87], v[148:151]
    ds_read_b64_tr_b16 v[128:129], v9 offset:16384
    v_lshlrev_b32 v5, 10, v4
    v_mfma_f32_16x16x32_bf16 v[152:155], v[96:99], v[88:91], v[152:155]
    ds_read_b64_tr_b16 v[130:131], v9 offset:20480
    v_add_u32 v5, v5, v3
    v_mfma_f32_16x16x32_bf16 v[156:159], v[96:99], v[92:95], v[156:159]
    ds_read_b128 v[116:119], v8 offset:1024
    v_cndmask_b32 v249, v5, v14, vcc
    v_mfma_f32_16x16x32_bf16 v[160:163], v[100:103], v[80:83], v[160:163]
    ds_read_b128 v[120:123], v8 offset:2048
    v_cndmask_b32 v253, v15, v6, vcc
    v_mfma_f32_16x16x32_bf16 v[164:167], v[100:103], v[84:87], v[164:167]
    ds_read_b128 v[124:127], v8 offset:3072
    v_subrev_u32 v4, 3, v2
    v_mfma_f32_16x16x32_bf16 v[168:171], v[100:103], v[88:91], v[168:171]
    ds_read_b64_tr_b16 v[132:133], v10 offset:16384
    v_cmp_gt_i32 vcc, 0, v4
    v_mfma_f32_16x16x32_bf16 v[172:175], v[100:103], v[92:95], v[172:175]
    ds_read_b64_tr_b16 v[134:135], v10 offset:20480
    v_lshlrev_b32 v5, 10, v4
    v_mfma_f32_16x16x32_bf16 v[176:179], v[104:107], v[80:83], v[176:179]
    ds_read_b64_tr_b16 v[136:137], v11 offset:16384
    v_add_u32 v5, v5, v3
    v_mfma_f32_16x16x32_bf16 v[180:183], v[104:107], v[84:87], v[180:183]
    ds_read_b64_tr_b16 v[138:139], v11 offset:20480
    v_cndmask_b32 v250, v5, v14, vcc
    v_mfma_f32_16x16x32_bf16 v[184:187], v[104:107], v[88:91], v[184:187]
    ds_read_b64_tr_b16 v[140:141], v12 offset:16384
    v_cndmask_b32 v254, v15, v6, vcc
    v_mfma_f32_16x16x32_bf16 v[188:191], v[104:107], v[92:95], v[188:191]
    ds_read_b64_tr_b16 v[142:143], v12 offset:20480
    v_subrev_u32 v4, 4, v2
    v_mfma_f32_16x16x32_bf16 v[192:195], v[108:111], v[80:83], v[192:195]
    v_cmp_gt_i32 vcc, 0, v4
    v_lshlrev_b32 v5, 10, v4
    v_mfma_f32_16x16x32_bf16 v[196:199], v[108:111], v[84:87], v[196:199]
    v_add_u32 v5, v5, v3
    v_cndmask_b32 v251, v5, v14, vcc
    v_mfma_f32_16x16x32_bf16 v[200:203], v[108:111], v[88:91], v[200:203]
    v_cndmask_b32 v255, v15, v6, vcc
    buffer_load_dwordx4 v[216:219], v248, s[8:11], s93 offen offset:0 sc1
    v_mfma_f32_16x16x32_bf16 v[204:207], v[108:111], v[92:95], v[204:207]
    buffer_load_dwordx4 v[220:223], v248, s[8:11], s93 offen offset:256 sc1
    buffer_load_dwordx4 v[224:227], v249, s[8:11], s93 offen offset:0 sc1
    s_waitcnt lgkmcnt(0)
    v_mfma_f32_16x16x32_bf16 v[144:147], v[128:131], v[112:115], v[144:147]
    ds_read_b128 v[80:83], v8 offset:8192
    v_mfma_f32_16x16x32_bf16 v[148:151], v[128:131], v[116:119], v[148:151]
    ds_read_b64_tr_b16 v[96:97], v9 offset:24576
    v_mfma_f32_16x16x32_bf16 v[152:155], v[128:131], v[120:123], v[152:155]
    ds_read_b64_tr_b16 v[98:99], v9 offset:28672
    v_mfma_f32_16x16x32_bf16 v[156:159], v[128:131], v[124:127], v[156:159]
    ds_read_b128 v[84:87], v8 offset:9216
    v_mfma_f32_16x16x32_bf16 v[160:163], v[132:135], v[112:115], v[160:163]
    ds_read_b128 v[88:91], v8 offset:10240
    v_mfma_f32_16x16x32_bf16 v[164:167], v[132:135], v[116:119], v[164:167]
    ds_read_b128 v[92:95], v8 offset:11264
    v_mfma_f32_16x16x32_bf16 v[168:171], v[132:135], v[120:123], v[168:171]
    ds_read_b64_tr_b16 v[100:101], v10 offset:24576
    v_mfma_f32_16x16x32_bf16 v[172:175], v[132:135], v[124:127], v[172:175]
    ds_read_b64_tr_b16 v[102:103], v10 offset:28672
    v_mfma_f32_16x16x32_bf16 v[176:179], v[136:139], v[112:115], v[176:179]
    ds_read_b64_tr_b16 v[104:105], v11 offset:24576
    v_mfma_f32_16x16x32_bf16 v[180:183], v[136:139], v[116:119], v[180:183]
    ds_read_b64_tr_b16 v[106:107], v11 offset:28672
    v_mfma_f32_16x16x32_bf16 v[184:187], v[136:139], v[120:123], v[184:187]
    ds_read_b64_tr_b16 v[108:109], v12 offset:24576
    v_mfma_f32_16x16x32_bf16 v[188:191], v[136:139], v[124:127], v[188:191]
    ds_read_b64_tr_b16 v[110:111], v12 offset:28672
    v_mfma_f32_16x16x32_bf16 v[192:195], v[140:143], v[112:115], v[192:195]
    v_add_u32 v8, 4294889472, v8
    v_add_u32 v9, 4294889472, v9
    buffer_load_dwordx4 v[228:231], v249, s[8:11], s93 offen offset:256 sc1
    v_mfma_f32_16x16x32_bf16 v[196:199], v[140:143], v[116:119], v[196:199]
    v_add_u32 v10, 4294889472, v10
    v_add_u32 v11, 4294889472, v11
    buffer_load_dwordx4 v[232:235], v250, s[8:11], s93 offen offset:0 sc1
    v_mfma_f32_16x16x32_bf16 v[200:203], v[140:143], v[120:123], v[200:203]
    v_add_u32 v12, 4294889472, v12
    buffer_load_dwordx4 v[236:239], v250, s[8:11], s93 offen offset:256 sc1
    v_mfma_f32_16x16x32_bf16 v[204:207], v[140:143], v[124:127], v[204:207]
    buffer_load_dwordx4 v[240:243], v251, s[8:11], s93 offen offset:0 sc1
    buffer_load_dwordx4 v[244:247], v251, s[8:11], s93 offen offset:256 sc1
    s_waitcnt lgkmcnt(0)
    s_barrier
    v_mfma_f32_16x16x32_bf16 v[144:147], v[96:99], v[80:83], v[144:147]
    ds_read_b128 v[112:115], v8 offset:0
    v_mfma_f32_16x16x32_bf16 v[148:151], v[96:99], v[84:87], v[148:151]
    ds_read_b64_tr_b16 v[128:129], v9 offset:16384
    v_mfma_f32_16x16x32_bf16 v[152:155], v[96:99], v[88:91], v[152:155]
    ds_read_b64_tr_b16 v[130:131], v9 offset:20480
    v_mfma_f32_16x16x32_bf16 v[156:159], v[96:99], v[92:95], v[156:159]
    ds_read_b128 v[116:119], v8 offset:1024
    v_mfma_f32_16x16x32_bf16 v[160:163], v[100:103], v[80:83], v[160:163]
    ds_read_b128 v[120:123], v8 offset:2048
    v_mfma_f32_16x16x32_bf16 v[164:167], v[100:103], v[84:87], v[164:167]
    ds_read_b128 v[124:127], v8 offset:3072
    v_mfma_f32_16x16x32_bf16 v[168:171], v[100:103], v[88:91], v[168:171]
    ds_read_b64_tr_b16 v[132:133], v10 offset:16384
    v_mfma_f32_16x16x32_bf16 v[172:175], v[100:103], v[92:95], v[172:175]
    ds_read_b64_tr_b16 v[134:135], v10 offset:20480
    v_mfma_f32_16x16x32_bf16 v[176:179], v[104:107], v[80:83], v[176:179]
    ds_read_b64_tr_b16 v[136:137], v11 offset:16384
    v_mfma_f32_16x16x32_bf16 v[180:183], v[104:107], v[84:87], v[180:183]
    ds_read_b64_tr_b16 v[138:139], v11 offset:20480
    v_mfma_f32_16x16x32_bf16 v[184:187], v[104:107], v[88:91], v[184:187]
    ds_read_b64_tr_b16 v[140:141], v12 offset:16384
    v_mfma_f32_16x16x32_bf16 v[188:191], v[104:107], v[92:95], v[188:191]
    ds_read_b64_tr_b16 v[142:143], v12 offset:20480
    v_mfma_f32_16x16x32_bf16 v[192:195], v[108:111], v[80:83], v[192:195]
    v_mfma_f32_16x16x32_bf16 v[196:199], v[108:111], v[84:87], v[196:199]
    v_mfma_f32_16x16x32_bf16 v[200:203], v[108:111], v[88:91], v[200:203]
    v_mfma_f32_16x16x32_bf16 v[204:207], v[108:111], v[92:95], v[204:207]
    s_waitcnt lgkmcnt(0)
    v_mfma_f32_16x16x32_bf16 v[144:147], v[128:131], v[112:115], v[144:147]
    ds_read_b128 v[80:83], v8 offset:8192
    v_mfma_f32_16x16x32_bf16 v[148:151], v[128:131], v[116:119], v[148:151]
    ds_read_b64_tr_b16 v[96:97], v9 offset:24576
    v_mfma_f32_16x16x32_bf16 v[152:155], v[128:131], v[120:123], v[152:155]
    ds_read_b64_tr_b16 v[98:99], v9 offset:28672
    v_mfma_f32_16x16x32_bf16 v[156:159], v[128:131], v[124:127], v[156:159]
    ds_read_b128 v[84:87], v8 offset:9216
    v_mfma_f32_16x16x32_bf16 v[160:163], v[132:135], v[112:115], v[160:163]
    ds_read_b128 v[88:91], v8 offset:10240
    v_mfma_f32_16x16x32_bf16 v[164:167], v[132:135], v[116:119], v[164:167]
    ds_read_b128 v[92:95], v8 offset:11264
    v_mfma_f32_16x16x32_bf16 v[168:171], v[132:135], v[120:123], v[168:171]
    ds_read_b64_tr_b16 v[100:101], v10 offset:24576
    v_mfma_f32_16x16x32_bf16 v[172:175], v[132:135], v[124:127], v[172:175]
    ds_read_b64_tr_b16 v[102:103], v10 offset:28672
    v_mfma_f32_16x16x32_bf16 v[176:179], v[136:139], v[112:115], v[176:179]
    ds_read_b64_tr_b16 v[104:105], v11 offset:24576
    v_mfma_f32_16x16x32_bf16 v[180:183], v[136:139], v[116:119], v[180:183]
    ds_read_b64_tr_b16 v[106:107], v11 offset:28672
    v_mfma_f32_16x16x32_bf16 v[184:187], v[136:139], v[120:123], v[184:187]
    ds_read_b64_tr_b16 v[108:109], v12 offset:24576
    v_mfma_f32_16x16x32_bf16 v[188:191], v[136:139], v[124:127], v[188:191]
    ds_read_b64_tr_b16 v[110:111], v12 offset:28672
    v_mfma_f32_16x16x32_bf16 v[192:195], v[140:143], v[112:115], v[192:195]
    v_add_u32 v8, 45056, v8
    v_add_u32 v9, 45056, v9
    v_mfma_f32_16x16x32_bf16 v[196:199], v[140:143], v[116:119], v[196:199]
    v_add_u32 v10, 45056, v10
    v_add_u32 v11, 45056, v11
    v_mfma_f32_16x16x32_bf16 v[200:203], v[140:143], v[120:123], v[200:203]
    v_add_u32 v12, 45056, v12
    v_mfma_f32_16x16x32_bf16 v[204:207], v[140:143], v[124:127], v[204:207]
    s_waitcnt lgkmcnt(0)
    s_barrier
    v_mfma_f32_16x16x32_bf16 v[144:147], v[96:99], v[80:83], v[144:147]
    ds_read_b128 v[112:115], v8 offset:0
    v_mfma_f32_16x16x32_bf16 v[148:151], v[96:99], v[84:87], v[148:151]
    ds_read_b64_tr_b16 v[128:129], v9 offset:16384
    v_mfma_f32_16x16x32_bf16 v[152:155], v[96:99], v[88:91], v[152:155]
    ds_read_b64_tr_b16 v[130:131], v9 offset:20480
    v_mfma_f32_16x16x32_bf16 v[156:159], v[96:99], v[92:95], v[156:159]
    ds_read_b128 v[116:119], v8 offset:1024
    v_mfma_f32_16x16x32_bf16 v[160:163], v[100:103], v[80:83], v[160:163]
    ds_read_b128 v[120:123], v8 offset:2048
    v_mfma_f32_16x16x32_bf16 v[164:167], v[100:103], v[84:87], v[164:167]
    ds_read_b128 v[124:127], v8 offset:3072
    v_mfma_f32_16x16x32_bf16 v[168:171], v[100:103], v[88:91], v[168:171]
    ds_read_b64_tr_b16 v[132:133], v10 offset:16384
    v_mfma_f32_16x16x32_bf16 v[172:175], v[100:103], v[92:95], v[172:175]
    ds_read_b64_tr_b16 v[134:135], v10 offset:20480
    v_mfma_f32_16x16x32_bf16 v[176:179], v[104:107], v[80:83], v[176:179]
    ds_read_b64_tr_b16 v[136:137], v11 offset:16384
    v_mfma_f32_16x16x32_bf16 v[180:183], v[104:107], v[84:87], v[180:183]
    ds_read_b64_tr_b16 v[138:139], v11 offset:20480
    v_mfma_f32_16x16x32_bf16 v[184:187], v[104:107], v[88:91], v[184:187]
    ds_read_b64_tr_b16 v[140:141], v12 offset:16384
    v_mfma_f32_16x16x32_bf16 v[188:191], v[104:107], v[92:95], v[188:191]
    ds_read_b64_tr_b16 v[142:143], v12 offset:20480
    v_mfma_f32_16x16x32_bf16 v[192:195], v[108:111], v[80:83], v[192:195]
    v_mfma_f32_16x16x32_bf16 v[196:199], v[108:111], v[84:87], v[196:199]
    v_mfma_f32_16x16x32_bf16 v[200:203], v[108:111], v[88:91], v[200:203]
    v_mfma_f32_16x16x32_bf16 v[204:207], v[108:111], v[92:95], v[204:207]
    s_mov_b32 s6, 262144
    s_waitcnt vmcnt(0)
L_gated_mix__ssm_conv_s5__dense_activation_squared_relu__prompt_kernel_poll:
    v_mov_b32 v2, 0
    v_xor_b32 v3, v218, v252
    v_or_b32 v2, v2, v3
    v_xor_b32 v3, v222, v252
    v_or_b32 v2, v2, v3
    v_xor_b32 v3, v226, v253
    v_or_b32 v2, v2, v3
    v_xor_b32 v3, v230, v253
    v_or_b32 v2, v2, v3
    v_xor_b32 v3, v234, v254
    v_or_b32 v2, v2, v3
    v_xor_b32 v3, v238, v254
    v_or_b32 v2, v2, v3
    v_xor_b32 v3, v242, v255
    v_or_b32 v2, v2, v3
    v_xor_b32 v3, v246, v255
    v_or_b32 v2, v2, v3
    v_cmp_ne_u32 vcc, 0, v2
    s_nop 1
    s_cmp_eq_u64 vcc, 0
    s_cbranch_scc1 L_gated_mix__ssm_conv_s5__dense_activation_squared_relu__prompt_kernel_got
    s_sub_u32 s6, s6, 1
    s_cbranch_scc1 L_gated_mix__ssm_conv_s5__dense_activation_squared_relu__prompt_kernel_got
    s_sleep 1
    buffer_load_dwordx4 v[216:219], v248, s[8:11], s93 offen offset:0 sc1
    buffer_load_dwordx4 v[220:223], v248, s[8:11], s93 offen offset:256 sc1
    buffer_load_dwordx4 v[224:227], v249, s[8:11], s93 offen offset:0 sc1
    buffer_load_dwordx4 v[228:231], v249, s[8:11], s93 offen offset:256 sc1
    buffer_load_dwordx4 v[232:235], v250, s[8:11], s93 offen offset:0 sc1
    buffer_load_dwordx4 v[236:239], v250, s[8:11], s93 offen offset:256 sc1
    buffer_load_dwordx4 v[240:243], v251, s[8:11], s93 offen offset:0 sc1
    buffer_load_dwordx4 v[244:247], v251, s[8:11], s93 offen offset:256 sc1
    s_waitcnt vmcnt(0)
    s_branch L_gated_mix__ssm_conv_s5__dense_activation_squared_relu__prompt_kernel_poll
L_gated_mix__ssm_conv_s5__dense_activation_squared_relu__prompt_kernel_got:
    s_waitcnt lgkmcnt(0)
    v_mfma_f32_16x16x32_bf16 v[144:147], v[128:131], v[112:115], v[144:147]
    ds_read_b128 v[80:83], v8 offset:8192
    v_and_b32 v238, 15, v0
    v_mfma_f32_16x16x32_bf16 v[148:151], v[128:131], v[116:119], v[148:151]
    ds_read_b64_tr_b16 v[96:97], v9 offset:24576
    v_lshlrev_b32 v238, 3, v238
    v_mfma_f32_16x16x32_bf16 v[152:155], v[128:131], v[120:123], v[152:155]
    ds_read_b64_tr_b16 v[98:99], v9 offset:28672
    s_lshl_b32 s85, s90, 8
    v_mfma_f32_16x16x32_bf16 v[156:159], v[128:131], v[124:127], v[156:159]
    ds_read_b128 v[84:87], v8 offset:9216
    v_add_u32 v238, s85, v238
    v_mfma_f32_16x16x32_bf16 v[160:163], v[132:135], v[112:115], v[160:163]
    ds_read_b128 v[88:91], v8 offset:10240
    v_add_u32 v238, 155648, v238
    v_mfma_f32_16x16x32_bf16 v[164:167], v[132:135], v[116:119], v[164:167]
    ds_read_b128 v[92:95], v8 offset:11264
    v_lshrrev_b32 v239, 4, v0
    v_mfma_f32_16x16x32_bf16 v[168:171], v[132:135], v[120:123], v[168:171]
    ds_read_b64_tr_b16 v[100:101], v10 offset:24576
    v_lshlrev_b32 v239, 9, v239
    v_mfma_f32_16x16x32_bf16 v[172:175], v[132:135], v[124:127], v[172:175]
    ds_read_b64_tr_b16 v[102:103], v10 offset:28672
    v_cmp_eq_u32 vcc, 0, v239
    v_mfma_f32_16x16x32_bf16 v[176:179], v[136:139], v[112:115], v[176:179]
    ds_read_b64_tr_b16 v[104:105], v11 offset:24576
    v_add_u32 v242, 6144, v239
    v_mfma_f32_16x16x32_bf16 v[180:183], v[136:139], v[116:119], v[180:183]
    ds_read_b64_tr_b16 v[106:107], v11 offset:28672
    v_mov_b32 v243, 2560
    v_mfma_f32_16x16x32_bf16 v[184:187], v[136:139], v[120:123], v[184:187]
    ds_read_b64_tr_b16 v[108:109], v12 offset:24576
    v_cndmask_b32 v242, v242, v243, vcc
    v_mfma_f32_16x16x32_bf16 v[188:191], v[136:139], v[124:127], v[188:191]
    ds_read_b64_tr_b16 v[110:111], v12 offset:28672
    v_add_u32 v242, v242, v238
    v_mfma_f32_16x16x32_bf16 v[192:195], v[140:143], v[112:115], v[192:195]
    v_add_u32 v8, 4294877184, v8
    v_add_u32 v9, 4294877184, v9
    s_lshl_b32 s85, s89, 11
    v_mfma_f32_16x16x32_bf16 v[196:199], v[140:143], v[116:119], v[196:199]
    v_add_u32 v10, 4294877184, v10
    v_add_u32 v11, 4294877184, v11
    s_add_u32 s85, s85, 2560
    v_mfma_f32_16x16x32_bf16 v[200:203], v[140:143], v[120:123], v[200:203]
    v_add_u32 v12, 4294877184, v12
    v_add_u32 v239, s85, v239
    v_mfma_f32_16x16x32_bf16 v[204:207], v[140:143], v[124:127], v[204:207]
    v_add_u32 v239, v239, v238
    v_mov_b32 v234, 0
    s_waitcnt lgkmcnt(0)
    s_barrier
    v_mfma_f32_16x16x32_bf16 v[144:147], v[96:99], v[80:83], v[144:147]
    ds_read_b128 v[112:115], v8 offset:0
    v_mfma_f32_16x16x32_bf16 v[148:151], v[96:99], v[84:87], v[148:151]
    ds_read_b64_tr_b16 v[128:129], v9 offset:16384
    v_mfma_f32_16x16x32_bf16 v[152:155], v[96:99], v[88:91], v[152:155]
    ds_read_b64_tr_b16 v[130:131], v9 offset:20480
    v_mfma_f32_16x16x32_bf16 v[156:159], v[96:99], v[92:95], v[156:159]
    ds_read_b128 v[116:119], v8 offset:1024
    v_mfma_f32_16x16x32_bf16 v[160:163], v[100:103], v[80:83], v[160:163]
    ds_read_b128 v[120:123], v8 offset:2048
    v_mfma_f32_16x16x32_bf16 v[164:167], v[100:103], v[84:87], v[164:167]
    ds_read_b128 v[124:127], v8 offset:3072
    v_mfma_f32_16x16x32_bf16 v[168:171], v[100:103], v[88:91], v[168:171]
    ds_read_b64_tr_b16 v[132:133], v10 offset:16384
    v_mfma_f32_16x16x32_bf16 v[172:175], v[100:103], v[92:95], v[172:175]
    ds_read_b64_tr_b16 v[134:135], v10 offset:20480
    v_mfma_f32_16x16x32_bf16 v[176:179], v[104:107], v[80:83], v[176:179]
    ds_read_b64_tr_b16 v[136:137], v11 offset:16384
    v_mfma_f32_16x16x32_bf16 v[180:183], v[104:107], v[84:87], v[180:183]
    ds_read_b64_tr_b16 v[138:139], v11 offset:20480
    v_mfma_f32_16x16x32_bf16 v[184:187], v[104:107], v[88:91], v[184:187]
    ds_read_b64_tr_b16 v[140:141], v12 offset:16384
    v_mfma_f32_16x16x32_bf16 v[188:191], v[104:107], v[92:95], v[188:191]
    ds_read_b64_tr_b16 v[142:143], v12 offset:20480
    v_mov_b32 v235, 0
    v_mfma_f32_16x16x32_bf16 v[192:195], v[108:111], v[80:83], v[192:195]
    ds_read_b64 v[2:3], v238 offset:1536
    ds_read_b64 v[6:7], v242 offset:0
    v_mfma_f32_16x16x32_bf16 v[196:199], v[108:111], v[84:87], v[196:199]
    ds_read_b64 v[248:249], v239 offset:0
    ds_read_b64 v[252:253], v238 offset:512
    v_mfma_f32_16x16x32_bf16 v[200:203], v[108:111], v[88:91], v[200:203]
    ds_read_b64 v[4:5], v238 offset:1664
    ds_read_b64 v[14:15], v242 offset:128
    v_mfma_f32_16x16x32_bf16 v[204:207], v[108:111], v[92:95], v[204:207]
    ds_read_b64 v[250:251], v239 offset:128
    ds_read_b64 v[254:255], v238 offset:640
    s_waitcnt lgkmcnt(0)
    v_mfma_f32_16x16x32_bf16 v[144:147], v[128:131], v[112:115], v[144:147]
    ds_read_b128 v[80:83], v8 offset:8192
    v_fma_f32 v226, v240, v2, v232
    v_mfma_f32_16x16x32_bf16 v[148:151], v[128:131], v[116:119], v[148:151]
    ds_read_b64_tr_b16 v[96:97], v9 offset:24576
    v_fma_f32 v227, v241, v2, v233
    v_mfma_f32_16x16x32_bf16 v[152:155], v[128:131], v[120:123], v[152:155]
    ds_read_b64_tr_b16 v[98:99], v9 offset:28672
    v_fma_f32 v226, -v241, v3, v226
    v_mfma_f32_16x16x32_bf16 v[156:159], v[128:131], v[124:127], v[156:159]
    ds_read_b128 v[84:87], v8 offset:9216
    v_fma_f32 v227, v240, v3, v227
    v_mfma_f32_16x16x32_bf16 v[160:163], v[132:135], v[112:115], v[160:163]
    ds_read_b128 v[88:91], v8 offset:10240
    v_fma_f32 v230, v244, v4, v236
    v_mfma_f32_16x16x32_bf16 v[164:167], v[132:135], v[116:119], v[164:167]
    ds_read_b128 v[92:95], v8 offset:11264
    v_fma_f32 v231, v245, v4, v237
    v_mfma_f32_16x16x32_bf16 v[168:171], v[132:135], v[120:123], v[168:171]
    ds_read_b64_tr_b16 v[100:101], v10 offset:24576
    v_fma_f32 v230, -v245, v5, v230
    v_mfma_f32_16x16x32_bf16 v[172:175], v[132:135], v[124:127], v[172:175]
    ds_read_b64_tr_b16 v[102:103], v10 offset:28672
    v_fma_f32 v231, v244, v5, v231
    v_mfma_f32_16x16x32_bf16 v[176:179], v[136:139], v[112:115], v[176:179]
    ds_read_b64_tr_b16 v[104:105], v11 offset:24576
    v_fma_f32 v218, v226, v2, v224
    v_mfma_f32_16x16x32_bf16 v[180:183], v[136:139], v[116:119], v[180:183]
    ds_read_b64_tr_b16 v[106:107], v11 offset:28672
    v_fma_f32 v219, v227, v2, v225
    v_mfma_f32_16x16x32_bf16 v[184:187], v[136:139], v[120:123], v[184:187]
    ds_read_b64_tr_b16 v[108:109], v12 offset:24576
    v_fma_f32 v218, -v227, v3, v218
    v_mfma_f32_16x16x32_bf16 v[188:191], v[136:139], v[124:127], v[188:191]
    ds_read_b64_tr_b16 v[110:111], v12 offset:28672
    v_fma_f32 v219, v226, v3, v219
    v_mfma_f32_16x16x32_bf16 v[192:195], v[140:143], v[112:115], v[192:195]
    v_add_u32 v8, 122880, v8
    v_add_u32 v9, 122880, v9
    v_fma_f32 v222, v230, v4, v228
    v_mfma_f32_16x16x32_bf16 v[196:199], v[140:143], v[116:119], v[196:199]
    v_add_u32 v10, 122880, v10
    v_add_u32 v11, 122880, v11
    v_fma_f32 v223, v231, v4, v229
    v_mfma_f32_16x16x32_bf16 v[200:203], v[140:143], v[120:123], v[200:203]
    v_add_u32 v12, 122880, v12
    v_fma_f32 v222, -v231, v5, v222
    v_mfma_f32_16x16x32_bf16 v[204:207], v[140:143], v[124:127], v[204:207]
    v_fma_f32 v223, v230, v5, v223
    v_fma_f32 v226, v218, v2, v216
    s_waitcnt lgkmcnt(0)
    s_barrier
    v_mfma_f32_16x16x32_bf16 v[144:147], v[96:99], v[80:83], v[144:147]
    ds_read_b128 v[112:115], v8 offset:0
    v_fma_f32 v227, v219, v2, v217
    v_mfma_f32_16x16x32_bf16 v[148:151], v[96:99], v[84:87], v[148:151]
    ds_read_b64_tr_b16 v[128:129], v9 offset:16384
    v_fma_f32 v226, -v219, v3, v226
    v_mfma_f32_16x16x32_bf16 v[152:155], v[96:99], v[88:91], v[152:155]
    ds_read_b64_tr_b16 v[130:131], v9 offset:20480
    v_fma_f32 v227, v218, v3, v227
    v_mfma_f32_16x16x32_bf16 v[156:159], v[96:99], v[92:95], v[156:159]
    ds_read_b128 v[116:119], v8 offset:1024
    v_fma_f32 v230, v222, v4, v220
    v_mfma_f32_16x16x32_bf16 v[160:163], v[100:103], v[80:83], v[160:163]
    ds_read_b128 v[120:123], v8 offset:2048
    v_fma_f32 v231, v223, v4, v221
    v_mfma_f32_16x16x32_bf16 v[164:167], v[100:103], v[84:87], v[164:167]
    ds_read_b128 v[124:127], v8 offset:3072
    v_fma_f32 v230, -v223, v5, v230
    v_mfma_f32_16x16x32_bf16 v[168:171], v[100:103], v[88:91], v[168:171]
    ds_read_b64_tr_b16 v[132:133], v10 offset:16384
    v_fma_f32 v231, v222, v5, v231
    v_mfma_f32_16x16x32_bf16 v[172:175], v[100:103], v[92:95], v[172:175]
    ds_read_b64_tr_b16 v[134:135], v10 offset:20480
    v_fma_f32 v218, v226, v6, v234
    v_mfma_f32_16x16x32_bf16 v[176:179], v[104:107], v[80:83], v[176:179]
    ds_read_b64_tr_b16 v[136:137], v11 offset:16384
    v_fma_f32 v219, v227, v6, v235
    v_mfma_f32_16x16x32_bf16 v[180:183], v[104:107], v[84:87], v[180:183]
    ds_read_b64_tr_b16 v[138:139], v11 offset:20480
    v_fma_f32 v218, -v227, v7, v218
    v_mfma_f32_16x16x32_bf16 v[184:187], v[104:107], v[88:91], v[184:187]
    ds_read_b64_tr_b16 v[140:141], v12 offset:16384
    v_fma_f32 v219, v226, v7, v219
    v_mfma_f32_16x16x32_bf16 v[188:191], v[104:107], v[92:95], v[188:191]
    ds_read_b64_tr_b16 v[142:143], v12 offset:20480
    v_fma_f32 v222, v230, v14, v234
    v_mfma_f32_16x16x32_bf16 v[192:195], v[108:111], v[80:83], v[192:195]
    v_fma_f32 v223, v231, v14, v235
    v_fma_f32 v222, -v231, v15, v222
    v_mfma_f32_16x16x32_bf16 v[196:199], v[108:111], v[84:87], v[196:199]
    v_fma_f32 v223, v230, v15, v223
    v_mov_b32 v226, v218
    v_mfma_f32_16x16x32_bf16 v[200:203], v[108:111], v[88:91], v[200:203]
    v_mov_b32 v227, v219
    v_mov_b32 v230, v222
    v_mfma_f32_16x16x32_bf16 v[204:207], v[108:111], v[92:95], v[204:207]
    v_mov_b32 v231, v223
    s_nop 1
    s_waitcnt lgkmcnt(0)
    v_mfma_f32_16x16x32_bf16 v[144:147], v[128:131], v[112:115], v[144:147]
    ds_read_b128 v[80:83], v8 offset:8192
    v_permlane16_swap_b32 v226, v218
    v_mfma_f32_16x16x32_bf16 v[148:151], v[128:131], v[116:119], v[148:151]
    ds_read_b64_tr_b16 v[96:97], v9 offset:24576
    v_permlane16_swap_b32 v227, v219
    v_mfma_f32_16x16x32_bf16 v[152:155], v[128:131], v[120:123], v[152:155]
    ds_read_b64_tr_b16 v[98:99], v9 offset:28672
    v_permlane16_swap_b32 v230, v222
    v_mfma_f32_16x16x32_bf16 v[156:159], v[128:131], v[124:127], v[156:159]
    ds_read_b128 v[84:87], v8 offset:9216
    v_permlane16_swap_b32 v231, v223
    v_mfma_f32_16x16x32_bf16 v[160:163], v[132:135], v[112:115], v[160:163]
    ds_read_b128 v[88:91], v8 offset:10240
    s_nop 1
    v_mfma_f32_16x16x32_bf16 v[164:167], v[132:135], v[116:119], v[164:167]
    ds_read_b128 v[92:95], v8 offset:11264
    v_add_f32 v218, v218, v226
    v_mfma_f32_16x16x32_bf16 v[168:171], v[132:135], v[120:123], v[168:171]
    ds_read_b64_tr_b16 v[100:101], v10 offset:24576
    v_add_f32 v219, v219, v227
    v_mfma_f32_16x16x32_bf16 v[172:175], v[132:135], v[124:127], v[172:175]
    ds_read_b64_tr_b16 v[102:103], v10 offset:28672
    v_add_f32 v222, v222, v230
    v_mfma_f32_16x16x32_bf16 v[176:179], v[136:139], v[112:115], v[176:179]
    ds_read_b64_tr_b16 v[104:105], v11 offset:24576
    v_add_f32 v223, v223, v231
    v_mfma_f32_16x16x32_bf16 v[180:183], v[136:139], v[116:119], v[180:183]
    ds_read_b64_tr_b16 v[106:107], v11 offset:28672
    v_mov_b32 v226, v218
    v_mfma_f32_16x16x32_bf16 v[184:187], v[136:139], v[120:123], v[184:187]
    ds_read_b64_tr_b16 v[108:109], v12 offset:24576
    v_mov_b32 v227, v219
    v_mfma_f32_16x16x32_bf16 v[188:191], v[136:139], v[124:127], v[188:191]
    ds_read_b64_tr_b16 v[110:111], v12 offset:28672
    v_mov_b32 v230, v222
    v_mfma_f32_16x16x32_bf16 v[192:195], v[140:143], v[112:115], v[192:195]
    v_add_u32 v8, 4294889472, v8
    v_add_u32 v9, 4294889472, v9
    v_mov_b32 v231, v223
    v_mfma_f32_16x16x32_bf16 v[196:199], v[140:143], v[116:119], v[196:199]
    v_add_u32 v10, 4294889472, v10
    v_add_u32 v11, 4294889472, v11
    s_nop 1
    v_mfma_f32_16x16x32_bf16 v[200:203], v[140:143], v[120:123], v[200:203]
    v_add_u32 v12, 4294889472, v12
    v_permlane32_swap_b32 v226, v218
    v_mfma_f32_16x16x32_bf16 v[204:207], v[140:143], v[124:127], v[204:207]
    v_permlane32_swap_b32 v227, v219
    v_permlane32_swap_b32 v230, v222
    s_waitcnt lgkmcnt(0)
    s_barrier
    v_mfma_f32_16x16x32_bf16 v[144:147], v[96:99], v[80:83], v[144:147]
    ds_read_b128 v[112:115], v8 offset:0
    v_permlane32_swap_b32 v231, v223
    v_mfma_f32_16x16x32_bf16 v[148:151], v[96:99], v[84:87], v[148:151]
    ds_read_b64_tr_b16 v[128:129], v9 offset:16384
    s_nop 1
    v_mfma_f32_16x16x32_bf16 v[152:155], v[96:99], v[88:91], v[152:155]
    ds_read_b64_tr_b16 v[130:131], v9 offset:20480
    v_add_f32 v218, v218, v226
    v_mfma_f32_16x16x32_bf16 v[156:159], v[96:99], v[92:95], v[156:159]
    ds_read_b128 v[116:119], v8 offset:1024
    v_add_f32 v219, v219, v227
    v_mfma_f32_16x16x32_bf16 v[160:163], v[100:103], v[80:83], v[160:163]
    ds_read_b128 v[120:123], v8 offset:2048
    v_add_f32 v222, v222, v230
    v_mfma_f32_16x16x32_bf16 v[164:167], v[100:103], v[84:87], v[164:167]
    ds_read_b128 v[124:127], v8 offset:3072
    v_add_f32 v223, v223, v231
    v_mfma_f32_16x16x32_bf16 v[168:171], v[100:103], v[88:91], v[168:171]
    ds_read_b64_tr_b16 v[132:133], v10 offset:16384
    ds_read_b64 v[2:3], v238 offset:0
    v_mfma_f32_16x16x32_bf16 v[172:175], v[100:103], v[92:95], v[172:175]
    ds_read_b64_tr_b16 v[134:135], v10 offset:20480
    ds_read_b64 v[6:7], v238 offset:2048
    v_mfma_f32_16x16x32_bf16 v[176:179], v[104:107], v[80:83], v[176:179]
    ds_read_b64_tr_b16 v[136:137], v11 offset:16384
    ds_read_b64 v[4:5], v238 offset:128
    v_mfma_f32_16x16x32_bf16 v[180:183], v[104:107], v[84:87], v[180:183]
    ds_read_b64_tr_b16 v[138:139], v11 offset:20480
    ds_read_b64 v[14:15], v238 offset:2176
    v_mfma_f32_16x16x32_bf16 v[184:187], v[104:107], v[88:91], v[184:187]
    ds_read_b64_tr_b16 v[140:141], v12 offset:16384
    v_fma_f32 v226, v218, v248, v212
    v_mfma_f32_16x16x32_bf16 v[188:191], v[104:107], v[92:95], v[188:191]
    ds_read_b64_tr_b16 v[142:143], v12 offset:20480
    v_fma_f32 v227, v219, v248, v213
    v_mfma_f32_16x16x32_bf16 v[192:195], v[108:111], v[80:83], v[192:195]
    v_fma_f32 v226, -v219, v249, v226
    v_fma_f32 v227, v218, v249, v227
    v_mfma_f32_16x16x32_bf16 v[196:199], v[108:111], v[84:87], v[196:199]
    v_fma_f32 v230, v222, v250, v214
    v_fma_f32 v231, v223, v250, v215
    v_mfma_f32_16x16x32_bf16 v[200:203], v[108:111], v[88:91], v[200:203]
    v_fma_f32 v230, -v223, v251, v230
    v_fma_f32 v231, v222, v251, v231
    v_mfma_f32_16x16x32_bf16 v[204:207], v[108:111], v[92:95], v[204:207]
    v_fma_f32 v212, v226, v252, v208
    v_fma_f32 v213, v227, v252, v209
    s_waitcnt lgkmcnt(0)
    v_mfma_f32_16x16x32_bf16 v[144:147], v[128:131], v[112:115], v[144:147]
    ds_read_b128 v[80:83], v8 offset:8192
    v_mfma_f32_16x16x32_bf16 v[148:151], v[128:131], v[116:119], v[148:151]
    ds_read_b64_tr_b16 v[96:97], v9 offset:24576
    v_mfma_f32_16x16x32_bf16 v[152:155], v[128:131], v[120:123], v[152:155]
    ds_read_b64_tr_b16 v[98:99], v9 offset:28672
    v_mfma_f32_16x16x32_bf16 v[156:159], v[128:131], v[124:127], v[156:159]
    ds_read_b128 v[84:87], v8 offset:9216
    v_fma_f32 v212, -v227, v253, v212
    v_mfma_f32_16x16x32_bf16 v[160:163], v[132:135], v[112:115], v[160:163]
    ds_read_b128 v[88:91], v8 offset:10240
    v_fma_f32 v213, v226, v253, v213
    v_mfma_f32_16x16x32_bf16 v[164:167], v[132:135], v[116:119], v[164:167]
    ds_read_b128 v[92:95], v8 offset:11264
    v_fma_f32 v214, v230, v254, v210
    v_mfma_f32_16x16x32_bf16 v[168:171], v[132:135], v[120:123], v[168:171]
    ds_read_b64_tr_b16 v[100:101], v10 offset:24576
    v_fma_f32 v215, v231, v254, v211
    v_mfma_f32_16x16x32_bf16 v[172:175], v[132:135], v[124:127], v[172:175]
    ds_read_b64_tr_b16 v[102:103], v10 offset:28672
    v_fma_f32 v214, -v231, v255, v214
    v_mfma_f32_16x16x32_bf16 v[176:179], v[136:139], v[112:115], v[176:179]
    ds_read_b64_tr_b16 v[104:105], v11 offset:24576
    v_fma_f32 v215, v230, v255, v215
    v_mfma_f32_16x16x32_bf16 v[180:183], v[136:139], v[116:119], v[180:183]
    ds_read_b64_tr_b16 v[106:107], v11 offset:28672
    v_mov_b32 v216, v226
    v_mfma_f32_16x16x32_bf16 v[184:187], v[136:139], v[120:123], v[184:187]
    ds_read_b64_tr_b16 v[108:109], v12 offset:24576
    v_mov_b32 v217, v212
    v_mfma_f32_16x16x32_bf16 v[188:191], v[136:139], v[124:127], v[188:191]
    ds_read_b64_tr_b16 v[110:111], v12 offset:28672
    v_mov_b32 v224, v227
    v_mfma_f32_16x16x32_bf16 v[192:195], v[140:143], v[112:115], v[192:195]
    v_add_u32 v8, 45056, v8
    v_add_u32 v9, 45056, v9
    v_mov_b32 v225, v213
    v_mfma_f32_16x16x32_bf16 v[196:199], v[140:143], v[116:119], v[196:199]
    v_add_u32 v10, 45056, v10
    v_add_u32 v11, 45056, v11
    v_mov_b32 v220, v230
    v_mfma_f32_16x16x32_bf16 v[200:203], v[140:143], v[120:123], v[200:203]
    v_add_u32 v12, 45056, v12
    v_mov_b32 v221, v214
    v_mfma_f32_16x16x32_bf16 v[204:207], v[140:143], v[124:127], v[204:207]
    v_mov_b32 v228, v231
    v_mov_b32 v229, v215
    s_waitcnt lgkmcnt(0)
    s_barrier
    v_mfma_f32_16x16x32_bf16 v[144:147], v[96:99], v[80:83], v[144:147]
    ds_read_b128 v[112:115], v8 offset:0
    v_fma_f32 v232, v216, v2, v16
    v_mfma_f32_16x16x32_bf16 v[148:151], v[96:99], v[84:87], v[148:151]
    ds_read_b64_tr_b16 v[128:129], v9 offset:16384
    v_fma_f32 v240, v224, v2, v20
    v_mfma_f32_16x16x32_bf16 v[152:155], v[96:99], v[88:91], v[152:155]
    ds_read_b64_tr_b16 v[130:131], v9 offset:20480
    v_fma_f32 v233, v217, v2, v17
    v_mfma_f32_16x16x32_bf16 v[156:159], v[96:99], v[92:95], v[156:159]
    ds_read_b128 v[116:119], v8 offset:1024
    v_fma_f32 v241, v225, v2, v21
    v_mfma_f32_16x16x32_bf16 v[160:163], v[100:103], v[80:83], v[160:163]
    ds_read_b128 v[120:123], v8 offset:2048
    v_fma_f32 v236, v220, v4, v24
    v_mfma_f32_16x16x32_bf16 v[164:167], v[100:103], v[84:87], v[164:167]
    ds_read_b128 v[124:127], v8 offset:3072
    v_fma_f32 v244, v228, v4, v28
    v_mfma_f32_16x16x32_bf16 v[168:171], v[100:103], v[88:91], v[168:171]
    ds_read_b64_tr_b16 v[132:133], v10 offset:16384
    v_fma_f32 v237, v221, v4, v25
    v_mfma_f32_16x16x32_bf16 v[172:175], v[100:103], v[92:95], v[172:175]
    ds_read_b64_tr_b16 v[134:135], v10 offset:20480
    v_fma_f32 v245, v229, v4, v29
    v_mfma_f32_16x16x32_bf16 v[176:179], v[104:107], v[80:83], v[176:179]
    ds_read_b64_tr_b16 v[136:137], v11 offset:16384
    v_fma_f32 v232, -v224, v3, v232
    v_mfma_f32_16x16x32_bf16 v[180:183], v[104:107], v[84:87], v[180:183]
    ds_read_b64_tr_b16 v[138:139], v11 offset:20480
    v_fma_f32 v224, v216, v3, v240
    v_mfma_f32_16x16x32_bf16 v[184:187], v[104:107], v[88:91], v[184:187]
    ds_read_b64_tr_b16 v[140:141], v12 offset:16384
    v_fma_f32 v233, -v225, v3, v233
    v_mfma_f32_16x16x32_bf16 v[188:191], v[104:107], v[92:95], v[188:191]
    ds_read_b64_tr_b16 v[142:143], v12 offset:20480
    v_fma_f32 v225, v217, v3, v241
    v_mfma_f32_16x16x32_bf16 v[192:195], v[108:111], v[80:83], v[192:195]
    v_fma_f32 v236, -v228, v5, v236
    v_fma_f32 v228, v220, v5, v244
    v_mfma_f32_16x16x32_bf16 v[196:199], v[108:111], v[84:87], v[196:199]
    v_fma_f32 v237, -v229, v5, v237
    v_fma_f32 v229, v221, v5, v245
    v_mfma_f32_16x16x32_bf16 v[200:203], v[108:111], v[88:91], v[200:203]
    v_mul_f32 v16, v232, v6
    v_mul_f32_e64 v20, -v224, v6
    v_mfma_f32_16x16x32_bf16 v[204:207], v[108:111], v[92:95], v[204:207]
    v_mul_f32 v17, v233, v6
    v_mul_f32_e64 v21, -v225, v6
    s_waitcnt lgkmcnt(0)
    v_mfma_f32_16x16x32_bf16 v[144:147], v[128:131], v[112:115], v[144:147]
    ds_read_b128 v[80:83], v8 offset:8192
    v_mul_f32 v24, v236, v14
    v_mfma_f32_16x16x32_bf16 v[148:151], v[128:131], v[116:119], v[148:151]
    ds_read_b64_tr_b16 v[96:97], v9 offset:24576
    v_mul_f32_e64 v28, -v228, v14
    v_mfma_f32_16x16x32_bf16 v[152:155], v[128:131], v[120:123], v[152:155]
    ds_read_b64_tr_b16 v[98:99], v9 offset:28672
    v_mul_f32 v25, v237, v14
    v_mfma_f32_16x16x32_bf16 v[156:159], v[128:131], v[124:127], v[156:159]
    ds_read_b128 v[84:87], v8 offset:9216
    v_mul_f32_e64 v29, -v229, v14
    v_mfma_f32_16x16x32_bf16 v[160:163], v[132:135], v[112:115], v[160:163]
    ds_read_b128 v[88:91], v8 offset:10240
    v_fma_f32 v16, -v224, v7, v16
    v_mfma_f32_16x16x32_bf16 v[164:167], v[132:135], v[116:119], v[164:167]
    ds_read_b128 v[92:95], v8 offset:11264
    v_fma_f32 v20, -v232, v7, v20
    v_mfma_f32_16x16x32_bf16 v[168:171], v[132:135], v[120:123], v[168:171]
    ds_read_b64_tr_b16 v[100:101], v10 offset:24576
    v_fma_f32 v17, -v225, v7, v17
    v_mfma_f32_16x16x32_bf16 v[172:175], v[132:135], v[124:127], v[172:175]
    ds_read_b64_tr_b16 v[102:103], v10 offset:28672
    v_fma_f32 v21, -v233, v7, v21
    v_mfma_f32_16x16x32_bf16 v[176:179], v[136:139], v[112:115], v[176:179]
    ds_read_b64_tr_b16 v[104:105], v11 offset:24576
    v_fma_f32 v24, -v228, v15, v24
    v_mfma_f32_16x16x32_bf16 v[180:183], v[136:139], v[116:119], v[180:183]
    ds_read_b64_tr_b16 v[106:107], v11 offset:28672
    v_fma_f32 v28, -v236, v15, v28
    v_mfma_f32_16x16x32_bf16 v[184:187], v[136:139], v[120:123], v[184:187]
    ds_read_b64_tr_b16 v[108:109], v12 offset:24576
    v_fma_f32 v25, -v229, v15, v25
    v_mfma_f32_16x16x32_bf16 v[188:191], v[136:139], v[124:127], v[188:191]
    ds_read_b64_tr_b16 v[110:111], v12 offset:28672
    v_fma_f32 v29, -v237, v15, v29
    v_mfma_f32_16x16x32_bf16 v[192:195], v[140:143], v[112:115], v[192:195]
    v_add_u32 v8, 4294877184, v8
    v_add_u32 v9, 4294877184, v9
    v_fma_f32 v216, v232, v2, v18
    v_mfma_f32_16x16x32_bf16 v[196:199], v[140:143], v[116:119], v[196:199]
    v_add_u32 v10, 4294877184, v10
    v_add_u32 v11, 4294877184, v11
    v_fma_f32 v240, v224, v2, v22
    v_mfma_f32_16x16x32_bf16 v[200:203], v[140:143], v[120:123], v[200:203]
    v_add_u32 v12, 4294877184, v12
    v_fma_f32 v217, v233, v2, v19
    v_mfma_f32_16x16x32_bf16 v[204:207], v[140:143], v[124:127], v[204:207]
    v_fma_f32 v241, v225, v2, v23
    v_fma_f32 v220, v236, v4, v26
    s_waitcnt lgkmcnt(0)
    s_barrier
    v_mfma_f32_16x16x32_bf16 v[144:147], v[96:99], v[80:83], v[144:147]
    ds_read_b128 v[112:115], v8 offset:0
    v_fma_f32 v244, v228, v4, v30
    v_mfma_f32_16x16x32_bf16 v[148:151], v[96:99], v[84:87], v[148:151]
    ds_read_b64_tr_b16 v[128:129], v9 offset:16384
    v_fma_f32 v221, v237, v4, v27
    v_mfma_f32_16x16x32_bf16 v[152:155], v[96:99], v[88:91], v[152:155]
    ds_read_b64_tr_b16 v[130:131], v9 offset:20480
    v_fma_f32 v245, v229, v4, v31
    v_mfma_f32_16x16x32_bf16 v[156:159], v[96:99], v[92:95], v[156:159]
    ds_read_b128 v[116:119], v8 offset:1024
    v_fma_f32 v216, -v224, v3, v216
    v_mfma_f32_16x16x32_bf16 v[160:163], v[100:103], v[80:83], v[160:163]
    ds_read_b128 v[120:123], v8 offset:2048
    v_fma_f32 v224, v232, v3, v240
    v_mfma_f32_16x16x32_bf16 v[164:167], v[100:103], v[84:87], v[164:167]
    ds_read_b128 v[124:127], v8 offset:3072
    v_fma_f32 v217, -v225, v3, v217
    v_mfma_f32_16x16x32_bf16 v[168:171], v[100:103], v[88:91], v[168:171]
    ds_read_b64_tr_b16 v[132:133], v10 offset:16384
    v_fma_f32 v225, v233, v3, v241
    v_mfma_f32_16x16x32_bf16 v[172:175], v[100:103], v[92:95], v[172:175]
    ds_read_b64_tr_b16 v[134:135], v10 offset:20480
    v_fma_f32 v220, -v228, v5, v220
    v_mfma_f32_16x16x32_bf16 v[176:179], v[104:107], v[80:83], v[176:179]
    ds_read_b64_tr_b16 v[136:137], v11 offset:16384
    v_fma_f32 v228, v236, v5, v244
    v_mfma_f32_16x16x32_bf16 v[180:183], v[104:107], v[84:87], v[180:183]
    ds_read_b64_tr_b16 v[138:139], v11 offset:20480
    v_fma_f32 v221, -v229, v5, v221
    v_mfma_f32_16x16x32_bf16 v[184:187], v[104:107], v[88:91], v[184:187]
    ds_read_b64_tr_b16 v[140:141], v12 offset:16384
    v_fma_f32 v229, v237, v5, v245
    v_mfma_f32_16x16x32_bf16 v[188:191], v[104:107], v[92:95], v[188:191]
    ds_read_b64_tr_b16 v[142:143], v12 offset:20480
    v_mul_f32 v18, v216, v6
    v_mfma_f32_16x16x32_bf16 v[192:195], v[108:111], v[80:83], v[192:195]
    v_mul_f32_e64 v22, -v224, v6
    v_mul_f32 v19, v217, v6
    v_mfma_f32_16x16x32_bf16 v[196:199], v[108:111], v[84:87], v[196:199]
    v_mul_f32_e64 v23, -v225, v6
    v_mul_f32 v26, v220, v14
    v_mfma_f32_16x16x32_bf16 v[200:203], v[108:111], v[88:91], v[200:203]
    v_mul_f32_e64 v30, -v228, v14
    v_mul_f32 v27, v221, v14
    v_mfma_f32_16x16x32_bf16 v[204:207], v[108:111], v[92:95], v[204:207]
    v_mul_f32_e64 v31, -v229, v14
    v_fma_f32 v18, -v224, v7, v18
    s_waitcnt lgkmcnt(0)
    v_mfma_f32_16x16x32_bf16 v[144:147], v[128:131], v[112:115], v[144:147]
    ds_read_b128 v[80:83], v8 offset:8192
    v_fma_f32 v22, -v216, v7, v22
    v_mfma_f32_16x16x32_bf16 v[148:151], v[128:131], v[116:119], v[148:151]
    ds_read_b64_tr_b16 v[96:97], v9 offset:24576
    v_fma_f32 v19, -v225, v7, v19
    v_mfma_f32_16x16x32_bf16 v[152:155], v[128:131], v[120:123], v[152:155]
    ds_read_b64_tr_b16 v[98:99], v9 offset:28672
    v_fma_f32 v23, -v217, v7, v23
    v_mfma_f32_16x16x32_bf16 v[156:159], v[128:131], v[124:127], v[156:159]
    ds_read_b128 v[84:87], v8 offset:9216
    v_fma_f32 v26, -v228, v15, v26
    v_mfma_f32_16x16x32_bf16 v[160:163], v[132:135], v[112:115], v[160:163]
    ds_read_b128 v[88:91], v8 offset:10240
    v_fma_f32 v30, -v220, v15, v30
    v_mfma_f32_16x16x32_bf16 v[164:167], v[132:135], v[116:119], v[164:167]
    ds_read_b128 v[92:95], v8 offset:11264
    v_fma_f32 v27, -v229, v15, v27
    v_mfma_f32_16x16x32_bf16 v[168:171], v[132:135], v[120:123], v[168:171]
    ds_read_b64_tr_b16 v[100:101], v10 offset:24576
    v_fma_f32 v31, -v221, v15, v31
    v_mfma_f32_16x16x32_bf16 v[172:175], v[132:135], v[124:127], v[172:175]
    ds_read_b64_tr_b16 v[102:103], v10 offset:28672
    v_fma_f32 v232, v216, v2, v32
    v_mfma_f32_16x16x32_bf16 v[176:179], v[136:139], v[112:115], v[176:179]
    ds_read_b64_tr_b16 v[104:105], v11 offset:24576
    v_fma_f32 v240, v224, v2, v36
    v_mfma_f32_16x16x32_bf16 v[180:183], v[136:139], v[116:119], v[180:183]
    ds_read_b64_tr_b16 v[106:107], v11 offset:28672
    v_fma_f32 v233, v217, v2, v33
    v_mfma_f32_16x16x32_bf16 v[184:187], v[136:139], v[120:123], v[184:187]
    ds_read_b64_tr_b16 v[108:109], v12 offset:24576
    v_fma_f32 v241, v225, v2, v37
    v_mfma_f32_16x16x32_bf16 v[188:191], v[136:139], v[124:127], v[188:191]
    ds_read_b64_tr_b16 v[110:111], v12 offset:28672
    v_fma_f32 v236, v220, v4, v40
    v_mfma_f32_16x16x32_bf16 v[192:195], v[140:143], v[112:115], v[192:195]
    v_add_u32 v8, 122880, v8
    v_add_u32 v9, 122880, v9
    v_fma_f32 v244, v228, v4, v44
    v_mfma_f32_16x16x32_bf16 v[196:199], v[140:143], v[116:119], v[196:199]
    v_add_u32 v10, 122880, v10
    v_add_u32 v11, 122880, v11
    v_fma_f32 v237, v221, v4, v41
    v_mfma_f32_16x16x32_bf16 v[200:203], v[140:143], v[120:123], v[200:203]
    v_add_u32 v12, 122880, v12
    v_fma_f32 v245, v229, v4, v45
    v_mfma_f32_16x16x32_bf16 v[204:207], v[140:143], v[124:127], v[204:207]
    v_fma_f32 v232, -v224, v3, v232
    v_fma_f32 v224, v216, v3, v240
    s_waitcnt lgkmcnt(0)
    s_barrier
    v_mfma_f32_16x16x32_bf16 v[144:147], v[96:99], v[80:83], v[144:147]
    ds_read_b128 v[112:115], v8 offset:0
    v_fma_f32 v233, -v225, v3, v233
    v_mfma_f32_16x16x32_bf16 v[148:151], v[96:99], v[84:87], v[148:151]
    ds_read_b64_tr_b16 v[128:129], v9 offset:16384
    v_fma_f32 v225, v217, v3, v241
    v_mfma_f32_16x16x32_bf16 v[152:155], v[96:99], v[88:91], v[152:155]
    ds_read_b64_tr_b16 v[130:131], v9 offset:20480
    v_fma_f32 v236, -v228, v5, v236
    v_mfma_f32_16x16x32_bf16 v[156:159], v[96:99], v[92:95], v[156:159]
    ds_read_b128 v[116:119], v8 offset:1024
    v_fma_f32 v228, v220, v5, v244
    v_mfma_f32_16x16x32_bf16 v[160:163], v[100:103], v[80:83], v[160:163]
    ds_read_b128 v[120:123], v8 offset:2048
    v_fma_f32 v237, -v229, v5, v237
    v_mfma_f32_16x16x32_bf16 v[164:167], v[100:103], v[84:87], v[164:167]
    ds_read_b128 v[124:127], v8 offset:3072
    v_fma_f32 v229, v221, v5, v245
    v_mfma_f32_16x16x32_bf16 v[168:171], v[100:103], v[88:91], v[168:171]
    ds_read_b64_tr_b16 v[132:133], v10 offset:16384
    v_mul_f32 v32, v232, v6
    v_mfma_f32_16x16x32_bf16 v[172:175], v[100:103], v[92:95], v[172:175]
    ds_read_b64_tr_b16 v[134:135], v10 offset:20480
    v_mul_f32_e64 v36, -v224, v6
    v_mfma_f32_16x16x32_bf16 v[176:179], v[104:107], v[80:83], v[176:179]
    ds_read_b64_tr_b16 v[136:137], v11 offset:16384
    v_mul_f32 v33, v233, v6
    v_mfma_f32_16x16x32_bf16 v[180:183], v[104:107], v[84:87], v[180:183]
    ds_read_b64_tr_b16 v[138:139], v11 offset:20480
    v_mul_f32_e64 v37, -v225, v6
    v_mfma_f32_16x16x32_bf16 v[184:187], v[104:107], v[88:91], v[184:187]
    ds_read_b64_tr_b16 v[140:141], v12 offset:16384
    v_mul_f32 v40, v236, v14
    v_mfma_f32_16x16x32_bf16 v[188:191], v[104:107], v[92:95], v[188:191]
    ds_read_b64_tr_b16 v[142:143], v12 offset:20480
    v_mul_f32_e64 v44, -v228, v14
    v_mfma_f32_16x16x32_bf16 v[192:195], v[108:111], v[80:83], v[192:195]
    v_mul_f32 v41, v237, v14
    v_mul_f32_e64 v45, -v229, v14
    v_mfma_f32_16x16x32_bf16 v[196:199], v[108:111], v[84:87], v[196:199]
    v_fma_f32 v32, -v224, v7, v32
    v_fma_f32 v36, -v232, v7, v36
    v_mfma_f32_16x16x32_bf16 v[200:203], v[108:111], v[88:91], v[200:203]
    v_fma_f32 v33, -v225, v7, v33
    v_fma_f32 v37, -v233, v7, v37
    v_mfma_f32_16x16x32_bf16 v[204:207], v[108:111], v[92:95], v[204:207]
    v_fma_f32 v40, -v228, v15, v40
    v_fma_f32 v44, -v236, v15, v44
    s_waitcnt lgkmcnt(0)
    v_mfma_f32_16x16x32_bf16 v[144:147], v[128:131], v[112:115], v[144:147]
    ds_read_b128 v[80:83], v8 offset:8192
    v_fma_f32 v41, -v229, v15, v41
    v_mfma_f32_16x16x32_bf16 v[148:151], v[128:131], v[116:119], v[148:151]
    ds_read_b64_tr_b16 v[96:97], v9 offset:24576
    v_fma_f32 v45, -v237, v15, v45
    v_mfma_f32_16x16x32_bf16 v[152:155], v[128:131], v[120:123], v[152:155]
    ds_read_b64_tr_b16 v[98:99], v9 offset:28672
    v_fma_f32 v216, v232, v2, v34
    v_mfma_f32_16x16x32_bf16 v[156:159], v[128:131], v[124:127], v[156:159]
    ds_read_b128 v[84:87], v8 offset:9216
    v_fma_f32 v240, v224, v2, v38
    v_mfma_f32_16x16x32_bf16 v[160:163], v[132:135], v[112:115], v[160:163]
    ds_read_b128 v[88:91], v8 offset:10240
    v_fma_f32 v217, v233, v2, v35
    v_mfma_f32_16x16x32_bf16 v[164:167], v[132:135], v[116:119], v[164:167]
    ds_read_b128 v[92:95], v8 offset:11264
    v_fma_f32 v241, v225, v2, v39
    v_mfma_f32_16x16x32_bf16 v[168:171], v[132:135], v[120:123], v[168:171]
    ds_read_b64_tr_b16 v[100:101], v10 offset:24576
    v_fma_f32 v220, v236, v4, v42
    v_mfma_f32_16x16x32_bf16 v[172:175], v[132:135], v[124:127], v[172:175]
    ds_read_b64_tr_b16 v[102:103], v10 offset:28672
    v_fma_f32 v244, v228, v4, v46
    v_mfma_f32_16x16x32_bf16 v[176:179], v[136:139], v[112:115], v[176:179]
    ds_read_b64_tr_b16 v[104:105], v11 offset:24576
    v_fma_f32 v221, v237, v4, v43
    v_mfma_f32_16x16x32_bf16 v[180:183], v[136:139], v[116:119], v[180:183]
    ds_read_b64_tr_b16 v[106:107], v11 offset:28672
    v_fma_f32 v245, v229, v4, v47
    v_mfma_f32_16x16x32_bf16 v[184:187], v[136:139], v[120:123], v[184:187]
    ds_read_b64_tr_b16 v[108:109], v12 offset:24576
    v_fma_f32 v216, -v224, v3, v216
    v_mfma_f32_16x16x32_bf16 v[188:191], v[136:139], v[124:127], v[188:191]
    ds_read_b64_tr_b16 v[110:111], v12 offset:28672
    v_fma_f32 v224, v232, v3, v240
    v_mfma_f32_16x16x32_bf16 v[192:195], v[140:143], v[112:115], v[192:195]
    v_add_u32 v8, 4294889472, v8
    v_add_u32 v9, 4294889472, v9
    v_fma_f32 v217, -v225, v3, v217
    v_mfma_f32_16x16x32_bf16 v[196:199], v[140:143], v[116:119], v[196:199]
    v_add_u32 v10, 4294889472, v10
    v_add_u32 v11, 4294889472, v11
    v_fma_f32 v225, v233, v3, v241
    v_mfma_f32_16x16x32_bf16 v[200:203], v[140:143], v[120:123], v[200:203]
    v_add_u32 v12, 4294889472, v12
    v_fma_f32 v220, -v228, v5, v220
    v_mfma_f32_16x16x32_bf16 v[204:207], v[140:143], v[124:127], v[204:207]
    v_fma_f32 v228, v236, v5, v244
    v_fma_f32 v221, -v229, v5, v221
    s_waitcnt lgkmcnt(0)
    s_barrier
    v_mfma_f32_16x16x32_bf16 v[144:147], v[96:99], v[80:83], v[144:147]
    ds_read_b128 v[112:115], v8 offset:0
    v_fma_f32 v229, v237, v5, v245
    v_mfma_f32_16x16x32_bf16 v[148:151], v[96:99], v[84:87], v[148:151]
    ds_read_b64_tr_b16 v[128:129], v9 offset:16384
    v_mul_f32 v34, v216, v6
    v_mfma_f32_16x16x32_bf16 v[152:155], v[96:99], v[88:91], v[152:155]
    ds_read_b64_tr_b16 v[130:131], v9 offset:20480
    v_mul_f32_e64 v38, -v224, v6
    v_mfma_f32_16x16x32_bf16 v[156:159], v[96:99], v[92:95], v[156:159]
    ds_read_b128 v[116:119], v8 offset:1024
    v_mul_f32 v35, v217, v6
    v_mfma_f32_16x16x32_bf16 v[160:163], v[100:103], v[80:83], v[160:163]
    ds_read_b128 v[120:123], v8 offset:2048
    v_mul_f32_e64 v39, -v225, v6
    v_mfma_f32_16x16x32_bf16 v[164:167], v[100:103], v[84:87], v[164:167]
    ds_read_b128 v[124:127], v8 offset:3072
    v_mul_f32 v42, v220, v14
    v_mfma_f32_16x16x32_bf16 v[168:171], v[100:103], v[88:91], v[168:171]
    ds_read_b64_tr_b16 v[132:133], v10 offset:16384
    v_mul_f32_e64 v46, -v228, v14
    v_mfma_f32_16x16x32_bf16 v[172:175], v[100:103], v[92:95], v[172:175]
    ds_read_b64_tr_b16 v[134:135], v10 offset:20480
    v_mul_f32 v43, v221, v14
    v_mfma_f32_16x16x32_bf16 v[176:179], v[104:107], v[80:83], v[176:179]
    ds_read_b64_tr_b16 v[136:137], v11 offset:16384
    v_mul_f32_e64 v47, -v229, v14
    v_mfma_f32_16x16x32_bf16 v[180:183], v[104:107], v[84:87], v[180:183]
    ds_read_b64_tr_b16 v[138:139], v11 offset:20480
    v_fma_f32 v34, -v224, v7, v34
    v_mfma_f32_16x16x32_bf16 v[184:187], v[104:107], v[88:91], v[184:187]
    ds_read_b64_tr_b16 v[140:141], v12 offset:16384
    v_fma_f32 v38, -v216, v7, v38
    v_mfma_f32_16x16x32_bf16 v[188:191], v[104:107], v[92:95], v[188:191]
    ds_read_b64_tr_b16 v[142:143], v12 offset:20480
    v_fma_f32 v35, -v225, v7, v35
    v_mfma_f32_16x16x32_bf16 v[192:195], v[108:111], v[80:83], v[192:195]
    v_fma_f32 v39, -v217, v7, v39
    v_fma_f32 v42, -v228, v15, v42
    v_mfma_f32_16x16x32_bf16 v[196:199], v[108:111], v[84:87], v[196:199]
    v_fma_f32 v46, -v220, v15, v46
    v_fma_f32 v43, -v229, v15, v43
    v_mfma_f32_16x16x32_bf16 v[200:203], v[108:111], v[88:91], v[200:203]
    v_fma_f32 v47, -v221, v15, v47
    v_fma_f32 v232, v216, v2, v48
    v_mfma_f32_16x16x32_bf16 v[204:207], v[108:111], v[92:95], v[204:207]
    v_fma_f32 v240, v224, v2, v52
    v_fma_f32 v233, v217, v2, v49
    s_waitcnt lgkmcnt(0)
    v_mfma_f32_16x16x32_bf16 v[144:147], v[128:131], v[112:115], v[144:147]
    ds_read_b128 v[80:83], v8 offset:8192
    v_fma_f32 v241, v225, v2, v53
    v_mfma_f32_16x16x32_bf16 v[148:151], v[128:131], v[116:119], v[148:151]
    ds_read_b64_tr_b16 v[96:97], v9 offset:24576
    v_fma_f32 v236, v220, v4, v56
    v_mfma_f32_16x16x32_bf16 v[152:155], v[128:131], v[120:123], v[152:155]
    ds_read_b64_tr_b16 v[98:99], v9 offset:28672
    v_fma_f32 v244, v228, v4, v60
    v_mfma_f32_16x16x32_bf16 v[156:159], v[128:131], v[124:127], v[156:159]
    ds_read_b128 v[84:87], v8 offset:9216
    v_fma_f32 v237, v221, v4, v57
    v_mfma_f32_16x16x32_bf16 v[160:163], v[132:135], v[112:115], v[160:163]
    ds_read_b128 v[88:91], v8 offset:10240
    v_fma_f32 v245, v229, v4, v61
    v_mfma_f32_16x16x32_bf16 v[164:167], v[132:135], v[116:119], v[164:167]
    ds_read_b128 v[92:95], v8 offset:11264
    v_fma_f32 v232, -v224, v3, v232
    v_mfma_f32_16x16x32_bf16 v[168:171], v[132:135], v[120:123], v[168:171]
    ds_read_b64_tr_b16 v[100:101], v10 offset:24576
    v_fma_f32 v224, v216, v3, v240
    v_mfma_f32_16x16x32_bf16 v[172:175], v[132:135], v[124:127], v[172:175]
    ds_read_b64_tr_b16 v[102:103], v10 offset:28672
    v_fma_f32 v233, -v225, v3, v233
    v_mfma_f32_16x16x32_bf16 v[176:179], v[136:139], v[112:115], v[176:179]
    ds_read_b64_tr_b16 v[104:105], v11 offset:24576
    v_fma_f32 v225, v217, v3, v241
    v_mfma_f32_16x16x32_bf16 v[180:183], v[136:139], v[116:119], v[180:183]
    ds_read_b64_tr_b16 v[106:107], v11 offset:28672
    v_fma_f32 v236, -v228, v5, v236
    v_mfma_f32_16x16x32_bf16 v[184:187], v[136:139], v[120:123], v[184:187]
    ds_read_b64_tr_b16 v[108:109], v12 offset:24576
    v_fma_f32 v228, v220, v5, v244
    v_mfma_f32_16x16x32_bf16 v[188:191], v[136:139], v[124:127], v[188:191]
    ds_read_b64_tr_b16 v[110:111], v12 offset:28672
    v_fma_f32 v237, -v229, v5, v237
    v_mfma_f32_16x16x32_bf16 v[192:195], v[140:143], v[112:115], v[192:195]
    v_add_u32 v8, 45056, v8
    v_add_u32 v9, 45056, v9
    v_fma_f32 v229, v221, v5, v245
    v_mfma_f32_16x16x32_bf16 v[196:199], v[140:143], v[116:119], v[196:199]
    v_add_u32 v10, 45056, v10
    v_add_u32 v11, 45056, v11
    v_mul_f32 v48, v232, v6
    v_mfma_f32_16x16x32_bf16 v[200:203], v[140:143], v[120:123], v[200:203]
    v_add_u32 v12, 45056, v12
    v_mul_f32_e64 v52, -v224, v6
    v_mfma_f32_16x16x32_bf16 v[204:207], v[140:143], v[124:127], v[204:207]
    v_mul_f32 v49, v233, v6
    v_mul_f32_e64 v53, -v225, v6
    s_waitcnt lgkmcnt(0)
    s_barrier
    v_mfma_f32_16x16x32_bf16 v[144:147], v[96:99], v[80:83], v[144:147]
    ds_read_b128 v[112:115], v8 offset:0
    v_mul_f32 v56, v236, v14
    v_mfma_f32_16x16x32_bf16 v[148:151], v[96:99], v[84:87], v[148:151]
    ds_read_b64_tr_b16 v[128:129], v9 offset:16384
    v_mul_f32_e64 v60, -v228, v14
    v_mfma_f32_16x16x32_bf16 v[152:155], v[96:99], v[88:91], v[152:155]
    ds_read_b64_tr_b16 v[130:131], v9 offset:20480
    v_mul_f32 v57, v237, v14
    v_mfma_f32_16x16x32_bf16 v[156:159], v[96:99], v[92:95], v[156:159]
    ds_read_b128 v[116:119], v8 offset:1024
    v_mul_f32_e64 v61, -v229, v14
    v_mfma_f32_16x16x32_bf16 v[160:163], v[100:103], v[80:83], v[160:163]
    ds_read_b128 v[120:123], v8 offset:2048
    v_fma_f32 v48, -v224, v7, v48
    v_mfma_f32_16x16x32_bf16 v[164:167], v[100:103], v[84:87], v[164:167]
    ds_read_b128 v[124:127], v8 offset:3072
    v_fma_f32 v52, -v232, v7, v52
    v_mfma_f32_16x16x32_bf16 v[168:171], v[100:103], v[88:91], v[168:171]
    ds_read_b64_tr_b16 v[132:133], v10 offset:16384
    v_fma_f32 v49, -v225, v7, v49
    v_mfma_f32_16x16x32_bf16 v[172:175], v[100:103], v[92:95], v[172:175]
    ds_read_b64_tr_b16 v[134:135], v10 offset:20480
    v_fma_f32 v53, -v233, v7, v53
    v_mfma_f32_16x16x32_bf16 v[176:179], v[104:107], v[80:83], v[176:179]
    ds_read_b64_tr_b16 v[136:137], v11 offset:16384
    v_fma_f32 v56, -v228, v15, v56
    v_mfma_f32_16x16x32_bf16 v[180:183], v[104:107], v[84:87], v[180:183]
    ds_read_b64_tr_b16 v[138:139], v11 offset:20480
    v_fma_f32 v60, -v236, v15, v60
    v_mfma_f32_16x16x32_bf16 v[184:187], v[104:107], v[88:91], v[184:187]
    ds_read_b64_tr_b16 v[140:141], v12 offset:16384
    v_fma_f32 v57, -v229, v15, v57
    v_mfma_f32_16x16x32_bf16 v[188:191], v[104:107], v[92:95], v[188:191]
    ds_read_b64_tr_b16 v[142:143], v12 offset:20480
    v_fma_f32 v61, -v237, v15, v61
    v_mfma_f32_16x16x32_bf16 v[192:195], v[108:111], v[80:83], v[192:195]
    v_fma_f32 v216, v232, v2, v50
    v_fma_f32 v240, v224, v2, v54
    v_mfma_f32_16x16x32_bf16 v[196:199], v[108:111], v[84:87], v[196:199]
    v_fma_f32 v217, v233, v2, v51
    v_fma_f32 v241, v225, v2, v55
    v_mfma_f32_16x16x32_bf16 v[200:203], v[108:111], v[88:91], v[200:203]
    v_fma_f32 v220, v236, v4, v58
    v_fma_f32 v244, v228, v4, v62
    v_mfma_f32_16x16x32_bf16 v[204:207], v[108:111], v[92:95], v[204:207]
    v_fma_f32 v221, v237, v4, v59
    v_fma_f32 v245, v229, v4, v63
    s_waitcnt lgkmcnt(0)
    v_mfma_f32_16x16x32_bf16 v[144:147], v[128:131], v[112:115], v[144:147]
    ds_read_b128 v[80:83], v8 offset:8192
    v_fma_f32 v216, -v224, v3, v216
    v_mfma_f32_16x16x32_bf16 v[148:151], v[128:131], v[116:119], v[148:151]
    ds_read_b64_tr_b16 v[96:97], v9 offset:24576
    v_fma_f32 v224, v232, v3, v240
    v_mfma_f32_16x16x32_bf16 v[152:155], v[128:131], v[120:123], v[152:155]
    ds_read_b64_tr_b16 v[98:99], v9 offset:28672
    v_fma_f32 v217, -v225, v3, v217
    v_mfma_f32_16x16x32_bf16 v[156:159], v[128:131], v[124:127], v[156:159]
    ds_read_b128 v[84:87], v8 offset:9216
    v_fma_f32 v225, v233, v3, v241
    v_mfma_f32_16x16x32_bf16 v[160:163], v[132:135], v[112:115], v[160:163]
    ds_read_b128 v[88:91], v8 offset:10240
    v_fma_f32 v220, -v228, v5, v220
    v_mfma_f32_16x16x32_bf16 v[164:167], v[132:135], v[116:119], v[164:167]
    ds_read_b128 v[92:95], v8 offset:11264
    v_fma_f32 v228, v236, v5, v244
    v_mfma_f32_16x16x32_bf16 v[168:171], v[132:135], v[120:123], v[168:171]
    ds_read_b64_tr_b16 v[100:101], v10 offset:24576
    v_fma_f32 v221, -v229, v5, v221
    v_mfma_f32_16x16x32_bf16 v[172:175], v[132:135], v[124:127], v[172:175]
    ds_read_b64_tr_b16 v[102:103], v10 offset:28672
    v_fma_f32 v229, v237, v5, v245
    v_mfma_f32_16x16x32_bf16 v[176:179], v[136:139], v[112:115], v[176:179]
    ds_read_b64_tr_b16 v[104:105], v11 offset:24576
    v_mul_f32 v50, v216, v6
    v_mfma_f32_16x16x32_bf16 v[180:183], v[136:139], v[116:119], v[180:183]
    ds_read_b64_tr_b16 v[106:107], v11 offset:28672
    v_mul_f32_e64 v54, -v224, v6
    v_mfma_f32_16x16x32_bf16 v[184:187], v[136:139], v[120:123], v[184:187]
    ds_read_b64_tr_b16 v[108:109], v12 offset:24576
    v_mul_f32 v51, v217, v6
    v_mfma_f32_16x16x32_bf16 v[188:191], v[136:139], v[124:127], v[188:191]
    ds_read_b64_tr_b16 v[110:111], v12 offset:28672
    v_mul_f32_e64 v55, -v225, v6
    v_mfma_f32_16x16x32_bf16 v[192:195], v[140:143], v[112:115], v[192:195]
    v_add_u32 v8, 4294877184, v8
    v_add_u32 v9, 4294877184, v9
    v_mul_f32 v58, v220, v14
    v_mfma_f32_16x16x32_bf16 v[196:199], v[140:143], v[116:119], v[196:199]
    v_add_u32 v10, 4294877184, v10
    v_add_u32 v11, 4294877184, v11
    v_mul_f32_e64 v62, -v228, v14
    v_mfma_f32_16x16x32_bf16 v[200:203], v[140:143], v[120:123], v[200:203]
    v_add_u32 v12, 4294877184, v12
    v_mul_f32 v59, v221, v14
    v_mfma_f32_16x16x32_bf16 v[204:207], v[140:143], v[124:127], v[204:207]
    v_mul_f32_e64 v63, -v229, v14
    v_fma_f32 v50, -v224, v7, v50
    s_waitcnt lgkmcnt(0)
    s_barrier
    v_mfma_f32_16x16x32_bf16 v[144:147], v[96:99], v[80:83], v[144:147]
    ds_read_b128 v[112:115], v8 offset:0
    v_fma_f32 v54, -v216, v7, v54
    v_mfma_f32_16x16x32_bf16 v[148:151], v[96:99], v[84:87], v[148:151]
    ds_read_b64_tr_b16 v[128:129], v9 offset:16384
    v_fma_f32 v51, -v225, v7, v51
    v_mfma_f32_16x16x32_bf16 v[152:155], v[96:99], v[88:91], v[152:155]
    ds_read_b64_tr_b16 v[130:131], v9 offset:20480
    v_fma_f32 v55, -v217, v7, v55
    v_mfma_f32_16x16x32_bf16 v[156:159], v[96:99], v[92:95], v[156:159]
    ds_read_b128 v[116:119], v8 offset:1024
    v_fma_f32 v58, -v228, v15, v58
    v_mfma_f32_16x16x32_bf16 v[160:163], v[100:103], v[80:83], v[160:163]
    ds_read_b128 v[120:123], v8 offset:2048
    v_fma_f32 v62, -v220, v15, v62
    v_mfma_f32_16x16x32_bf16 v[164:167], v[100:103], v[84:87], v[164:167]
    ds_read_b128 v[124:127], v8 offset:3072
    v_fma_f32 v59, -v229, v15, v59
    v_mfma_f32_16x16x32_bf16 v[168:171], v[100:103], v[88:91], v[168:171]
    ds_read_b64_tr_b16 v[132:133], v10 offset:16384
    v_fma_f32 v63, -v221, v15, v63
    v_mfma_f32_16x16x32_bf16 v[172:175], v[100:103], v[92:95], v[172:175]
    ds_read_b64_tr_b16 v[134:135], v10 offset:20480
    v_fma_f32 v232, v216, v2, v64
    v_mfma_f32_16x16x32_bf16 v[176:179], v[104:107], v[80:83], v[176:179]
    ds_read_b64_tr_b16 v[136:137], v11 offset:16384
    v_fma_f32 v240, v224, v2, v68
    v_mfma_f32_16x16x32_bf16 v[180:183], v[104:107], v[84:87], v[180:183]
    ds_read_b64_tr_b16 v[138:139], v11 offset:20480
    v_fma_f32 v233, v217, v2, v65
    v_mfma_f32_16x16x32_bf16 v[184:187], v[104:107], v[88:91], v[184:187]
    ds_read_b64_tr_b16 v[140:141], v12 offset:16384
    v_fma_f32 v241, v225, v2, v69
    v_mfma_f32_16x16x32_bf16 v[188:191], v[104:107], v[92:95], v[188:191]
    ds_read_b64_tr_b16 v[142:143], v12 offset:20480
    v_fma_f32 v236, v220, v4, v72
    v_mfma_f32_16x16x32_bf16 v[192:195], v[108:111], v[80:83], v[192:195]
    v_fma_f32 v244, v228, v4, v76
    v_fma_f32 v237, v221, v4, v73
    v_mfma_f32_16x16x32_bf16 v[196:199], v[108:111], v[84:87], v[196:199]
    v_fma_f32 v245, v229, v4, v77
    v_fma_f32 v232, -v224, v3, v232
    v_mfma_f32_16x16x32_bf16 v[200:203], v[108:111], v[88:91], v[200:203]
    v_fma_f32 v224, v216, v3, v240
    v_fma_f32 v233, -v225, v3, v233
    v_mfma_f32_16x16x32_bf16 v[204:207], v[108:111], v[92:95], v[204:207]
    v_fma_f32 v225, v217, v3, v241
    v_fma_f32 v236, -v228, v5, v236
    s_waitcnt lgkmcnt(0)
    v_mfma_f32_16x16x32_bf16 v[144:147], v[128:131], v[112:115], v[144:147]
    ds_read_b128 v[80:83], v8 offset:8192
    v_fma_f32 v228, v220, v5, v244
    v_mfma_f32_16x16x32_bf16 v[148:151], v[128:131], v[116:119], v[148:151]
    ds_read_b64_tr_b16 v[96:97], v9 offset:24576
    v_fma_f32 v237, -v229, v5, v237
    v_mfma_f32_16x16x32_bf16 v[152:155], v[128:131], v[120:123], v[152:155]
    ds_read_b64_tr_b16 v[98:99], v9 offset:28672
    v_fma_f32 v229, v221, v5, v245
    v_mfma_f32_16x16x32_bf16 v[156:159], v[128:131], v[124:127], v[156:159]
    ds_read_b128 v[84:87], v8 offset:9216
    v_mul_f32 v64, v232, v6
    v_mfma_f32_16x16x32_bf16 v[160:163], v[132:135], v[112:115], v[160:163]
    ds_read_b128 v[88:91], v8 offset:10240
    v_mul_f32_e64 v68, -v224, v6
    v_mfma_f32_16x16x32_bf16 v[164:167], v[132:135], v[116:119], v[164:167]
    ds_read_b128 v[92:95], v8 offset:11264
    v_mul_f32 v65, v233, v6
    v_mfma_f32_16x16x32_bf16 v[168:171], v[132:135], v[120:123], v[168:171]
    ds_read_b64_tr_b16 v[100:101], v10 offset:24576
    v_mul_f32_e64 v69, -v225, v6
    v_mfma_f32_16x16x32_bf16 v[172:175], v[132:135], v[124:127], v[172:175]
    ds_read_b64_tr_b16 v[102:103], v10 offset:28672
    v_mul_f32 v72, v236, v14
    v_mfma_f32_16x16x32_bf16 v[176:179], v[136:139], v[112:115], v[176:179]
    ds_read_b64_tr_b16 v[104:105], v11 offset:24576
    v_mul_f32_e64 v76, -v228, v14
    v_mfma_f32_16x16x32_bf16 v[180:183], v[136:139], v[116:119], v[180:183]
    ds_read_b64_tr_b16 v[106:107], v11 offset:28672
    v_mul_f32 v73, v237, v14
    v_mfma_f32_16x16x32_bf16 v[184:187], v[136:139], v[120:123], v[184:187]
    ds_read_b64_tr_b16 v[108:109], v12 offset:24576
    v_mul_f32_e64 v77, -v229, v14
    v_mfma_f32_16x16x32_bf16 v[188:191], v[136:139], v[124:127], v[188:191]
    ds_read_b64_tr_b16 v[110:111], v12 offset:28672
    v_fma_f32 v64, -v224, v7, v64
    v_mfma_f32_16x16x32_bf16 v[192:195], v[140:143], v[112:115], v[192:195]
    v_add_u32 v8, 122880, v8
    v_add_u32 v9, 122880, v9
    v_fma_f32 v68, -v232, v7, v68
    v_mfma_f32_16x16x32_bf16 v[196:199], v[140:143], v[116:119], v[196:199]
    v_add_u32 v10, 122880, v10
    v_add_u32 v11, 122880, v11
    v_fma_f32 v65, -v225, v7, v65
    v_mfma_f32_16x16x32_bf16 v[200:203], v[140:143], v[120:123], v[200:203]
    v_add_u32 v12, 122880, v12
    v_fma_f32 v69, -v233, v7, v69
    v_mfma_f32_16x16x32_bf16 v[204:207], v[140:143], v[124:127], v[204:207]
    v_fma_f32 v72, -v228, v15, v72
    v_fma_f32 v76, -v236, v15, v76
    s_waitcnt lgkmcnt(0)
    s_barrier
    v_mfma_f32_16x16x32_bf16 v[144:147], v[96:99], v[80:83], v[144:147]
    ds_read_b128 v[112:115], v8 offset:0
    v_fma_f32 v73, -v229, v15, v73
    v_mfma_f32_16x16x32_bf16 v[148:151], v[96:99], v[84:87], v[148:151]
    ds_read_b64_tr_b16 v[128:129], v9 offset:16384
    v_fma_f32 v77, -v237, v15, v77
    v_mfma_f32_16x16x32_bf16 v[152:155], v[96:99], v[88:91], v[152:155]
    ds_read_b64_tr_b16 v[130:131], v9 offset:20480
    v_fma_f32 v216, v232, v2, v66
    v_mfma_f32_16x16x32_bf16 v[156:159], v[96:99], v[92:95], v[156:159]
    ds_read_b128 v[116:119], v8 offset:1024
    v_fma_f32 v240, v224, v2, v70
    v_mfma_f32_16x16x32_bf16 v[160:163], v[100:103], v[80:83], v[160:163]
    ds_read_b128 v[120:123], v8 offset:2048
    v_fma_f32 v217, v233, v2, v67
    v_mfma_f32_16x16x32_bf16 v[164:167], v[100:103], v[84:87], v[164:167]
    ds_read_b128 v[124:127], v8 offset:3072
    v_fma_f32 v241, v225, v2, v71
    v_mfma_f32_16x16x32_bf16 v[168:171], v[100:103], v[88:91], v[168:171]
    ds_read_b64_tr_b16 v[132:133], v10 offset:16384
    v_fma_f32 v220, v236, v4, v74
    v_mfma_f32_16x16x32_bf16 v[172:175], v[100:103], v[92:95], v[172:175]
    ds_read_b64_tr_b16 v[134:135], v10 offset:20480
    v_fma_f32 v244, v228, v4, v78
    v_mfma_f32_16x16x32_bf16 v[176:179], v[104:107], v[80:83], v[176:179]
    ds_read_b64_tr_b16 v[136:137], v11 offset:16384
    v_fma_f32 v221, v237, v4, v75
    v_mfma_f32_16x16x32_bf16 v[180:183], v[104:107], v[84:87], v[180:183]
    ds_read_b64_tr_b16 v[138:139], v11 offset:20480
    v_fma_f32 v245, v229, v4, v79
    v_mfma_f32_16x16x32_bf16 v[184:187], v[104:107], v[88:91], v[184:187]
    ds_read_b64_tr_b16 v[140:141], v12 offset:16384
    v_fma_f32 v216, -v224, v3, v216
    v_mfma_f32_16x16x32_bf16 v[188:191], v[104:107], v[92:95], v[188:191]
    ds_read_b64_tr_b16 v[142:143], v12 offset:20480
    v_fma_f32 v224, v232, v3, v240
    v_mfma_f32_16x16x32_bf16 v[192:195], v[108:111], v[80:83], v[192:195]
    v_fma_f32 v217, -v225, v3, v217
    v_fma_f32 v225, v233, v3, v241
    v_mfma_f32_16x16x32_bf16 v[196:199], v[108:111], v[84:87], v[196:199]
    v_fma_f32 v220, -v228, v5, v220
    v_fma_f32 v228, v236, v5, v244
    v_mfma_f32_16x16x32_bf16 v[200:203], v[108:111], v[88:91], v[200:203]
    v_fma_f32 v221, -v229, v5, v221
    v_fma_f32 v229, v237, v5, v245
    v_mfma_f32_16x16x32_bf16 v[204:207], v[108:111], v[92:95], v[204:207]
    v_mul_f32 v66, v216, v6
    v_mul_f32_e64 v70, -v224, v6
    s_waitcnt lgkmcnt(0)
    v_mfma_f32_16x16x32_bf16 v[144:147], v[128:131], v[112:115], v[144:147]
    ds_read_b128 v[80:83], v8 offset:8192
    v_mul_f32 v67, v217, v6
    v_mfma_f32_16x16x32_bf16 v[148:151], v[128:131], v[116:119], v[148:151]
    ds_read_b64_tr_b16 v[96:97], v9 offset:24576
    v_mul_f32_e64 v71, -v225, v6
    v_mfma_f32_16x16x32_bf16 v[152:155], v[128:131], v[120:123], v[152:155]
    ds_read_b64_tr_b16 v[98:99], v9 offset:28672
    v_mul_f32 v74, v220, v14
    v_mfma_f32_16x16x32_bf16 v[156:159], v[128:131], v[124:127], v[156:159]
    ds_read_b128 v[84:87], v8 offset:9216
    v_mul_f32_e64 v78, -v228, v14
    v_mfma_f32_16x16x32_bf16 v[160:163], v[132:135], v[112:115], v[160:163]
    ds_read_b128 v[88:91], v8 offset:10240
    v_mul_f32 v75, v221, v14
    v_mfma_f32_16x16x32_bf16 v[164:167], v[132:135], v[116:119], v[164:167]
    ds_read_b128 v[92:95], v8 offset:11264
    v_mul_f32_e64 v79, -v229, v14
    v_mfma_f32_16x16x32_bf16 v[168:171], v[132:135], v[120:123], v[168:171]
    ds_read_b64_tr_b16 v[100:101], v10 offset:24576
    v_fma_f32 v66, -v224, v7, v66
    v_mfma_f32_16x16x32_bf16 v[172:175], v[132:135], v[124:127], v[172:175]
    ds_read_b64_tr_b16 v[102:103], v10 offset:28672
    v_fma_f32 v70, -v216, v7, v70
    v_mfma_f32_16x16x32_bf16 v[176:179], v[136:139], v[112:115], v[176:179]
    ds_read_b64_tr_b16 v[104:105], v11 offset:24576
    v_fma_f32 v67, -v225, v7, v67
    v_mfma_f32_16x16x32_bf16 v[180:183], v[136:139], v[116:119], v[180:183]
    ds_read_b64_tr_b16 v[106:107], v11 offset:28672
    v_fma_f32 v71, -v217, v7, v71
    v_mfma_f32_16x16x32_bf16 v[184:187], v[136:139], v[120:123], v[184:187]
    ds_read_b64_tr_b16 v[108:109], v12 offset:24576
    v_fma_f32 v74, -v228, v15, v74
    v_mfma_f32_16x16x32_bf16 v[188:191], v[136:139], v[124:127], v[188:191]
    ds_read_b64_tr_b16 v[110:111], v12 offset:28672
    v_fma_f32 v78, -v220, v15, v78
    v_mfma_f32_16x16x32_bf16 v[192:195], v[140:143], v[112:115], v[192:195]
    v_add_u32 v8, 4294889472, v8
    v_add_u32 v9, 4294889472, v9
    v_fma_f32 v75, -v229, v15, v75
    v_mfma_f32_16x16x32_bf16 v[196:199], v[140:143], v[116:119], v[196:199]
    v_add_u32 v10, 4294889472, v10
    v_add_u32 v11, 4294889472, v11
    v_fma_f32 v79, -v221, v15, v79
    v_mfma_f32_16x16x32_bf16 v[200:203], v[140:143], v[120:123], v[200:203]
    v_add_u32 v12, 4294889472, v12
    v_and_b32 v250, 15, v0
    v_mfma_f32_16x16x32_bf16 v[204:207], v[140:143], v[124:127], v[204:207]
    v_lshrrev_b32 v249, 2, v250
    v_and_b32 v249, 1, v249
    s_waitcnt lgkmcnt(0)
    s_barrier
    v_mfma_f32_16x16x32_bf16 v[144:147], v[96:99], v[80:83], v[144:147]
    ds_read_b128 v[112:115], v8 offset:0
    v_lshlrev_b32 v248, 9, v249
    v_mfma_f32_16x16x32_bf16 v[148:151], v[96:99], v[84:87], v[148:151]
    ds_read_b64_tr_b16 v[128:129], v9 offset:16384
    v_lshrrev_b32 v249, 3, v250
    v_mfma_f32_16x16x32_bf16 v[152:155], v[96:99], v[88:91], v[152:155]
    ds_read_b64_tr_b16 v[130:131], v9 offset:20480
    v_lshlrev_b32 v249, 6, v249
    v_mfma_f32_16x16x32_bf16 v[156:159], v[96:99], v[92:95], v[156:159]
    ds_read_b128 v[116:119], v8 offset:1024
    v_add_u32 v248, v248, v249
    v_mfma_f32_16x16x32_bf16 v[160:163], v[100:103], v[80:83], v[160:163]
    ds_read_b128 v[120:123], v8 offset:2048
    v_and_b32 v249, 3, v250
    v_mfma_f32_16x16x32_bf16 v[164:167], v[100:103], v[84:87], v[164:167]
    ds_read_b128 v[124:127], v8 offset:3072
    v_lshlrev_b32 v249, 4, v249
    v_mfma_f32_16x16x32_bf16 v[168:171], v[100:103], v[88:91], v[168:171]
    ds_read_b64_tr_b16 v[132:133], v10 offset:16384
    v_add_u32 v248, v248, v249
    v_mfma_f32_16x16x32_bf16 v[172:175], v[100:103], v[92:95], v[172:175]
    ds_read_b64_tr_b16 v[134:135], v10 offset:20480
    v_lshrrev_b32 v249, 4, v0
    v_mfma_f32_16x16x32_bf16 v[176:179], v[104:107], v[80:83], v[176:179]
    ds_read_b64_tr_b16 v[136:137], v11 offset:16384
    v_lshlrev_b32 v249, 10, v249
    v_mfma_f32_16x16x32_bf16 v[180:183], v[104:107], v[84:87], v[180:183]
    ds_read_b64_tr_b16 v[138:139], v11 offset:20480
    v_add_u32 v248, v248, v249
    v_mfma_f32_16x16x32_bf16 v[184:187], v[104:107], v[88:91], v[184:187]
    ds_read_b64_tr_b16 v[140:141], v12 offset:16384
    s_lshl_b32 s94, s80, 4
    v_mfma_f32_16x16x32_bf16 v[188:191], v[104:107], v[92:95], v[188:191]
    ds_read_b64_tr_b16 v[142:143], v12 offset:20480
    s_add_u32 s94, s94, s84
    v_mfma_f32_16x16x32_bf16 v[192:195], v[108:111], v[80:83], v[192:195]
    s_lshl_b32 s94, s94, 15
    s_lshl_b32 s85, s90, 13
    v_mfma_f32_16x16x32_bf16 v[196:199], v[108:111], v[84:87], v[196:199]
    s_add_u32 s94, s94, s85
    s_lshl_b32 s85, s89, 12
    v_mfma_f32_16x16x32_bf16 v[200:203], v[108:111], v[88:91], v[200:203]
    s_add_u32 s94, s94, s85
    s_add_u32 s94, s94, 16777216
    v_mfma_f32_16x16x32_bf16 v[204:207], v[108:111], v[92:95], v[204:207]
    s_add_u32 s91, s94, 16384
    v_cvt_pk_bf16_f32 v208, v16, v18
    s_waitcnt lgkmcnt(0)
    v_mfma_f32_16x16x32_bf16 v[144:147], v[128:131], v[112:115], v[144:147]
    ds_read_b128 v[80:83], v8 offset:8192
    v_cvt_pk_bf16_f32 v209, v32, v34
    v_mfma_f32_16x16x32_bf16 v[148:151], v[128:131], v[116:119], v[148:151]
    ds_read_b64_tr_b16 v[96:97], v9 offset:24576
    v_cvt_pk_bf16_f32 v210, v48, v50
    v_mfma_f32_16x16x32_bf16 v[152:155], v[128:131], v[120:123], v[152:155]
    ds_read_b64_tr_b16 v[98:99], v9 offset:28672
    v_cvt_pk_bf16_f32 v211, v64, v66
    v_mfma_f32_16x16x32_bf16 v[156:159], v[128:131], v[124:127], v[156:159]
    ds_read_b128 v[84:87], v8 offset:9216
    buffer_store_dwordx4 v[208:211], v248, s[8:11], s94 offen offset:0 sc1
    v_mfma_f32_16x16x32_bf16 v[160:163], v[132:135], v[112:115], v[160:163]
    ds_read_b128 v[88:91], v8 offset:10240
    v_cvt_pk_bf16_f32 v212, v17, v19
    v_mfma_f32_16x16x32_bf16 v[164:167], v[132:135], v[116:119], v[164:167]
    ds_read_b128 v[92:95], v8 offset:11264
    v_cvt_pk_bf16_f32 v213, v33, v35
    v_mfma_f32_16x16x32_bf16 v[168:171], v[132:135], v[120:123], v[168:171]
    ds_read_b64_tr_b16 v[100:101], v10 offset:24576
    v_cvt_pk_bf16_f32 v214, v49, v51
    v_mfma_f32_16x16x32_bf16 v[172:175], v[132:135], v[124:127], v[172:175]
    ds_read_b64_tr_b16 v[102:103], v10 offset:28672
    v_cvt_pk_bf16_f32 v215, v65, v67
    v_mfma_f32_16x16x32_bf16 v[176:179], v[136:139], v[112:115], v[176:179]
    ds_read_b64_tr_b16 v[104:105], v11 offset:24576
    buffer_store_dwordx4 v[212:215], v248, s[8:11], s94 offen offset:128 sc1
    v_mfma_f32_16x16x32_bf16 v[180:183], v[136:139], v[116:119], v[180:183]
    ds_read_b64_tr_b16 v[106:107], v11 offset:28672
    v_cvt_pk_bf16_f32 v252, v24, v26
    v_mfma_f32_16x16x32_bf16 v[184:187], v[136:139], v[120:123], v[184:187]
    ds_read_b64_tr_b16 v[108:109], v12 offset:24576
    v_cvt_pk_bf16_f32 v253, v40, v42
    v_mfma_f32_16x16x32_bf16 v[188:191], v[136:139], v[124:127], v[188:191]
    ds_read_b64_tr_b16 v[110:111], v12 offset:28672
    v_cvt_pk_bf16_f32 v254, v56, v58
    v_mfma_f32_16x16x32_bf16 v[192:195], v[140:143], v[112:115], v[192:195]
    v_add_u32 v8, 45056, v8
    v_add_u32 v9, 45056, v9
    v_cvt_pk_bf16_f32 v255, v72, v74
    v_mfma_f32_16x16x32_bf16 v[196:199], v[140:143], v[116:119], v[196:199]
    v_add_u32 v10, 45056, v10
    v_add_u32 v11, 45056, v11
    buffer_store_dwordx4 v[252:255], v248, s[8:11], s94 offen offset:256 sc1
    v_mfma_f32_16x16x32_bf16 v[200:203], v[140:143], v[120:123], v[200:203]
    v_add_u32 v12, 45056, v12
    v_cvt_pk_bf16_f32 v208, v25, v27
    v_mfma_f32_16x16x32_bf16 v[204:207], v[140:143], v[124:127], v[204:207]
    v_cvt_pk_bf16_f32 v209, v41, v43
    v_cvt_pk_bf16_f32 v210, v57, v59
    s_waitcnt lgkmcnt(0)
    s_barrier
    v_mfma_f32_16x16x32_bf16 v[144:147], v[96:99], v[80:83], v[144:147]
    ds_read_b128 v[112:115], v8 offset:0
    v_cvt_pk_bf16_f32 v211, v73, v75
    v_mfma_f32_16x16x32_bf16 v[148:151], v[96:99], v[84:87], v[148:151]
    ds_read_b64_tr_b16 v[128:129], v9 offset:16384
    buffer_store_dwordx4 v[208:211], v248, s[8:11], s94 offen offset:384 sc1
    v_mfma_f32_16x16x32_bf16 v[152:155], v[96:99], v[88:91], v[152:155]
    ds_read_b64_tr_b16 v[130:131], v9 offset:20480
    v_cvt_pk_bf16_f32 v212, v20, v22
    v_mfma_f32_16x16x32_bf16 v[156:159], v[96:99], v[92:95], v[156:159]
    ds_read_b128 v[116:119], v8 offset:1024
    v_cvt_pk_bf16_f32 v213, v36, v38
    v_mfma_f32_16x16x32_bf16 v[160:163], v[100:103], v[80:83], v[160:163]
    ds_read_b128 v[120:123], v8 offset:2048
    v_cvt_pk_bf16_f32 v214, v52, v54
    v_mfma_f32_16x16x32_bf16 v[164:167], v[100:103], v[84:87], v[164:167]
    ds_read_b128 v[124:127], v8 offset:3072
    v_cvt_pk_bf16_f32 v215, v68, v70
    v_mfma_f32_16x16x32_bf16 v[168:171], v[100:103], v[88:91], v[168:171]
    ds_read_b64_tr_b16 v[132:133], v10 offset:16384
    buffer_store_dwordx4 v[212:215], v248, s[8:11], s91 offen offset:0 sc1
    v_mfma_f32_16x16x32_bf16 v[172:175], v[100:103], v[92:95], v[172:175]
    ds_read_b64_tr_b16 v[134:135], v10 offset:20480
    v_cvt_pk_bf16_f32 v252, v21, v23
    v_mfma_f32_16x16x32_bf16 v[176:179], v[104:107], v[80:83], v[176:179]
    ds_read_b64_tr_b16 v[136:137], v11 offset:16384
    v_cvt_pk_bf16_f32 v253, v37, v39
    v_mfma_f32_16x16x32_bf16 v[180:183], v[104:107], v[84:87], v[180:183]
    ds_read_b64_tr_b16 v[138:139], v11 offset:20480
    v_cvt_pk_bf16_f32 v254, v53, v55
    v_mfma_f32_16x16x32_bf16 v[184:187], v[104:107], v[88:91], v[184:187]
    ds_read_b64_tr_b16 v[140:141], v12 offset:16384
    v_cvt_pk_bf16_f32 v255, v69, v71
    v_mfma_f32_16x16x32_bf16 v[188:191], v[104:107], v[92:95], v[188:191]
    ds_read_b64_tr_b16 v[142:143], v12 offset:20480
    buffer_store_dwordx4 v[252:255], v248, s[8:11], s91 offen offset:128 sc1
    v_mfma_f32_16x16x32_bf16 v[192:195], v[108:111], v[80:83], v[192:195]
    v_cvt_pk_bf16_f32 v208, v28, v30
    v_cvt_pk_bf16_f32 v209, v44, v46
    v_mfma_f32_16x16x32_bf16 v[196:199], v[108:111], v[84:87], v[196:199]
    v_cvt_pk_bf16_f32 v210, v60, v62
    v_cvt_pk_bf16_f32 v211, v76, v78
    v_mfma_f32_16x16x32_bf16 v[200:203], v[108:111], v[88:91], v[200:203]
    buffer_store_dwordx4 v[208:211], v248, s[8:11], s91 offen offset:256 sc1
    v_cvt_pk_bf16_f32 v212, v29, v31
    v_mfma_f32_16x16x32_bf16 v[204:207], v[108:111], v[92:95], v[204:207]
    v_cvt_pk_bf16_f32 v213, v45, v47
    v_cvt_pk_bf16_f32 v214, v61, v63
    s_waitcnt lgkmcnt(0)
    v_mfma_f32_16x16x32_bf16 v[144:147], v[128:131], v[112:115], v[144:147]
    ds_read_b128 v[80:83], v8 offset:8192
    v_mfma_f32_16x16x32_bf16 v[148:151], v[128:131], v[116:119], v[148:151]
    ds_read_b64_tr_b16 v[96:97], v9 offset:24576
    v_mfma_f32_16x16x32_bf16 v[152:155], v[128:131], v[120:123], v[152:155]
    ds_read_b64_tr_b16 v[98:99], v9 offset:28672
    v_mfma_f32_16x16x32_bf16 v[156:159], v[128:131], v[124:127], v[156:159]
    ds_read_b128 v[84:87], v8 offset:9216
    v_mfma_f32_16x16x32_bf16 v[160:163], v[132:135], v[112:115], v[160:163]
    ds_read_b128 v[88:91], v8 offset:10240
    v_mfma_f32_16x16x32_bf16 v[164:167], v[132:135], v[116:119], v[164:167]
    ds_read_b128 v[92:95], v8 offset:11264
    v_mfma_f32_16x16x32_bf16 v[168:171], v[132:135], v[120:123], v[168:171]
    ds_read_b64_tr_b16 v[100:101], v10 offset:24576
    v_mfma_f32_16x16x32_bf16 v[172:175], v[132:135], v[124:127], v[172:175]
    ds_read_b64_tr_b16 v[102:103], v10 offset:28672
    v_mfma_f32_16x16x32_bf16 v[176:179], v[136:139], v[112:115], v[176:179]
    ds_read_b64_tr_b16 v[104:105], v11 offset:24576
    v_mfma_f32_16x16x32_bf16 v[180:183], v[136:139], v[116:119], v[180:183]
    ds_read_b64_tr_b16 v[106:107], v11 offset:28672
    v_mfma_f32_16x16x32_bf16 v[184:187], v[136:139], v[120:123], v[184:187]
    ds_read_b64_tr_b16 v[108:109], v12 offset:24576
    v_mfma_f32_16x16x32_bf16 v[188:191], v[136:139], v[124:127], v[188:191]
    ds_read_b64_tr_b16 v[110:111], v12 offset:28672
    v_mfma_f32_16x16x32_bf16 v[192:195], v[140:143], v[112:115], v[192:195]
    v_add_u32 v8, 4294877184, v8
    v_add_u32 v9, 4294877184, v9
    v_mfma_f32_16x16x32_bf16 v[196:199], v[140:143], v[116:119], v[196:199]
    v_add_u32 v10, 4294877184, v10
    v_add_u32 v11, 4294877184, v11
    v_mfma_f32_16x16x32_bf16 v[200:203], v[140:143], v[120:123], v[200:203]
    v_add_u32 v12, 4294877184, v12
    v_mfma_f32_16x16x32_bf16 v[204:207], v[140:143], v[124:127], v[204:207]
    v_cvt_pk_bf16_f32 v215, v77, v79
    buffer_store_dwordx4 v[212:215], v248, s[8:11], s91 offen offset:384 sc1
    s_waitcnt lgkmcnt(0)
    s_barrier
    v_mfma_f32_16x16x32_bf16 v[144:147], v[96:99], v[80:83], v[144:147]
    ds_read_b128 v[112:115], v8 offset:0
    v_mfma_f32_16x16x32_bf16 v[148:151], v[96:99], v[84:87], v[148:151]
    ds_read_b64_tr_b16 v[128:129], v9 offset:16384
    v_mfma_f32_16x16x32_bf16 v[152:155], v[96:99], v[88:91], v[152:155]
    ds_read_b64_tr_b16 v[130:131], v9 offset:20480
    v_mfma_f32_16x16x32_bf16 v[156:159], v[96:99], v[92:95], v[156:159]
    ds_read_b128 v[116:119], v8 offset:1024
    v_mfma_f32_16x16x32_bf16 v[160:163], v[100:103], v[80:83], v[160:163]
    ds_read_b128 v[120:123], v8 offset:2048
    v_mfma_f32_16x16x32_bf16 v[164:167], v[100:103], v[84:87], v[164:167]
    ds_read_b128 v[124:127], v8 offset:3072
    v_mfma_f32_16x16x32_bf16 v[168:171], v[100:103], v[88:91], v[168:171]
    ds_read_b64_tr_b16 v[132:133], v10 offset:16384
    v_mfma_f32_16x16x32_bf16 v[172:175], v[100:103], v[92:95], v[172:175]
    ds_read_b64_tr_b16 v[134:135], v10 offset:20480
    v_mfma_f32_16x16x32_bf16 v[176:179], v[104:107], v[80:83], v[176:179]
    ds_read_b64_tr_b16 v[136:137], v11 offset:16384
    v_mfma_f32_16x16x32_bf16 v[180:183], v[104:107], v[84:87], v[180:183]
    ds_read_b64_tr_b16 v[138:139], v11 offset:20480
    v_mfma_f32_16x16x32_bf16 v[184:187], v[104:107], v[88:91], v[184:187]
    ds_read_b64_tr_b16 v[140:141], v12 offset:16384
    v_mfma_f32_16x16x32_bf16 v[188:191], v[104:107], v[92:95], v[188:191]
    ds_read_b64_tr_b16 v[142:143], v12 offset:20480
    v_mfma_f32_16x16x32_bf16 v[192:195], v[108:111], v[80:83], v[192:195]
    v_mfma_f32_16x16x32_bf16 v[196:199], v[108:111], v[84:87], v[196:199]
    v_mfma_f32_16x16x32_bf16 v[200:203], v[108:111], v[88:91], v[200:203]
    v_mfma_f32_16x16x32_bf16 v[204:207], v[108:111], v[92:95], v[204:207]
    s_waitcnt lgkmcnt(0)
    v_mfma_f32_16x16x32_bf16 v[144:147], v[128:131], v[112:115], v[144:147]
    ds_read_b128 v[80:83], v8 offset:8192
    v_mfma_f32_16x16x32_bf16 v[148:151], v[128:131], v[116:119], v[148:151]
    ds_read_b64_tr_b16 v[96:97], v9 offset:24576
    v_mfma_f32_16x16x32_bf16 v[152:155], v[128:131], v[120:123], v[152:155]
    ds_read_b64_tr_b16 v[98:99], v9 offset:28672
    v_mfma_f32_16x16x32_bf16 v[156:159], v[128:131], v[124:127], v[156:159]
    ds_read_b128 v[84:87], v8 offset:9216
    v_mfma_f32_16x16x32_bf16 v[160:163], v[132:135], v[112:115], v[160:163]
    ds_read_b128 v[88:91], v8 offset:10240
    v_mfma_f32_16x16x32_bf16 v[164:167], v[132:135], v[116:119], v[164:167]
    ds_read_b128 v[92:95], v8 offset:11264
    v_mfma_f32_16x16x32_bf16 v[168:171], v[132:135], v[120:123], v[168:171]
    ds_read_b64_tr_b16 v[100:101], v10 offset:24576
    v_mfma_f32_16x16x32_bf16 v[172:175], v[132:135], v[124:127], v[172:175]
    ds_read_b64_tr_b16 v[102:103], v10 offset:28672
    v_mfma_f32_16x16x32_bf16 v[176:179], v[136:139], v[112:115], v[176:179]
    ds_read_b64_tr_b16 v[104:105], v11 offset:24576
    v_mfma_f32_16x16x32_bf16 v[180:183], v[136:139], v[116:119], v[180:183]
    ds_read_b64_tr_b16 v[106:107], v11 offset:28672
    v_mfma_f32_16x16x32_bf16 v[184:187], v[136:139], v[120:123], v[184:187]
    ds_read_b64_tr_b16 v[108:109], v12 offset:24576
    v_mfma_f32_16x16x32_bf16 v[188:191], v[136:139], v[124:127], v[188:191]
    ds_read_b64_tr_b16 v[110:111], v12 offset:28672
    v_mfma_f32_16x16x32_bf16 v[192:195], v[140:143], v[112:115], v[192:195]
    v_add_u32 v8, 122880, v8
    v_add_u32 v9, 122880, v9
    v_mfma_f32_16x16x32_bf16 v[196:199], v[140:143], v[116:119], v[196:199]
    v_add_u32 v10, 122880, v10
    v_add_u32 v11, 122880, v11
    v_mfma_f32_16x16x32_bf16 v[200:203], v[140:143], v[120:123], v[200:203]
    v_add_u32 v12, 122880, v12
    v_mfma_f32_16x16x32_bf16 v[204:207], v[140:143], v[124:127], v[204:207]
    s_waitcnt lgkmcnt(0)
    s_barrier
    v_mfma_f32_16x16x32_bf16 v[144:147], v[96:99], v[80:83], v[144:147]
    ds_read_b128 v[112:115], v8 offset:0
    v_mfma_f32_16x16x32_bf16 v[148:151], v[96:99], v[84:87], v[148:151]
    ds_read_b64_tr_b16 v[128:129], v9 offset:16384
    v_mfma_f32_16x16x32_bf16 v[152:155], v[96:99], v[88:91], v[152:155]
    ds_read_b64_tr_b16 v[130:131], v9 offset:20480
    v_mfma_f32_16x16x32_bf16 v[156:159], v[96:99], v[92:95], v[156:159]
    ds_read_b128 v[116:119], v8 offset:1024
    v_mfma_f32_16x16x32_bf16 v[160:163], v[100:103], v[80:83], v[160:163]
    ds_read_b128 v[120:123], v8 offset:2048
    v_mfma_f32_16x16x32_bf16 v[164:167], v[100:103], v[84:87], v[164:167]
    ds_read_b128 v[124:127], v8 offset:3072
    v_mfma_f32_16x16x32_bf16 v[168:171], v[100:103], v[88:91], v[168:171]
    ds_read_b64_tr_b16 v[132:133], v10 offset:16384
    v_mfma_f32_16x16x32_bf16 v[172:175], v[100:103], v[92:95], v[172:175]
    ds_read_b64_tr_b16 v[134:135], v10 offset:20480
    v_mfma_f32_16x16x32_bf16 v[176:179], v[104:107], v[80:83], v[176:179]
    ds_read_b64_tr_b16 v[136:137], v11 offset:16384
    v_mfma_f32_16x16x32_bf16 v[180:183], v[104:107], v[84:87], v[180:183]
    ds_read_b64_tr_b16 v[138:139], v11 offset:20480
    v_mfma_f32_16x16x32_bf16 v[184:187], v[104:107], v[88:91], v[184:187]
    ds_read_b64_tr_b16 v[140:141], v12 offset:16384
    v_mfma_f32_16x16x32_bf16 v[188:191], v[104:107], v[92:95], v[188:191]
    ds_read_b64_tr_b16 v[142:143], v12 offset:20480
    v_mfma_f32_16x16x32_bf16 v[192:195], v[108:111], v[80:83], v[192:195]
    v_mfma_f32_16x16x32_bf16 v[196:199], v[108:111], v[84:87], v[196:199]
    v_mfma_f32_16x16x32_bf16 v[200:203], v[108:111], v[88:91], v[200:203]
    v_mfma_f32_16x16x32_bf16 v[204:207], v[108:111], v[92:95], v[204:207]
    s_waitcnt vmcnt(0)
    s_waitcnt lgkmcnt(0)
    v_mfma_f32_16x16x32_bf16 v[144:147], v[128:131], v[112:115], v[144:147]
    ds_read_b128 v[80:83], v8 offset:8192
    v_mfma_f32_16x16x32_bf16 v[148:151], v[128:131], v[116:119], v[148:151]
    ds_read_b64_tr_b16 v[96:97], v9 offset:24576
    v_mfma_f32_16x16x32_bf16 v[152:155], v[128:131], v[120:123], v[152:155]
    ds_read_b64_tr_b16 v[98:99], v9 offset:28672
    v_mfma_f32_16x16x32_bf16 v[156:159], v[128:131], v[124:127], v[156:159]
    ds_read_b128 v[84:87], v8 offset:9216
    v_mfma_f32_16x16x32_bf16 v[160:163], v[132:135], v[112:115], v[160:163]
    ds_read_b128 v[88:91], v8 offset:10240
    v_mfma_f32_16x16x32_bf16 v[164:167], v[132:135], v[116:119], v[164:167]
    ds_read_b128 v[92:95], v8 offset:11264
    v_mfma_f32_16x16x32_bf16 v[168:171], v[132:135], v[120:123], v[168:171]
    ds_read_b64_tr_b16 v[100:101], v10 offset:24576
    v_mfma_f32_16x16x32_bf16 v[172:175], v[132:135], v[124:127], v[172:175]
    ds_read_b64_tr_b16 v[102:103], v10 offset:28672
    v_mfma_f32_16x16x32_bf16 v[176:179], v[136:139], v[112:115], v[176:179]
    ds_read_b64_tr_b16 v[104:105], v11 offset:24576
    v_mfma_f32_16x16x32_bf16 v[180:183], v[136:139], v[116:119], v[180:183]
    ds_read_b64_tr_b16 v[106:107], v11 offset:28672
    v_mfma_f32_16x16x32_bf16 v[184:187], v[136:139], v[120:123], v[184:187]
    ds_read_b64_tr_b16 v[108:109], v12 offset:24576
    v_mfma_f32_16x16x32_bf16 v[188:191], v[136:139], v[124:127], v[188:191]
    ds_read_b64_tr_b16 v[110:111], v12 offset:28672
    v_mfma_f32_16x16x32_bf16 v[192:195], v[140:143], v[112:115], v[192:195]
    v_add_u32 v8, 4294889472, v8
    v_add_u32 v9, 4294889472, v9
    v_mfma_f32_16x16x32_bf16 v[196:199], v[140:143], v[116:119], v[196:199]
    v_add_u32 v10, 4294889472, v10
    v_add_u32 v11, 4294889472, v11
    v_mfma_f32_16x16x32_bf16 v[200:203], v[140:143], v[120:123], v[200:203]
    v_add_u32 v12, 4294889472, v12
    v_mfma_f32_16x16x32_bf16 v[204:207], v[140:143], v[124:127], v[204:207]
    s_waitcnt lgkmcnt(0)
    s_barrier
    v_mfma_f32_16x16x32_bf16 v[144:147], v[96:99], v[80:83], v[144:147]
    ds_read_b128 v[112:115], v8 offset:0
    v_mfma_f32_16x16x32_bf16 v[148:151], v[96:99], v[84:87], v[148:151]
    ds_read_b64_tr_b16 v[128:129], v9 offset:16384
    v_mfma_f32_16x16x32_bf16 v[152:155], v[96:99], v[88:91], v[152:155]
    ds_read_b64_tr_b16 v[130:131], v9 offset:20480
    v_mfma_f32_16x16x32_bf16 v[156:159], v[96:99], v[92:95], v[156:159]
    ds_read_b128 v[116:119], v8 offset:1024
    v_mfma_f32_16x16x32_bf16 v[160:163], v[100:103], v[80:83], v[160:163]
    ds_read_b128 v[120:123], v8 offset:2048
    v_mfma_f32_16x16x32_bf16 v[164:167], v[100:103], v[84:87], v[164:167]
    ds_read_b128 v[124:127], v8 offset:3072
    v_mfma_f32_16x16x32_bf16 v[168:171], v[100:103], v[88:91], v[168:171]
    ds_read_b64_tr_b16 v[132:133], v10 offset:16384
    v_mfma_f32_16x16x32_bf16 v[172:175], v[100:103], v[92:95], v[172:175]
    ds_read_b64_tr_b16 v[134:135], v10 offset:20480
    v_mfma_f32_16x16x32_bf16 v[176:179], v[104:107], v[80:83], v[176:179]
    ds_read_b64_tr_b16 v[136:137], v11 offset:16384
    v_mfma_f32_16x16x32_bf16 v[180:183], v[104:107], v[84:87], v[180:183]
    ds_read_b64_tr_b16 v[138:139], v11 offset:20480
    v_mfma_f32_16x16x32_bf16 v[184:187], v[104:107], v[88:91], v[184:187]
    ds_read_b64_tr_b16 v[140:141], v12 offset:16384
    v_mfma_f32_16x16x32_bf16 v[188:191], v[104:107], v[92:95], v[188:191]
    ds_read_b64_tr_b16 v[142:143], v12 offset:20480
    v_mfma_f32_16x16x32_bf16 v[192:195], v[108:111], v[80:83], v[192:195]
    v_mfma_f32_16x16x32_bf16 v[196:199], v[108:111], v[84:87], v[196:199]
    v_mfma_f32_16x16x32_bf16 v[200:203], v[108:111], v[88:91], v[200:203]
    v_mfma_f32_16x16x32_bf16 v[204:207], v[108:111], v[92:95], v[204:207]
    s_waitcnt lgkmcnt(0)
    v_mfma_f32_16x16x32_bf16 v[144:147], v[128:131], v[112:115], v[144:147]
    ds_read_b128 v[80:83], v8 offset:8192
    v_mfma_f32_16x16x32_bf16 v[148:151], v[128:131], v[116:119], v[148:151]
    ds_read_b64_tr_b16 v[96:97], v9 offset:24576
    v_mfma_f32_16x16x32_bf16 v[152:155], v[128:131], v[120:123], v[152:155]
    ds_read_b64_tr_b16 v[98:99], v9 offset:28672
    v_mfma_f32_16x16x32_bf16 v[156:159], v[128:131], v[124:127], v[156:159]
    ds_read_b128 v[84:87], v8 offset:9216
    v_mfma_f32_16x16x32_bf16 v[160:163], v[132:135], v[112:115], v[160:163]
    ds_read_b128 v[88:91], v8 offset:10240
    v_mfma_f32_16x16x32_bf16 v[164:167], v[132:135], v[116:119], v[164:167]
    ds_read_b128 v[92:95], v8 offset:11264
    v_mfma_f32_16x16x32_bf16 v[168:171], v[132:135], v[120:123], v[168:171]
    ds_read_b64_tr_b16 v[100:101], v10 offset:24576
    v_mfma_f32_16x16x32_bf16 v[172:175], v[132:135], v[124:127], v[172:175]
    ds_read_b64_tr_b16 v[102:103], v10 offset:28672
    v_mfma_f32_16x16x32_bf16 v[176:179], v[136:139], v[112:115], v[176:179]
    ds_read_b64_tr_b16 v[104:105], v11 offset:24576
    v_mfma_f32_16x16x32_bf16 v[180:183], v[136:139], v[116:119], v[180:183]
    ds_read_b64_tr_b16 v[106:107], v11 offset:28672
    v_mfma_f32_16x16x32_bf16 v[184:187], v[136:139], v[120:123], v[184:187]
    ds_read_b64_tr_b16 v[108:109], v12 offset:24576
    v_mfma_f32_16x16x32_bf16 v[188:191], v[136:139], v[124:127], v[188:191]
    ds_read_b64_tr_b16 v[110:111], v12 offset:28672
    v_mfma_f32_16x16x32_bf16 v[192:195], v[140:143], v[112:115], v[192:195]
    v_add_u32 v8, 45056, v8
    v_add_u32 v9, 45056, v9
    v_mfma_f32_16x16x32_bf16 v[196:199], v[140:143], v[116:119], v[196:199]
    v_add_u32 v10, 45056, v10
    v_add_u32 v11, 45056, v11
    v_mfma_f32_16x16x32_bf16 v[200:203], v[140:143], v[120:123], v[200:203]
    v_add_u32 v12, 45056, v12
    v_mfma_f32_16x16x32_bf16 v[204:207], v[140:143], v[124:127], v[204:207]
    s_waitcnt lgkmcnt(0)
    s_barrier
    v_mfma_f32_16x16x32_bf16 v[144:147], v[96:99], v[80:83], v[144:147]
    ds_read_b128 v[112:115], v8 offset:0
    v_mfma_f32_16x16x32_bf16 v[148:151], v[96:99], v[84:87], v[148:151]
    ds_read_b64_tr_b16 v[128:129], v9 offset:16384
    v_mfma_f32_16x16x32_bf16 v[152:155], v[96:99], v[88:91], v[152:155]
    ds_read_b64_tr_b16 v[130:131], v9 offset:20480
    v_mfma_f32_16x16x32_bf16 v[156:159], v[96:99], v[92:95], v[156:159]
    ds_read_b128 v[116:119], v8 offset:1024
    v_mfma_f32_16x16x32_bf16 v[160:163], v[100:103], v[80:83], v[160:163]
    ds_read_b128 v[120:123], v8 offset:2048
    v_mfma_f32_16x16x32_bf16 v[164:167], v[100:103], v[84:87], v[164:167]
    ds_read_b128 v[124:127], v8 offset:3072
    v_mfma_f32_16x16x32_bf16 v[168:171], v[100:103], v[88:91], v[168:171]
    ds_read_b64_tr_b16 v[132:133], v10 offset:16384
    v_mfma_f32_16x16x32_bf16 v[172:175], v[100:103], v[92:95], v[172:175]
    ds_read_b64_tr_b16 v[134:135], v10 offset:20480
    v_mfma_f32_16x16x32_bf16 v[176:179], v[104:107], v[80:83], v[176:179]
    ds_read_b64_tr_b16 v[136:137], v11 offset:16384
    v_mfma_f32_16x16x32_bf16 v[180:183], v[104:107], v[84:87], v[180:183]
    ds_read_b64_tr_b16 v[138:139], v11 offset:20480
    v_mfma_f32_16x16x32_bf16 v[184:187], v[104:107], v[88:91], v[184:187]
    ds_read_b64_tr_b16 v[140:141], v12 offset:16384
    v_mfma_f32_16x16x32_bf16 v[188:191], v[104:107], v[92:95], v[188:191]
    ds_read_b64_tr_b16 v[142:143], v12 offset:20480
    v_mfma_f32_16x16x32_bf16 v[192:195], v[108:111], v[80:83], v[192:195]
    v_mfma_f32_16x16x32_bf16 v[196:199], v[108:111], v[84:87], v[196:199]
    v_mfma_f32_16x16x32_bf16 v[200:203], v[108:111], v[88:91], v[200:203]
    v_mfma_f32_16x16x32_bf16 v[204:207], v[108:111], v[92:95], v[204:207]
    s_waitcnt lgkmcnt(0)
    v_mfma_f32_16x16x32_bf16 v[144:147], v[128:131], v[112:115], v[144:147]
    ds_read_b128 v[80:83], v8 offset:8192
    v_mfma_f32_16x16x32_bf16 v[148:151], v[128:131], v[116:119], v[148:151]
    ds_read_b64_tr_b16 v[96:97], v9 offset:24576
    v_mfma_f32_16x16x32_bf16 v[152:155], v[128:131], v[120:123], v[152:155]
    ds_read_b64_tr_b16 v[98:99], v9 offset:28672
    v_mfma_f32_16x16x32_bf16 v[156:159], v[128:131], v[124:127], v[156:159]
    ds_read_b128 v[84:87], v8 offset:9216
    v_mfma_f32_16x16x32_bf16 v[160:163], v[132:135], v[112:115], v[160:163]
    ds_read_b128 v[88:91], v8 offset:10240
    v_mfma_f32_16x16x32_bf16 v[164:167], v[132:135], v[116:119], v[164:167]
    ds_read_b128 v[92:95], v8 offset:11264
    v_mfma_f32_16x16x32_bf16 v[168:171], v[132:135], v[120:123], v[168:171]
    ds_read_b64_tr_b16 v[100:101], v10 offset:24576
    v_mfma_f32_16x16x32_bf16 v[172:175], v[132:135], v[124:127], v[172:175]
    ds_read_b64_tr_b16 v[102:103], v10 offset:28672
    v_mfma_f32_16x16x32_bf16 v[176:179], v[136:139], v[112:115], v[176:179]
    ds_read_b64_tr_b16 v[104:105], v11 offset:24576
    v_mfma_f32_16x16x32_bf16 v[180:183], v[136:139], v[116:119], v[180:183]
    ds_read_b64_tr_b16 v[106:107], v11 offset:28672
    v_mfma_f32_16x16x32_bf16 v[184:187], v[136:139], v[120:123], v[184:187]
    ds_read_b64_tr_b16 v[108:109], v12 offset:24576
    v_mfma_f32_16x16x32_bf16 v[188:191], v[136:139], v[124:127], v[188:191]
    ds_read_b64_tr_b16 v[110:111], v12 offset:28672
    v_mfma_f32_16x16x32_bf16 v[192:195], v[140:143], v[112:115], v[192:195]
    v_add_u32 v8, 4294877184, v8
    v_add_u32 v9, 4294877184, v9
    v_mfma_f32_16x16x32_bf16 v[196:199], v[140:143], v[116:119], v[196:199]
    v_add_u32 v10, 4294877184, v10
    v_add_u32 v11, 4294877184, v11
    v_mfma_f32_16x16x32_bf16 v[200:203], v[140:143], v[120:123], v[200:203]
    v_add_u32 v12, 4294877184, v12
    v_mfma_f32_16x16x32_bf16 v[204:207], v[140:143], v[124:127], v[204:207]
    s_waitcnt lgkmcnt(0)
    s_barrier
    v_mfma_f32_16x16x32_bf16 v[144:147], v[96:99], v[80:83], v[144:147]
    ds_read_b128 v[112:115], v8 offset:0
    v_mfma_f32_16x16x32_bf16 v[148:151], v[96:99], v[84:87], v[148:151]
    ds_read_b64_tr_b16 v[128:129], v9 offset:16384
    v_mfma_f32_16x16x32_bf16 v[152:155], v[96:99], v[88:91], v[152:155]
    ds_read_b64_tr_b16 v[130:131], v9 offset:20480
    v_mfma_f32_16x16x32_bf16 v[156:159], v[96:99], v[92:95], v[156:159]
    ds_read_b128 v[116:119], v8 offset:1024
    v_mfma_f32_16x16x32_bf16 v[160:163], v[100:103], v[80:83], v[160:163]
    ds_read_b128 v[120:123], v8 offset:2048
    v_mfma_f32_16x16x32_bf16 v[164:167], v[100:103], v[84:87], v[164:167]
    ds_read_b128 v[124:127], v8 offset:3072
    v_mfma_f32_16x16x32_bf16 v[168:171], v[100:103], v[88:91], v[168:171]
    ds_read_b64_tr_b16 v[132:133], v10 offset:16384
    v_mfma_f32_16x16x32_bf16 v[172:175], v[100:103], v[92:95], v[172:175]
    ds_read_b64_tr_b16 v[134:135], v10 offset:20480
    v_mfma_f32_16x16x32_bf16 v[176:179], v[104:107], v[80:83], v[176:179]
    ds_read_b64_tr_b16 v[136:137], v11 offset:16384
    v_mfma_f32_16x16x32_bf16 v[180:183], v[104:107], v[84:87], v[180:183]
    ds_read_b64_tr_b16 v[138:139], v11 offset:20480
    v_mfma_f32_16x16x32_bf16 v[184:187], v[104:107], v[88:91], v[184:187]
    ds_read_b64_tr_b16 v[140:141], v12 offset:16384
    v_mfma_f32_16x16x32_bf16 v[188:191], v[104:107], v[92:95], v[188:191]
    ds_read_b64_tr_b16 v[142:143], v12 offset:20480
    v_mfma_f32_16x16x32_bf16 v[192:195], v[108:111], v[80:83], v[192:195]
    v_mfma_f32_16x16x32_bf16 v[196:199], v[108:111], v[84:87], v[196:199]
    v_mfma_f32_16x16x32_bf16 v[200:203], v[108:111], v[88:91], v[200:203]
    v_mfma_f32_16x16x32_bf16 v[204:207], v[108:111], v[92:95], v[204:207]
    s_waitcnt lgkmcnt(0)
    v_mfma_f32_16x16x32_bf16 v[144:147], v[128:131], v[112:115], v[144:147]
    ds_read_b128 v[80:83], v8 offset:8192
    v_mfma_f32_16x16x32_bf16 v[148:151], v[128:131], v[116:119], v[148:151]
    ds_read_b64_tr_b16 v[96:97], v9 offset:24576
    v_mfma_f32_16x16x32_bf16 v[152:155], v[128:131], v[120:123], v[152:155]
    ds_read_b64_tr_b16 v[98:99], v9 offset:28672
    v_mfma_f32_16x16x32_bf16 v[156:159], v[128:131], v[124:127], v[156:159]
    ds_read_b128 v[84:87], v8 offset:9216
    v_mfma_f32_16x16x32_bf16 v[160:163], v[132:135], v[112:115], v[160:163]
    ds_read_b128 v[88:91], v8 offset:10240
    v_mfma_f32_16x16x32_bf16 v[164:167], v[132:135], v[116:119], v[164:167]
    ds_read_b128 v[92:95], v8 offset:11264
    v_mfma_f32_16x16x32_bf16 v[168:171], v[132:135], v[120:123], v[168:171]
    ds_read_b64_tr_b16 v[100:101], v10 offset:24576
    v_mfma_f32_16x16x32_bf16 v[172:175], v[132:135], v[124:127], v[172:175]
    ds_read_b64_tr_b16 v[102:103], v10 offset:28672
    v_mfma_f32_16x16x32_bf16 v[176:179], v[136:139], v[112:115], v[176:179]
    ds_read_b64_tr_b16 v[104:105], v11 offset:24576
    v_mfma_f32_16x16x32_bf16 v[180:183], v[136:139], v[116:119], v[180:183]
    ds_read_b64_tr_b16 v[106:107], v11 offset:28672
    v_mfma_f32_16x16x32_bf16 v[184:187], v[136:139], v[120:123], v[184:187]
    ds_read_b64_tr_b16 v[108:109], v12 offset:24576
    v_mfma_f32_16x16x32_bf16 v[188:191], v[136:139], v[124:127], v[188:191]
    ds_read_b64_tr_b16 v[110:111], v12 offset:28672
    v_mfma_f32_16x16x32_bf16 v[192:195], v[140:143], v[112:115], v[192:195]
    v_add_u32 v8, 122880, v8
    v_add_u32 v9, 122880, v9
    v_mfma_f32_16x16x32_bf16 v[196:199], v[140:143], v[116:119], v[196:199]
    v_add_u32 v10, 122880, v10
    v_add_u32 v11, 122880, v11
    v_mfma_f32_16x16x32_bf16 v[200:203], v[140:143], v[120:123], v[200:203]
    v_add_u32 v12, 122880, v12
    v_mfma_f32_16x16x32_bf16 v[204:207], v[140:143], v[124:127], v[204:207]
    s_waitcnt lgkmcnt(0)
    s_barrier
    v_mfma_f32_16x16x32_bf16 v[144:147], v[96:99], v[80:83], v[144:147]
    ds_read_b128 v[112:115], v8 offset:0
    v_mfma_f32_16x16x32_bf16 v[148:151], v[96:99], v[84:87], v[148:151]
    ds_read_b64_tr_b16 v[128:129], v9 offset:16384
    v_mfma_f32_16x16x32_bf16 v[152:155], v[96:99], v[88:91], v[152:155]
    ds_read_b64_tr_b16 v[130:131], v9 offset:20480
    v_mfma_f32_16x16x32_bf16 v[156:159], v[96:99], v[92:95], v[156:159]
    ds_read_b128 v[116:119], v8 offset:1024
    v_mfma_f32_16x16x32_bf16 v[160:163], v[100:103], v[80:83], v[160:163]
    ds_read_b128 v[120:123], v8 offset:2048
    v_mfma_f32_16x16x32_bf16 v[164:167], v[100:103], v[84:87], v[164:167]
    ds_read_b128 v[124:127], v8 offset:3072
    v_mfma_f32_16x16x32_bf16 v[168:171], v[100:103], v[88:91], v[168:171]
    ds_read_b64_tr_b16 v[132:133], v10 offset:16384
    v_mfma_f32_16x16x32_bf16 v[172:175], v[100:103], v[92:95], v[172:175]
    ds_read_b64_tr_b16 v[134:135], v10 offset:20480
    v_mfma_f32_16x16x32_bf16 v[176:179], v[104:107], v[80:83], v[176:179]
    ds_read_b64_tr_b16 v[136:137], v11 offset:16384
    v_mfma_f32_16x16x32_bf16 v[180:183], v[104:107], v[84:87], v[180:183]
    ds_read_b64_tr_b16 v[138:139], v11 offset:20480
    v_mfma_f32_16x16x32_bf16 v[184:187], v[104:107], v[88:91], v[184:187]
    ds_read_b64_tr_b16 v[140:141], v12 offset:16384
    v_mfma_f32_16x16x32_bf16 v[188:191], v[104:107], v[92:95], v[188:191]
    ds_read_b64_tr_b16 v[142:143], v12 offset:20480
    v_mfma_f32_16x16x32_bf16 v[192:195], v[108:111], v[80:83], v[192:195]
    v_mfma_f32_16x16x32_bf16 v[196:199], v[108:111], v[84:87], v[196:199]
    v_mfma_f32_16x16x32_bf16 v[200:203], v[108:111], v[88:91], v[200:203]
    v_mfma_f32_16x16x32_bf16 v[204:207], v[108:111], v[92:95], v[204:207]
    s_waitcnt lgkmcnt(0)
    v_mfma_f32_16x16x32_bf16 v[144:147], v[128:131], v[112:115], v[144:147]
    ds_read_b128 v[80:83], v8 offset:8192
    v_mfma_f32_16x16x32_bf16 v[148:151], v[128:131], v[116:119], v[148:151]
    ds_read_b64_tr_b16 v[96:97], v9 offset:24576
    v_mfma_f32_16x16x32_bf16 v[152:155], v[128:131], v[120:123], v[152:155]
    ds_read_b64_tr_b16 v[98:99], v9 offset:28672
    v_mfma_f32_16x16x32_bf16 v[156:159], v[128:131], v[124:127], v[156:159]
    ds_read_b128 v[84:87], v8 offset:9216
    v_mfma_f32_16x16x32_bf16 v[160:163], v[132:135], v[112:115], v[160:163]
    ds_read_b128 v[88:91], v8 offset:10240
    v_mfma_f32_16x16x32_bf16 v[164:167], v[132:135], v[116:119], v[164:167]
    ds_read_b128 v[92:95], v8 offset:11264
    v_mfma_f32_16x16x32_bf16 v[168:171], v[132:135], v[120:123], v[168:171]
    ds_read_b64_tr_b16 v[100:101], v10 offset:24576
    v_mfma_f32_16x16x32_bf16 v[172:175], v[132:135], v[124:127], v[172:175]
    ds_read_b64_tr_b16 v[102:103], v10 offset:28672
    v_mfma_f32_16x16x32_bf16 v[176:179], v[136:139], v[112:115], v[176:179]
    ds_read_b64_tr_b16 v[104:105], v11 offset:24576
    v_mfma_f32_16x16x32_bf16 v[180:183], v[136:139], v[116:119], v[180:183]
    ds_read_b64_tr_b16 v[106:107], v11 offset:28672
    v_mfma_f32_16x16x32_bf16 v[184:187], v[136:139], v[120:123], v[184:187]
    ds_read_b64_tr_b16 v[108:109], v12 offset:24576
    v_mfma_f32_16x16x32_bf16 v[188:191], v[136:139], v[124:127], v[188:191]
    ds_read_b64_tr_b16 v[110:111], v12 offset:28672
    v_mfma_f32_16x16x32_bf16 v[192:195], v[140:143], v[112:115], v[192:195]
    v_add_u32 v8, 4294889472, v8
    v_add_u32 v9, 4294889472, v9
    v_mfma_f32_16x16x32_bf16 v[196:199], v[140:143], v[116:119], v[196:199]
    v_add_u32 v10, 4294889472, v10
    v_add_u32 v11, 4294889472, v11
    v_mfma_f32_16x16x32_bf16 v[200:203], v[140:143], v[120:123], v[200:203]
    v_add_u32 v12, 4294889472, v12
    v_mfma_f32_16x16x32_bf16 v[204:207], v[140:143], v[124:127], v[204:207]
    s_waitcnt lgkmcnt(0)
    s_barrier
    v_mfma_f32_16x16x32_bf16 v[144:147], v[96:99], v[80:83], v[144:147]
    ds_read_b128 v[112:115], v8 offset:0
    v_mfma_f32_16x16x32_bf16 v[148:151], v[96:99], v[84:87], v[148:151]
    ds_read_b64_tr_b16 v[128:129], v9 offset:16384
    v_mfma_f32_16x16x32_bf16 v[152:155], v[96:99], v[88:91], v[152:155]
    ds_read_b64_tr_b16 v[130:131], v9 offset:20480
    v_mfma_f32_16x16x32_bf16 v[156:159], v[96:99], v[92:95], v[156:159]
    ds_read_b128 v[116:119], v8 offset:1024
    v_mfma_f32_16x16x32_bf16 v[160:163], v[100:103], v[80:83], v[160:163]
    ds_read_b128 v[120:123], v8 offset:2048
    v_mfma_f32_16x16x32_bf16 v[164:167], v[100:103], v[84:87], v[164:167]
    ds_read_b128 v[124:127], v8 offset:3072
    v_mfma_f32_16x16x32_bf16 v[168:171], v[100:103], v[88:91], v[168:171]
    ds_read_b64_tr_b16 v[132:133], v10 offset:16384
    v_mfma_f32_16x16x32_bf16 v[172:175], v[100:103], v[92:95], v[172:175]
    ds_read_b64_tr_b16 v[134:135], v10 offset:20480
    v_mfma_f32_16x16x32_bf16 v[176:179], v[104:107], v[80:83], v[176:179]
    ds_read_b64_tr_b16 v[136:137], v11 offset:16384
    v_mfma_f32_16x16x32_bf16 v[180:183], v[104:107], v[84:87], v[180:183]
    ds_read_b64_tr_b16 v[138:139], v11 offset:20480
    v_mfma_f32_16x16x32_bf16 v[184:187], v[104:107], v[88:91], v[184:187]
    ds_read_b64_tr_b16 v[140:141], v12 offset:16384
    v_mfma_f32_16x16x32_bf16 v[188:191], v[104:107], v[92:95], v[188:191]
    ds_read_b64_tr_b16 v[142:143], v12 offset:20480
    v_mfma_f32_16x16x32_bf16 v[192:195], v[108:111], v[80:83], v[192:195]
    v_mfma_f32_16x16x32_bf16 v[196:199], v[108:111], v[84:87], v[196:199]
    v_mfma_f32_16x16x32_bf16 v[200:203], v[108:111], v[88:91], v[200:203]
    v_mfma_f32_16x16x32_bf16 v[204:207], v[108:111], v[92:95], v[204:207]
    s_waitcnt lgkmcnt(0)
    v_mfma_f32_16x16x32_bf16 v[144:147], v[128:131], v[112:115], v[144:147]
    ds_read_b128 v[80:83], v8 offset:8192
    v_mfma_f32_16x16x32_bf16 v[148:151], v[128:131], v[116:119], v[148:151]
    ds_read_b64_tr_b16 v[96:97], v9 offset:24576
    v_mfma_f32_16x16x32_bf16 v[152:155], v[128:131], v[120:123], v[152:155]
    ds_read_b64_tr_b16 v[98:99], v9 offset:28672
    v_mfma_f32_16x16x32_bf16 v[156:159], v[128:131], v[124:127], v[156:159]
    ds_read_b128 v[84:87], v8 offset:9216
    v_mfma_f32_16x16x32_bf16 v[160:163], v[132:135], v[112:115], v[160:163]
    ds_read_b128 v[88:91], v8 offset:10240
    v_mfma_f32_16x16x32_bf16 v[164:167], v[132:135], v[116:119], v[164:167]
    ds_read_b128 v[92:95], v8 offset:11264
    v_mfma_f32_16x16x32_bf16 v[168:171], v[132:135], v[120:123], v[168:171]
    ds_read_b64_tr_b16 v[100:101], v10 offset:24576
    v_mfma_f32_16x16x32_bf16 v[172:175], v[132:135], v[124:127], v[172:175]
    ds_read_b64_tr_b16 v[102:103], v10 offset:28672
    v_mfma_f32_16x16x32_bf16 v[176:179], v[136:139], v[112:115], v[176:179]
    ds_read_b64_tr_b16 v[104:105], v11 offset:24576
    v_mfma_f32_16x16x32_bf16 v[180:183], v[136:139], v[116:119], v[180:183]
    ds_read_b64_tr_b16 v[106:107], v11 offset:28672
    v_mfma_f32_16x16x32_bf16 v[184:187], v[136:139], v[120:123], v[184:187]
    ds_read_b64_tr_b16 v[108:109], v12 offset:24576
    v_mfma_f32_16x16x32_bf16 v[188:191], v[136:139], v[124:127], v[188:191]
    ds_read_b64_tr_b16 v[110:111], v12 offset:28672
    v_mfma_f32_16x16x32_bf16 v[192:195], v[140:143], v[112:115], v[192:195]
    v_add_u32 v8, 45056, v8
    v_add_u32 v9, 45056, v9
    v_mfma_f32_16x16x32_bf16 v[196:199], v[140:143], v[116:119], v[196:199]
    v_add_u32 v10, 45056, v10
    v_add_u32 v11, 45056, v11
    v_mfma_f32_16x16x32_bf16 v[200:203], v[140:143], v[120:123], v[200:203]
    v_add_u32 v12, 45056, v12
    v_mfma_f32_16x16x32_bf16 v[204:207], v[140:143], v[124:127], v[204:207]
    s_waitcnt lgkmcnt(0)
    s_barrier
    v_mfma_f32_16x16x32_bf16 v[144:147], v[96:99], v[80:83], v[144:147]
    ds_read_b128 v[112:115], v8 offset:0
    v_mfma_f32_16x16x32_bf16 v[148:151], v[96:99], v[84:87], v[148:151]
    ds_read_b64_tr_b16 v[128:129], v9 offset:16384
    v_mfma_f32_16x16x32_bf16 v[152:155], v[96:99], v[88:91], v[152:155]
    ds_read_b64_tr_b16 v[130:131], v9 offset:20480
    v_mfma_f32_16x16x32_bf16 v[156:159], v[96:99], v[92:95], v[156:159]
    ds_read_b128 v[116:119], v8 offset:1024
    v_mfma_f32_16x16x32_bf16 v[160:163], v[100:103], v[80:83], v[160:163]
    ds_read_b128 v[120:123], v8 offset:2048
    v_mfma_f32_16x16x32_bf16 v[164:167], v[100:103], v[84:87], v[164:167]
    ds_read_b128 v[124:127], v8 offset:3072
    v_mfma_f32_16x16x32_bf16 v[168:171], v[100:103], v[88:91], v[168:171]
    ds_read_b64_tr_b16 v[132:133], v10 offset:16384
    v_mfma_f32_16x16x32_bf16 v[172:175], v[100:103], v[92:95], v[172:175]
    ds_read_b64_tr_b16 v[134:135], v10 offset:20480
    v_mfma_f32_16x16x32_bf16 v[176:179], v[104:107], v[80:83], v[176:179]
    ds_read_b64_tr_b16 v[136:137], v11 offset:16384
    v_mfma_f32_16x16x32_bf16 v[180:183], v[104:107], v[84:87], v[180:183]
    ds_read_b64_tr_b16 v[138:139], v11 offset:20480
    v_mfma_f32_16x16x32_bf16 v[184:187], v[104:107], v[88:91], v[184:187]
    ds_read_b64_tr_b16 v[140:141], v12 offset:16384
    v_mfma_f32_16x16x32_bf16 v[188:191], v[104:107], v[92:95], v[188:191]
    ds_read_b64_tr_b16 v[142:143], v12 offset:20480
    v_mfma_f32_16x16x32_bf16 v[192:195], v[108:111], v[80:83], v[192:195]
    v_mfma_f32_16x16x32_bf16 v[196:199], v[108:111], v[84:87], v[196:199]
    v_mfma_f32_16x16x32_bf16 v[200:203], v[108:111], v[88:91], v[200:203]
    v_mfma_f32_16x16x32_bf16 v[204:207], v[108:111], v[92:95], v[204:207]
    s_waitcnt lgkmcnt(0)
    v_mfma_f32_16x16x32_bf16 v[144:147], v[128:131], v[112:115], v[144:147]
    ds_read_b128 v[80:83], v8 offset:8192
    v_lshrrev_b32 v220, 4, v0
    v_mfma_f32_16x16x32_bf16 v[148:151], v[128:131], v[116:119], v[148:151]
    ds_read_b64_tr_b16 v[96:97], v9 offset:24576
    v_lshrrev_b32 v221, 2, v0
    v_mfma_f32_16x16x32_bf16 v[152:155], v[128:131], v[120:123], v[152:155]
    ds_read_b64_tr_b16 v[98:99], v9 offset:28672
    v_and_b32 v221, 3, v221
    v_mfma_f32_16x16x32_bf16 v[156:159], v[128:131], v[124:127], v[156:159]
    ds_read_b128 v[84:87], v8 offset:9216
    v_and_b32 v222, 3, v0
    v_mfma_f32_16x16x32_bf16 v[160:163], v[132:135], v[112:115], v[160:163]
    ds_read_b128 v[88:91], v8 offset:10240
    v_and_b32 v223, 15, v0
    v_mfma_f32_16x16x32_bf16 v[164:167], v[132:135], v[116:119], v[164:167]
    ds_read_b128 v[92:95], v8 offset:11264
    v_and_b32 v216, 1, v220
    v_mfma_f32_16x16x32_bf16 v[168:171], v[132:135], v[120:123], v[168:171]
    ds_read_b64_tr_b16 v[100:101], v10 offset:24576
    v_lshlrev_b32 v216, 2, v216
    v_mfma_f32_16x16x32_bf16 v[172:175], v[132:135], v[124:127], v[172:175]
    ds_read_b64_tr_b16 v[102:103], v10 offset:28672
    v_add_u32 v216, v216, v221
    v_mfma_f32_16x16x32_bf16 v[176:179], v[136:139], v[112:115], v[176:179]
    ds_read_b64_tr_b16 v[104:105], v11 offset:24576
    v_lshrrev_b32 v217, 1, v220
    v_mfma_f32_16x16x32_bf16 v[180:183], v[136:139], v[116:119], v[180:183]
    ds_read_b64_tr_b16 v[106:107], v11 offset:28672
    v_lshlrev_b32 v217, 8, v217
    v_mfma_f32_16x16x32_bf16 v[184:187], v[136:139], v[120:123], v[184:187]
    ds_read_b64_tr_b16 v[108:109], v12 offset:24576
    v_lshrrev_b32 v218, 1, v222
    v_mfma_f32_16x16x32_bf16 v[188:191], v[136:139], v[124:127], v[188:191]
    ds_read_b64_tr_b16 v[110:111], v12 offset:28672
    v_lshlrev_b32 v218, 7, v218
    v_mfma_f32_16x16x32_bf16 v[192:195], v[140:143], v[112:115], v[192:195]
    v_add_u32 v8, 4294877184, v8
    v_add_u32 v9, 4294877184, v9
    v_add_u32 v217, v217, v218
    v_mfma_f32_16x16x32_bf16 v[196:199], v[140:143], v[116:119], v[196:199]
    v_add_u32 v10, 4294877184, v10
    v_add_u32 v11, 4294877184, v11
    v_lshlrev_b32 v218, 4, v216
    v_mfma_f32_16x16x32_bf16 v[200:203], v[140:143], v[120:123], v[200:203]
    v_add_u32 v12, 4294877184, v12
    v_add_u32 v217, v217, v218
    v_mfma_f32_16x16x32_bf16 v[204:207], v[140:143], v[124:127], v[204:207]
    v_and_b32 v218, 1, v222
    v_lshlrev_b32 v218, 3, v218
    s_waitcnt lgkmcnt(0)
    s_barrier
    v_mfma_f32_16x16x32_bf16 v[144:147], v[96:99], v[80:83], v[144:147]
    ds_read_b128 v[112:115], v8 offset:0
    v_mfma_f32_16x16x32_bf16 v[148:151], v[96:99], v[84:87], v[148:151]
    ds_read_b64_tr_b16 v[128:129], v9 offset:16384
    v_mfma_f32_16x16x32_bf16 v[152:155], v[96:99], v[88:91], v[152:155]
    ds_read_b64_tr_b16 v[130:131], v9 offset:20480
    v_mfma_f32_16x16x32_bf16 v[156:159], v[96:99], v[92:95], v[156:159]
    ds_read_b128 v[116:119], v8 offset:1024
    v_add_u32 v217, v217, v218
    v_mfma_f32_16x16x32_bf16 v[160:163], v[100:103], v[80:83], v[160:163]
    ds_read_b128 v[120:123], v8 offset:2048
    s_lshl_b32 s87, s89, 12
    v_mfma_f32_16x16x32_bf16 v[164:167], v[100:103], v[84:87], v[164:167]
    ds_read_b128 v[124:127], v8 offset:3072
    s_add_u32 s87, s87, 45056
    v_mfma_f32_16x16x32_bf16 v[168:171], v[100:103], v[88:91], v[168:171]
    ds_read_b64_tr_b16 v[132:133], v10 offset:16384
    v_add_u32 v2, s87, v217
    v_mfma_f32_16x16x32_bf16 v[172:175], v[100:103], v[92:95], v[172:175]
    ds_read_b64_tr_b16 v[134:135], v10 offset:20480
    v_lshrrev_b32 v216, 1, v223
    v_mfma_f32_16x16x32_bf16 v[176:179], v[104:107], v[80:83], v[176:179]
    ds_read_b64_tr_b16 v[136:137], v11 offset:16384
    s_lshl_b32 s87, s90, 13
    v_mfma_f32_16x16x32_bf16 v[180:183], v[104:107], v[84:87], v[180:183]
    ds_read_b64_tr_b16 v[138:139], v11 offset:20480
    s_add_u32 s87, s87, 45056
    v_mfma_f32_16x16x32_bf16 v[184:187], v[104:107], v[88:91], v[184:187]
    ds_read_b64_tr_b16 v[140:141], v12 offset:16384
    v_lshlrev_b32 v217, 7, v223
    v_mfma_f32_16x16x32_bf16 v[188:191], v[104:107], v[92:95], v[188:191]
    ds_read_b64_tr_b16 v[142:143], v12 offset:20480
    v_add_u32 v217, s87, v217
    v_mfma_f32_16x16x32_bf16 v[192:195], v[108:111], v[80:83], v[192:195]
    v_or_b32 v218, 0, v220
    v_xor_b32 v218, v218, v216
    v_mfma_f32_16x16x32_bf16 v[196:199], v[108:111], v[84:87], v[196:199]
    v_lshlrev_b32 v218, 4, v218
    v_add_u32 v3, v217, v218
    v_mfma_f32_16x16x32_bf16 v[200:203], v[108:111], v[88:91], v[200:203]
    v_or_b32 v218, 4, v220
    v_xor_b32 v218, v218, v216
    v_mfma_f32_16x16x32_bf16 v[204:207], v[108:111], v[92:95], v[204:207]
    v_lshlrev_b32 v218, 4, v218
    v_add_u32 v4, v217, v218
    s_waitcnt lgkmcnt(0)
    v_mfma_f32_16x16x32_bf16 v[144:147], v[128:131], v[112:115], v[144:147]
    ds_read_b128 v[80:83], v8 offset:8192
    v_mfma_f32_16x16x32_bf16 v[148:151], v[128:131], v[116:119], v[148:151]
    ds_read_b64_tr_b16 v[96:97], v9 offset:24576
    v_mfma_f32_16x16x32_bf16 v[152:155], v[128:131], v[120:123], v[152:155]
    ds_read_b64_tr_b16 v[98:99], v9 offset:28672
    v_mfma_f32_16x16x32_bf16 v[156:159], v[128:131], v[124:127], v[156:159]
    ds_read_b128 v[84:87], v8 offset:9216
    v_mfma_f32_16x16x32_bf16 v[160:163], v[132:135], v[112:115], v[160:163]
    ds_read_b128 v[88:91], v8 offset:10240
    v_mfma_f32_16x16x32_bf16 v[164:167], v[132:135], v[116:119], v[164:167]
    ds_read_b128 v[92:95], v8 offset:11264
    v_mfma_f32_16x16x32_bf16 v[168:171], v[132:135], v[120:123], v[168:171]
    ds_read_b64_tr_b16 v[100:101], v10 offset:24576
    v_mfma_f32_16x16x32_bf16 v[172:175], v[132:135], v[124:127], v[172:175]
    ds_read_b64_tr_b16 v[102:103], v10 offset:28672
    v_mfma_f32_16x16x32_bf16 v[176:179], v[136:139], v[112:115], v[176:179]
    ds_read_b64_tr_b16 v[104:105], v11 offset:24576
    v_mfma_f32_16x16x32_bf16 v[180:183], v[136:139], v[116:119], v[180:183]
    ds_read_b64_tr_b16 v[106:107], v11 offset:28672
    v_mfma_f32_16x16x32_bf16 v[184:187], v[136:139], v[120:123], v[184:187]
    ds_read_b64_tr_b16 v[108:109], v12 offset:24576
    v_mfma_f32_16x16x32_bf16 v[188:191], v[136:139], v[124:127], v[188:191]
    ds_read_b64_tr_b16 v[110:111], v12 offset:28672
    v_mfma_f32_16x16x32_bf16 v[192:195], v[140:143], v[112:115], v[192:195]
    v_add_u32 v8, 122880, v8
    v_add_u32 v9, 122880, v9
    v_mfma_f32_16x16x32_bf16 v[196:199], v[140:143], v[116:119], v[196:199]
    v_add_u32 v10, 122880, v10
    v_add_u32 v11, 122880, v11
    v_mfma_f32_16x16x32_bf16 v[200:203], v[140:143], v[120:123], v[200:203]
    v_add_u32 v12, 122880, v12
    v_mfma_f32_16x16x32_bf16 v[204:207], v[140:143], v[124:127], v[204:207]
    s_waitcnt lgkmcnt(0)
    s_barrier
    v_mfma_f32_16x16x32_bf16 v[144:147], v[96:99], v[80:83], v[144:147]
    ds_read_b128 v[112:115], v8 offset:0
    v_mfma_f32_16x16x32_bf16 v[148:151], v[96:99], v[84:87], v[148:151]
    ds_read_b64_tr_b16 v[128:129], v9 offset:16384
    v_mfma_f32_16x16x32_bf16 v[152:155], v[96:99], v[88:91], v[152:155]
    ds_read_b64_tr_b16 v[130:131], v9 offset:20480
    v_mfma_f32_16x16x32_bf16 v[156:159], v[96:99], v[92:95], v[156:159]
    ds_read_b128 v[116:119], v8 offset:1024
    v_mfma_f32_16x16x32_bf16 v[160:163], v[100:103], v[80:83], v[160:163]
    ds_read_b128 v[120:123], v8 offset:2048
    v_mfma_f32_16x16x32_bf16 v[164:167], v[100:103], v[84:87], v[164:167]
    ds_read_b128 v[124:127], v8 offset:3072
    v_mfma_f32_16x16x32_bf16 v[168:171], v[100:103], v[88:91], v[168:171]
    ds_read_b64_tr_b16 v[132:133], v10 offset:16384
    v_mfma_f32_16x16x32_bf16 v[172:175], v[100:103], v[92:95], v[172:175]
    ds_read_b64_tr_b16 v[134:135], v10 offset:20480
    v_mfma_f32_16x16x32_bf16 v[176:179], v[104:107], v[80:83], v[176:179]
    ds_read_b64_tr_b16 v[136:137], v11 offset:16384
    v_mfma_f32_16x16x32_bf16 v[180:183], v[104:107], v[84:87], v[180:183]
    ds_read_b64_tr_b16 v[138:139], v11 offset:20480
    v_mfma_f32_16x16x32_bf16 v[184:187], v[104:107], v[88:91], v[184:187]
    ds_read_b64_tr_b16 v[140:141], v12 offset:16384
    v_mfma_f32_16x16x32_bf16 v[188:191], v[104:107], v[92:95], v[188:191]
    ds_read_b64_tr_b16 v[142:143], v12 offset:20480
    v_mfma_f32_16x16x32_bf16 v[192:195], v[108:111], v[80:83], v[192:195]
    v_mfma_f32_16x16x32_bf16 v[196:199], v[108:111], v[84:87], v[196:199]
    v_mfma_f32_16x16x32_bf16 v[200:203], v[108:111], v[88:91], v[200:203]
    v_mfma_f32_16x16x32_bf16 v[204:207], v[108:111], v[92:95], v[204:207]
    s_waitcnt lgkmcnt(0)
    v_mfma_f32_16x16x32_bf16 v[144:147], v[128:131], v[112:115], v[144:147]
    ds_read_b128 v[80:83], v8 offset:8192
    v_mfma_f32_16x16x32_bf16 v[148:151], v[128:131], v[116:119], v[148:151]
    ds_read_b64_tr_b16 v[96:97], v9 offset:24576
    v_mfma_f32_16x16x32_bf16 v[152:155], v[128:131], v[120:123], v[152:155]
    ds_read_b64_tr_b16 v[98:99], v9 offset:28672
    v_mfma_f32_16x16x32_bf16 v[156:159], v[128:131], v[124:127], v[156:159]
    ds_read_b128 v[84:87], v8 offset:9216
    v_mfma_f32_16x16x32_bf16 v[160:163], v[132:135], v[112:115], v[160:163]
    ds_read_b128 v[88:91], v8 offset:10240
    v_mfma_f32_16x16x32_bf16 v[164:167], v[132:135], v[116:119], v[164:167]
    ds_read_b128 v[92:95], v8 offset:11264
    v_mfma_f32_16x16x32_bf16 v[168:171], v[132:135], v[120:123], v[168:171]
    ds_read_b64_tr_b16 v[100:101], v10 offset:24576
    v_mfma_f32_16x16x32_bf16 v[172:175], v[132:135], v[124:127], v[172:175]
    ds_read_b64_tr_b16 v[102:103], v10 offset:28672
    v_mfma_f32_16x16x32_bf16 v[176:179], v[136:139], v[112:115], v[176:179]
    ds_read_b64_tr_b16 v[104:105], v11 offset:24576
    v_mfma_f32_16x16x32_bf16 v[180:183], v[136:139], v[116:119], v[180:183]
    ds_read_b64_tr_b16 v[106:107], v11 offset:28672
    v_mfma_f32_16x16x32_bf16 v[184:187], v[136:139], v[120:123], v[184:187]
    ds_read_b64_tr_b16 v[108:109], v12 offset:24576
    v_mfma_f32_16x16x32_bf16 v[188:191], v[136:139], v[124:127], v[188:191]
    ds_read_b64_tr_b16 v[110:111], v12 offset:28672
    v_mfma_f32_16x16x32_bf16 v[192:195], v[140:143], v[112:115], v[192:195]
    v_mfma_f32_16x16x32_bf16 v[196:199], v[140:143], v[116:119], v[196:199]
    v_mfma_f32_16x16x32_bf16 v[200:203], v[140:143], v[120:123], v[200:203]
    v_mfma_f32_16x16x32_bf16 v[204:207], v[140:143], v[124:127], v[204:207]
    s_waitcnt lgkmcnt(0)
    s_barrier
    v_mfma_f32_16x16x32_bf16 v[144:147], v[96:99], v[80:83], v[144:147]
    ds_read_b64_tr_b16 v[112:113], v2 offset:0
    v_mfma_f32_16x16x32_bf16 v[148:151], v[96:99], v[84:87], v[148:151]
    ds_read_b64_tr_b16 v[114:115], v2 offset:512
    v_mfma_f32_16x16x32_bf16 v[152:155], v[96:99], v[88:91], v[152:155]
    ds_read_b128 v[128:131], v3 offset:16384
    v_mfma_f32_16x16x32_bf16 v[156:159], v[96:99], v[92:95], v[156:159]
    ds_read_b64_tr_b16 v[116:117], v2 offset:1024
    v_mfma_f32_16x16x32_bf16 v[160:163], v[100:103], v[80:83], v[160:163]
    ds_read_b64_tr_b16 v[118:119], v2 offset:1536
    v_mfma_f32_16x16x32_bf16 v[164:167], v[100:103], v[84:87], v[164:167]
    ds_read_b64_tr_b16 v[120:121], v2 offset:2048
    v_mfma_f32_16x16x32_bf16 v[168:171], v[100:103], v[88:91], v[168:171]
    ds_read_b64_tr_b16 v[122:123], v2 offset:2560
    v_mfma_f32_16x16x32_bf16 v[172:175], v[100:103], v[92:95], v[172:175]
    ds_read_b64_tr_b16 v[124:125], v2 offset:3072
    v_mfma_f32_16x16x32_bf16 v[176:179], v[104:107], v[80:83], v[176:179]
    ds_read_b64_tr_b16 v[126:127], v2 offset:3584
    v_mfma_f32_16x16x32_bf16 v[180:183], v[104:107], v[84:87], v[180:183]
    ds_read_b128 v[132:135], v3 offset:18432
    v_mfma_f32_16x16x32_bf16 v[184:187], v[104:107], v[88:91], v[184:187]
    ds_read_b128 v[136:139], v3 offset:20480
    v_mfma_f32_16x16x32_bf16 v[188:191], v[104:107], v[92:95], v[188:191]
    ds_read_b128 v[140:143], v3 offset:22528
    v_mfma_f32_16x16x32_bf16 v[192:195], v[108:111], v[80:83], v[192:195]
    v_mfma_f32_16x16x32_bf16 v[196:199], v[108:111], v[84:87], v[196:199]
    v_mfma_f32_16x16x32_bf16 v[200:203], v[108:111], v[88:91], v[200:203]
    v_mfma_f32_16x16x32_bf16 v[204:207], v[108:111], v[92:95], v[204:207]
    s_waitcnt lgkmcnt(0)
    v_mfma_f32_16x16x32_bf16 v[16:19], v[128:131], v[112:115], 0
    ds_read_b64_tr_b16 v[80:81], v2 offset:8192
    v_mfma_f32_16x16x32_bf16 v[20:23], v[128:131], v[116:119], 0
    ds_read_b64_tr_b16 v[82:83], v2 offset:8704
    v_mfma_f32_16x16x32_bf16 v[24:27], v[128:131], v[120:123], 0
    ds_read_b128 v[96:99], v4 offset:16384
    v_mfma_f32_16x16x32_bf16 v[28:31], v[128:131], v[124:127], 0
    ds_read_b64_tr_b16 v[84:85], v2 offset:9216
    v_mfma_f32_16x16x32_bf16 v[32:35], v[132:135], v[112:115], 0
    ds_read_b64_tr_b16 v[86:87], v2 offset:9728
    v_mfma_f32_16x16x32_bf16 v[36:39], v[132:135], v[116:119], 0
    ds_read_b64_tr_b16 v[88:89], v2 offset:10240
    v_mfma_f32_16x16x32_bf16 v[40:43], v[132:135], v[120:123], 0
    ds_read_b64_tr_b16 v[90:91], v2 offset:10752
    v_mfma_f32_16x16x32_bf16 v[44:47], v[132:135], v[124:127], 0
    ds_read_b64_tr_b16 v[92:93], v2 offset:11264
    v_mfma_f32_16x16x32_bf16 v[48:51], v[136:139], v[112:115], 0
    ds_read_b64_tr_b16 v[94:95], v2 offset:11776
    v_mfma_f32_16x16x32_bf16 v[52:55], v[136:139], v[116:119], 0
    ds_read_b128 v[100:103], v4 offset:18432
    v_mfma_f32_16x16x32_bf16 v[56:59], v[136:139], v[120:123], 0
    ds_read_b128 v[104:107], v4 offset:20480
    v_mfma_f32_16x16x32_bf16 v[60:63], v[136:139], v[124:127], 0
    ds_read_b128 v[108:111], v4 offset:22528
    v_mfma_f32_16x16x32_bf16 v[64:67], v[140:143], v[112:115], 0
    v_add_u32 v2, 45056, v2
    v_add_u32 v3, 45056, v3
    v_mfma_f32_16x16x32_bf16 v[68:71], v[140:143], v[116:119], 0
    v_add_u32 v4, 45056, v4
    v_mfma_f32_16x16x32_bf16 v[72:75], v[140:143], v[120:123], 0
    v_mfma_f32_16x16x32_bf16 v[76:79], v[140:143], v[124:127], 0
    s_waitcnt lgkmcnt(0)
    s_barrier
    v_mfma_f32_16x16x32_bf16 v[16:19], v[96:99], v[80:83], v[16:19]
    ds_read_b64_tr_b16 v[112:113], v2 offset:0
    v_mfma_f32_16x16x32_bf16 v[20:23], v[96:99], v[84:87], v[20:23]
    ds_read_b64_tr_b16 v[114:115], v2 offset:512
    v_mfma_f32_16x16x32_bf16 v[24:27], v[96:99], v[88:91], v[24:27]
    ds_read_b128 v[128:131], v3 offset:16384
    v_mfma_f32_16x16x32_bf16 v[28:31], v[96:99], v[92:95], v[28:31]
    ds_read_b64_tr_b16 v[116:117], v2 offset:1024
    v_mfma_f32_16x16x32_bf16 v[32:35], v[100:103], v[80:83], v[32:35]
    ds_read_b64_tr_b16 v[118:119], v2 offset:1536
    v_mfma_f32_16x16x32_bf16 v[36:39], v[100:103], v[84:87], v[36:39]
    ds_read_b64_tr_b16 v[120:121], v2 offset:2048
    v_mfma_f32_16x16x32_bf16 v[40:43], v[100:103], v[88:91], v[40:43]
    ds_read_b64_tr_b16 v[122:123], v2 offset:2560
    v_mfma_f32_16x16x32_bf16 v[44:47], v[100:103], v[92:95], v[44:47]
    ds_read_b64_tr_b16 v[124:125], v2 offset:3072
    v_mfma_f32_16x16x32_bf16 v[48:51], v[104:107], v[80:83], v[48:51]
    ds_read_b64_tr_b16 v[126:127], v2 offset:3584
    v_mfma_f32_16x16x32_bf16 v[52:55], v[104:107], v[84:87], v[52:55]
    ds_read_b128 v[132:135], v3 offset:18432
    v_mfma_f32_16x16x32_bf16 v[56:59], v[104:107], v[88:91], v[56:59]
    ds_read_b128 v[136:139], v3 offset:20480
    v_mfma_f32_16x16x32_bf16 v[60:63], v[104:107], v[92:95], v[60:63]
    ds_read_b128 v[140:143], v3 offset:22528
    v_mfma_f32_16x16x32_bf16 v[64:67], v[108:111], v[80:83], v[64:67]
    v_mfma_f32_16x16x32_bf16 v[68:71], v[108:111], v[84:87], v[68:71]
    v_mfma_f32_16x16x32_bf16 v[72:75], v[108:111], v[88:91], v[72:75]
    v_mfma_f32_16x16x32_bf16 v[76:79], v[108:111], v[92:95], v[76:79]
    s_waitcnt lgkmcnt(0)
    v_mfma_f32_16x16x32_bf16 v[16:19], v[128:131], v[112:115], v[16:19]
    ds_read_b64_tr_b16 v[80:81], v2 offset:8192
    v_mfma_f32_16x16x32_bf16 v[20:23], v[128:131], v[116:119], v[20:23]
    ds_read_b64_tr_b16 v[82:83], v2 offset:8704
    v_mfma_f32_16x16x32_bf16 v[24:27], v[128:131], v[120:123], v[24:27]
    ds_read_b128 v[96:99], v4 offset:16384
    v_mfma_f32_16x16x32_bf16 v[28:31], v[128:131], v[124:127], v[28:31]
    ds_read_b64_tr_b16 v[84:85], v2 offset:9216
    v_mfma_f32_16x16x32_bf16 v[32:35], v[132:135], v[112:115], v[32:35]
    ds_read_b64_tr_b16 v[86:87], v2 offset:9728
    v_mfma_f32_16x16x32_bf16 v[36:39], v[132:135], v[116:119], v[36:39]
    ds_read_b64_tr_b16 v[88:89], v2 offset:10240
    v_mfma_f32_16x16x32_bf16 v[40:43], v[132:135], v[120:123], v[40:43]
    ds_read_b64_tr_b16 v[90:91], v2 offset:10752
    v_mfma_f32_16x16x32_bf16 v[44:47], v[132:135], v[124:127], v[44:47]
    ds_read_b64_tr_b16 v[92:93], v2 offset:11264
    v_mfma_f32_16x16x32_bf16 v[48:51], v[136:139], v[112:115], v[48:51]
    ds_read_b64_tr_b16 v[94:95], v2 offset:11776
    v_mfma_f32_16x16x32_bf16 v[52:55], v[136:139], v[116:119], v[52:55]
    ds_read_b128 v[100:103], v4 offset:18432
    v_mfma_f32_16x16x32_bf16 v[56:59], v[136:139], v[120:123], v[56:59]
    ds_read_b128 v[104:107], v4 offset:20480
    v_mfma_f32_16x16x32_bf16 v[60:63], v[136:139], v[124:127], v[60:63]
    ds_read_b128 v[108:111], v4 offset:22528
    v_mfma_f32_16x16x32_bf16 v[64:67], v[140:143], v[112:115], v[64:67]
    v_add_u32 v2, 4294877184, v2
    v_add_u32 v3, 4294877184, v3
    v_mfma_f32_16x16x32_bf16 v[68:71], v[140:143], v[116:119], v[68:71]
    v_add_u32 v4, 4294877184, v4
    v_mfma_f32_16x16x32_bf16 v[72:75], v[140:143], v[120:123], v[72:75]
    v_mfma_f32_16x16x32_bf16 v[76:79], v[140:143], v[124:127], v[76:79]
    s_waitcnt lgkmcnt(0)
    s_barrier
    v_mfma_f32_16x16x32_bf16 v[16:19], v[96:99], v[80:83], v[16:19]
    ds_read_b64_tr_b16 v[112:113], v2 offset:0
    v_mfma_f32_16x16x32_bf16 v[20:23], v[96:99], v[84:87], v[20:23]
    ds_read_b64_tr_b16 v[114:115], v2 offset:512
    v_mfma_f32_16x16x32_bf16 v[24:27], v[96:99], v[88:91], v[24:27]
    ds_read_b128 v[128:131], v3 offset:16384
    v_mfma_f32_16x16x32_bf16 v[28:31], v[96:99], v[92:95], v[28:31]
    ds_read_b64_tr_b16 v[116:117], v2 offset:1024
    v_mfma_f32_16x16x32_bf16 v[32:35], v[100:103], v[80:83], v[32:35]
    ds_read_b64_tr_b16 v[118:119], v2 offset:1536
    v_mfma_f32_16x16x32_bf16 v[36:39], v[100:103], v[84:87], v[36:39]
    ds_read_b64_tr_b16 v[120:121], v2 offset:2048
    v_mfma_f32_16x16x32_bf16 v[40:43], v[100:103], v[88:91], v[40:43]
    ds_read_b64_tr_b16 v[122:123], v2 offset:2560
    v_mfma_f32_16x16x32_bf16 v[44:47], v[100:103], v[92:95], v[44:47]
    ds_read_b64_tr_b16 v[124:125], v2 offset:3072
    v_mfma_f32_16x16x32_bf16 v[48:51], v[104:107], v[80:83], v[48:51]
    ds_read_b64_tr_b16 v[126:127], v2 offset:3584
    v_mfma_f32_16x16x32_bf16 v[52:55], v[104:107], v[84:87], v[52:55]
    ds_read_b128 v[132:135], v3 offset:18432
    v_mfma_f32_16x16x32_bf16 v[56:59], v[104:107], v[88:91], v[56:59]
    ds_read_b128 v[136:139], v3 offset:20480
    v_mfma_f32_16x16x32_bf16 v[60:63], v[104:107], v[92:95], v[60:63]
    ds_read_b128 v[140:143], v3 offset:22528
    v_mfma_f32_16x16x32_bf16 v[64:67], v[108:111], v[80:83], v[64:67]
    v_mfma_f32_16x16x32_bf16 v[68:71], v[108:111], v[84:87], v[68:71]
    v_mfma_f32_16x16x32_bf16 v[72:75], v[108:111], v[88:91], v[72:75]
    v_mfma_f32_16x16x32_bf16 v[76:79], v[108:111], v[92:95], v[76:79]
    s_waitcnt lgkmcnt(0)
    v_mfma_f32_16x16x32_bf16 v[16:19], v[128:131], v[112:115], v[16:19]
    ds_read_b64_tr_b16 v[80:81], v2 offset:8192
    v_mfma_f32_16x16x32_bf16 v[20:23], v[128:131], v[116:119], v[20:23]
    ds_read_b64_tr_b16 v[82:83], v2 offset:8704
    v_mfma_f32_16x16x32_bf16 v[24:27], v[128:131], v[120:123], v[24:27]
    ds_read_b128 v[96:99], v4 offset:16384
    v_mfma_f32_16x16x32_bf16 v[28:31], v[128:131], v[124:127], v[28:31]
    ds_read_b64_tr_b16 v[84:85], v2 offset:9216
    v_mfma_f32_16x16x32_bf16 v[32:35], v[132:135], v[112:115], v[32:35]
    ds_read_b64_tr_b16 v[86:87], v2 offset:9728
    v_mfma_f32_16x16x32_bf16 v[36:39], v[132:135], v[116:119], v[36:39]
    ds_read_b64_tr_b16 v[88:89], v2 offset:10240
    v_mfma_f32_16x16x32_bf16 v[40:43], v[132:135], v[120:123], v[40:43]
    ds_read_b64_tr_b16 v[90:91], v2 offset:10752
    v_mfma_f32_16x16x32_bf16 v[44:47], v[132:135], v[124:127], v[44:47]
    ds_read_b64_tr_b16 v[92:93], v2 offset:11264
    v_mfma_f32_16x16x32_bf16 v[48:51], v[136:139], v[112:115], v[48:51]
    ds_read_b64_tr_b16 v[94:95], v2 offset:11776
    v_mfma_f32_16x16x32_bf16 v[52:55], v[136:139], v[116:119], v[52:55]
    ds_read_b128 v[100:103], v4 offset:18432
    v_mfma_f32_16x16x32_bf16 v[56:59], v[136:139], v[120:123], v[56:59]
    ds_read_b128 v[104:107], v4 offset:20480
    v_mfma_f32_16x16x32_bf16 v[60:63], v[136:139], v[124:127], v[60:63]
    ds_read_b128 v[108:111], v4 offset:22528
    v_mfma_f32_16x16x32_bf16 v[64:67], v[140:143], v[112:115], v[64:67]
    v_add_u32 v2, 122880, v2
    v_add_u32 v3, 122880, v3
    v_mfma_f32_16x16x32_bf16 v[68:71], v[140:143], v[116:119], v[68:71]
    v_add_u32 v4, 122880, v4
    v_mfma_f32_16x16x32_bf16 v[72:75], v[140:143], v[120:123], v[72:75]
    v_mfma_f32_16x16x32_bf16 v[76:79], v[140:143], v[124:127], v[76:79]
    s_waitcnt lgkmcnt(0)
    s_barrier
    v_mfma_f32_16x16x32_bf16 v[16:19], v[96:99], v[80:83], v[16:19]
    ds_read_b64_tr_b16 v[112:113], v2 offset:0
    v_mfma_f32_16x16x32_bf16 v[20:23], v[96:99], v[84:87], v[20:23]
    ds_read_b64_tr_b16 v[114:115], v2 offset:512
    v_mfma_f32_16x16x32_bf16 v[24:27], v[96:99], v[88:91], v[24:27]
    ds_read_b128 v[128:131], v3 offset:16384
    v_mfma_f32_16x16x32_bf16 v[28:31], v[96:99], v[92:95], v[28:31]
    ds_read_b64_tr_b16 v[116:117], v2 offset:1024
    v_mfma_f32_16x16x32_bf16 v[32:35], v[100:103], v[80:83], v[32:35]
    ds_read_b64_tr_b16 v[118:119], v2 offset:1536
    v_mfma_f32_16x16x32_bf16 v[36:39], v[100:103], v[84:87], v[36:39]
    ds_read_b64_tr_b16 v[120:121], v2 offset:2048
    v_mfma_f32_16x16x32_bf16 v[40:43], v[100:103], v[88:91], v[40:43]
    ds_read_b64_tr_b16 v[122:123], v2 offset:2560
    v_mfma_f32_16x16x32_bf16 v[44:47], v[100:103], v[92:95], v[44:47]
    ds_read_b64_tr_b16 v[124:125], v2 offset:3072
    v_mfma_f32_16x16x32_bf16 v[48:51], v[104:107], v[80:83], v[48:51]
    ds_read_b64_tr_b16 v[126:127], v2 offset:3584
    v_mfma_f32_16x16x32_bf16 v[52:55], v[104:107], v[84:87], v[52:55]
    ds_read_b128 v[132:135], v3 offset:18432
    v_mfma_f32_16x16x32_bf16 v[56:59], v[104:107], v[88:91], v[56:59]
    ds_read_b128 v[136:139], v3 offset:20480
    v_mfma_f32_16x16x32_bf16 v[60:63], v[104:107], v[92:95], v[60:63]
    ds_read_b128 v[140:143], v3 offset:22528
    v_mfma_f32_16x16x32_bf16 v[64:67], v[108:111], v[80:83], v[64:67]
    v_mfma_f32_16x16x32_bf16 v[68:71], v[108:111], v[84:87], v[68:71]
    v_mfma_f32_16x16x32_bf16 v[72:75], v[108:111], v[88:91], v[72:75]
    v_mfma_f32_16x16x32_bf16 v[76:79], v[108:111], v[92:95], v[76:79]
    s_waitcnt lgkmcnt(0)
    v_mfma_f32_16x16x32_bf16 v[16:19], v[128:131], v[112:115], v[16:19]
    ds_read_b64_tr_b16 v[80:81], v2 offset:8192
    v_mfma_f32_16x16x32_bf16 v[20:23], v[128:131], v[116:119], v[20:23]
    ds_read_b64_tr_b16 v[82:83], v2 offset:8704
    v_mfma_f32_16x16x32_bf16 v[24:27], v[128:131], v[120:123], v[24:27]
    ds_read_b128 v[96:99], v4 offset:16384
    v_mfma_f32_16x16x32_bf16 v[28:31], v[128:131], v[124:127], v[28:31]
    ds_read_b64_tr_b16 v[84:85], v2 offset:9216
    v_mfma_f32_16x16x32_bf16 v[32:35], v[132:135], v[112:115], v[32:35]
    ds_read_b64_tr_b16 v[86:87], v2 offset:9728
    v_mfma_f32_16x16x32_bf16 v[36:39], v[132:135], v[116:119], v[36:39]
    ds_read_b64_tr_b16 v[88:89], v2 offset:10240
    v_mfma_f32_16x16x32_bf16 v[40:43], v[132:135], v[120:123], v[40:43]
    ds_read_b64_tr_b16 v[90:91], v2 offset:10752
    v_mfma_f32_16x16x32_bf16 v[44:47], v[132:135], v[124:127], v[44:47]
    ds_read_b64_tr_b16 v[92:93], v2 offset:11264
    v_mfma_f32_16x16x32_bf16 v[48:51], v[136:139], v[112:115], v[48:51]
    ds_read_b64_tr_b16 v[94:95], v2 offset:11776
    v_mfma_f32_16x16x32_bf16 v[52:55], v[136:139], v[116:119], v[52:55]
    ds_read_b128 v[100:103], v4 offset:18432
    v_mfma_f32_16x16x32_bf16 v[56:59], v[136:139], v[120:123], v[56:59]
    ds_read_b128 v[104:107], v4 offset:20480
    v_mfma_f32_16x16x32_bf16 v[60:63], v[136:139], v[124:127], v[60:63]
    ds_read_b128 v[108:111], v4 offset:22528
    v_mfma_f32_16x16x32_bf16 v[64:67], v[140:143], v[112:115], v[64:67]
    v_add_u32 v2, 4294889472, v2
    v_add_u32 v3, 4294889472, v3
    v_mfma_f32_16x16x32_bf16 v[68:71], v[140:143], v[116:119], v[68:71]
    v_add_u32 v4, 4294889472, v4
    v_mfma_f32_16x16x32_bf16 v[72:75], v[140:143], v[120:123], v[72:75]
    v_mfma_f32_16x16x32_bf16 v[76:79], v[140:143], v[124:127], v[76:79]
    s_waitcnt lgkmcnt(0)
    s_barrier
    v_mfma_f32_16x16x32_bf16 v[16:19], v[96:99], v[80:83], v[16:19]
    ds_read_b64_tr_b16 v[112:113], v2 offset:0
    v_mfma_f32_16x16x32_bf16 v[20:23], v[96:99], v[84:87], v[20:23]
    ds_read_b64_tr_b16 v[114:115], v2 offset:512
    v_mfma_f32_16x16x32_bf16 v[24:27], v[96:99], v[88:91], v[24:27]
    ds_read_b128 v[128:131], v3 offset:16384
    v_mfma_f32_16x16x32_bf16 v[28:31], v[96:99], v[92:95], v[28:31]
    ds_read_b64_tr_b16 v[116:117], v2 offset:1024
    v_mfma_f32_16x16x32_bf16 v[32:35], v[100:103], v[80:83], v[32:35]
    ds_read_b64_tr_b16 v[118:119], v2 offset:1536
    v_mfma_f32_16x16x32_bf16 v[36:39], v[100:103], v[84:87], v[36:39]
    ds_read_b64_tr_b16 v[120:121], v2 offset:2048
    v_mfma_f32_16x16x32_bf16 v[40:43], v[100:103], v[88:91], v[40:43]
    ds_read_b64_tr_b16 v[122:123], v2 offset:2560
    v_mfma_f32_16x16x32_bf16 v[44:47], v[100:103], v[92:95], v[44:47]
    ds_read_b64_tr_b16 v[124:125], v2 offset:3072
    v_mfma_f32_16x16x32_bf16 v[48:51], v[104:107], v[80:83], v[48:51]
    ds_read_b64_tr_b16 v[126:127], v2 offset:3584
    v_mfma_f32_16x16x32_bf16 v[52:55], v[104:107], v[84:87], v[52:55]
    ds_read_b128 v[132:135], v3 offset:18432
    v_mfma_f32_16x16x32_bf16 v[56:59], v[104:107], v[88:91], v[56:59]
    ds_read_b128 v[136:139], v3 offset:20480
    v_mfma_f32_16x16x32_bf16 v[60:63], v[104:107], v[92:95], v[60:63]
    ds_read_b128 v[140:143], v3 offset:22528
    v_mfma_f32_16x16x32_bf16 v[64:67], v[108:111], v[80:83], v[64:67]
    v_mfma_f32_16x16x32_bf16 v[68:71], v[108:111], v[84:87], v[68:71]
    v_mfma_f32_16x16x32_bf16 v[72:75], v[108:111], v[88:91], v[72:75]
    v_mfma_f32_16x16x32_bf16 v[76:79], v[108:111], v[92:95], v[76:79]
    s_mov_b32 s97, 2
L_gated_mix__ssm_conv_s5__dense_activation_squared_relu__prompt_kernel_a2:
    s_waitcnt lgkmcnt(0)
    v_mfma_f32_16x16x32_bf16 v[16:19], v[128:131], v[112:115], v[16:19]
    ds_read_b64_tr_b16 v[80:81], v2 offset:8192
    v_mfma_f32_16x16x32_bf16 v[20:23], v[128:131], v[116:119], v[20:23]
    ds_read_b64_tr_b16 v[82:83], v2 offset:8704
    v_mfma_f32_16x16x32_bf16 v[24:27], v[128:131], v[120:123], v[24:27]
    ds_read_b128 v[96:99], v4 offset:16384
    v_mfma_f32_16x16x32_bf16 v[28:31], v[128:131], v[124:127], v[28:31]
    ds_read_b64_tr_b16 v[84:85], v2 offset:9216
    v_mfma_f32_16x16x32_bf16 v[32:35], v[132:135], v[112:115], v[32:35]
    ds_read_b64_tr_b16 v[86:87], v2 offset:9728
    v_mfma_f32_16x16x32_bf16 v[36:39], v[132:135], v[116:119], v[36:39]
    ds_read_b64_tr_b16 v[88:89], v2 offset:10240
    v_mfma_f32_16x16x32_bf16 v[40:43], v[132:135], v[120:123], v[40:43]
    ds_read_b64_tr_b16 v[90:91], v2 offset:10752
    v_mfma_f32_16x16x32_bf16 v[44:47], v[132:135], v[124:127], v[44:47]
    ds_read_b64_tr_b16 v[92:93], v2 offset:11264
    v_mfma_f32_16x16x32_bf16 v[48:51], v[136:139], v[112:115], v[48:51]
    ds_read_b64_tr_b16 v[94:95], v2 offset:11776
    v_mfma_f32_16x16x32_bf16 v[52:55], v[136:139], v[116:119], v[52:55]
    ds_read_b128 v[100:103], v4 offset:18432
    v_mfma_f32_16x16x32_bf16 v[56:59], v[136:139], v[120:123], v[56:59]
    ds_read_b128 v[104:107], v4 offset:20480
    v_mfma_f32_16x16x32_bf16 v[60:63], v[136:139], v[124:127], v[60:63]
    ds_read_b128 v[108:111], v4 offset:22528
    v_mfma_f32_16x16x32_bf16 v[64:67], v[140:143], v[112:115], v[64:67]
    v_add_u32 v2, 45056, v2
    v_add_u32 v3, 45056, v3
    v_mfma_f32_16x16x32_bf16 v[68:71], v[140:143], v[116:119], v[68:71]
    v_add_u32 v4, 45056, v4
    v_mfma_f32_16x16x32_bf16 v[72:75], v[140:143], v[120:123], v[72:75]
    v_mfma_f32_16x16x32_bf16 v[76:79], v[140:143], v[124:127], v[76:79]
    s_waitcnt lgkmcnt(0)
    s_barrier
    v_mfma_f32_16x16x32_bf16 v[16:19], v[96:99], v[80:83], v[16:19]
    ds_read_b64_tr_b16 v[112:113], v2 offset:0
    v_mfma_f32_16x16x32_bf16 v[20:23], v[96:99], v[84:87], v[20:23]
    ds_read_b64_tr_b16 v[114:115], v2 offset:512
    v_mfma_f32_16x16x32_bf16 v[24:27], v[96:99], v[88:91], v[24:27]
    ds_read_b128 v[128:131], v3 offset:16384
    v_mfma_f32_16x16x32_bf16 v[28:31], v[96:99], v[92:95], v[28:31]
    ds_read_b64_tr_b16 v[116:117], v2 offset:1024
    v_mfma_f32_16x16x32_bf16 v[32:35], v[100:103], v[80:83], v[32:35]
    ds_read_b64_tr_b16 v[118:119], v2 offset:1536
    v_mfma_f32_16x16x32_bf16 v[36:39], v[100:103], v[84:87], v[36:39]
    ds_read_b64_tr_b16 v[120:121], v2 offset:2048
    v_mfma_f32_16x16x32_bf16 v[40:43], v[100:103], v[88:91], v[40:43]
    ds_read_b64_tr_b16 v[122:123], v2 offset:2560
    v_mfma_f32_16x16x32_bf16 v[44:47], v[100:103], v[92:95], v[44:47]
    ds_read_b64_tr_b16 v[124:125], v2 offset:3072
    v_mfma_f32_16x16x32_bf16 v[48:51], v[104:107], v[80:83], v[48:51]
    ds_read_b64_tr_b16 v[126:127], v2 offset:3584
    v_mfma_f32_16x16x32_bf16 v[52:55], v[104:107], v[84:87], v[52:55]
    ds_read_b128 v[132:135], v3 offset:18432
    v_mfma_f32_16x16x32_bf16 v[56:59], v[104:107], v[88:91], v[56:59]
    ds_read_b128 v[136:139], v3 offset:20480
    v_mfma_f32_16x16x32_bf16 v[60:63], v[104:107], v[92:95], v[60:63]
    ds_read_b128 v[140:143], v3 offset:22528
    v_mfma_f32_16x16x32_bf16 v[64:67], v[108:111], v[80:83], v[64:67]
    v_mfma_f32_16x16x32_bf16 v[68:71], v[108:111], v[84:87], v[68:71]
    v_mfma_f32_16x16x32_bf16 v[72:75], v[108:111], v[88:91], v[72:75]
    v_mfma_f32_16x16x32_bf16 v[76:79], v[108:111], v[92:95], v[76:79]
    s_waitcnt lgkmcnt(0)
    v_mfma_f32_16x16x32_bf16 v[16:19], v[128:131], v[112:115], v[16:19]
    ds_read_b64_tr_b16 v[80:81], v2 offset:8192
    v_mfma_f32_16x16x32_bf16 v[20:23], v[128:131], v[116:119], v[20:23]
    ds_read_b64_tr_b16 v[82:83], v2 offset:8704
    v_mfma_f32_16x16x32_bf16 v[24:27], v[128:131], v[120:123], v[24:27]
    ds_read_b128 v[96:99], v4 offset:16384
    v_mfma_f32_16x16x32_bf16 v[28:31], v[128:131], v[124:127], v[28:31]
    ds_read_b64_tr_b16 v[84:85], v2 offset:9216
    v_mfma_f32_16x16x32_bf16 v[32:35], v[132:135], v[112:115], v[32:35]
    ds_read_b64_tr_b16 v[86:87], v2 offset:9728
    v_mfma_f32_16x16x32_bf16 v[36:39], v[132:135], v[116:119], v[36:39]
    ds_read_b64_tr_b16 v[88:89], v2 offset:10240
    v_mfma_f32_16x16x32_bf16 v[40:43], v[132:135], v[120:123], v[40:43]
    ds_read_b64_tr_b16 v[90:91], v2 offset:10752
    v_mfma_f32_16x16x32_bf16 v[44:47], v[132:135], v[124:127], v[44:47]
    ds_read_b64_tr_b16 v[92:93], v2 offset:11264
    v_mfma_f32_16x16x32_bf16 v[48:51], v[136:139], v[112:115], v[48:51]
    ds_read_b64_tr_b16 v[94:95], v2 offset:11776
    v_mfma_f32_16x16x32_bf16 v[52:55], v[136:139], v[116:119], v[52:55]
    ds_read_b128 v[100:103], v4 offset:18432
    v_mfma_f32_16x16x32_bf16 v[56:59], v[136:139], v[120:123], v[56:59]
    ds_read_b128 v[104:107], v4 offset:20480
    v_mfma_f32_16x16x32_bf16 v[60:63], v[136:139], v[124:127], v[60:63]
    ds_read_b128 v[108:111], v4 offset:22528
    v_mfma_f32_16x16x32_bf16 v[64:67], v[140:143], v[112:115], v[64:67]
    v_add_u32 v2, 4294877184, v2
    v_add_u32 v3, 4294877184, v3
    v_mfma_f32_16x16x32_bf16 v[68:71], v[140:143], v[116:119], v[68:71]
    v_add_u32 v4, 4294877184, v4
    v_mfma_f32_16x16x32_bf16 v[72:75], v[140:143], v[120:123], v[72:75]
    v_mfma_f32_16x16x32_bf16 v[76:79], v[140:143], v[124:127], v[76:79]
    s_waitcnt lgkmcnt(0)
    s_barrier
    v_mfma_f32_16x16x32_bf16 v[16:19], v[96:99], v[80:83], v[16:19]
    ds_read_b64_tr_b16 v[112:113], v2 offset:0
    v_mfma_f32_16x16x32_bf16 v[20:23], v[96:99], v[84:87], v[20:23]
    ds_read_b64_tr_b16 v[114:115], v2 offset:512
    v_mfma_f32_16x16x32_bf16 v[24:27], v[96:99], v[88:91], v[24:27]
    ds_read_b128 v[128:131], v3 offset:16384
    v_mfma_f32_16x16x32_bf16 v[28:31], v[96:99], v[92:95], v[28:31]
    ds_read_b64_tr_b16 v[116:117], v2 offset:1024
    v_mfma_f32_16x16x32_bf16 v[32:35], v[100:103], v[80:83], v[32:35]
    ds_read_b64_tr_b16 v[118:119], v2 offset:1536
    v_mfma_f32_16x16x32_bf16 v[36:39], v[100:103], v[84:87], v[36:39]
    ds_read_b64_tr_b16 v[120:121], v2 offset:2048
    v_mfma_f32_16x16x32_bf16 v[40:43], v[100:103], v[88:91], v[40:43]
    ds_read_b64_tr_b16 v[122:123], v2 offset:2560
    v_mfma_f32_16x16x32_bf16 v[44:47], v[100:103], v[92:95], v[44:47]
    ds_read_b64_tr_b16 v[124:125], v2 offset:3072
    v_mfma_f32_16x16x32_bf16 v[48:51], v[104:107], v[80:83], v[48:51]
    ds_read_b64_tr_b16 v[126:127], v2 offset:3584
    v_mfma_f32_16x16x32_bf16 v[52:55], v[104:107], v[84:87], v[52:55]
    ds_read_b128 v[132:135], v3 offset:18432
    v_mfma_f32_16x16x32_bf16 v[56:59], v[104:107], v[88:91], v[56:59]
    ds_read_b128 v[136:139], v3 offset:20480
    v_mfma_f32_16x16x32_bf16 v[60:63], v[104:107], v[92:95], v[60:63]
    ds_read_b128 v[140:143], v3 offset:22528
    v_mfma_f32_16x16x32_bf16 v[64:67], v[108:111], v[80:83], v[64:67]
    v_mfma_f32_16x16x32_bf16 v[68:71], v[108:111], v[84:87], v[68:71]
    v_mfma_f32_16x16x32_bf16 v[72:75], v[108:111], v[88:91], v[72:75]
    v_mfma_f32_16x16x32_bf16 v[76:79], v[108:111], v[92:95], v[76:79]
    s_waitcnt lgkmcnt(0)
    v_mfma_f32_16x16x32_bf16 v[16:19], v[128:131], v[112:115], v[16:19]
    ds_read_b64_tr_b16 v[80:81], v2 offset:8192
    v_mfma_f32_16x16x32_bf16 v[20:23], v[128:131], v[116:119], v[20:23]
    ds_read_b64_tr_b16 v[82:83], v2 offset:8704
    v_mfma_f32_16x16x32_bf16 v[24:27], v[128:131], v[120:123], v[24:27]
    ds_read_b128 v[96:99], v4 offset:16384
    v_mfma_f32_16x16x32_bf16 v[28:31], v[128:131], v[124:127], v[28:31]
    ds_read_b64_tr_b16 v[84:85], v2 offset:9216
    v_mfma_f32_16x16x32_bf16 v[32:35], v[132:135], v[112:115], v[32:35]
    ds_read_b64_tr_b16 v[86:87], v2 offset:9728
    v_mfma_f32_16x16x32_bf16 v[36:39], v[132:135], v[116:119], v[36:39]
    ds_read_b64_tr_b16 v[88:89], v2 offset:10240
    v_mfma_f32_16x16x32_bf16 v[40:43], v[132:135], v[120:123], v[40:43]
    ds_read_b64_tr_b16 v[90:91], v2 offset:10752
    v_mfma_f32_16x16x32_bf16 v[44:47], v[132:135], v[124:127], v[44:47]
    ds_read_b64_tr_b16 v[92:93], v2 offset:11264
    v_mfma_f32_16x16x32_bf16 v[48:51], v[136:139], v[112:115], v[48:51]
    ds_read_b64_tr_b16 v[94:95], v2 offset:11776
    v_mfma_f32_16x16x32_bf16 v[52:55], v[136:139], v[116:119], v[52:55]
    ds_read_b128 v[100:103], v4 offset:18432
    v_mfma_f32_16x16x32_bf16 v[56:59], v[136:139], v[120:123], v[56:59]
    ds_read_b128 v[104:107], v4 offset:20480
    v_mfma_f32_16x16x32_bf16 v[60:63], v[136:139], v[124:127], v[60:63]
    ds_read_b128 v[108:111], v4 offset:22528
    v_mfma_f32_16x16x32_bf16 v[64:67], v[140:143], v[112:115], v[64:67]
    v_add_u32 v2, 122880, v2
    v_add_u32 v3, 122880, v3
    v_mfma_f32_16x16x32_bf16 v[68:71], v[140:143], v[116:119], v[68:71]
    v_add_u32 v4, 122880, v4
    v_mfma_f32_16x16x32_bf16 v[72:75], v[140:143], v[120:123], v[72:75]
    v_mfma_f32_16x16x32_bf16 v[76:79], v[140:143], v[124:127], v[76:79]
    s_waitcnt lgkmcnt(0)
    s_barrier
    v_mfma_f32_16x16x32_bf16 v[16:19], v[96:99], v[80:83], v[16:19]
    ds_read_b64_tr_b16 v[112:113], v2 offset:0
    v_mfma_f32_16x16x32_bf16 v[20:23], v[96:99], v[84:87], v[20:23]
    ds_read_b64_tr_b16 v[114:115], v2 offset:512
    v_mfma_f32_16x16x32_bf16 v[24:27], v[96:99], v[88:91], v[24:27]
    ds_read_b128 v[128:131], v3 offset:16384
    v_mfma_f32_16x16x32_bf16 v[28:31], v[96:99], v[92:95], v[28:31]
    ds_read_b64_tr_b16 v[116:117], v2 offset:1024
    v_mfma_f32_16x16x32_bf16 v[32:35], v[100:103], v[80:83], v[32:35]
    ds_read_b64_tr_b16 v[118:119], v2 offset:1536
    v_mfma_f32_16x16x32_bf16 v[36:39], v[100:103], v[84:87], v[36:39]
    ds_read_b64_tr_b16 v[120:121], v2 offset:2048
    v_mfma_f32_16x16x32_bf16 v[40:43], v[100:103], v[88:91], v[40:43]
    ds_read_b64_tr_b16 v[122:123], v2 offset:2560
    v_mfma_f32_16x16x32_bf16 v[44:47], v[100:103], v[92:95], v[44:47]
    ds_read_b64_tr_b16 v[124:125], v2 offset:3072
    v_mfma_f32_16x16x32_bf16 v[48:51], v[104:107], v[80:83], v[48:51]
    ds_read_b64_tr_b16 v[126:127], v2 offset:3584
    v_mfma_f32_16x16x32_bf16 v[52:55], v[104:107], v[84:87], v[52:55]
    ds_read_b128 v[132:135], v3 offset:18432
    v_mfma_f32_16x16x32_bf16 v[56:59], v[104:107], v[88:91], v[56:59]
    ds_read_b128 v[136:139], v3 offset:20480
    v_mfma_f32_16x16x32_bf16 v[60:63], v[104:107], v[92:95], v[60:63]
    ds_read_b128 v[140:143], v3 offset:22528
    v_mfma_f32_16x16x32_bf16 v[64:67], v[108:111], v[80:83], v[64:67]
    v_mfma_f32_16x16x32_bf16 v[68:71], v[108:111], v[84:87], v[68:71]
    v_mfma_f32_16x16x32_bf16 v[72:75], v[108:111], v[88:91], v[72:75]
    v_mfma_f32_16x16x32_bf16 v[76:79], v[108:111], v[92:95], v[76:79]
    s_waitcnt lgkmcnt(0)
    v_mfma_f32_16x16x32_bf16 v[16:19], v[128:131], v[112:115], v[16:19]
    ds_read_b64_tr_b16 v[80:81], v2 offset:8192
    v_mfma_f32_16x16x32_bf16 v[20:23], v[128:131], v[116:119], v[20:23]
    ds_read_b64_tr_b16 v[82:83], v2 offset:8704
    v_mfma_f32_16x16x32_bf16 v[24:27], v[128:131], v[120:123], v[24:27]
    ds_read_b128 v[96:99], v4 offset:16384
    v_mfma_f32_16x16x32_bf16 v[28:31], v[128:131], v[124:127], v[28:31]
    ds_read_b64_tr_b16 v[84:85], v2 offset:9216
    v_mfma_f32_16x16x32_bf16 v[32:35], v[132:135], v[112:115], v[32:35]
    ds_read_b64_tr_b16 v[86:87], v2 offset:9728
    v_mfma_f32_16x16x32_bf16 v[36:39], v[132:135], v[116:119], v[36:39]
    ds_read_b64_tr_b16 v[88:89], v2 offset:10240
    v_mfma_f32_16x16x32_bf16 v[40:43], v[132:135], v[120:123], v[40:43]
    ds_read_b64_tr_b16 v[90:91], v2 offset:10752
    v_mfma_f32_16x16x32_bf16 v[44:47], v[132:135], v[124:127], v[44:47]
    ds_read_b64_tr_b16 v[92:93], v2 offset:11264
    v_mfma_f32_16x16x32_bf16 v[48:51], v[136:139], v[112:115], v[48:51]
    ds_read_b64_tr_b16 v[94:95], v2 offset:11776
    v_mfma_f32_16x16x32_bf16 v[52:55], v[136:139], v[116:119], v[52:55]
    ds_read_b128 v[100:103], v4 offset:18432
    v_mfma_f32_16x16x32_bf16 v[56:59], v[136:139], v[120:123], v[56:59]
    ds_read_b128 v[104:107], v4 offset:20480
    v_mfma_f32_16x16x32_bf16 v[60:63], v[136:139], v[124:127], v[60:63]
    ds_read_b128 v[108:111], v4 offset:22528
    v_mfma_f32_16x16x32_bf16 v[64:67], v[140:143], v[112:115], v[64:67]
    v_add_u32 v2, 4294889472, v2
    v_add_u32 v3, 4294889472, v3
    v_mfma_f32_16x16x32_bf16 v[68:71], v[140:143], v[116:119], v[68:71]
    v_add_u32 v4, 4294889472, v4
    v_mfma_f32_16x16x32_bf16 v[72:75], v[140:143], v[120:123], v[72:75]
    v_mfma_f32_16x16x32_bf16 v[76:79], v[140:143], v[124:127], v[76:79]
    s_waitcnt lgkmcnt(0)
    s_barrier
    v_mfma_f32_16x16x32_bf16 v[16:19], v[96:99], v[80:83], v[16:19]
    ds_read_b64_tr_b16 v[112:113], v2 offset:0
    v_mfma_f32_16x16x32_bf16 v[20:23], v[96:99], v[84:87], v[20:23]
    ds_read_b64_tr_b16 v[114:115], v2 offset:512
    v_mfma_f32_16x16x32_bf16 v[24:27], v[96:99], v[88:91], v[24:27]
    ds_read_b128 v[128:131], v3 offset:16384
    v_mfma_f32_16x16x32_bf16 v[28:31], v[96:99], v[92:95], v[28:31]
    ds_read_b64_tr_b16 v[116:117], v2 offset:1024
    v_mfma_f32_16x16x32_bf16 v[32:35], v[100:103], v[80:83], v[32:35]
    ds_read_b64_tr_b16 v[118:119], v2 offset:1536
    v_mfma_f32_16x16x32_bf16 v[36:39], v[100:103], v[84:87], v[36:39]
    ds_read_b64_tr_b16 v[120:121], v2 offset:2048
    v_mfma_f32_16x16x32_bf16 v[40:43], v[100:103], v[88:91], v[40:43]
    ds_read_b64_tr_b16 v[122:123], v2 offset:2560
    v_mfma_f32_16x16x32_bf16 v[44:47], v[100:103], v[92:95], v[44:47]
    ds_read_b64_tr_b16 v[124:125], v2 offset:3072
    v_mfma_f32_16x16x32_bf16 v[48:51], v[104:107], v[80:83], v[48:51]
    ds_read_b64_tr_b16 v[126:127], v2 offset:3584
    v_mfma_f32_16x16x32_bf16 v[52:55], v[104:107], v[84:87], v[52:55]
    ds_read_b128 v[132:135], v3 offset:18432
    v_mfma_f32_16x16x32_bf16 v[56:59], v[104:107], v[88:91], v[56:59]
    ds_read_b128 v[136:139], v3 offset:20480
    v_mfma_f32_16x16x32_bf16 v[60:63], v[104:107], v[92:95], v[60:63]
    ds_read_b128 v[140:143], v3 offset:22528
    v_mfma_f32_16x16x32_bf16 v[64:67], v[108:111], v[80:83], v[64:67]
    v_mfma_f32_16x16x32_bf16 v[68:71], v[108:111], v[84:87], v[68:71]
    v_mfma_f32_16x16x32_bf16 v[72:75], v[108:111], v[88:91], v[72:75]
    v_mfma_f32_16x16x32_bf16 v[76:79], v[108:111], v[92:95], v[76:79]
    s_sub_u32 s97, s97, 1
    s_cmp_lg_u32 s97, 0
    s_cbranch_scc1 L_gated_mix__ssm_conv_s5__dense_activation_squared_relu__prompt_kernel_a2
    s_waitcnt lgkmcnt(0)
    v_mfma_f32_16x16x32_bf16 v[16:19], v[128:131], v[112:115], v[16:19]
    ds_read_b64_tr_b16 v[80:81], v2 offset:8192
    v_mfma_f32_16x16x32_bf16 v[20:23], v[128:131], v[116:119], v[20:23]
    ds_read_b64_tr_b16 v[82:83], v2 offset:8704
    v_mfma_f32_16x16x32_bf16 v[24:27], v[128:131], v[120:123], v[24:27]
    ds_read_b128 v[96:99], v4 offset:16384
    v_mfma_f32_16x16x32_bf16 v[28:31], v[128:131], v[124:127], v[28:31]
    ds_read_b64_tr_b16 v[84:85], v2 offset:9216
    v_mfma_f32_16x16x32_bf16 v[32:35], v[132:135], v[112:115], v[32:35]
    ds_read_b64_tr_b16 v[86:87], v2 offset:9728
    v_mfma_f32_16x16x32_bf16 v[36:39], v[132:135], v[116:119], v[36:39]
    ds_read_b64_tr_b16 v[88:89], v2 offset:10240
    v_mfma_f32_16x16x32_bf16 v[40:43], v[132:135], v[120:123], v[40:43]
    ds_read_b64_tr_b16 v[90:91], v2 offset:10752
    s_lshl_b32 s95, s80, 7
    v_mfma_f32_16x16x32_bf16 v[44:47], v[132:135], v[124:127], v[44:47]
    ds_read_b64_tr_b16 v[92:93], v2 offset:11264
    s_lshl_b32 s87, s89, 6
    v_mfma_f32_16x16x32_bf16 v[48:51], v[136:139], v[112:115], v[48:51]
    ds_read_b64_tr_b16 v[94:95], v2 offset:11776
    s_add_u32 s95, s95, s87
    v_mfma_f32_16x16x32_bf16 v[52:55], v[136:139], v[116:119], v[52:55]
    ds_read_b128 v[100:103], v4 offset:18432
    s_lshl_b32 s96, s81, 7
    v_mfma_f32_16x16x32_bf16 v[56:59], v[136:139], v[120:123], v[56:59]
    ds_read_b128 v[104:107], v4 offset:20480
    s_lshl_b32 s87, s90, 6
    v_mfma_f32_16x16x32_bf16 v[60:63], v[136:139], v[124:127], v[60:63]
    ds_read_b128 v[108:111], v4 offset:22528
    s_add_u32 s96, s96, s87
    v_mfma_f32_16x16x32_bf16 v[64:67], v[140:143], v[112:115], v[64:67]
    v_add_u32 v2, 45056, v2
    v_add_u32 v3, 45056, v3
    s_lshl_b32 s98, s80, 3
    v_mfma_f32_16x16x32_bf16 v[68:71], v[140:143], v[116:119], v[68:71]
    v_add_u32 v4, 45056, v4
    s_add_u32 s98, s98, s81
    v_mfma_f32_16x16x32_bf16 v[72:75], v[140:143], v[120:123], v[72:75]
    s_lshl_b32 s88, s98, 1
    s_add_u32 s91, s88, s82
    v_mfma_f32_16x16x32_bf16 v[76:79], v[140:143], v[124:127], v[76:79]
    s_xor_b32 s93, s91, 1
    s_lshl_b32 s88, s83, 2
    s_waitcnt lgkmcnt(0)
    s_barrier
    v_mfma_f32_16x16x32_bf16 v[16:19], v[96:99], v[80:83], v[16:19]
    ds_read_b64_tr_b16 v[112:113], v2 offset:0
    v_mfma_f32_16x16x32_bf16 v[20:23], v[96:99], v[84:87], v[20:23]
    ds_read_b64_tr_b16 v[114:115], v2 offset:512
    v_mfma_f32_16x16x32_bf16 v[24:27], v[96:99], v[88:91], v[24:27]
    ds_read_b128 v[128:131], v3 offset:16384
    v_mfma_f32_16x16x32_bf16 v[28:31], v[96:99], v[92:95], v[28:31]
    ds_read_b64_tr_b16 v[116:117], v2 offset:1024
    v_mfma_f32_16x16x32_bf16 v[32:35], v[100:103], v[80:83], v[32:35]
    ds_read_b64_tr_b16 v[118:119], v2 offset:1536
    v_mfma_f32_16x16x32_bf16 v[36:39], v[100:103], v[84:87], v[36:39]
    ds_read_b64_tr_b16 v[120:121], v2 offset:2048
    v_mfma_f32_16x16x32_bf16 v[40:43], v[100:103], v[88:91], v[40:43]
    ds_read_b64_tr_b16 v[122:123], v2 offset:2560
    v_mfma_f32_16x16x32_bf16 v[44:47], v[100:103], v[92:95], v[44:47]
    ds_read_b64_tr_b16 v[124:125], v2 offset:3072
    v_mfma_f32_16x16x32_bf16 v[48:51], v[104:107], v[80:83], v[48:51]
    ds_read_b64_tr_b16 v[126:127], v2 offset:3584
    s_lshl_b32 s92, s91, 7
    v_mfma_f32_16x16x32_bf16 v[52:55], v[104:107], v[84:87], v[52:55]
    ds_read_b128 v[132:135], v3 offset:18432
    s_add_u32 s92, s92, s88
    v_mfma_f32_16x16x32_bf16 v[56:59], v[104:107], v[88:91], v[56:59]
    ds_read_b128 v[136:139], v3 offset:20480
    s_add_u32 s92, s92, 34611200
    v_mfma_f32_16x16x32_bf16 v[60:63], v[104:107], v[92:95], v[60:63]
    ds_read_b128 v[140:143], v3 offset:22528
    s_lshl_b32 s94, s93, 7
    v_mfma_f32_16x16x32_bf16 v[64:67], v[108:111], v[80:83], v[64:67]
    s_add_u32 s94, s94, s88
    s_add_u32 s94, s94, 34611200
    v_mfma_f32_16x16x32_bf16 v[68:71], v[108:111], v[84:87], v[68:71]
    s_lshl_b32 s91, s91, 2
    s_add_u32 s91, s91, s83
    v_mfma_f32_16x16x32_bf16 v[72:75], v[108:111], v[88:91], v[72:75]
    s_lshl_b32 s91, s91, 13
    s_add_u32 s91, s91, 26214400
    v_mfma_f32_16x16x32_bf16 v[76:79], v[108:111], v[92:95], v[76:79]
    s_lshl_b32 s93, s93, 2
    s_add_u32 s93, s93, s83
    s_waitcnt lgkmcnt(0)
    v_mfma_f32_16x16x32_bf16 v[16:19], v[128:131], v[112:115], v[16:19]
    ds_read_b64_tr_b16 v[80:81], v2 offset:8192
    v_mfma_f32_16x16x32_bf16 v[20:23], v[128:131], v[116:119], v[20:23]
    ds_read_b64_tr_b16 v[82:83], v2 offset:8704
    v_mfma_f32_16x16x32_bf16 v[24:27], v[128:131], v[120:123], v[24:27]
    ds_read_b128 v[96:99], v4 offset:16384
    v_mfma_f32_16x16x32_bf16 v[28:31], v[128:131], v[124:127], v[28:31]
    ds_read_b64_tr_b16 v[84:85], v2 offset:9216
    v_mfma_f32_16x16x32_bf16 v[32:35], v[132:135], v[112:115], v[32:35]
    ds_read_b64_tr_b16 v[86:87], v2 offset:9728
    v_mfma_f32_16x16x32_bf16 v[36:39], v[132:135], v[116:119], v[36:39]
    ds_read_b64_tr_b16 v[88:89], v2 offset:10240
    v_mfma_f32_16x16x32_bf16 v[40:43], v[132:135], v[120:123], v[40:43]
    ds_read_b64_tr_b16 v[90:91], v2 offset:10752
    s_lshl_b32 s93, s93, 13
    v_mfma_f32_16x16x32_bf16 v[44:47], v[132:135], v[124:127], v[44:47]
    ds_read_b64_tr_b16 v[92:93], v2 offset:11264
    s_add_u32 s93, s93, 26214400
    v_mfma_f32_16x16x32_bf16 v[48:51], v[136:139], v[112:115], v[48:51]
    ds_read_b64_tr_b16 v[94:95], v2 offset:11776
    v_and_b32 v11, 15, v0
    v_mfma_f32_16x16x32_bf16 v[52:55], v[136:139], v[116:119], v[52:55]
    ds_read_b128 v[100:103], v4 offset:18432
    v_lshlrev_b32 v11, 4, v11
    v_mfma_f32_16x16x32_bf16 v[56:59], v[136:139], v[120:123], v[56:59]
    ds_read_b128 v[104:107], v4 offset:20480
    s_lshl_b32 s87, s89, 10
    v_mfma_f32_16x16x32_bf16 v[60:63], v[136:139], v[124:127], v[60:63]
    ds_read_b128 v[108:111], v4 offset:22528
    s_add_u32 s87, s87, 32768
    v_mfma_f32_16x16x32_bf16 v[64:67], v[140:143], v[112:115], v[64:67]
    v_add_u32 v2, 4294877184, v2
    v_add_u32 v3, 4294877184, v3
    v_add_u32 v11, s87, v11
    v_mfma_f32_16x16x32_bf16 v[68:71], v[140:143], v[116:119], v[68:71]
    v_add_u32 v4, 4294877184, v4
    v_and_b32 v12, 15, v0
    v_mfma_f32_16x16x32_bf16 v[72:75], v[140:143], v[120:123], v[72:75]
    v_lshrrev_b32 v13, 4, v0
    v_lshlrev_b32 v13, 3, v13
    v_mfma_f32_16x16x32_bf16 v[76:79], v[140:143], v[124:127], v[76:79]
    v_lshlrev_b32 v14, 8, v12
    v_add_u32 v14, v14, v13
    s_waitcnt lgkmcnt(0)
    s_barrier
    v_mfma_f32_16x16x32_bf16 v[16:19], v[96:99], v[80:83], v[16:19]
    ds_read_b64_tr_b16 v[112:113], v2 offset:0
    v_mfma_f32_16x16x32_bf16 v[20:23], v[96:99], v[84:87], v[20:23]
    ds_read_b64_tr_b16 v[114:115], v2 offset:512
    v_mfma_f32_16x16x32_bf16 v[24:27], v[96:99], v[88:91], v[24:27]
    ds_read_b128 v[128:131], v3 offset:16384
    v_mfma_f32_16x16x32_bf16 v[28:31], v[96:99], v[92:95], v[28:31]
    ds_read_b64_tr_b16 v[116:117], v2 offset:1024
    v_mfma_f32_16x16x32_bf16 v[32:35], v[100:103], v[80:83], v[32:35]
    ds_read_b64_tr_b16 v[118:119], v2 offset:1536
    v_mfma_f32_16x16x32_bf16 v[36:39], v[100:103], v[84:87], v[36:39]
    ds_read_b64_tr_b16 v[120:121], v2 offset:2048
    v_mfma_f32_16x16x32_bf16 v[40:43], v[100:103], v[88:91], v[40:43]
    ds_read_b64_tr_b16 v[122:123], v2 offset:2560
    v_mfma_f32_16x16x32_bf16 v[44:47], v[100:103], v[92:95], v[44:47]
    ds_read_b64_tr_b16 v[124:125], v2 offset:3072
    v_mfma_f32_16x16x32_bf16 v[48:51], v[104:107], v[80:83], v[48:51]
    ds_read_b64_tr_b16 v[126:127], v2 offset:3584
    s_lshl_b32 s87, s89, 13
    v_mfma_f32_16x16x32_bf16 v[52:55], v[104:107], v[84:87], v[52:55]
    ds_read_b128 v[132:135], v3 offset:18432
    s_add_u32 s87, s87, 45056
    v_mfma_f32_16x16x32_bf16 v[56:59], v[104:107], v[88:91], v[56:59]
    ds_read_b128 v[136:139], v3 offset:20480
    v_add_u32 v14, s87, v14
    v_mfma_f32_16x16x32_bf16 v[60:63], v[104:107], v[92:95], v[60:63]
    ds_read_b128 v[140:143], v3 offset:22528
    v_and_b32 v12, 7, v12
    v_mfma_f32_16x16x32_bf16 v[64:67], v[108:111], v[80:83], v[64:67]
    s_lshl_b32 s88, s90, 2
    s_add_u32 s87, s88, 0
    v_mfma_f32_16x16x32_bf16 v[68:71], v[108:111], v[84:87], v[68:71]
    v_xor_b32 v15, s87, v12
    v_lshlrev_b32 v15, 5, v15
    v_mfma_f32_16x16x32_bf16 v[72:75], v[108:111], v[88:91], v[72:75]
    v_add_u32 v5, v15, v14
    s_add_u32 s87, s88, 1
    v_mfma_f32_16x16x32_bf16 v[76:79], v[108:111], v[92:95], v[76:79]
    v_xor_b32 v15, s87, v12
    v_lshlrev_b32 v15, 5, v15
    s_waitcnt lgkmcnt(0)
    v_mfma_f32_16x16x32_bf16 v[16:19], v[128:131], v[112:115], v[16:19]
    ds_read_b64_tr_b16 v[80:81], v2 offset:8192
    v_mfma_f32_16x16x32_bf16 v[20:23], v[128:131], v[116:119], v[20:23]
    ds_read_b64_tr_b16 v[82:83], v2 offset:8704
    v_mfma_f32_16x16x32_bf16 v[24:27], v[128:131], v[120:123], v[24:27]
    ds_read_b128 v[96:99], v4 offset:16384
    v_mfma_f32_16x16x32_bf16 v[28:31], v[128:131], v[124:127], v[28:31]
    ds_read_b64_tr_b16 v[84:85], v2 offset:9216
    v_mfma_f32_16x16x32_bf16 v[32:35], v[132:135], v[112:115], v[32:35]
    ds_read_b64_tr_b16 v[86:87], v2 offset:9728
    v_mfma_f32_16x16x32_bf16 v[36:39], v[132:135], v[116:119], v[36:39]
    ds_read_b64_tr_b16 v[88:89], v2 offset:10240
    v_mfma_f32_16x16x32_bf16 v[40:43], v[132:135], v[120:123], v[40:43]
    ds_read_b64_tr_b16 v[90:91], v2 offset:10752
    v_add_u32 v6, v15, v14
    v_mfma_f32_16x16x32_bf16 v[44:47], v[132:135], v[124:127], v[44:47]
    ds_read_b64_tr_b16 v[92:93], v2 offset:11264
    s_add_u32 s87, s88, 2
    v_mfma_f32_16x16x32_bf16 v[48:51], v[136:139], v[112:115], v[48:51]
    ds_read_b64_tr_b16 v[94:95], v2 offset:11776
    v_xor_b32 v15, s87, v12
    v_mfma_f32_16x16x32_bf16 v[52:55], v[136:139], v[116:119], v[52:55]
    ds_read_b128 v[100:103], v4 offset:18432
    v_lshlrev_b32 v15, 5, v15
    v_mfma_f32_16x16x32_bf16 v[56:59], v[136:139], v[120:123], v[56:59]
    ds_read_b128 v[104:107], v4 offset:20480
    v_add_u32 v7, v15, v14
    v_mfma_f32_16x16x32_bf16 v[60:63], v[136:139], v[124:127], v[60:63]
    ds_read_b128 v[108:111], v4 offset:22528
    s_add_u32 s87, s88, 3
    v_mfma_f32_16x16x32_bf16 v[64:67], v[140:143], v[112:115], v[64:67]
    v_add_u32 v2, 122880, v2
    v_add_u32 v3, 122880, v3
    v_xor_b32 v15, s87, v12
    v_mfma_f32_16x16x32_bf16 v[68:71], v[140:143], v[116:119], v[68:71]
    v_add_u32 v4, 122880, v4
    v_lshlrev_b32 v15, 5, v15
    v_mfma_f32_16x16x32_bf16 v[72:75], v[140:143], v[120:123], v[72:75]
    v_add_u32 v8, v15, v14
    s_lshl_b32 s87, s90, 7
    v_mfma_f32_16x16x32_bf16 v[76:79], v[140:143], v[124:127], v[76:79]
    s_add_u32 s87, s87, 34816
    v_add_u32 v13, s87, v13
    s_waitcnt lgkmcnt(0)
    s_barrier
    v_mfma_f32_16x16x32_bf16 v[16:19], v[96:99], v[80:83], v[16:19]
    ds_read_b64_tr_b16 v[112:113], v2 offset:0
    v_mfma_f32_16x16x32_bf16 v[20:23], v[96:99], v[84:87], v[20:23]
    ds_read_b64_tr_b16 v[114:115], v2 offset:512
    v_mfma_f32_16x16x32_bf16 v[24:27], v[96:99], v[88:91], v[24:27]
    ds_read_b128 v[128:131], v3 offset:16384
    v_mfma_f32_16x16x32_bf16 v[28:31], v[96:99], v[92:95], v[28:31]
    ds_read_b64_tr_b16 v[116:117], v2 offset:1024
    v_mfma_f32_16x16x32_bf16 v[32:35], v[100:103], v[80:83], v[32:35]
    ds_read_b64_tr_b16 v[118:119], v2 offset:1536
    v_mfma_f32_16x16x32_bf16 v[36:39], v[100:103], v[84:87], v[36:39]
    ds_read_b64_tr_b16 v[120:121], v2 offset:2048
    v_mfma_f32_16x16x32_bf16 v[40:43], v[100:103], v[88:91], v[40:43]
    ds_read_b64_tr_b16 v[122:123], v2 offset:2560
    v_mfma_f32_16x16x32_bf16 v[44:47], v[100:103], v[92:95], v[44:47]
    ds_read_b64_tr_b16 v[124:125], v2 offset:3072
    v_mfma_f32_16x16x32_bf16 v[48:51], v[104:107], v[80:83], v[48:51]
    ds_read_b64_tr_b16 v[126:127], v2 offset:3584
    v_mfma_f32_16x16x32_bf16 v[52:55], v[104:107], v[84:87], v[52:55]
    ds_read_b128 v[132:135], v3 offset:18432
    v_mfma_f32_16x16x32_bf16 v[56:59], v[104:107], v[88:91], v[56:59]
    ds_read_b128 v[136:139], v3 offset:20480
    v_mfma_f32_16x16x32_bf16 v[60:63], v[104:107], v[92:95], v[60:63]
    ds_read_b128 v[140:143], v3 offset:22528
    v_mfma_f32_16x16x32_bf16 v[64:67], v[108:111], v[80:83], v[64:67]
    v_mfma_f32_16x16x32_bf16 v[68:71], v[108:111], v[84:87], v[68:71]
    v_mfma_f32_16x16x32_bf16 v[72:75], v[108:111], v[88:91], v[72:75]
    v_mfma_f32_16x16x32_bf16 v[76:79], v[108:111], v[92:95], v[76:79]
    s_waitcnt lgkmcnt(0)
    v_mfma_f32_16x16x32_bf16 v[16:19], v[128:131], v[112:115], v[16:19]
    ds_read_b64_tr_b16 v[80:81], v2 offset:8192
    ds_read_b128 v[208:211], v11 offset:0
    v_mfma_f32_16x16x32_bf16 v[20:23], v[128:131], v[116:119], v[20:23]
    ds_read_b64_tr_b16 v[82:83], v2 offset:8704
    ds_read_b128 v[212:215], v11 offset:256
    v_mfma_f32_16x16x32_bf16 v[24:27], v[128:131], v[120:123], v[24:27]
    ds_read_b128 v[96:99], v4 offset:16384
    ds_read_b128 v[216:219], v11 offset:512
    v_mfma_f32_16x16x32_bf16 v[28:31], v[128:131], v[124:127], v[28:31]
    ds_read_b64_tr_b16 v[84:85], v2 offset:9216
    ds_read_b128 v[220:223], v11 offset:768
    v_mfma_f32_16x16x32_bf16 v[32:35], v[132:135], v[112:115], v[32:35]
    ds_read_b64_tr_b16 v[86:87], v2 offset:9728
    ds_read_b64 v[224:225], v5 offset:0
    v_mfma_f32_16x16x32_bf16 v[36:39], v[132:135], v[116:119], v[36:39]
    ds_read_b64_tr_b16 v[88:89], v2 offset:10240
    ds_read_b64 v[226:227], v5 offset:4096
    v_mfma_f32_16x16x32_bf16 v[40:43], v[132:135], v[120:123], v[40:43]
    ds_read_b64_tr_b16 v[90:91], v2 offset:10752
    ds_read_b64 v[228:229], v6 offset:0
    v_mfma_f32_16x16x32_bf16 v[44:47], v[132:135], v[124:127], v[44:47]
    ds_read_b64_tr_b16 v[92:93], v2 offset:11264
    ds_read_b64 v[230:231], v6 offset:4096
    v_mfma_f32_16x16x32_bf16 v[48:51], v[136:139], v[112:115], v[48:51]
    ds_read_b64_tr_b16 v[94:95], v2 offset:11776
    ds_read_b64 v[232:233], v7 offset:0
    v_mfma_f32_16x16x32_bf16 v[52:55], v[136:139], v[116:119], v[52:55]
    ds_read_b128 v[100:103], v4 offset:18432
    ds_read_b64 v[234:235], v7 offset:4096
    v_mfma_f32_16x16x32_bf16 v[56:59], v[136:139], v[120:123], v[56:59]
    ds_read_b128 v[104:107], v4 offset:20480
    ds_read_b64 v[236:237], v8 offset:0
    v_mfma_f32_16x16x32_bf16 v[60:63], v[136:139], v[124:127], v[60:63]
    ds_read_b128 v[108:111], v4 offset:22528
    ds_read_b64 v[238:239], v8 offset:4096
    v_mfma_f32_16x16x32_bf16 v[64:67], v[140:143], v[112:115], v[64:67]
    ds_read_b64 v[240:241], v13 offset:0
    ds_read_b64 v[248:249], v13 offset:256
    v_mfma_f32_16x16x32_bf16 v[68:71], v[140:143], v[116:119], v[68:71]
    ds_read_b64 v[242:243], v13 offset:32
    ds_read_b64 v[250:251], v13 offset:288
    v_mfma_f32_16x16x32_bf16 v[72:75], v[140:143], v[120:123], v[72:75]
    ds_read_b64 v[244:245], v13 offset:64
    ds_read_b64 v[252:253], v13 offset:320
    v_mfma_f32_16x16x32_bf16 v[76:79], v[140:143], v[124:127], v[76:79]
    ds_read_b64 v[246:247], v13 offset:96
    ds_read_b64 v[254:255], v13 offset:352
    s_waitcnt lgkmcnt(0)
    v_mfma_f32_16x16x32_bf16 v[16:19], v[96:99], v[80:83], v[16:19]
    v_mfma_f32_16x16x32_bf16 v[20:23], v[96:99], v[84:87], v[20:23]
    v_mfma_f32_16x16x32_bf16 v[24:27], v[96:99], v[88:91], v[24:27]
    v_mfma_f32_16x16x32_bf16 v[28:31], v[96:99], v[92:95], v[28:31]
    v_mfma_f32_16x16x32_bf16 v[32:35], v[100:103], v[80:83], v[32:35]
    v_mfma_f32_16x16x32_bf16 v[36:39], v[100:103], v[84:87], v[36:39]
    v_mfma_f32_16x16x32_bf16 v[40:43], v[100:103], v[88:91], v[40:43]
    v_mfma_f32_16x16x32_bf16 v[44:47], v[100:103], v[92:95], v[44:47]
    v_mfma_f32_16x16x32_bf16 v[48:51], v[104:107], v[80:83], v[48:51]
    v_mfma_f32_16x16x32_bf16 v[52:55], v[104:107], v[84:87], v[52:55]
    v_mfma_f32_16x16x32_bf16 v[56:59], v[104:107], v[88:91], v[56:59]
    v_mfma_f32_16x16x32_bf16 v[60:63], v[104:107], v[92:95], v[60:63]
    v_mfma_f32_16x16x32_bf16 v[64:67], v[108:111], v[80:83], v[64:67]
    v_mfma_f32_16x16x32_bf16 v[68:71], v[108:111], v[84:87], v[68:71]
    v_mfma_f32_16x16x32_bf16 v[72:75], v[108:111], v[88:91], v[72:75]
    v_mfma_f32_16x16x32_bf16 v[76:79], v[108:111], v[92:95], v[76:79]
    v_lshlrev_b32 v13, 4, v0
    s_mov_b32 s6, 262144
    s_waitcnt lgkmcnt(0)
L_gated_mix__ssm_conv_s5__dense_activation_squared_relu__prompt_kernel_gchk:
    v_xor_b32 v117, s99, v210
    v_xor_b32 v118, s99, v214
    v_or_b32 v117, v117, v118
    v_xor_b32 v118, s99, v218
    v_or_b32 v117, v117, v118
    v_xor_b32 v118, s99, v222
    v_or_b32 v117, v117, v118
    v_cmp_ne_u32 vcc, 0, v117
    s_nop 1
    s_cmp_eq_u64 vcc, 0
    s_cbranch_scc1 L_gated_mix__ssm_conv_s5__dense_activation_squared_relu__prompt_kernel_gok
    s_sub_u32 s6, s6, 1
    s_cbranch_scc1 L_gated_mix__ssm_conv_s5__dense_activation_squared_relu__prompt_kernel_gok
    s_sleep 2
    v_and_b32 v117, 15, v0
    v_lshlrev_b32 v117, 4, v117
    s_lshl_b32 s87, s95, 4
    s_add_u32 s87, s87, 25165824
    buffer_load_dwordx4 v[208:211], v117, s[8:11], s87 offen offset:0 sc1
    buffer_load_dwordx4 v[212:215], v117, s[8:11], s87 offen offset:256 sc1
    buffer_load_dwordx4 v[216:219], v117, s[8:11], s87 offen offset:512 sc1
    buffer_load_dwordx4 v[220:223], v117, s[8:11], s87 offen offset:768 sc1
    s_waitcnt vmcnt(0)
    s_branch L_gated_mix__ssm_conv_s5__dense_activation_squared_relu__prompt_kernel_gchk
L_gated_mix__ssm_conv_s5__dense_activation_squared_relu__prompt_kernel_gok:
    v_add_f32 v112, v208, v208
    v_add_f32 v124, v208, v208
    v_add_f32 v113, v212, v212
    v_add_f32 v126, v212, v212
    v_add_f32 v114, v216, v216
    v_add_f32 v128, v216, v216
    v_add_f32 v115, v220, v220
    v_add_f32 v130, v220, v220
    s_lshl_b32 s87, s82, 5
    s_add_u32 s95, s95, s87
    s_bfe_u32 s87, s99, 524288
    v_mov_b32 v120, s87
    s_bfe_u32 s87, s99, 524296
    v_mov_b32 v121, s87
    s_bfe_u32 s87, s99, 524304
    v_mov_b32 v122, s87
    s_bfe_u32 s87, s99, 524312
    v_mov_b32 v123, s87
    s_mov_b32 s58, 0xffffff00
    s_mov_b32 s59, 0xff
    s_cmp_eq_u32 s82, 1
    s_cbranch_scc1 L_gated_mix__ssm_conv_s5__dense_activation_squared_relu__prompt_kernel_epi1
    v_and_b32 v116, 15, v0
    v_lshlrev_b32 v116, 10, v116
    v_lshrrev_b32 v117, 4, v0
    v_lshlrev_b32 v118, 2, v117
    v_add_u32 v116, v116, v118
    s_add_u32 s85, s91, 4096
    v_mul_f32 v152, v217, v152
    v_mul_f32 v153, v217, v153
    v_mul_f32 v154, v217, v154
    v_mul_f32 v155, v217, v155
    v_fmac_f32 v152, v114, v24
    v_fmac_f32 v153, v114, v25
    v_fmac_f32 v154, v114, v26
    v_fmac_f32 v155, v114, v27
    v_and_or_b32 v152, v152, s58, v120
    v_and_or_b32 v153, v153, s58, v121
    v_and_or_b32 v154, v154, s58, v122
    v_and_or_b32 v155, v155, s58, v123
    buffer_store_dwordx4 v[152:155], v13, s[8:11], s91 offen offset:0 sc1
    v_mul_f32 v156, v221, v156
    v_mul_f32 v157, v221, v157
    v_mul_f32 v158, v221, v158
    v_mul_f32 v159, v221, v159
    v_fmac_f32 v156, v115, v28
    v_fmac_f32 v157, v115, v29
    v_fmac_f32 v158, v115, v30
    v_fmac_f32 v159, v115, v31
    v_and_or_b32 v156, v156, s58, v120
    v_and_or_b32 v157, v157, s58, v121
    v_and_or_b32 v158, v158, s58, v122
    v_and_or_b32 v159, v159, s58, v123
    buffer_store_dwordx4 v[156:159], v13, s[8:11], s91 offen offset:1024 sc1
    v_mul_f32 v168, v217, v168
    v_mul_f32 v169, v217, v169
    v_mul_f32 v170, v217, v170
    v_mul_f32 v171, v217, v171
    v_fmac_f32 v168, v114, v40
    v_fmac_f32 v169, v114, v41
    v_fmac_f32 v170, v114, v42
    v_fmac_f32 v171, v114, v43
    v_and_or_b32 v168, v168, s58, v120
    v_and_or_b32 v169, v169, s58, v121
    v_and_or_b32 v170, v170, s58, v122
    v_and_or_b32 v171, v171, s58, v123
    buffer_store_dwordx4 v[168:171], v13, s[8:11], s91 offen offset:2048 sc1
    v_mul_f32 v172, v221, v172
    v_mul_f32 v173, v221, v173
    v_mul_f32 v174, v221, v174
    v_mul_f32 v175, v221, v175
    v_fmac_f32 v172, v115, v44
    v_fmac_f32 v173, v115, v45
    v_fmac_f32 v174, v115, v46
    v_fmac_f32 v175, v115, v47
    v_and_or_b32 v172, v172, s58, v120
    v_and_or_b32 v173, v173, s58, v121
    v_and_or_b32 v174, v174, s58, v122
    v_and_or_b32 v175, v175, s58, v123
    buffer_store_dwordx4 v[172:175], v13, s[8:11], s91 offen offset:3072 sc1
    v_mul_f32 v184, v217, v184
    v_mul_f32 v185, v217, v185
    v_mul_f32 v186, v217, v186
    v_mul_f32 v187, v217, v187
    v_fmac_f32 v184, v114, v56
    v_fmac_f32 v185, v114, v57
    v_fmac_f32 v186, v114, v58
    v_fmac_f32 v187, v114, v59
    v_and_or_b32 v184, v184, s58, v120
    v_and_or_b32 v185, v185, s58, v121
    v_and_or_b32 v186, v186, s58, v122
    v_and_or_b32 v187, v187, s58, v123
    buffer_store_dwordx4 v[184:187], v13, s[8:11], s85 offen offset:0 sc1
    v_mul_f32 v188, v221, v188
    v_mul_f32 v189, v221, v189
    v_mul_f32 v190, v221, v190
    v_mul_f32 v191, v221, v191
    v_fmac_f32 v188, v115, v60
    v_fmac_f32 v189, v115, v61
    v_fmac_f32 v190, v115, v62
    v_fmac_f32 v191, v115, v63
    v_and_or_b32 v188, v188, s58, v120
    v_and_or_b32 v189, v189, s58, v121
    v_and_or_b32 v190, v190, s58, v122
    v_and_or_b32 v191, v191, s58, v123
    buffer_store_dwordx4 v[188:191], v13, s[8:11], s85 offen offset:1024 sc1
    v_mul_f32 v200, v217, v200
    v_mul_f32 v201, v217, v201
    v_mul_f32 v202, v217, v202
    v_mul_f32 v203, v217, v203
    v_fmac_f32 v200, v114, v72
    v_fmac_f32 v201, v114, v73
    v_fmac_f32 v202, v114, v74
    v_fmac_f32 v203, v114, v75
    v_and_or_b32 v200, v200, s58, v120
    v_and_or_b32 v201, v201, s58, v121
    v_and_or_b32 v202, v202, s58, v122
    v_and_or_b32 v203, v203, s58, v123
    buffer_store_dwordx4 v[200:203], v13, s[8:11], s85 offen offset:2048 sc1
    v_mul_f32 v204, v221, v204
    v_mul_f32 v205, v221, v205
    v_mul_f32 v206, v221, v206
    v_mul_f32 v207, v221, v207
    v_fmac_f32 v204, v115, v76
    v_fmac_f32 v205, v115, v77
    v_fmac_f32 v206, v115, v78
    v_fmac_f32 v207, v115, v79
    v_and_or_b32 v204, v204, s58, v120
    v_and_or_b32 v205, v205, s58, v121
    v_and_or_b32 v206, v206, s58, v122
    v_and_or_b32 v207, v207, s58, v123
    buffer_store_dwordx4 v[204:207], v13, s[8:11], s85 offen offset:3072 sc1
    v_mul_f32 v144, v209, v144
    v_mul_f32 v145, v209, v145
    v_mul_f32 v146, v209, v146
    v_mul_f32 v147, v209, v147
    v_fmac_f32 v144, v112, v16
    v_fmac_f32 v145, v112, v17
    v_fmac_f32 v146, v112, v18
    v_fmac_f32 v147, v112, v19
    v_mul_f32 v148, v213, v148
    v_mul_f32 v149, v213, v149
    v_mul_f32 v150, v213, v150
    v_mul_f32 v151, v213, v151
    v_fmac_f32 v148, v113, v20
    v_fmac_f32 v149, v113, v21
    v_fmac_f32 v150, v113, v22
    v_fmac_f32 v151, v113, v23
    v_mul_f32 v160, v209, v160
    v_mul_f32 v161, v209, v161
    v_mul_f32 v162, v209, v162
    v_mul_f32 v163, v209, v163
    v_fmac_f32 v160, v112, v32
    v_fmac_f32 v161, v112, v33
    v_fmac_f32 v162, v112, v34
    v_fmac_f32 v163, v112, v35
    v_mul_f32 v164, v213, v164
    v_mul_f32 v165, v213, v165
    v_mul_f32 v166, v213, v166
    v_mul_f32 v167, v213, v167
    v_fmac_f32 v164, v113, v36
    v_fmac_f32 v165, v113, v37
    v_fmac_f32 v166, v113, v38
    v_fmac_f32 v167, v113, v39
    v_mul_f32 v176, v209, v176
    v_mul_f32 v177, v209, v177
    v_mul_f32 v178, v209, v178
    v_mul_f32 v179, v209, v179
    v_fmac_f32 v176, v112, v48
    v_fmac_f32 v177, v112, v49
    v_fmac_f32 v178, v112, v50
    v_fmac_f32 v179, v112, v51
    v_mul_f32 v180, v213, v180
    v_mul_f32 v181, v213, v181
    v_mul_f32 v182, v213, v182
    v_mul_f32 v183, v213, v183
    v_fmac_f32 v180, v113, v52
    v_fmac_f32 v181, v113, v53
    v_fmac_f32 v182, v113, v54
    v_fmac_f32 v183, v113, v55
    v_mul_f32 v192, v209, v192
    v_mul_f32 v193, v209, v193
    v_mul_f32 v194, v209, v194
    v_mul_f32 v195, v209, v195
    v_fmac_f32 v192, v112, v64
    v_fmac_f32 v193, v112, v65
    v_fmac_f32 v194, v112, v66
    v_fmac_f32 v195, v112, v67
    v_mul_f32 v196, v213, v196
    v_mul_f32 v197, v213, v197
    v_mul_f32 v198, v213, v198
    v_mul_f32 v199, v213, v199
    v_fmac_f32 v196, v113, v68
    v_fmac_f32 v197, v113, v69
    v_fmac_f32 v198, v113, v70
    v_fmac_f32 v199, v113, v71
    s_add_u32 s85, s93, 4096
    v_lshlrev_b32 v16, 16, v240
    v_and_b32 v17, 0xffff0000, v240
    v_lshlrev_b32 v32, 16, v248
    v_and_b32 v33, 0xffff0000, v248
    v_lshlrev_b32 v18, 16, v241
    v_and_b32 v19, 0xffff0000, v241
    v_lshlrev_b32 v34, 16, v249
    v_and_b32 v35, 0xffff0000, v249
    v_lshlrev_b32 v20, 16, v242
    v_and_b32 v21, 0xffff0000, v242
    v_lshlrev_b32 v36, 16, v250
    v_and_b32 v37, 0xffff0000, v250
    v_lshlrev_b32 v22, 16, v243
    v_and_b32 v23, 0xffff0000, v243
    v_lshlrev_b32 v38, 16, v251
    v_and_b32 v39, 0xffff0000, v251
    v_lshlrev_b32 v24, 16, v244
    v_and_b32 v25, 0xffff0000, v244
    v_lshlrev_b32 v40, 16, v252
    v_and_b32 v41, 0xffff0000, v252
    v_lshlrev_b32 v26, 16, v245
    v_and_b32 v27, 0xffff0000, v245
    v_lshlrev_b32 v42, 16, v253
    v_and_b32 v43, 0xffff0000, v253
    v_lshlrev_b32 v28, 16, v246
    v_and_b32 v29, 0xffff0000, v246
    v_lshlrev_b32 v44, 16, v254
    v_and_b32 v45, 0xffff0000, v254
    v_lshlrev_b32 v30, 16, v247
    v_and_b32 v31, 0xffff0000, v247
    v_lshlrev_b32 v46, 16, v255
    v_and_b32 v47, 0xffff0000, v255
    v_lshlrev_b32 v117, 16, v224
    v_and_b32 v118, 0xffff0000, v224
    v_mul_f32 v117, v117, v16
    v_mul_f32 v118, v118, v17
    v_fmac_f32 v144, v208, v117
    v_fmac_f32 v145, v208, v118
    v_fmac_f32 v144, v209, v32
    v_fmac_f32 v145, v209, v33
    v_lshlrev_b32 v117, 16, v225
    v_and_b32 v118, 0xffff0000, v225
    v_mul_f32 v117, v117, v18
    v_mul_f32 v118, v118, v19
    v_fmac_f32 v146, v208, v117
    v_fmac_f32 v147, v208, v118
    v_fmac_f32 v146, v209, v34
    v_fmac_f32 v147, v209, v35
    v_lshlrev_b32 v117, 16, v226
    v_and_b32 v118, 0xffff0000, v226
    v_mul_f32 v117, v117, v16
    v_mul_f32 v118, v118, v17
    v_fmac_f32 v148, v212, v117
    v_fmac_f32 v149, v212, v118
    v_fmac_f32 v148, v213, v32
    v_fmac_f32 v149, v213, v33
    v_lshlrev_b32 v117, 16, v227
    v_and_b32 v118, 0xffff0000, v227
    v_mul_f32 v117, v117, v18
    v_mul_f32 v118, v118, v19
    v_fmac_f32 v150, v212, v117
    v_fmac_f32 v151, v212, v118
    v_fmac_f32 v150, v213, v34
    v_fmac_f32 v151, v213, v35
    v_lshlrev_b32 v117, 16, v228
    v_and_b32 v118, 0xffff0000, v228
    v_mul_f32 v117, v117, v20
    v_mul_f32 v118, v118, v21
    v_fmac_f32 v160, v208, v117
    v_fmac_f32 v161, v208, v118
    v_fmac_f32 v160, v209, v36
    v_fmac_f32 v161, v209, v37
    v_lshlrev_b32 v117, 16, v229
    v_and_b32 v118, 0xffff0000, v229
    v_mul_f32 v117, v117, v22
    v_mul_f32 v118, v118, v23
    v_fmac_f32 v162, v208, v117
    v_fmac_f32 v163, v208, v118
    v_fmac_f32 v162, v209, v38
    v_fmac_f32 v163, v209, v39
    v_lshlrev_b32 v117, 16, v230
    v_and_b32 v118, 0xffff0000, v230
    v_mul_f32 v117, v117, v20
    v_mul_f32 v118, v118, v21
    v_fmac_f32 v164, v212, v117
    v_fmac_f32 v165, v212, v118
    v_fmac_f32 v164, v213, v36
    v_fmac_f32 v165, v213, v37
    v_lshlrev_b32 v117, 16, v231
    v_and_b32 v118, 0xffff0000, v231
    v_mul_f32 v117, v117, v22
    v_mul_f32 v118, v118, v23
    v_fmac_f32 v166, v212, v117
    v_fmac_f32 v167, v212, v118
    v_fmac_f32 v166, v213, v38
    v_fmac_f32 v167, v213, v39
    v_lshlrev_b32 v117, 16, v232
    v_and_b32 v118, 0xffff0000, v232
    v_mul_f32 v117, v117, v24
    v_mul_f32 v118, v118, v25
    v_fmac_f32 v176, v208, v117
    v_fmac_f32 v177, v208, v118
    v_fmac_f32 v176, v209, v40
    v_fmac_f32 v177, v209, v41
    v_lshlrev_b32 v117, 16, v233
    v_and_b32 v118, 0xffff0000, v233
    v_mul_f32 v117, v117, v26
    v_mul_f32 v118, v118, v27
    v_fmac_f32 v178, v208, v117
    v_fmac_f32 v179, v208, v118
    v_fmac_f32 v178, v209, v42
    v_fmac_f32 v179, v209, v43
    v_lshlrev_b32 v117, 16, v234
    v_and_b32 v118, 0xffff0000, v234
    v_mul_f32 v117, v117, v24
    v_mul_f32 v118, v118, v25
    v_fmac_f32 v180, v212, v117
    v_fmac_f32 v181, v212, v118
    v_fmac_f32 v180, v213, v40
    v_fmac_f32 v181, v213, v41
    v_lshlrev_b32 v117, 16, v235
    v_and_b32 v118, 0xffff0000, v235
    v_mul_f32 v117, v117, v26
    v_mul_f32 v118, v118, v27
    v_fmac_f32 v182, v212, v117
    v_fmac_f32 v183, v212, v118
    v_fmac_f32 v182, v213, v42
    v_fmac_f32 v183, v213, v43
    v_lshlrev_b32 v117, 16, v236
    v_and_b32 v118, 0xffff0000, v236
    v_mul_f32 v117, v117, v28
    v_mul_f32 v118, v118, v29
    v_fmac_f32 v192, v208, v117
    v_fmac_f32 v193, v208, v118
    v_fmac_f32 v192, v209, v44
    v_fmac_f32 v193, v209, v45
    v_lshlrev_b32 v117, 16, v237
    v_and_b32 v118, 0xffff0000, v237
    v_mul_f32 v117, v117, v30
    v_mul_f32 v118, v118, v31
    v_fmac_f32 v194, v208, v117
    v_fmac_f32 v195, v208, v118
    v_fmac_f32 v194, v209, v46
    v_fmac_f32 v195, v209, v47
    v_lshlrev_b32 v117, 16, v238
    v_and_b32 v118, 0xffff0000, v238
    v_mul_f32 v117, v117, v28
    v_mul_f32 v118, v118, v29
    v_fmac_f32 v196, v212, v117
    v_fmac_f32 v197, v212, v118
    v_fmac_f32 v196, v213, v44
    v_fmac_f32 v197, v213, v45
    v_lshlrev_b32 v117, 16, v239
    v_and_b32 v118, 0xffff0000, v239
    v_mul_f32 v117, v117, v30
    v_mul_f32 v118, v118, v31
    v_fmac_f32 v198, v212, v117
    v_fmac_f32 v199, v212, v118
    v_fmac_f32 v198, v213, v46
    v_fmac_f32 v199, v213, v47
    s_mov_b32 s6, 262144
L_gated_mix__ssm_conv_s5__dense_activation_squared_relu__prompt_kernel_xq0:
    buffer_load_dwordx4 v[76:79], v13, s[8:11], s85 offen offset:3072 sc1
    s_waitcnt vmcnt(0)
    v_xor_b32 v118, v76, v120
    v_and_b32 v117, s59, v118
    v_cmp_ne_u32 vcc, 0, v117
    s_nop 1
    s_cmp_eq_u64 vcc, 0
    s_cbranch_scc1 L_gated_mix__ssm_conv_s5__dense_activation_squared_relu__prompt_kernel_xr0
    s_sub_u32 s6, s6, 1
    s_cbranch_scc1 L_gated_mix__ssm_conv_s5__dense_activation_squared_relu__prompt_kernel_xr0
    s_sleep 1
    s_branch L_gated_mix__ssm_conv_s5__dense_activation_squared_relu__prompt_kernel_xq0
L_gated_mix__ssm_conv_s5__dense_activation_squared_relu__prompt_kernel_xr0:
    buffer_load_dwordx4 v[48:51], v13, s[8:11], s93 offen offset:0 sc1
    buffer_load_dwordx4 v[52:55], v13, s[8:11], s93 offen offset:1024 sc1
    buffer_load_dwordx4 v[56:59], v13, s[8:11], s93 offen offset:2048 sc1
    buffer_load_dwordx4 v[60:63], v13, s[8:11], s93 offen offset:3072 sc1
    buffer_load_dwordx4 v[64:67], v13, s[8:11], s85 offen offset:0 sc1
    buffer_load_dwordx4 v[68:71], v13, s[8:11], s85 offen offset:1024 sc1
    buffer_load_dwordx4 v[72:75], v13, s[8:11], s85 offen offset:2048 sc1
    buffer_load_dwordx4 v[76:79], v13, s[8:11], s85 offen offset:3072 sc1
L_gated_mix__ssm_conv_s5__dense_activation_squared_relu__prompt_kernel_xp0:
    s_waitcnt vmcnt(0)
    v_mov_b32 v117, 0
    v_xor_b32 v118, v48, v120
    v_and_or_b32 v117, v118, s59, v117
    v_xor_b32 v118, v49, v121
    v_and_or_b32 v117, v118, s59, v117
    v_xor_b32 v118, v50, v122
    v_and_or_b32 v117, v118, s59, v117
    v_xor_b32 v118, v51, v123
    v_and_or_b32 v117, v118, s59, v117
    v_xor_b32 v118, v52, v120
    v_and_or_b32 v117, v118, s59, v117
    v_xor_b32 v118, v53, v121
    v_and_or_b32 v117, v118, s59, v117
    v_xor_b32 v118, v54, v122
    v_and_or_b32 v117, v118, s59, v117
    v_xor_b32 v118, v55, v123
    v_and_or_b32 v117, v118, s59, v117
    v_xor_b32 v118, v56, v120
    v_and_or_b32 v117, v118, s59, v117
    v_xor_b32 v118, v57, v121
    v_and_or_b32 v117, v118, s59, v117
    v_xor_b32 v118, v58, v122
    v_and_or_b32 v117, v118, s59, v117
    v_xor_b32 v118, v59, v123
    v_and_or_b32 v117, v118, s59, v117
    v_xor_b32 v118, v60, v120
    v_and_or_b32 v117, v118, s59, v117
    v_xor_b32 v118, v61, v121
    v_and_or_b32 v117, v118, s59, v117
    v_xor_b32 v118, v62, v122
    v_and_or_b32 v117, v118, s59, v117
    v_xor_b32 v118, v63, v123
    v_and_or_b32 v117, v118, s59, v117
    v_xor_b32 v118, v64, v120
    v_and_or_b32 v117, v118, s59, v117
    v_xor_b32 v118, v65, v121
    v_and_or_b32 v117, v118, s59, v117
    v_xor_b32 v118, v66, v122
    v_and_or_b32 v117, v118, s59, v117
    v_xor_b32 v118, v67, v123
    v_and_or_b32 v117, v118, s59, v117
    v_xor_b32 v118, v68, v120
    v_and_or_b32 v117, v118, s59, v117
    v_xor_b32 v118, v69, v121
    v_and_or_b32 v117, v118, s59, v117
    v_xor_b32 v118, v70, v122
    v_and_or_b32 v117, v118, s59, v117
    v_xor_b32 v118, v71, v123
    v_and_or_b32 v117, v118, s59, v117
    v_xor_b32 v118, v72, v120
    v_and_or_b32 v117, v118, s59, v117
    v_xor_b32 v118, v73, v121
    v_and_or_b32 v117, v118, s59, v117
    v_xor_b32 v118, v74, v122
    v_and_or_b32 v117, v118, s59, v117
    v_xor_b32 v118, v75, v123
    v_and_or_b32 v117, v118, s59, v117
    v_xor_b32 v118, v76, v120
    v_and_or_b32 v117, v118, s59, v117
    v_xor_b32 v118, v77, v121
    v_and_or_b32 v117, v118, s59, v117
    v_xor_b32 v118, v78, v122
    v_and_or_b32 v117, v118, s59, v117
    v_xor_b32 v118, v79, v123
    v_and_or_b32 v117, v118, s59, v117
    v_cmp_ne_u32 vcc, 0, v117
    s_nop 1
    s_cmp_eq_u64 vcc, 0
    s_cbranch_scc1 L_gated_mix__ssm_conv_s5__dense_activation_squared_relu__prompt_kernel_xg0
    s_sub_u32 s6, s6, 1
    s_cbranch_scc1 L_gated_mix__ssm_conv_s5__dense_activation_squared_relu__prompt_kernel_xg0
    buffer_load_dwordx4 v[48:51], v13, s[8:11], s93 offen offset:0 sc1
    buffer_load_dwordx4 v[52:55], v13, s[8:11], s93 offen offset:1024 sc1
    buffer_load_dwordx4 v[56:59], v13, s[8:11], s93 offen offset:2048 sc1
    buffer_load_dwordx4 v[60:63], v13, s[8:11], s93 offen offset:3072 sc1
    buffer_load_dwordx4 v[64:67], v13, s[8:11], s85 offen offset:0 sc1
    buffer_load_dwordx4 v[68:71], v13, s[8:11], s85 offen offset:1024 sc1
    buffer_load_dwordx4 v[72:75], v13, s[8:11], s85 offen offset:2048 sc1
    buffer_load_dwordx4 v[76:79], v13, s[8:11], s85 offen offset:3072 sc1
    s_branch L_gated_mix__ssm_conv_s5__dense_activation_squared_relu__prompt_kernel_xp0
L_gated_mix__ssm_conv_s5__dense_activation_squared_relu__prompt_kernel_xg0:
    v_and_b32 v117, 7, v0
    v_lshlrev_b32 v117, 12, v117
    v_lshrrev_b32 v118, 3, v0
    v_and_b32 v118, 1, v118
    v_lshlrev_b32 v118, 6, v118
    v_add_u32 v117, v117, v118
    v_lshrrev_b32 v118, 4, v0
    v_lshlrev_b32 v118, 4, v118
    v_add_u32 v117, v117, v118
    s_mov_b32 s58, 0x00ff00ff
    s_mov_b32 s59, 0x00ff00ff
    s_lshl_b32 s86, s95, 10
    s_add_u32 s86, s86, s96
    s_lshl_b32 s86, s86, 2
    s_add_u32 s87, s86, 32768
    s_add_u32 s88, s86, 65536
    s_add_u32 s85, s86, 98304
    v_add_f32 v144, v144, v48
    v_add_f32 v145, v145, v49
    v_add_f32 v146, v146, v50
    v_add_f32 v147, v147, v51
    v_add_f32 v148, v148, v52
    v_add_f32 v149, v149, v53
    v_add_f32 v150, v150, v54
    v_add_f32 v151, v151, v55
    v_add_f32 v160, v160, v56
    v_add_f32 v161, v161, v57
    v_add_f32 v162, v162, v58
    v_add_f32 v163, v163, v59
    v_add_f32 v164, v164, v60
    v_add_f32 v165, v165, v61
    v_add_f32 v166, v166, v62
    v_add_f32 v167, v167, v63
    v_add_f32 v176, v176, v64
    v_add_f32 v177, v177, v65
    v_add_f32 v178, v178, v66
    v_add_f32 v179, v179, v67
    v_add_f32 v180, v180, v68
    v_add_f32 v181, v181, v69
    v_add_f32 v182, v182, v70
    v_add_f32 v183, v183, v71
    v_add_f32 v192, v192, v72
    v_add_f32 v193, v193, v73
    v_add_f32 v194, v194, v74
    v_add_f32 v195, v195, v75
    v_add_f32 v196, v196, v76
    v_add_f32 v197, v197, v77
    v_add_f32 v198, v198, v78
    v_add_f32 v199, v199, v79
    v_mov_b32_dpp v48, v160 row_ror:8 row_mask:0xf bank_mask:0xf
    v_mov_b32_dpp v49, v161 row_ror:8 row_mask:0xf bank_mask:0xf
    v_mov_b32_dpp v50, v162 row_ror:8 row_mask:0xf bank_mask:0xf
    v_mov_b32_dpp v51, v163 row_ror:8 row_mask:0xf bank_mask:0xf
    v_mov_b32_dpp v52, v144 row_ror:8 row_mask:0xf bank_mask:0xf
    v_mov_b32_dpp v53, v145 row_ror:8 row_mask:0xf bank_mask:0xf
    v_mov_b32_dpp v54, v146 row_ror:8 row_mask:0xf bank_mask:0xf
    v_mov_b32_dpp v55, v147 row_ror:8 row_mask:0xf bank_mask:0xf
    v_cndmask_b32 v48, v48, v144, s[58:59]
    v_cndmask_b32 v49, v49, v145, s[58:59]
    v_cndmask_b32 v50, v50, v146, s[58:59]
    v_cndmask_b32 v51, v51, v147, s[58:59]
    v_cndmask_b32 v52, v160, v52, s[58:59]
    v_cndmask_b32 v53, v161, v53, s[58:59]
    v_cndmask_b32 v54, v162, v54, s[58:59]
    v_cndmask_b32 v55, v163, v55, s[58:59]
    buffer_store_dwordx4 v[48:51], v117, s[16:19], s86 offen offset:0 sc1
    buffer_store_dwordx4 v[52:55], v117, s[16:19], s87 offen offset:0 sc1
    v_mov_b32_dpp v56, v164 row_ror:8 row_mask:0xf bank_mask:0xf
    v_mov_b32_dpp v57, v165 row_ror:8 row_mask:0xf bank_mask:0xf
    v_mov_b32_dpp v58, v166 row_ror:8 row_mask:0xf bank_mask:0xf
    v_mov_b32_dpp v59, v167 row_ror:8 row_mask:0xf bank_mask:0xf
    v_mov_b32_dpp v60, v148 row_ror:8 row_mask:0xf bank_mask:0xf
    v_mov_b32_dpp v61, v149 row_ror:8 row_mask:0xf bank_mask:0xf
    v_mov_b32_dpp v62, v150 row_ror:8 row_mask:0xf bank_mask:0xf
    v_mov_b32_dpp v63, v151 row_ror:8 row_mask:0xf bank_mask:0xf
    v_cndmask_b32 v56, v56, v148, s[58:59]
    v_cndmask_b32 v57, v57, v149, s[58:59]
    v_cndmask_b32 v58, v58, v150, s[58:59]
    v_cndmask_b32 v59, v59, v151, s[58:59]
    v_cndmask_b32 v60, v164, v60, s[58:59]
    v_cndmask_b32 v61, v165, v61, s[58:59]
    v_cndmask_b32 v62, v166, v62, s[58:59]
    v_cndmask_b32 v63, v167, v63, s[58:59]
    buffer_store_dwordx4 v[56:59], v117, s[16:19], s88 offen offset:0 sc1
    buffer_store_dwordx4 v[60:63], v117, s[16:19], s85 offen offset:0 sc1
    v_mov_b32_dpp v64, v192 row_ror:8 row_mask:0xf bank_mask:0xf
    v_mov_b32_dpp v65, v193 row_ror:8 row_mask:0xf bank_mask:0xf
    v_mov_b32_dpp v66, v194 row_ror:8 row_mask:0xf bank_mask:0xf
    v_mov_b32_dpp v67, v195 row_ror:8 row_mask:0xf bank_mask:0xf
    v_mov_b32_dpp v68, v176 row_ror:8 row_mask:0xf bank_mask:0xf
    v_mov_b32_dpp v69, v177 row_ror:8 row_mask:0xf bank_mask:0xf
    v_mov_b32_dpp v70, v178 row_ror:8 row_mask:0xf bank_mask:0xf
    v_mov_b32_dpp v71, v179 row_ror:8 row_mask:0xf bank_mask:0xf
    v_cndmask_b32 v64, v64, v176, s[58:59]
    v_cndmask_b32 v65, v65, v177, s[58:59]
    v_cndmask_b32 v66, v66, v178, s[58:59]
    v_cndmask_b32 v67, v67, v179, s[58:59]
    v_cndmask_b32 v68, v192, v68, s[58:59]
    v_cndmask_b32 v69, v193, v69, s[58:59]
    v_cndmask_b32 v70, v194, v70, s[58:59]
    v_cndmask_b32 v71, v195, v71, s[58:59]
    buffer_store_dwordx4 v[64:67], v117, s[16:19], s86 offen offset:128 sc1
    buffer_store_dwordx4 v[68:71], v117, s[16:19], s87 offen offset:128 sc1
    v_mov_b32_dpp v72, v196 row_ror:8 row_mask:0xf bank_mask:0xf
    v_mov_b32_dpp v73, v197 row_ror:8 row_mask:0xf bank_mask:0xf
    v_mov_b32_dpp v74, v198 row_ror:8 row_mask:0xf bank_mask:0xf
    v_mov_b32_dpp v75, v199 row_ror:8 row_mask:0xf bank_mask:0xf
    v_mov_b32_dpp v76, v180 row_ror:8 row_mask:0xf bank_mask:0xf
    v_mov_b32_dpp v77, v181 row_ror:8 row_mask:0xf bank_mask:0xf
    v_mov_b32_dpp v78, v182 row_ror:8 row_mask:0xf bank_mask:0xf
    v_mov_b32_dpp v79, v183 row_ror:8 row_mask:0xf bank_mask:0xf
    v_cndmask_b32 v72, v72, v180, s[58:59]
    v_cndmask_b32 v73, v73, v181, s[58:59]
    v_cndmask_b32 v74, v74, v182, s[58:59]
    v_cndmask_b32 v75, v75, v183, s[58:59]
    v_cndmask_b32 v76, v196, v76, s[58:59]
    v_cndmask_b32 v77, v197, v77, s[58:59]
    v_cndmask_b32 v78, v198, v78, s[58:59]
    v_cndmask_b32 v79, v199, v79, s[58:59]
    buffer_store_dwordx4 v[72:75], v117, s[16:19], s88 offen offset:128 sc1
    buffer_store_dwordx4 v[76:79], v117, s[16:19], s85 offen offset:128 sc1
    s_branch L_gated_mix__ssm_conv_s5__dense_activation_squared_relu__prompt_kernel_fin
L_gated_mix__ssm_conv_s5__dense_activation_squared_relu__prompt_kernel_epi1:
    v_and_b32 v116, 15, v0
    v_lshlrev_b32 v116, 10, v116
    v_lshrrev_b32 v117, 4, v0
    v_lshlrev_b32 v118, 2, v117
    v_add_u32 v116, v116, v118
    s_add_u32 s85, s91, 4096
    v_mul_f32 v144, v209, v144
    v_mul_f32 v145, v209, v145
    v_mul_f32 v146, v209, v146
    v_mul_f32 v147, v209, v147
    v_fmac_f32 v144, v112, v16
    v_fmac_f32 v145, v112, v17
    v_fmac_f32 v146, v112, v18
    v_fmac_f32 v147, v112, v19
    v_and_or_b32 v144, v144, s58, v120
    v_and_or_b32 v145, v145, s58, v121
    v_and_or_b32 v146, v146, s58, v122
    v_and_or_b32 v147, v147, s58, v123
    buffer_store_dwordx4 v[144:147], v13, s[8:11], s91 offen offset:0 sc1
    v_mul_f32 v148, v213, v148
    v_mul_f32 v149, v213, v149
    v_mul_f32 v150, v213, v150
    v_mul_f32 v151, v213, v151
    v_fmac_f32 v148, v113, v20
    v_fmac_f32 v149, v113, v21
    v_fmac_f32 v150, v113, v22
    v_fmac_f32 v151, v113, v23
    v_and_or_b32 v148, v148, s58, v120
    v_and_or_b32 v149, v149, s58, v121
    v_and_or_b32 v150, v150, s58, v122
    v_and_or_b32 v151, v151, s58, v123
    buffer_store_dwordx4 v[148:151], v13, s[8:11], s91 offen offset:1024 sc1
    v_mul_f32 v160, v209, v160
    v_mul_f32 v161, v209, v161
    v_mul_f32 v162, v209, v162
    v_mul_f32 v163, v209, v163
    v_fmac_f32 v160, v112, v32
    v_fmac_f32 v161, v112, v33
    v_fmac_f32 v162, v112, v34
    v_fmac_f32 v163, v112, v35
    v_and_or_b32 v160, v160, s58, v120
    v_and_or_b32 v161, v161, s58, v121
    v_and_or_b32 v162, v162, s58, v122
    v_and_or_b32 v163, v163, s58, v123
    buffer_store_dwordx4 v[160:163], v13, s[8:11], s91 offen offset:2048 sc1
    v_mul_f32 v164, v213, v164
    v_mul_f32 v165, v213, v165
    v_mul_f32 v166, v213, v166
    v_mul_f32 v167, v213, v167
    v_fmac_f32 v164, v113, v36
    v_fmac_f32 v165, v113, v37
    v_fmac_f32 v166, v113, v38
    v_fmac_f32 v167, v113, v39
    v_and_or_b32 v164, v164, s58, v120
    v_and_or_b32 v165, v165, s58, v121
    v_and_or_b32 v166, v166, s58, v122
    v_and_or_b32 v167, v167, s58, v123
    buffer_store_dwordx4 v[164:167], v13, s[8:11], s91 offen offset:3072 sc1
    v_mul_f32 v176, v209, v176
    v_mul_f32 v177, v209, v177
    v_mul_f32 v178, v209, v178
    v_mul_f32 v179, v209, v179
    v_fmac_f32 v176, v112, v48
    v_fmac_f32 v177, v112, v49
    v_fmac_f32 v178, v112, v50
    v_fmac_f32 v179, v112, v51
    v_and_or_b32 v176, v176, s58, v120
    v_and_or_b32 v177, v177, s58, v121
    v_and_or_b32 v178, v178, s58, v122
    v_and_or_b32 v179, v179, s58, v123
    buffer_store_dwordx4 v[176:179], v13, s[8:11], s85 offen offset:0 sc1
    v_mul_f32 v180, v213, v180
    v_mul_f32 v181, v213, v181
    v_mul_f32 v182, v213, v182
    v_mul_f32 v183, v213, v183
    v_fmac_f32 v180, v113, v52
    v_fmac_f32 v181, v113, v53
    v_fmac_f32 v182, v113, v54
    v_fmac_f32 v183, v113, v55
    v_and_or_b32 v180, v180, s58, v120
    v_and_or_b32 v181, v181, s58, v121
    v_and_or_b32 v182, v182, s58, v122
    v_and_or_b32 v183, v183, s58, v123
    buffer_store_dwordx4 v[180:183], v13, s[8:11], s85 offen offset:1024 sc1
    v_mul_f32 v192, v209, v192
    v_mul_f32 v193, v209, v193
    v_mul_f32 v194, v209, v194
    v_mul_f32 v195, v209, v195
    v_fmac_f32 v192, v112, v64
    v_fmac_f32 v193, v112, v65
    v_fmac_f32 v194, v112, v66
    v_fmac_f32 v195, v112, v67
    v_and_or_b32 v192, v192, s58, v120
    v_and_or_b32 v193, v193, s58, v121
    v_and_or_b32 v194, v194, s58, v122
    v_and_or_b32 v195, v195, s58, v123
    buffer_store_dwordx4 v[192:195], v13, s[8:11], s85 offen offset:2048 sc1
    v_mul_f32 v196, v213, v196
    v_mul_f32 v197, v213, v197
    v_mul_f32 v198, v213, v198
    v_mul_f32 v199, v213, v199
    v_fmac_f32 v196, v113, v68
    v_fmac_f32 v197, v113, v69
    v_fmac_f32 v198, v113, v70
    v_fmac_f32 v199, v113, v71
    v_and_or_b32 v196, v196, s58, v120
    v_and_or_b32 v197, v197, s58, v121
    v_and_or_b32 v198, v198, s58, v122
    v_and_or_b32 v199, v199, s58, v123
    buffer_store_dwordx4 v[196:199], v13, s[8:11], s85 offen offset:3072 sc1
    v_mul_f32 v152, v217, v152
    v_mul_f32 v153, v217, v153
    v_mul_f32 v154, v217, v154
    v_mul_f32 v155, v217, v155
    v_fmac_f32 v152, v114, v24
    v_fmac_f32 v153, v114, v25
    v_fmac_f32 v154, v114, v26
    v_fmac_f32 v155, v114, v27
    v_mul_f32 v156, v221, v156
    v_mul_f32 v157, v221, v157
    v_mul_f32 v158, v221, v158
    v_mul_f32 v159, v221, v159
    v_fmac_f32 v156, v115, v28
    v_fmac_f32 v157, v115, v29
    v_fmac_f32 v158, v115, v30
    v_fmac_f32 v159, v115, v31
    v_mul_f32 v168, v217, v168
    v_mul_f32 v169, v217, v169
    v_mul_f32 v170, v217, v170
    v_mul_f32 v171, v217, v171
    v_fmac_f32 v168, v114, v40
    v_fmac_f32 v169, v114, v41
    v_fmac_f32 v170, v114, v42
    v_fmac_f32 v171, v114, v43
    v_mul_f32 v172, v221, v172
    v_mul_f32 v173, v221, v173
    v_mul_f32 v174, v221, v174
    v_mul_f32 v175, v221, v175
    v_fmac_f32 v172, v115, v44
    v_fmac_f32 v173, v115, v45
    v_fmac_f32 v174, v115, v46
    v_fmac_f32 v175, v115, v47
    v_mul_f32 v184, v217, v184
    v_mul_f32 v185, v217, v185
    v_mul_f32 v186, v217, v186
    v_mul_f32 v187, v217, v187
    v_fmac_f32 v184, v114, v56
    v_fmac_f32 v185, v114, v57
    v_fmac_f32 v186, v114, v58
    v_fmac_f32 v187, v114, v59
    v_mul_f32 v188, v221, v188
    v_mul_f32 v189, v221, v189
    v_mul_f32 v190, v221, v190
    v_mul_f32 v191, v221, v191
    v_fmac_f32 v188, v115, v60
    v_fmac_f32 v189, v115, v61
    v_fmac_f32 v190, v115, v62
    v_fmac_f32 v191, v115, v63
    v_mul_f32 v200, v217, v200
    v_mul_f32 v201, v217, v201
    v_mul_f32 v202, v217, v202
    v_mul_f32 v203, v217, v203
    v_fmac_f32 v200, v114, v72
    v_fmac_f32 v201, v114, v73
    v_fmac_f32 v202, v114, v74
    v_fmac_f32 v203, v114, v75
    v_mul_f32 v204, v221, v204
    v_mul_f32 v205, v221, v205
    v_mul_f32 v206, v221, v206
    v_mul_f32 v207, v221, v207
    v_fmac_f32 v204, v115, v76
    v_fmac_f32 v205, v115, v77
    v_fmac_f32 v206, v115, v78
    v_fmac_f32 v207, v115, v79
    s_add_u32 s85, s93, 4096
    v_lshlrev_b32 v16, 16, v240
    v_and_b32 v17, 0xffff0000, v240
    v_lshlrev_b32 v32, 16, v248
    v_and_b32 v33, 0xffff0000, v248
    v_lshlrev_b32 v18, 16, v241
    v_and_b32 v19, 0xffff0000, v241
    v_lshlrev_b32 v34, 16, v249
    v_and_b32 v35, 0xffff0000, v249
    v_lshlrev_b32 v20, 16, v242
    v_and_b32 v21, 0xffff0000, v242
    v_lshlrev_b32 v36, 16, v250
    v_and_b32 v37, 0xffff0000, v250
    v_lshlrev_b32 v22, 16, v243
    v_and_b32 v23, 0xffff0000, v243
    v_lshlrev_b32 v38, 16, v251
    v_and_b32 v39, 0xffff0000, v251
    v_lshlrev_b32 v24, 16, v244
    v_and_b32 v25, 0xffff0000, v244
    v_lshlrev_b32 v40, 16, v252
    v_and_b32 v41, 0xffff0000, v252
    v_lshlrev_b32 v26, 16, v245
    v_and_b32 v27, 0xffff0000, v245
    v_lshlrev_b32 v42, 16, v253
    v_and_b32 v43, 0xffff0000, v253
    v_lshlrev_b32 v28, 16, v246
    v_and_b32 v29, 0xffff0000, v246
    v_lshlrev_b32 v44, 16, v254
    v_and_b32 v45, 0xffff0000, v254
    v_lshlrev_b32 v30, 16, v247
    v_and_b32 v31, 0xffff0000, v247
    v_lshlrev_b32 v46, 16, v255
    v_and_b32 v47, 0xffff0000, v255
    v_lshlrev_b32 v117, 16, v224
    v_and_b32 v118, 0xffff0000, v224
    v_mul_f32 v117, v117, v16
    v_mul_f32 v118, v118, v17
    v_fmac_f32 v152, v216, v117
    v_fmac_f32 v153, v216, v118
    v_fmac_f32 v152, v217, v32
    v_fmac_f32 v153, v217, v33
    v_lshlrev_b32 v117, 16, v225
    v_and_b32 v118, 0xffff0000, v225
    v_mul_f32 v117, v117, v18
    v_mul_f32 v118, v118, v19
    v_fmac_f32 v154, v216, v117
    v_fmac_f32 v155, v216, v118
    v_fmac_f32 v154, v217, v34
    v_fmac_f32 v155, v217, v35
    v_lshlrev_b32 v117, 16, v226
    v_and_b32 v118, 0xffff0000, v226
    v_mul_f32 v117, v117, v16
    v_mul_f32 v118, v118, v17
    v_fmac_f32 v156, v220, v117
    v_fmac_f32 v157, v220, v118
    v_fmac_f32 v156, v221, v32
    v_fmac_f32 v157, v221, v33
    v_lshlrev_b32 v117, 16, v227
    v_and_b32 v118, 0xffff0000, v227
    v_mul_f32 v117, v117, v18
    v_mul_f32 v118, v118, v19
    v_fmac_f32 v158, v220, v117
    v_fmac_f32 v159, v220, v118
    v_fmac_f32 v158, v221, v34
    v_fmac_f32 v159, v221, v35
    v_lshlrev_b32 v117, 16, v228
    v_and_b32 v118, 0xffff0000, v228
    v_mul_f32 v117, v117, v20
    v_mul_f32 v118, v118, v21
    v_fmac_f32 v168, v216, v117
    v_fmac_f32 v169, v216, v118
    v_fmac_f32 v168, v217, v36
    v_fmac_f32 v169, v217, v37
    v_lshlrev_b32 v117, 16, v229
    v_and_b32 v118, 0xffff0000, v229
    v_mul_f32 v117, v117, v22
    v_mul_f32 v118, v118, v23
    v_fmac_f32 v170, v216, v117
    v_fmac_f32 v171, v216, v118
    v_fmac_f32 v170, v217, v38
    v_fmac_f32 v171, v217, v39
    v_lshlrev_b32 v117, 16, v230
    v_and_b32 v118, 0xffff0000, v230
    v_mul_f32 v117, v117, v20
    v_mul_f32 v118, v118, v21
    v_fmac_f32 v172, v220, v117
    v_fmac_f32 v173, v220, v118
    v_fmac_f32 v172, v221, v36
    v_fmac_f32 v173, v221, v37
    v_lshlrev_b32 v117, 16, v231
    v_and_b32 v118, 0xffff0000, v231
    v_mul_f32 v117, v117, v22
    v_mul_f32 v118, v118, v23
    v_fmac_f32 v174, v220, v117
    v_fmac_f32 v175, v220, v118
    v_fmac_f32 v174, v221, v38
    v_fmac_f32 v175, v221, v39
    v_lshlrev_b32 v117, 16, v232
    v_and_b32 v118, 0xffff0000, v232
    v_mul_f32 v117, v117, v24
    v_mul_f32 v118, v118, v25
    v_fmac_f32 v184, v216, v117
    v_fmac_f32 v185, v216, v118
    v_fmac_f32 v184, v217, v40
    v_fmac_f32 v185, v217, v41
    v_lshlrev_b32 v117, 16, v233
    v_and_b32 v118, 0xffff0000, v233
    v_mul_f32 v117, v117, v26
    v_mul_f32 v118, v118, v27
    v_fmac_f32 v186, v216, v117
    v_fmac_f32 v187, v216, v118
    v_fmac_f32 v186, v217, v42
    v_fmac_f32 v187, v217, v43
    v_lshlrev_b32 v117, 16, v234
    v_and_b32 v118, 0xffff0000, v234
    v_mul_f32 v117, v117, v24
    v_mul_f32 v118, v118, v25
    v_fmac_f32 v188, v220, v117
    v_fmac_f32 v189, v220, v118
    v_fmac_f32 v188, v221, v40
    v_fmac_f32 v189, v221, v41
    v_lshlrev_b32 v117, 16, v235
    v_and_b32 v118, 0xffff0000, v235
    v_mul_f32 v117, v117, v26
    v_mul_f32 v118, v118, v27
    v_fmac_f32 v190, v220, v117
    v_fmac_f32 v191, v220, v118
    v_fmac_f32 v190, v221, v42
    v_fmac_f32 v191, v221, v43
    v_lshlrev_b32 v117, 16, v236
    v_and_b32 v118, 0xffff0000, v236
    v_mul_f32 v117, v117, v28
    v_mul_f32 v118, v118, v29
    v_fmac_f32 v200, v216, v117
    v_fmac_f32 v201, v216, v118
    v_fmac_f32 v200, v217, v44
    v_fmac_f32 v201, v217, v45
    v_lshlrev_b32 v117, 16, v237
    v_and_b32 v118, 0xffff0000, v237
    v_mul_f32 v117, v117, v30
    v_mul_f32 v118, v118, v31
    v_fmac_f32 v202, v216, v117
    v_fmac_f32 v203, v216, v118
    v_fmac_f32 v202, v217, v46
    v_fmac_f32 v203, v217, v47
    v_lshlrev_b32 v117, 16, v238
    v_and_b32 v118, 0xffff0000, v238
    v_mul_f32 v117, v117, v28
    v_mul_f32 v118, v118, v29
    v_fmac_f32 v204, v220, v117
    v_fmac_f32 v205, v220, v118
    v_fmac_f32 v204, v221, v44
    v_fmac_f32 v205, v221, v45
    v_lshlrev_b32 v117, 16, v239
    v_and_b32 v118, 0xffff0000, v239
    v_mul_f32 v117, v117, v30
    v_mul_f32 v118, v118, v31
    v_fmac_f32 v206, v220, v117
    v_fmac_f32 v207, v220, v118
    v_fmac_f32 v206, v221, v46
    v_fmac_f32 v207, v221, v47
    s_mov_b32 s6, 262144
L_gated_mix__ssm_conv_s5__dense_activation_squared_relu__prompt_kernel_xq1:
    buffer_load_dwordx4 v[76:79], v13, s[8:11], s85 offen offset:3072 sc1
    s_waitcnt vmcnt(0)
    v_xor_b32 v118, v76, v120
    v_and_b32 v117, s59, v118
    v_cmp_ne_u32 vcc, 0, v117
    s_nop 1
    s_cmp_eq_u64 vcc, 0
    s_cbranch_scc1 L_gated_mix__ssm_conv_s5__dense_activation_squared_relu__prompt_kernel_xr1
    s_sub_u32 s6, s6, 1
    s_cbranch_scc1 L_gated_mix__ssm_conv_s5__dense_activation_squared_relu__prompt_kernel_xr1
    s_sleep 1
    s_branch L_gated_mix__ssm_conv_s5__dense_activation_squared_relu__prompt_kernel_xq1
L_gated_mix__ssm_conv_s5__dense_activation_squared_relu__prompt_kernel_xr1:
    buffer_load_dwordx4 v[48:51], v13, s[8:11], s93 offen offset:0 sc1
    buffer_load_dwordx4 v[52:55], v13, s[8:11], s93 offen offset:1024 sc1
    buffer_load_dwordx4 v[56:59], v13, s[8:11], s93 offen offset:2048 sc1
    buffer_load_dwordx4 v[60:63], v13, s[8:11], s93 offen offset:3072 sc1
    buffer_load_dwordx4 v[64:67], v13, s[8:11], s85 offen offset:0 sc1
    buffer_load_dwordx4 v[68:71], v13, s[8:11], s85 offen offset:1024 sc1
    buffer_load_dwordx4 v[72:75], v13, s[8:11], s85 offen offset:2048 sc1
    buffer_load_dwordx4 v[76:79], v13, s[8:11], s85 offen offset:3072 sc1
L_gated_mix__ssm_conv_s5__dense_activation_squared_relu__prompt_kernel_xp1:
    s_waitcnt vmcnt(0)
    v_mov_b32 v117, 0
    v_xor_b32 v118, v48, v120
    v_and_or_b32 v117, v118, s59, v117
    v_xor_b32 v118, v49, v121
    v_and_or_b32 v117, v118, s59, v117
    v_xor_b32 v118, v50, v122
    v_and_or_b32 v117, v118, s59, v117
    v_xor_b32 v118, v51, v123
    v_and_or_b32 v117, v118, s59, v117
    v_xor_b32 v118, v52, v120
    v_and_or_b32 v117, v118, s59, v117
    v_xor_b32 v118, v53, v121
    v_and_or_b32 v117, v118, s59, v117
    v_xor_b32 v118, v54, v122
    v_and_or_b32 v117, v118, s59, v117
    v_xor_b32 v118, v55, v123
    v_and_or_b32 v117, v118, s59, v117
    v_xor_b32 v118, v56, v120
    v_and_or_b32 v117, v118, s59, v117
    v_xor_b32 v118, v57, v121
    v_and_or_b32 v117, v118, s59, v117
    v_xor_b32 v118, v58, v122
    v_and_or_b32 v117, v118, s59, v117
    v_xor_b32 v118, v59, v123
    v_and_or_b32 v117, v118, s59, v117
    v_xor_b32 v118, v60, v120
    v_and_or_b32 v117, v118, s59, v117
    v_xor_b32 v118, v61, v121
    v_and_or_b32 v117, v118, s59, v117
    v_xor_b32 v118, v62, v122
    v_and_or_b32 v117, v118, s59, v117
    v_xor_b32 v118, v63, v123
    v_and_or_b32 v117, v118, s59, v117
    v_xor_b32 v118, v64, v120
    v_and_or_b32 v117, v118, s59, v117
    v_xor_b32 v118, v65, v121
    v_and_or_b32 v117, v118, s59, v117
    v_xor_b32 v118, v66, v122
    v_and_or_b32 v117, v118, s59, v117
    v_xor_b32 v118, v67, v123
    v_and_or_b32 v117, v118, s59, v117
    v_xor_b32 v118, v68, v120
    v_and_or_b32 v117, v118, s59, v117
    v_xor_b32 v118, v69, v121
    v_and_or_b32 v117, v118, s59, v117
    v_xor_b32 v118, v70, v122
    v_and_or_b32 v117, v118, s59, v117
    v_xor_b32 v118, v71, v123
    v_and_or_b32 v117, v118, s59, v117
    v_xor_b32 v118, v72, v120
    v_and_or_b32 v117, v118, s59, v117
    v_xor_b32 v118, v73, v121
    v_and_or_b32 v117, v118, s59, v117
    v_xor_b32 v118, v74, v122
    v_and_or_b32 v117, v118, s59, v117
    v_xor_b32 v118, v75, v123
    v_and_or_b32 v117, v118, s59, v117
    v_xor_b32 v118, v76, v120
    v_and_or_b32 v117, v118, s59, v117
    v_xor_b32 v118, v77, v121
    v_and_or_b32 v117, v118, s59, v117
    v_xor_b32 v118, v78, v122
    v_and_or_b32 v117, v118, s59, v117
    v_xor_b32 v118, v79, v123
    v_and_or_b32 v117, v118, s59, v117
    v_cmp_ne_u32 vcc, 0, v117
    s_nop 1
    s_cmp_eq_u64 vcc, 0
    s_cbranch_scc1 L_gated_mix__ssm_conv_s5__dense_activation_squared_relu__prompt_kernel_xg1
    s_sub_u32 s6, s6, 1
    s_cbranch_scc1 L_gated_mix__ssm_conv_s5__dense_activation_squared_relu__prompt_kernel_xg1
    buffer_load_dwordx4 v[48:51], v13, s[8:11], s93 offen offset:0 sc1
    buffer_load_dwordx4 v[52:55], v13, s[8:11], s93 offen offset:1024 sc1
    buffer_load_dwordx4 v[56:59], v13, s[8:11], s93 offen offset:2048 sc1
    buffer_load_dwordx4 v[60:63], v13, s[8:11], s93 offen offset:3072 sc1
    buffer_load_dwordx4 v[64:67], v13, s[8:11], s85 offen offset:0 sc1
    buffer_load_dwordx4 v[68:71], v13, s[8:11], s85 offen offset:1024 sc1
    buffer_load_dwordx4 v[72:75], v13, s[8:11], s85 offen offset:2048 sc1
    buffer_load_dwordx4 v[76:79], v13, s[8:11], s85 offen offset:3072 sc1
    s_branch L_gated_mix__ssm_conv_s5__dense_activation_squared_relu__prompt_kernel_xp1
L_gated_mix__ssm_conv_s5__dense_activation_squared_relu__prompt_kernel_xg1:
    v_and_b32 v117, 7, v0
    v_lshlrev_b32 v117, 12, v117
    v_lshrrev_b32 v118, 3, v0
    v_and_b32 v118, 1, v118
    v_lshlrev_b32 v118, 6, v118
    v_add_u32 v117, v117, v118
    v_lshrrev_b32 v118, 4, v0
    v_lshlrev_b32 v118, 4, v118
    v_add_u32 v117, v117, v118
    s_mov_b32 s58, 0x00ff00ff
    s_mov_b32 s59, 0x00ff00ff
    s_lshl_b32 s86, s95, 10
    s_add_u32 s86, s86, s96
    s_lshl_b32 s86, s86, 2
    s_add_u32 s87, s86, 32768
    s_add_u32 s88, s86, 65536
    s_add_u32 s85, s86, 98304
    v_add_f32 v152, v152, v48
    v_add_f32 v153, v153, v49
    v_add_f32 v154, v154, v50
    v_add_f32 v155, v155, v51
    v_add_f32 v156, v156, v52
    v_add_f32 v157, v157, v53
    v_add_f32 v158, v158, v54
    v_add_f32 v159, v159, v55
    v_add_f32 v168, v168, v56
    v_add_f32 v169, v169, v57
    v_add_f32 v170, v170, v58
    v_add_f32 v171, v171, v59
    v_add_f32 v172, v172, v60
    v_add_f32 v173, v173, v61
    v_add_f32 v174, v174, v62
    v_add_f32 v175, v175, v63
    v_add_f32 v184, v184, v64
    v_add_f32 v185, v185, v65
    v_add_f32 v186, v186, v66
    v_add_f32 v187, v187, v67
    v_add_f32 v188, v188, v68
    v_add_f32 v189, v189, v69
    v_add_f32 v190, v190, v70
    v_add_f32 v191, v191, v71
    v_add_f32 v200, v200, v72
    v_add_f32 v201, v201, v73
    v_add_f32 v202, v202, v74
    v_add_f32 v203, v203, v75
    v_add_f32 v204, v204, v76
    v_add_f32 v205, v205, v77
    v_add_f32 v206, v206, v78
    v_add_f32 v207, v207, v79
    v_mov_b32_dpp v48, v168 row_ror:8 row_mask:0xf bank_mask:0xf
    v_mov_b32_dpp v49, v169 row_ror:8 row_mask:0xf bank_mask:0xf
    v_mov_b32_dpp v50, v170 row_ror:8 row_mask:0xf bank_mask:0xf
    v_mov_b32_dpp v51, v171 row_ror:8 row_mask:0xf bank_mask:0xf
    v_mov_b32_dpp v52, v152 row_ror:8 row_mask:0xf bank_mask:0xf
    v_mov_b32_dpp v53, v153 row_ror:8 row_mask:0xf bank_mask:0xf
    v_mov_b32_dpp v54, v154 row_ror:8 row_mask:0xf bank_mask:0xf
    v_mov_b32_dpp v55, v155 row_ror:8 row_mask:0xf bank_mask:0xf
    v_cndmask_b32 v48, v48, v152, s[58:59]
    v_cndmask_b32 v49, v49, v153, s[58:59]
    v_cndmask_b32 v50, v50, v154, s[58:59]
    v_cndmask_b32 v51, v51, v155, s[58:59]
    v_cndmask_b32 v52, v168, v52, s[58:59]
    v_cndmask_b32 v53, v169, v53, s[58:59]
    v_cndmask_b32 v54, v170, v54, s[58:59]
    v_cndmask_b32 v55, v171, v55, s[58:59]
    buffer_store_dwordx4 v[48:51], v117, s[16:19], s86 offen offset:0 sc1
    buffer_store_dwordx4 v[52:55], v117, s[16:19], s87 offen offset:0 sc1
    v_mov_b32_dpp v56, v172 row_ror:8 row_mask:0xf bank_mask:0xf
    v_mov_b32_dpp v57, v173 row_ror:8 row_mask:0xf bank_mask:0xf
    v_mov_b32_dpp v58, v174 row_ror:8 row_mask:0xf bank_mask:0xf
    v_mov_b32_dpp v59, v175 row_ror:8 row_mask:0xf bank_mask:0xf
    v_mov_b32_dpp v60, v156 row_ror:8 row_mask:0xf bank_mask:0xf
    v_mov_b32_dpp v61, v157 row_ror:8 row_mask:0xf bank_mask:0xf
    v_mov_b32_dpp v62, v158 row_ror:8 row_mask:0xf bank_mask:0xf
    v_mov_b32_dpp v63, v159 row_ror:8 row_mask:0xf bank_mask:0xf
    v_cndmask_b32 v56, v56, v156, s[58:59]
    v_cndmask_b32 v57, v57, v157, s[58:59]
    v_cndmask_b32 v58, v58, v158, s[58:59]
    v_cndmask_b32 v59, v59, v159, s[58:59]
    v_cndmask_b32 v60, v172, v60, s[58:59]
    v_cndmask_b32 v61, v173, v61, s[58:59]
    v_cndmask_b32 v62, v174, v62, s[58:59]
    v_cndmask_b32 v63, v175, v63, s[58:59]
    buffer_store_dwordx4 v[56:59], v117, s[16:19], s88 offen offset:0 sc1
    buffer_store_dwordx4 v[60:63], v117, s[16:19], s85 offen offset:0 sc1
    v_mov_b32_dpp v64, v200 row_ror:8 row_mask:0xf bank_mask:0xf
    v_mov_b32_dpp v65, v201 row_ror:8 row_mask:0xf bank_mask:0xf
    v_mov_b32_dpp v66, v202 row_ror:8 row_mask:0xf bank_mask:0xf
    v_mov_b32_dpp v67, v203 row_ror:8 row_mask:0xf bank_mask:0xf
    v_mov_b32_dpp v68, v184 row_ror:8 row_mask:0xf bank_mask:0xf
    v_mov_b32_dpp v69, v185 row_ror:8 row_mask:0xf bank_mask:0xf
    v_mov_b32_dpp v70, v186 row_ror:8 row_mask:0xf bank_mask:0xf
    v_mov_b32_dpp v71, v187 row_ror:8 row_mask:0xf bank_mask:0xf
    v_cndmask_b32 v64, v64, v184, s[58:59]
    v_cndmask_b32 v65, v65, v185, s[58:59]
    v_cndmask_b32 v66, v66, v186, s[58:59]
    v_cndmask_b32 v67, v67, v187, s[58:59]
    v_cndmask_b32 v68, v200, v68, s[58:59]
    v_cndmask_b32 v69, v201, v69, s[58:59]
    v_cndmask_b32 v70, v202, v70, s[58:59]
    v_cndmask_b32 v71, v203, v71, s[58:59]
    buffer_store_dwordx4 v[64:67], v117, s[16:19], s86 offen offset:128 sc1
    buffer_store_dwordx4 v[68:71], v117, s[16:19], s87 offen offset:128 sc1
    v_mov_b32_dpp v72, v204 row_ror:8 row_mask:0xf bank_mask:0xf
    v_mov_b32_dpp v73, v205 row_ror:8 row_mask:0xf bank_mask:0xf
    v_mov_b32_dpp v74, v206 row_ror:8 row_mask:0xf bank_mask:0xf
    v_mov_b32_dpp v75, v207 row_ror:8 row_mask:0xf bank_mask:0xf
    v_mov_b32_dpp v76, v188 row_ror:8 row_mask:0xf bank_mask:0xf
    v_mov_b32_dpp v77, v189 row_ror:8 row_mask:0xf bank_mask:0xf
    v_mov_b32_dpp v78, v190 row_ror:8 row_mask:0xf bank_mask:0xf
    v_mov_b32_dpp v79, v191 row_ror:8 row_mask:0xf bank_mask:0xf
    v_cndmask_b32 v72, v72, v188, s[58:59]
    v_cndmask_b32 v73, v73, v189, s[58:59]
    v_cndmask_b32 v74, v74, v190, s[58:59]
    v_cndmask_b32 v75, v75, v191, s[58:59]
    v_cndmask_b32 v76, v204, v76, s[58:59]
    v_cndmask_b32 v77, v205, v77, s[58:59]
    v_cndmask_b32 v78, v206, v78, s[58:59]
    v_cndmask_b32 v79, v207, v79, s[58:59]
    buffer_store_dwordx4 v[72:75], v117, s[16:19], s88 offen offset:128 sc1
    buffer_store_dwordx4 v[76:79], v117, s[16:19], s85 offen offset:128 sc1
L_gated_mix__ssm_conv_s5__dense_activation_squared_relu__prompt_kernel_fin:
    s_endpgm
L_gated_mix__ssm_conv_s5__dense_activation_squared_relu__prompt_kernel_end:
    s_endpgm
.section .rodata,"a"
.p2align 6
.amdhsa_kernel gated_mix__ssm_conv_s5__dense_activation_squared_relu__prompt_kernel
.amdhsa_next_free_vgpr 256
.amdhsa_next_free_sgpr 102
.amdhsa_accum_offset 256
.amdhsa_group_segment_fixed_size 0
.amdhsa_kernarg_size 144
.amdhsa_user_sgpr_count 2
.amdhsa_user_sgpr_kernarg_segment_ptr 1
.amdhsa_system_sgpr_workgroup_id_x 1
.amdhsa_float_denorm_mode_32 3
.end_amdhsa_kernel
```
